```python
import torch

def _softmax(x, axis=-1):
    return torch.softmax(x, dim=axis)
def _gelu(x):
    return torch.nn.functional.gelu(x, approximate="tanh")
def _silu(x):
    return torch.nn.functional.silu(x)
def _sigmoid(x):
    return torch.sigmoid(x)
def _layernorm(x, axis=-1, eps=1e-5):
    m = x.mean(dim=axis, keepdim=True)
    v = x.var(dim=axis, keepdim=True, unbiased=False)
    return (x - m) / torch.sqrt(v + eps)
def _scatter_add(tgt, idx, src, axis=0):
    return tgt.clone().index_add_(axis, idx, src)
def _segment_sum(src, seg, n):
    out = torch.zeros((n,) + src.shape[1:], dtype=src.dtype)
    return out.index_add_(0, seg, src)
def _pad(x, pw):
    flat = tuple(v for pair in reversed(pw) for v in pair)
    return torch.nn.functional.pad(x, flat)

kernel_name = 'standalone__weight_only_int_squeezellm__prompt'

def setup_inputs():

    _w = (lambda a: (lambda t: t.to(torch.bfloat16) if t.is_floating_point() else t)(torch.as_tensor(a)))
    B, S, D, F = 1, 2048, 1024, 3584
    bits = 8 if (2 <= 8 <= 4) else 4
    L = 2 ** bits
    qw = torch.randint(0, L, (D, F)).to(torch.int64)
    lut = (lambda *s: torch.randn(*s, dtype=torch.bfloat16) * 0.05)(L, F)
    return {
        "x": _w((lambda *s: torch.randn(*s, dtype=torch.bfloat16) * 0.05)(B, S, D)),
        "qw": _w(qw),
        "lut": _w(lut),
    }

def reference(x, qw, lut):
    w = (lambda x, i, axis: torch.take_along_dim(x, i, dim=axis))(lut, qw, axis=0)
    w = (lambda x, dt: x.to(dt))(w, x.dtype)
    return torch.einsum('bsd,df->bsf', x, w)
```

```asm
; @launch grid=(256,1,1) block=(768,1,1) lds=163840
.amdgcn_target "amdgcn-amd-amdhsa--gfx950"
.text
.globl standalone__weight_only_int_squeezellm__prompt_kernel
.p2align 8
.type standalone__weight_only_int_squeezellm__prompt_kernel,@function
standalone__weight_only_int_squeezellm__prompt_kernel:
    s_load_dwordx8 s[4:11], s[0:1], 0
    s_lshr_b32 s13, s2, 3
    s_cmp_ge_u32 s13, 32
    s_cbranch_scc1 L_done
    s_load_dwordx2 s[56:57], s[0:1], 40
    v_lshrrev_b32 v1, 6, v0
    v_and_b32 v2, 63, v0
    s_sub_u32 s14, s13, 4
    v_readfirstlane_b32 s32, v1
    s_lshr_b32 s15, s14, 2
    s_and_b32 s14, s14, 3
    s_and_b32 s16, s2, 1
    s_lshl2_add_u32 s14, s16, s14
    s_cmp_lt_u32 s13, 4
    s_cselect_b32 s15, s14, s15
    s_cmp_eq_u32 s15, 7
    s_cbranch_scc1 L_done
    s_bfe_u32 s16, s2, 0x20001
    s_mul_i32 s16, s16, 7
    s_add_u32 s15, s15, s16
    s_and_b32 s33, s32, 3
    s_cmp_ge_u32 s32, 4
    s_cbranch_scc1 L_h0
    s_getpc_b64 s[50:51]
    s_and_b32 s12, s13, 7
    s_mul_i32 s12, s12, 13
    v_add_lshl_u32 v1, v0, s12, 7
    v_cmp_gt_u32 vcc, 13, v0
    s_and_saveexec_b64 s[54:55], vcc
    s_cbranch_execz L_cw
    global_load_dword v39, v1, s[50:51] offset:512
L_cw:
    s_mov_b64 exec, s[54:55]
    v_lshrrev_b32 v5, 3, v2
    v_and_b32 v7, 7, v2
    v_mul_u32_u24 v5, 7168, v5
    v_lshl_add_u32 v5, v7, 4, v5
    s_and_b32 s36, s32, 1
    s_lshl1_add_u32 s35, s15, s36
    s_lshl_b32 s35, s35, 7
    s_add_u32 s36, s35, 57344
    s_mov_b32 s26, 114688
    s_mov_b32 s27, 0x20000
    s_setprio 3
    s_waitcnt lgkmcnt(0)
    s_mov_b64 s[24:25], s[8:9]
    buffer_load_dwordx4 v[40:43], v5, s[24:27], s35 offen
    buffer_load_dwordx4 v[44:47], v5, s[24:27], s36 offen
    s_branch L_mfma
L_h0:
    s_and_b32 s48, s15, 3
    s_lshr_b32 s59, s15, 2
    s_add_u32 s59, s59, s14
    s_and_b32 s59, s59, 3
    s_lshl2_add_u32 s48, s48, s59
    s_lshl_b32 s50, s48, 1
    s_lshr_b32 s50, 0x4424e4, s50
    s_and_b32 s50, s50, 3
    s_cmp_ge_u32 s32, 8
    s_cbranch_scc1 L_h1
    v_lshrrev_b32 v3, 5, v2
    s_lshl_b32 s35, s33, 1
    v_add_u32 v4, s35, v3
    v_and_b32 v6, 31, v2
    v_mul_u32_u24 v8, 114688, v4
    v_lshl_add_u32 v8, v6, 4, v8
    s_lshl_b32 s35, s15, 9
    v_add_u32 v8, s35, v8
    s_mov_b32 s22, 14680064
    s_mov_b32 s23, 0x20000
    s_movk_i32 s97, 14336
    s_mul_i32 s43, s50, 917504
    s_setprio 2
    s_waitcnt lgkmcnt(0)
    s_mov_b64 s[20:21], s[6:7]
    s_cmp_lt_u32 s13, 4
    s_cbranch_scc1 L_e2
    tbuffer_load_format_d16_xyzw v[72:73], v8, s[20:23], s43 format:[BUF_DATA_FORMAT_32_32_32_32,BUF_NUM_FORMAT_UINT] offen
    s_add_u32 s43, s43, s97
    tbuffer_load_format_d16_xyzw v[74:75], v8, s[20:23], s43 format:[BUF_DATA_FORMAT_32_32_32_32,BUF_NUM_FORMAT_UINT] offen
    s_add_u32 s43, s43, s97
    tbuffer_load_format_d16_xyzw v[76:77], v8, s[20:23], s43 format:[BUF_DATA_FORMAT_32_32_32_32,BUF_NUM_FORMAT_UINT] offen
    s_add_u32 s43, s43, s97
    tbuffer_load_format_d16_xyzw v[78:79], v8, s[20:23], s43 format:[BUF_DATA_FORMAT_32_32_32_32,BUF_NUM_FORMAT_UINT] offen
    s_add_u32 s43, s43, s97
    tbuffer_load_format_d16_xyzw v[80:81], v8, s[20:23], s43 format:[BUF_DATA_FORMAT_32_32_32_32,BUF_NUM_FORMAT_UINT] offen
    s_add_u32 s43, s43, s97
    tbuffer_load_format_d16_xyzw v[82:83], v8, s[20:23], s43 format:[BUF_DATA_FORMAT_32_32_32_32,BUF_NUM_FORMAT_UINT] offen
    s_add_u32 s43, s43, s97
    tbuffer_load_format_d16_xyzw v[84:85], v8, s[20:23], s43 format:[BUF_DATA_FORMAT_32_32_32_32,BUF_NUM_FORMAT_UINT] offen
    s_add_u32 s43, s43, s97
    tbuffer_load_format_d16_xyzw v[86:87], v8, s[20:23], s43 format:[BUF_DATA_FORMAT_32_32_32_32,BUF_NUM_FORMAT_UINT] offen
    s_branch L_e2
L_h1:
    v_lshrrev_b32 v5, 3, v2
    v_lshrrev_b32 v7, 4, v2
    v_and_b32 v10, 7, v2
    v_xor_b32 v7, v7, v10
    v_lshlrev_b32 v7, 4, v7
    s_lshl_b32 s35, s14, 19
    s_lshl_b32 s36, s33, 17
    s_add_u32 s35, s35, s36
    v_lshl_add_u32 v7, v5, 11, v7
    v_add_u32 v9, s35, v7
    v_xor_b32 v10, 64, v9
    s_lshl_b32 s44, s33, 13
    s_add_u32 s44, s44, 65536
    s_mov_b32 s18, 4194304
    s_mov_b32 s19, 0x20000
    s_movk_i32 s98, 15360
    s_movk_i32 s99, 19456
    s_mov_b32 s53, s44
    s_mov_b32 m0, s53
    s_lshl_b32 s42, s50, 7
    s_setprio 1
    s_waitcnt lgkmcnt(0)
    s_mov_b64 s[16:17], s[4:5]
    s_cmp_lt_u32 s13, 4
    s_cbranch_scc1 L_e2
    buffer_load_dwordx4 v9, s[16:19], s42 offen offset:0 lds
    s_add_u32 s42, s42, s98
    buffer_load_dwordx4 v10, s[16:19], s42 offen offset:1024 lds
    s_add_u32 s42, s42, s98
    buffer_load_dwordx4 v9, s[16:19], s42 offen offset:2048 lds
    s_add_u32 s42, s42, s98
    buffer_load_dwordx4 v10, s[16:19], s42 offen offset:3072 lds
    s_add_u32 m0, s53, 4096
    s_add_u32 s42, s42, s99
    buffer_load_dwordx4 v9, s[16:19], s42 offen offset:0 lds
    s_add_u32 s42, s42, s98
    buffer_load_dwordx4 v10, s[16:19], s42 offen offset:1024 lds
    s_add_u32 s42, s42, s98
    buffer_load_dwordx4 v9, s[16:19], s42 offen offset:2048 lds
    s_add_u32 s42, s42, s98
    buffer_load_dwordx4 v10, s[16:19], s42 offen offset:3072 lds
    s_branch L_e2
L_mfma:
    s_mov_b32 s28, s10
    s_mov_b32 s29, s11
    s_mov_b32 s30, 14680064
    s_mov_b32 s31, 0x20000
    s_lshl_b32 s36, s32, 11
    s_add_u32 s36, s36, 135168
    v_lshlrev_b32 v5, 4, v2
    v_add_u32 v5, s36, v5
    s_lshr_b32 s37, s32, 1
    s_add_u32 s36, s36, s37
    v_lshlrev_b32 v7, 1, v2
    v_add_u32 v7, s36, v7
    v_and_b32 v3, 127, v0
    v_and_b32 v6, 3, v3
    v_lshlrev_b32 v6, 1, v6
    v_add_u32 v6, s37, v6
    v_lshrrev_b32 v3, 2, v3
    v_lshl_add_u32 v6, v6, 5, v3
    v_lshlrev_b32 v6, 4, v6
    v_add_u32 v6, 131072, v6
    s_mov_b32 s45, 0x0b0a0908
    s_mov_b32 s54, 0xffffff00
    v_mov_b32 v72, 0
    v_mov_b32 v73, 0
    v_mov_b32 v74, 0
    v_mov_b32 v75, 0
    v_mov_b32 v76, 0
    v_mov_b32 v77, 0
    v_mov_b32 v78, 0
    v_mov_b32 v79, 0
    v_mov_b32 v80, 0
    v_mov_b32 v81, 0
    v_mov_b32 v82, 0
    v_mov_b32 v83, 0
    v_mov_b32 v84, 0
    v_mov_b32 v85, 0
    v_mov_b32 v86, 0
    v_mov_b32 v87, 0
    v_mov_b32 v88, 0
    v_mov_b32 v89, 0
    v_mov_b32 v90, 0
    v_mov_b32 v91, 0
    v_mov_b32 v92, 0
    v_mov_b32 v93, 0
    v_mov_b32 v94, 0
    v_mov_b32 v95, 0
    v_mov_b32 v96, 0
    v_mov_b32 v97, 0
    v_mov_b32 v98, 0
    v_mov_b32 v99, 0
    v_mov_b32 v100, 0
    v_mov_b32 v101, 0
    v_mov_b32 v102, 0
    v_mov_b32 v103, 0
    v_mov_b32 v104, 0
    v_mov_b32 v105, 0
    v_mov_b32 v106, 0
    v_mov_b32 v107, 0
    v_mov_b32 v108, 0
    v_mov_b32 v109, 0
    v_mov_b32 v110, 0
    v_mov_b32 v111, 0
    v_mov_b32 v112, 0
    v_mov_b32 v113, 0
    v_mov_b32 v114, 0
    v_mov_b32 v115, 0
    v_mov_b32 v116, 0
    v_mov_b32 v117, 0
    v_mov_b32 v118, 0
    v_mov_b32 v119, 0
    v_mov_b32 v120, 0
    v_mov_b32 v121, 0
    v_mov_b32 v122, 0
    v_mov_b32 v123, 0
    v_mov_b32 v124, 0
    v_mov_b32 v125, 0
    v_mov_b32 v126, 0
    v_mov_b32 v127, 0
    v_mov_b32 v128, 0
    v_mov_b32 v129, 0
    v_mov_b32 v130, 0
    v_mov_b32 v131, 0
    v_mov_b32 v132, 0
    v_mov_b32 v133, 0
    v_mov_b32 v134, 0
    v_mov_b32 v135, 0
    v_mov_b32 v136, 0
    v_mov_b32 v137, 0
    v_mov_b32 v138, 0
    v_mov_b32 v139, 0
    v_mov_b32 v140, 0
    v_mov_b32 v141, 0
    v_mov_b32 v142, 0
    v_mov_b32 v143, 0
    v_mov_b32 v144, 0
    v_mov_b32 v145, 0
    v_mov_b32 v146, 0
    v_mov_b32 v147, 0
    v_mov_b32 v148, 0
    v_mov_b32 v149, 0
    v_mov_b32 v150, 0
    v_mov_b32 v151, 0
    v_mov_b32 v152, 0
    v_mov_b32 v153, 0
    v_mov_b32 v154, 0
    v_mov_b32 v155, 0
    v_mov_b32 v156, 0
    v_mov_b32 v157, 0
    v_mov_b32 v158, 0
    v_mov_b32 v159, 0
    v_mov_b32 v160, 0
    v_mov_b32 v161, 0
    v_mov_b32 v162, 0
    v_mov_b32 v163, 0
    v_mov_b32 v164, 0
    v_mov_b32 v165, 0
    v_mov_b32 v166, 0
    v_mov_b32 v167, 0
    s_waitcnt vmcnt(0)
    ds_write_b128 v5, v[40:43]
    ds_write_b128 v5, v[44:47] offset:1024
    s_waitcnt lgkmcnt(0)
    ds_read_u8 v40, v7 offset:0
    ds_read_u8 v41, v7 offset:128
    ds_read_u8 v42, v7 offset:256
    ds_read_u8 v43, v7 offset:384
    ds_read_u8 v44, v7 offset:512
    ds_read_u8 v45, v7 offset:640
    ds_read_u8 v46, v7 offset:768
    ds_read_u8 v47, v7 offset:896
    ds_read_u8 v48, v7 offset:1024
    ds_read_u8 v49, v7 offset:1152
    ds_read_u8 v50, v7 offset:1280
    ds_read_u8 v51, v7 offset:1408
    ds_read_u8 v52, v7 offset:1536
    ds_read_u8 v53, v7 offset:1664
    ds_read_u8 v54, v7 offset:1792
    ds_read_u8 v55, v7 offset:1920
    s_waitcnt lgkmcnt(0)
    v_lshl_or_b32 v24, v41, 8, v40
    v_lshl_or_b32 v56, v43, 8, v42
    v_lshl_or_b32 v25, v45, 8, v44
    v_lshl_or_b32 v57, v47, 8, v46
    v_lshl_or_b32 v26, v49, 8, v48
    v_lshl_or_b32 v58, v51, 8, v50
    v_lshl_or_b32 v27, v53, 8, v52
    v_lshl_or_b32 v59, v55, 8, v54
    v_lshl_or_b32 v24, v56, 16, v24
    v_lshl_or_b32 v25, v57, 16, v25
    v_lshl_or_b32 v26, v58, 16, v26
    v_lshl_or_b32 v27, v59, 16, v27
    v_xor_b32 v25, s54, v25
    v_xor_b32 v27, s54, v27
    v_mov_b32 v28, v24
    v_mov_b32 v29, v26
    v_perm_b32 v30, v27, v26, s45
    v_perm_b32 v31, v25, v24, s45
    v_xor_b32 v24, v28, v30
    v_xor_b32 v26, v29, v31
    v_perm_b32 v30, v27, v26, s45
    v_perm_b32 v31, v25, v24, s45
    v_xor_b32 v24, v28, v30
    v_xor_b32 v26, v29, v31
    v_perm_b32 v30, v27, v26, s45
    v_perm_b32 v31, v25, v24, s45
    v_xor_b32 v24, v28, v30
    v_xor_b32 v26, v29, v31
    ds_write_b128 v6, v[24:27]
    s_waitcnt lgkmcnt(0)
    s_barrier
    s_cmp_lt_u32 s13, 4
    s_cbranch_scc1 L_done
    v_mov_b32 v40, 0
    v_mov_b32 v41, 0
    v_mov_b32 v42, 0
    v_mov_b32 v43, 0
    v_mov_b32 v44, 0
    v_mov_b32 v45, 0
    v_mov_b32 v46, 0
    v_mov_b32 v47, 0
    v_mov_b32 v48, 0
    v_mov_b32 v49, 0
    v_mov_b32 v50, 0
    v_mov_b32 v51, 0
    v_mov_b32 v52, 0
    v_mov_b32 v53, 0
    v_mov_b32 v54, 0
    v_mov_b32 v55, 0
    v_mov_b32 v56, 0
    v_mov_b32 v57, 0
    v_mov_b32 v58, 0
    v_mov_b32 v59, 0
    v_mov_b32 v60, 0
    v_mov_b32 v61, 0
    v_mov_b32 v62, 0
    v_mov_b32 v63, 0
    v_mov_b32 v64, 0
    v_mov_b32 v65, 0
    v_mov_b32 v66, 0
    v_mov_b32 v67, 0
    v_mov_b32 v68, 0
    v_mov_b32 v69, 0
    v_mov_b32 v70, 0
    v_mov_b32 v71, 0
    v_and_b32 v7, 15, v2
    v_lshrrev_b32 v6, 4, v2
    v_lshrrev_b32 v4, 1, v7
    v_xor_b32 v4, v4, v6
    v_lshlrev_b32 v4, 4, v4
    v_lshl_add_u32 v4, v7, 7, v4
    s_lshl_b32 s35, s32, 13
    s_add_u32 s35, s35, 65536
    v_add_u32 v1, s35, v4
    v_xor_b32 v3, 64, v1
    v_and_b32 v4, 1, v6
    v_lshl_add_u32 v4, v7, 1, v4
    v_lshlrev_b32 v4, 4, v4
    v_lshl_add_u32 v4, v6, 11, v4
    v_xor_b32 v5, 16, v4
    v_mul_u32_u24 v6, 28672, v6
    v_lshl_add_u32 v6, v7, 4, v6
    s_lshl_b32 s36, s14, 2
    s_add_u32 s36, s36, s32
    s_mul_i32 s36, s36, 458752
    s_lshl_b32 s37, s15, 8
    s_add_u32 s36, s36, s37
    s_mov_b32 s40, 0
    s_mov_b32 s41, 0
    s_mov_b32 s46, 32768
    s_mov_b32 s47, 16384
    s_setprio 3
    s_barrier
    ds_read_b128 v[24:27], v4 offset:0
    ds_read_b128 v[28:31], v4 offset:512
    ds_read_b128 v[8:11], v1 offset:0
    ds_read_b128 v[12:15], v1 offset:2048
    ds_read_b128 v[16:19], v1 offset:4096
    ds_read_b128 v[32:35], v4 offset:1024
    ds_read_b128 v[20:23], v1 offset:6144
    ds_read_b128 v[36:39], v4 offset:1536
    .p2align 6
L_mloop:
    s_waitcnt lgkmcnt(5)
    v_mfma_f32_16x16x32_bf16 v[40:43], v[8:11], v[24:27], v[40:43]
    v_mfma_f32_16x16x32_bf16 v[44:47], v[8:11], v[28:31], v[44:47]
    s_waitcnt lgkmcnt(4)
    v_mfma_f32_16x16x32_bf16 v[72:75], v[12:15], v[24:27], v[72:75]
    v_mfma_f32_16x16x32_bf16 v[76:79], v[12:15], v[28:31], v[76:79]
    s_waitcnt lgkmcnt(3)
    v_mfma_f32_16x16x32_bf16 v[104:107], v[16:19], v[24:27], v[104:107]
    v_mfma_f32_16x16x32_bf16 v[108:111], v[16:19], v[28:31], v[108:111]
    s_waitcnt lgkmcnt(1)
    v_mfma_f32_16x16x32_bf16 v[136:139], v[20:23], v[24:27], v[136:139]
    ds_read_b128 v[24:27], v5 offset:0
    v_mfma_f32_16x16x32_bf16 v[140:143], v[20:23], v[28:31], v[140:143]
    ds_read_b128 v[28:31], v5 offset:512
    v_mfma_f32_16x16x32_bf16 v[48:51], v[8:11], v[32:35], v[48:51]
    s_add_u32 s40, s40, 1
    s_waitcnt lgkmcnt(2)
    v_mfma_f32_16x16x32_bf16 v[52:55], v[8:11], v[36:39], v[52:55]
    s_and_b32 s42, s40, 3
    v_mfma_f32_16x16x32_bf16 v[80:83], v[12:15], v[32:35], v[80:83]
    s_cselect_b32 s42, s47, 0xffff4000
    v_mfma_f32_16x16x32_bf16 v[84:87], v[12:15], v[36:39], v[84:87]
    s_add_u32 s41, s41, 1
    v_mfma_f32_16x16x32_bf16 v[112:115], v[16:19], v[32:35], v[112:115]
    s_cmp_eq_u32 s41, 3
    v_mfma_f32_16x16x32_bf16 v[116:119], v[16:19], v[36:39], v[116:119]
    s_cselect_b32 s43, 0xffff0000, s46
    v_mfma_f32_16x16x32_bf16 v[144:147], v[20:23], v[32:35], v[144:147]
    s_cselect_b32 s41, 0, s41
    ds_read_b128 v[32:35], v5 offset:1024
    v_mfma_f32_16x16x32_bf16 v[148:151], v[20:23], v[36:39], v[148:151]
    ds_read_b128 v[36:39], v5 offset:1536
    s_waitcnt lgkmcnt(3)
    v_mfma_f32_16x16x32_bf16 v[56:59], v[8:11], v[24:27], v[56:59]
    s_waitcnt lgkmcnt(2)
    v_mfma_f32_16x16x32_bf16 v[60:63], v[8:11], v[28:31], v[60:63]
    v_mfma_f32_16x16x32_bf16 v[88:91], v[12:15], v[24:27], v[88:91]
    v_mfma_f32_16x16x32_bf16 v[92:95], v[12:15], v[28:31], v[92:95]
    v_mfma_f32_16x16x32_bf16 v[120:123], v[16:19], v[24:27], v[120:123]
    v_mfma_f32_16x16x32_bf16 v[124:127], v[16:19], v[28:31], v[124:127]
    v_mfma_f32_16x16x32_bf16 v[152:155], v[20:23], v[24:27], v[152:155]
    ds_read_b128 v[24:27], v4 offset:8192
    v_mfma_f32_16x16x32_bf16 v[156:159], v[20:23], v[28:31], v[156:159]
    ds_read_b128 v[28:31], v4 offset:8704
    s_waitcnt lgkmcnt(3)
    v_mfma_f32_16x16x32_bf16 v[64:67], v[8:11], v[32:35], v[64:67]
    s_waitcnt lgkmcnt(2)
    v_mfma_f32_16x16x32_bf16 v[68:71], v[8:11], v[36:39], v[68:71]
    ds_read_b128 v[8:11], v3 offset:0
    v_mfma_f32_16x16x32_bf16 v[96:99], v[12:15], v[32:35], v[96:99]
    v_mfma_f32_16x16x32_bf16 v[100:103], v[12:15], v[36:39], v[100:103]
    ds_read_b128 v[12:15], v3 offset:2048
    v_mfma_f32_16x16x32_bf16 v[128:131], v[16:19], v[32:35], v[128:131]
    v_mfma_f32_16x16x32_bf16 v[132:135], v[16:19], v[36:39], v[132:135]
    ds_read_b128 v[16:19], v3 offset:4096
    v_mfma_f32_16x16x32_bf16 v[160:163], v[20:23], v[32:35], v[160:163]
    ds_read_b128 v[32:35], v4 offset:9216
    v_mfma_f32_16x16x32_bf16 v[164:167], v[20:23], v[36:39], v[164:167]
    ds_read_b128 v[20:23], v3 offset:6144
    ds_read_b128 v[36:39], v4 offset:9728
    s_waitcnt lgkmcnt(5)
    v_mfma_f32_16x16x32_bf16 v[40:43], v[8:11], v[24:27], v[40:43]
    v_mfma_f32_16x16x32_bf16 v[44:47], v[8:11], v[28:31], v[44:47]
    s_waitcnt lgkmcnt(4)
    v_mfma_f32_16x16x32_bf16 v[72:75], v[12:15], v[24:27], v[72:75]
    v_mfma_f32_16x16x32_bf16 v[76:79], v[12:15], v[28:31], v[76:79]
    s_waitcnt lgkmcnt(3)
    v_mfma_f32_16x16x32_bf16 v[104:107], v[16:19], v[24:27], v[104:107]
    v_mfma_f32_16x16x32_bf16 v[108:111], v[16:19], v[28:31], v[108:111]
    s_waitcnt lgkmcnt(1)
    v_mfma_f32_16x16x32_bf16 v[136:139], v[20:23], v[24:27], v[136:139]
    ds_read_b128 v[24:27], v5 offset:8192
    v_mfma_f32_16x16x32_bf16 v[140:143], v[20:23], v[28:31], v[140:143]
    ds_read_b128 v[28:31], v5 offset:8704
    v_mfma_f32_16x16x32_bf16 v[48:51], v[8:11], v[32:35], v[48:51]
    s_waitcnt lgkmcnt(2)
    v_mfma_f32_16x16x32_bf16 v[52:55], v[8:11], v[36:39], v[52:55]
    v_mfma_f32_16x16x32_bf16 v[80:83], v[12:15], v[32:35], v[80:83]
    v_mfma_f32_16x16x32_bf16 v[84:87], v[12:15], v[36:39], v[84:87]
    v_mfma_f32_16x16x32_bf16 v[112:115], v[16:19], v[32:35], v[112:115]
    v_mfma_f32_16x16x32_bf16 v[116:119], v[16:19], v[36:39], v[116:119]
    v_mfma_f32_16x16x32_bf16 v[144:147], v[20:23], v[32:35], v[144:147]
    ds_read_b128 v[32:35], v5 offset:9216
    v_mfma_f32_16x16x32_bf16 v[148:151], v[20:23], v[36:39], v[148:151]
    ds_read_b128 v[36:39], v5 offset:9728
    s_waitcnt lgkmcnt(3)
    v_mfma_f32_16x16x32_bf16 v[56:59], v[8:11], v[24:27], v[56:59]
    s_waitcnt lgkmcnt(2)
    v_mfma_f32_16x16x32_bf16 v[60:63], v[8:11], v[28:31], v[60:63]
    v_mfma_f32_16x16x32_bf16 v[88:91], v[12:15], v[24:27], v[88:91]
    v_mfma_f32_16x16x32_bf16 v[92:95], v[12:15], v[28:31], v[92:95]
    v_mfma_f32_16x16x32_bf16 v[120:123], v[16:19], v[24:27], v[120:123]
    v_mfma_f32_16x16x32_bf16 v[124:127], v[16:19], v[28:31], v[124:127]
    s_waitcnt lgkmcnt(0)
    s_barrier
    v_add_u32 v4, s42, v4
    v_mfma_f32_16x16x32_bf16 v[152:155], v[20:23], v[24:27], v[152:155]
    v_add_u32 v1, s43, v1
    ds_read_b128 v[24:27], v4 offset:0
    v_mfma_f32_16x16x32_bf16 v[156:159], v[20:23], v[28:31], v[156:159]
    v_add_u32 v5, s42, v5
    ds_read_b128 v[28:31], v4 offset:512
    v_mfma_f32_16x16x32_bf16 v[64:67], v[8:11], v[32:35], v[64:67]
    v_add_u32 v3, s43, v3
    v_mfma_f32_16x16x32_bf16 v[68:71], v[8:11], v[36:39], v[68:71]
    ds_read_b128 v[8:11], v1 offset:0
    v_mfma_f32_16x16x32_bf16 v[96:99], v[12:15], v[32:35], v[96:99]
    v_mfma_f32_16x16x32_bf16 v[100:103], v[12:15], v[36:39], v[100:103]
    ds_read_b128 v[12:15], v1 offset:2048
    v_mfma_f32_16x16x32_bf16 v[128:131], v[16:19], v[32:35], v[128:131]
    v_mfma_f32_16x16x32_bf16 v[132:135], v[16:19], v[36:39], v[132:135]
    ds_read_b128 v[16:19], v1 offset:4096
    v_mfma_f32_16x16x32_bf16 v[160:163], v[20:23], v[32:35], v[160:163]
    ds_read_b128 v[32:35], v4 offset:1024
    v_mfma_f32_16x16x32_bf16 v[164:167], v[20:23], v[36:39], v[164:167]
    ds_read_b128 v[20:23], v1 offset:6144
    ds_read_b128 v[36:39], v4 offset:1536
    s_cmp_lt_u32 s40, 11
    s_cbranch_scc1 L_mloop
    s_waitcnt lgkmcnt(5)
    v_mfma_f32_16x16x32_bf16 v[40:43], v[8:11], v[24:27], v[40:43]
    v_mfma_f32_16x16x32_bf16 v[44:47], v[8:11], v[28:31], v[44:47]
    s_waitcnt lgkmcnt(4)
    v_mfma_f32_16x16x32_bf16 v[72:75], v[12:15], v[24:27], v[72:75]
    v_mfma_f32_16x16x32_bf16 v[76:79], v[12:15], v[28:31], v[76:79]
    s_waitcnt lgkmcnt(3)
    v_mfma_f32_16x16x32_bf16 v[104:107], v[16:19], v[24:27], v[104:107]
    v_mfma_f32_16x16x32_bf16 v[108:111], v[16:19], v[28:31], v[108:111]
    s_waitcnt lgkmcnt(1)
    v_mfma_f32_16x16x32_bf16 v[136:139], v[20:23], v[24:27], v[136:139]
    ds_read_b128 v[24:27], v5 offset:0
    v_mfma_f32_16x16x32_bf16 v[140:143], v[20:23], v[28:31], v[140:143]
    ds_read_b128 v[28:31], v5 offset:512
    v_mfma_f32_16x16x32_bf16 v[48:51], v[8:11], v[32:35], v[48:51]
    s_waitcnt lgkmcnt(2)
    v_mfma_f32_16x16x32_bf16 v[52:55], v[8:11], v[36:39], v[52:55]
    v_mfma_f32_16x16x32_bf16 v[80:83], v[12:15], v[32:35], v[80:83]
    v_mfma_f32_16x16x32_bf16 v[84:87], v[12:15], v[36:39], v[84:87]
    v_mfma_f32_16x16x32_bf16 v[112:115], v[16:19], v[32:35], v[112:115]
    v_mfma_f32_16x16x32_bf16 v[116:119], v[16:19], v[36:39], v[116:119]
    v_mfma_f32_16x16x32_bf16 v[144:147], v[20:23], v[32:35], v[144:147]
    ds_read_b128 v[32:35], v5 offset:1024
    v_mfma_f32_16x16x32_bf16 v[148:151], v[20:23], v[36:39], v[148:151]
    ds_read_b128 v[36:39], v5 offset:1536
    s_waitcnt lgkmcnt(3)
    v_mfma_f32_16x16x32_bf16 v[56:59], v[8:11], v[24:27], v[56:59]
    s_waitcnt lgkmcnt(2)
    v_mfma_f32_16x16x32_bf16 v[60:63], v[8:11], v[28:31], v[60:63]
    v_mfma_f32_16x16x32_bf16 v[88:91], v[12:15], v[24:27], v[88:91]
    v_mfma_f32_16x16x32_bf16 v[92:95], v[12:15], v[28:31], v[92:95]
    v_mfma_f32_16x16x32_bf16 v[120:123], v[16:19], v[24:27], v[120:123]
    v_mfma_f32_16x16x32_bf16 v[124:127], v[16:19], v[28:31], v[124:127]
    v_mfma_f32_16x16x32_bf16 v[152:155], v[20:23], v[24:27], v[152:155]
    ds_read_b128 v[24:27], v4 offset:8192
    v_mfma_f32_16x16x32_bf16 v[156:159], v[20:23], v[28:31], v[156:159]
    ds_read_b128 v[28:31], v4 offset:8704
    s_waitcnt lgkmcnt(3)
    v_mfma_f32_16x16x32_bf16 v[64:67], v[8:11], v[32:35], v[64:67]
    s_waitcnt lgkmcnt(2)
    v_mfma_f32_16x16x32_bf16 v[68:71], v[8:11], v[36:39], v[68:71]
    ds_read_b128 v[8:11], v3 offset:0
    v_mfma_f32_16x16x32_bf16 v[96:99], v[12:15], v[32:35], v[96:99]
    v_mfma_f32_16x16x32_bf16 v[100:103], v[12:15], v[36:39], v[100:103]
    ds_read_b128 v[12:15], v3 offset:2048
    v_mfma_f32_16x16x32_bf16 v[128:131], v[16:19], v[32:35], v[128:131]
    v_mfma_f32_16x16x32_bf16 v[132:135], v[16:19], v[36:39], v[132:135]
    ds_read_b128 v[16:19], v3 offset:4096
    v_mfma_f32_16x16x32_bf16 v[160:163], v[20:23], v[32:35], v[160:163]
    ds_read_b128 v[32:35], v4 offset:9216
    v_mfma_f32_16x16x32_bf16 v[164:167], v[20:23], v[36:39], v[164:167]
    ds_read_b128 v[20:23], v3 offset:6144
    ds_read_b128 v[36:39], v4 offset:9728
    s_waitcnt lgkmcnt(5)
    v_mfma_f32_16x16x32_bf16 v[40:43], v[8:11], v[24:27], v[40:43]
    v_mfma_f32_16x16x32_bf16 v[44:47], v[8:11], v[28:31], v[44:47]
    s_waitcnt lgkmcnt(4)
    v_mfma_f32_16x16x32_bf16 v[72:75], v[12:15], v[24:27], v[72:75]
    v_mfma_f32_16x16x32_bf16 v[76:79], v[12:15], v[28:31], v[76:79]
    s_waitcnt lgkmcnt(3)
    v_mfma_f32_16x16x32_bf16 v[104:107], v[16:19], v[24:27], v[104:107]
    v_mfma_f32_16x16x32_bf16 v[108:111], v[16:19], v[28:31], v[108:111]
    s_waitcnt lgkmcnt(1)
    v_mfma_f32_16x16x32_bf16 v[136:139], v[20:23], v[24:27], v[136:139]
    ds_read_b128 v[24:27], v5 offset:8192
    v_mfma_f32_16x16x32_bf16 v[140:143], v[20:23], v[28:31], v[140:143]
    ds_read_b128 v[28:31], v5 offset:8704
    v_mfma_f32_16x16x32_bf16 v[48:51], v[8:11], v[32:35], v[48:51]
    s_waitcnt lgkmcnt(2)
    v_mfma_f32_16x16x32_bf16 v[52:55], v[8:11], v[36:39], v[52:55]
    v_mfma_f32_16x16x32_bf16 v[80:83], v[12:15], v[32:35], v[80:83]
    v_mfma_f32_16x16x32_bf16 v[84:87], v[12:15], v[36:39], v[84:87]
    v_mfma_f32_16x16x32_bf16 v[112:115], v[16:19], v[32:35], v[112:115]
    v_mfma_f32_16x16x32_bf16 v[116:119], v[16:19], v[36:39], v[116:119]
    v_mfma_f32_16x16x32_bf16 v[144:147], v[20:23], v[32:35], v[144:147]
    ds_read_b128 v[32:35], v5 offset:9216
    v_mfma_f32_16x16x32_bf16 v[148:151], v[20:23], v[36:39], v[148:151]
    ds_read_b128 v[36:39], v5 offset:9728
    s_waitcnt lgkmcnt(3)
    v_mfma_f32_16x16x32_bf16 v[56:59], v[8:11], v[24:27], v[56:59]
    s_waitcnt lgkmcnt(2)
    v_mfma_f32_16x16x32_bf16 v[60:63], v[8:11], v[28:31], v[60:63]
    v_mfma_f32_16x16x32_bf16 v[88:91], v[12:15], v[24:27], v[88:91]
    v_mfma_f32_16x16x32_bf16 v[92:95], v[12:15], v[28:31], v[92:95]
    v_mfma_f32_16x16x32_bf16 v[120:123], v[16:19], v[24:27], v[120:123]
    v_mfma_f32_16x16x32_bf16 v[124:127], v[16:19], v[28:31], v[124:127]
    s_waitcnt lgkmcnt(0)
    s_barrier
    v_add_u32 v4, 0xffff4000, v4
    v_mfma_f32_16x16x32_bf16 v[152:155], v[20:23], v[24:27], v[152:155]
    v_add_u32 v7, 0x0, v1
    v_add_u32 v1, 0xffff0000, v1
    ds_read_b128 v[24:27], v1 offset:0
    v_mfma_f32_16x16x32_bf16 v[156:159], v[20:23], v[28:31], v[156:159]
    v_add_u32 v5, 0xffff4000, v5
    v_mfma_f32_16x16x32_bf16 v[64:67], v[8:11], v[32:35], v[64:67]
    v_add_u32 v0, 0x0, v3
    ds_read_b128 v[28:31], v4 offset:0
    v_mfma_f32_16x16x32_bf16 v[68:71], v[8:11], v[36:39], v[68:71]
    v_add_u32 v3, 0xffff0000, v3
    ds_read_b128 v[8:11], v1 offset:2048
    v_mfma_f32_16x16x32_bf16 v[96:99], v[12:15], v[32:35], v[96:99]
    v_mfma_f32_16x16x32_bf16 v[100:103], v[12:15], v[36:39], v[100:103]
    ds_read_b128 v[12:15], v4 offset:512
    v_mfma_f32_16x16x32_bf16 v[128:131], v[16:19], v[32:35], v[128:131]
    v_mfma_f32_16x16x32_bf16 v[132:135], v[16:19], v[36:39], v[132:135]
    ds_read_b128 v[16:19], v4 offset:1024
    v_mfma_f32_16x16x32_bf16 v[160:163], v[20:23], v[32:35], v[160:163]
    ds_read_b128 v[32:35], v4 offset:1536
    v_mfma_f32_16x16x32_bf16 v[164:167], v[20:23], v[36:39], v[164:167]
    s_waitcnt lgkmcnt(4)
    v_mfma_f32_16x16x32_bf16 v[40:43], v[24:27], v[28:31], v[40:43]
    ds_read_b128 v[20:23], v5 offset:0
    s_waitcnt lgkmcnt(4)
    v_mfma_f32_16x16x32_bf16 v[72:75], v[8:11], v[28:31], v[72:75]
    s_waitcnt lgkmcnt(3)
    v_mfma_f32_16x16x32_bf16 v[44:47], v[24:27], v[12:15], v[44:47]
    ds_read_b128 v[28:31], v5 offset:512
    v_mfma_f32_16x16x32_bf16 v[76:79], v[8:11], v[12:15], v[76:79]
    s_waitcnt lgkmcnt(3)
    v_mfma_f32_16x16x32_bf16 v[48:51], v[24:27], v[16:19], v[48:51]
    ds_read_b128 v[12:15], v5 offset:1024
    v_mfma_f32_16x16x32_bf16 v[80:83], v[8:11], v[16:19], v[80:83]
    ds_read_b128 v[36:39], v3 offset:0
    s_waitcnt lgkmcnt(4)
    v_mfma_f32_16x16x32_bf16 v[52:55], v[24:27], v[32:35], v[52:55]
    ds_read_b128 v[16:19], v5 offset:1536
    v_mfma_f32_16x16x32_bf16 v[84:87], v[8:11], v[32:35], v[84:87]
    s_waitcnt lgkmcnt(4)
    v_mfma_f32_16x16x32_bf16 v[56:59], v[24:27], v[20:23], v[56:59]
    ds_read_b128 v[32:35], v4 offset:8192
    v_mfma_f32_16x16x32_bf16 v[88:91], v[8:11], v[20:23], v[88:91]
    ds_read_b128 v[20:23], v3 offset:2048
    s_waitcnt lgkmcnt(5)
    v_mfma_f32_16x16x32_bf16 v[60:63], v[24:27], v[28:31], v[60:63]
    v_mfma_f32_16x16x32_bf16 v[92:95], v[8:11], v[28:31], v[92:95]
    ds_read_b128 v[28:31], v4 offset:8704
    s_waitcnt lgkmcnt(5)
    v_mfma_f32_16x16x32_bf16 v[64:67], v[24:27], v[12:15], v[64:67]
    v_mfma_f32_16x16x32_bf16 v[96:99], v[8:11], v[12:15], v[96:99]
    ds_read_b128 v[12:15], v4 offset:9216
    s_waitcnt lgkmcnt(4)
    v_mfma_f32_16x16x32_bf16 v[68:71], v[24:27], v[16:19], v[68:71]
    ds_read_b128 v[24:27], v4 offset:9728
    v_mfma_f32_16x16x32_bf16 v[100:103], v[8:11], v[16:19], v[100:103]
    s_waitcnt lgkmcnt(4)
    v_mfma_f32_16x16x32_bf16 v[40:43], v[36:39], v[32:35], v[40:43]
    ds_read_b128 v[8:11], v5 offset:8192
    s_waitcnt lgkmcnt(4)
    v_mfma_f32_16x16x32_bf16 v[72:75], v[20:23], v[32:35], v[72:75]
    s_waitcnt lgkmcnt(3)
    v_mfma_f32_16x16x32_bf16 v[44:47], v[36:39], v[28:31], v[44:47]
    ds_read_b128 v[32:35], v5 offset:8704
    v_mfma_f32_16x16x32_bf16 v[76:79], v[20:23], v[28:31], v[76:79]
    s_waitcnt lgkmcnt(3)
    v_mfma_f32_16x16x32_bf16 v[48:51], v[36:39], v[12:15], v[48:51]
    ds_read_b128 v[28:31], v5 offset:9216
    v_mfma_f32_16x16x32_bf16 v[80:83], v[20:23], v[12:15], v[80:83]
    s_barrier
    ds_read_b128 v[16:19], v1 offset:32768
    s_waitcnt lgkmcnt(4)
    v_mfma_f32_16x16x32_bf16 v[52:55], v[36:39], v[24:27], v[52:55]
    ds_read_b128 v[12:15], v5 offset:9728
    v_mfma_f32_16x16x32_bf16 v[84:87], v[20:23], v[24:27], v[84:87]
    s_waitcnt lgkmcnt(4)
    v_mfma_f32_16x16x32_bf16 v[56:59], v[36:39], v[8:11], v[56:59]
    ds_read_b128 v[24:27], v4 offset:16384
    v_mfma_f32_16x16x32_bf16 v[88:91], v[20:23], v[8:11], v[88:91]
    ds_read_b128 v[8:11], v1 offset:34816
    s_waitcnt lgkmcnt(5)
    v_mfma_f32_16x16x32_bf16 v[60:63], v[36:39], v[32:35], v[60:63]
    v_mfma_f32_16x16x32_bf16 v[92:95], v[20:23], v[32:35], v[92:95]
    ds_read_b128 v[32:35], v4 offset:16896
    s_waitcnt lgkmcnt(5)
    v_mfma_f32_16x16x32_bf16 v[64:67], v[36:39], v[28:31], v[64:67]
    v_mfma_f32_16x16x32_bf16 v[96:99], v[20:23], v[28:31], v[96:99]
    ds_read_b128 v[28:31], v4 offset:17408
    s_waitcnt lgkmcnt(4)
    v_mfma_f32_16x16x32_bf16 v[68:71], v[36:39], v[12:15], v[68:71]
    ds_read_b128 v[36:39], v4 offset:17920
    v_mfma_f32_16x16x32_bf16 v[100:103], v[20:23], v[12:15], v[100:103]
    s_waitcnt lgkmcnt(4)
    v_mfma_f32_16x16x32_bf16 v[40:43], v[16:19], v[24:27], v[40:43]
    ds_read_b128 v[12:15], v5 offset:16384
    s_waitcnt lgkmcnt(4)
    v_mfma_f32_16x16x32_bf16 v[72:75], v[8:11], v[24:27], v[72:75]
    s_waitcnt lgkmcnt(3)
    v_mfma_f32_16x16x32_bf16 v[44:47], v[16:19], v[32:35], v[44:47]
    ds_read_b128 v[24:27], v5 offset:16896
    v_mfma_f32_16x16x32_bf16 v[76:79], v[8:11], v[32:35], v[76:79]
    s_waitcnt lgkmcnt(3)
    v_mfma_f32_16x16x32_bf16 v[48:51], v[16:19], v[28:31], v[48:51]
    ds_read_b128 v[32:35], v5 offset:17408
    v_mfma_f32_16x16x32_bf16 v[80:83], v[8:11], v[28:31], v[80:83]
    ds_read_b128 v[20:23], v3 offset:32768
    s_waitcnt lgkmcnt(4)
    v_mfma_f32_16x16x32_bf16 v[52:55], v[16:19], v[36:39], v[52:55]
    ds_read_b128 v[28:31], v5 offset:17920
    v_mfma_f32_16x16x32_bf16 v[84:87], v[8:11], v[36:39], v[84:87]
    s_waitcnt lgkmcnt(4)
    v_mfma_f32_16x16x32_bf16 v[56:59], v[16:19], v[12:15], v[56:59]
    ds_read_b128 v[36:39], v4 offset:24576
    v_mfma_f32_16x16x32_bf16 v[88:91], v[8:11], v[12:15], v[88:91]
    ds_read_b128 v[12:15], v3 offset:34816
    s_waitcnt lgkmcnt(5)
    v_mfma_f32_16x16x32_bf16 v[60:63], v[16:19], v[24:27], v[60:63]
    v_mfma_f32_16x16x32_bf16 v[92:95], v[8:11], v[24:27], v[92:95]
    ds_read_b128 v[24:27], v4 offset:25088
    s_waitcnt lgkmcnt(5)
    v_mfma_f32_16x16x32_bf16 v[64:67], v[16:19], v[32:35], v[64:67]
    v_mfma_f32_16x16x32_bf16 v[96:99], v[8:11], v[32:35], v[96:99]
    ds_read_b128 v[32:35], v4 offset:25600
    s_waitcnt lgkmcnt(4)
    v_mfma_f32_16x16x32_bf16 v[68:71], v[16:19], v[28:31], v[68:71]
    ds_read_b128 v[16:19], v4 offset:26112
    v_mfma_f32_16x16x32_bf16 v[100:103], v[8:11], v[28:31], v[100:103]
    s_waitcnt lgkmcnt(4)
    v_mfma_f32_16x16x32_bf16 v[40:43], v[20:23], v[36:39], v[40:43]
    ds_read_b128 v[8:11], v5 offset:24576
    s_waitcnt lgkmcnt(4)
    v_mfma_f32_16x16x32_bf16 v[72:75], v[12:15], v[36:39], v[72:75]
    s_waitcnt lgkmcnt(3)
    v_mfma_f32_16x16x32_bf16 v[44:47], v[20:23], v[24:27], v[44:47]
    ds_read_b128 v[36:39], v5 offset:25088
    v_mfma_f32_16x16x32_bf16 v[76:79], v[12:15], v[24:27], v[76:79]
    s_waitcnt lgkmcnt(3)
    v_mfma_f32_16x16x32_bf16 v[48:51], v[20:23], v[32:35], v[48:51]
    ds_read_b128 v[24:27], v5 offset:25600
    v_mfma_f32_16x16x32_bf16 v[80:83], v[12:15], v[32:35], v[80:83]
    s_barrier
    ds_read_b128 v[28:31], v7 offset:0
    s_waitcnt lgkmcnt(4)
    v_mfma_f32_16x16x32_bf16 v[52:55], v[20:23], v[16:19], v[52:55]
    ds_read_b128 v[32:35], v5 offset:26112
    v_mfma_f32_16x16x32_bf16 v[84:87], v[12:15], v[16:19], v[84:87]
    s_waitcnt lgkmcnt(4)
    v_mfma_f32_16x16x32_bf16 v[56:59], v[20:23], v[8:11], v[56:59]
    ds_read_b128 v[16:19], v4 offset:32768
    v_mfma_f32_16x16x32_bf16 v[88:91], v[12:15], v[8:11], v[88:91]
    ds_read_b128 v[8:11], v7 offset:2048
    s_waitcnt lgkmcnt(5)
    v_mfma_f32_16x16x32_bf16 v[60:63], v[20:23], v[36:39], v[60:63]
    v_mfma_f32_16x16x32_bf16 v[92:95], v[12:15], v[36:39], v[92:95]
    ds_read_b128 v[36:39], v4 offset:33280
    s_waitcnt lgkmcnt(5)
    v_mfma_f32_16x16x32_bf16 v[64:67], v[20:23], v[24:27], v[64:67]
    v_mfma_f32_16x16x32_bf16 v[96:99], v[12:15], v[24:27], v[96:99]
    ds_read_b128 v[24:27], v4 offset:33792
    s_waitcnt lgkmcnt(4)
    v_mfma_f32_16x16x32_bf16 v[68:71], v[20:23], v[32:35], v[68:71]
    ds_read_b128 v[20:23], v4 offset:34304
    v_mfma_f32_16x16x32_bf16 v[100:103], v[12:15], v[32:35], v[100:103]
    s_waitcnt lgkmcnt(4)
    v_mfma_f32_16x16x32_bf16 v[40:43], v[28:31], v[16:19], v[40:43]
    ds_read_b128 v[12:15], v5 offset:32768
    s_waitcnt lgkmcnt(4)
    v_mfma_f32_16x16x32_bf16 v[72:75], v[8:11], v[16:19], v[72:75]
    s_waitcnt lgkmcnt(3)
    v_mfma_f32_16x16x32_bf16 v[44:47], v[28:31], v[36:39], v[44:47]
    ds_read_b128 v[16:19], v5 offset:33280
    v_mfma_f32_16x16x32_bf16 v[76:79], v[8:11], v[36:39], v[76:79]
    s_waitcnt lgkmcnt(3)
    v_mfma_f32_16x16x32_bf16 v[48:51], v[28:31], v[24:27], v[48:51]
    ds_read_b128 v[36:39], v5 offset:33792
    v_mfma_f32_16x16x32_bf16 v[80:83], v[8:11], v[24:27], v[80:83]
    ds_read_b128 v[32:35], v0 offset:0
    s_waitcnt lgkmcnt(4)
    v_mfma_f32_16x16x32_bf16 v[52:55], v[28:31], v[20:23], v[52:55]
    ds_read_b128 v[24:27], v5 offset:34304
    v_mfma_f32_16x16x32_bf16 v[84:87], v[8:11], v[20:23], v[84:87]
    s_waitcnt lgkmcnt(4)
    v_mfma_f32_16x16x32_bf16 v[56:59], v[28:31], v[12:15], v[56:59]
    ds_read_b128 v[20:23], v4 offset:40960
    v_mfma_f32_16x16x32_bf16 v[88:91], v[8:11], v[12:15], v[88:91]
    ds_read_b128 v[12:15], v0 offset:2048
    s_waitcnt lgkmcnt(5)
    v_mfma_f32_16x16x32_bf16 v[60:63], v[28:31], v[16:19], v[60:63]
    v_mfma_f32_16x16x32_bf16 v[92:95], v[8:11], v[16:19], v[92:95]
    ds_read_b128 v[16:19], v4 offset:41472
    s_waitcnt lgkmcnt(5)
    v_mfma_f32_16x16x32_bf16 v[64:67], v[28:31], v[36:39], v[64:67]
    v_mfma_f32_16x16x32_bf16 v[96:99], v[8:11], v[36:39], v[96:99]
    ds_read_b128 v[36:39], v4 offset:41984
    s_waitcnt lgkmcnt(4)
    v_mfma_f32_16x16x32_bf16 v[68:71], v[28:31], v[24:27], v[68:71]
    ds_read_b128 v[28:31], v4 offset:42496
    v_mfma_f32_16x16x32_bf16 v[100:103], v[8:11], v[24:27], v[100:103]
    s_waitcnt lgkmcnt(4)
    v_mfma_f32_16x16x32_bf16 v[40:43], v[32:35], v[20:23], v[40:43]
    ds_read_b128 v[8:11], v5 offset:40960
    s_waitcnt lgkmcnt(4)
    v_mfma_f32_16x16x32_bf16 v[72:75], v[12:15], v[20:23], v[72:75]
    s_waitcnt lgkmcnt(3)
    v_mfma_f32_16x16x32_bf16 v[44:47], v[32:35], v[16:19], v[44:47]
    ds_read_b128 v[20:23], v5 offset:41472
    v_mfma_f32_16x16x32_bf16 v[76:79], v[12:15], v[16:19], v[76:79]
    s_waitcnt lgkmcnt(3)
    v_mfma_f32_16x16x32_bf16 v[48:51], v[32:35], v[36:39], v[48:51]
    ds_read_b128 v[16:19], v5 offset:41984
    v_mfma_f32_16x16x32_bf16 v[80:83], v[12:15], v[36:39], v[80:83]
    s_barrier
    ds_read_b128 v[24:27], v1 offset:0
    s_waitcnt lgkmcnt(4)
    v_mfma_f32_16x16x32_bf16 v[52:55], v[32:35], v[28:31], v[52:55]
    ds_read_b128 v[36:39], v5 offset:42496
    v_mfma_f32_16x16x32_bf16 v[84:87], v[12:15], v[28:31], v[84:87]
    s_waitcnt lgkmcnt(4)
    v_mfma_f32_16x16x32_bf16 v[56:59], v[32:35], v[8:11], v[56:59]
    ds_read_b128 v[28:31], v4 offset:49152
    v_mfma_f32_16x16x32_bf16 v[88:91], v[12:15], v[8:11], v[88:91]
    ds_read_b128 v[8:11], v1 offset:2048
    s_waitcnt lgkmcnt(5)
    v_mfma_f32_16x16x32_bf16 v[60:63], v[32:35], v[20:23], v[60:63]
    v_mfma_f32_16x16x32_bf16 v[92:95], v[12:15], v[20:23], v[92:95]
    ds_read_b128 v[20:23], v4 offset:49664
    s_waitcnt lgkmcnt(5)
    v_mfma_f32_16x16x32_bf16 v[64:67], v[32:35], v[16:19], v[64:67]
    v_mfma_f32_16x16x32_bf16 v[96:99], v[12:15], v[16:19], v[96:99]
    ds_read_b128 v[16:19], v4 offset:50176
    s_waitcnt lgkmcnt(4)
    v_mfma_f32_16x16x32_bf16 v[68:71], v[32:35], v[36:39], v[68:71]
    ds_read_b128 v[32:35], v4 offset:50688
    v_mfma_f32_16x16x32_bf16 v[100:103], v[12:15], v[36:39], v[100:103]
    s_waitcnt lgkmcnt(4)
    v_mfma_f32_16x16x32_bf16 v[40:43], v[24:27], v[28:31], v[40:43]
    ds_read_b128 v[12:15], v5 offset:49152
    s_waitcnt lgkmcnt(4)
    v_mfma_f32_16x16x32_bf16 v[72:75], v[8:11], v[28:31], v[72:75]
    s_waitcnt lgkmcnt(3)
    v_mfma_f32_16x16x32_bf16 v[44:47], v[24:27], v[20:23], v[44:47]
    ds_read_b128 v[28:31], v5 offset:49664
    v_mfma_f32_16x16x32_bf16 v[76:79], v[8:11], v[20:23], v[76:79]
    s_waitcnt lgkmcnt(3)
    v_mfma_f32_16x16x32_bf16 v[48:51], v[24:27], v[16:19], v[48:51]
    ds_read_b128 v[20:23], v5 offset:50176
    v_mfma_f32_16x16x32_bf16 v[80:83], v[8:11], v[16:19], v[80:83]
    ds_read_b128 v[36:39], v3 offset:0
    s_waitcnt lgkmcnt(4)
    v_mfma_f32_16x16x32_bf16 v[52:55], v[24:27], v[32:35], v[52:55]
    ds_read_b128 v[16:19], v5 offset:50688
    v_mfma_f32_16x16x32_bf16 v[84:87], v[8:11], v[32:35], v[84:87]
    s_waitcnt lgkmcnt(4)
    v_mfma_f32_16x16x32_bf16 v[56:59], v[24:27], v[12:15], v[56:59]
    ds_read_b128 v[32:35], v4 offset:57344
    v_mfma_f32_16x16x32_bf16 v[88:91], v[8:11], v[12:15], v[88:91]
    ds_read_b128 v[12:15], v3 offset:2048
    s_waitcnt lgkmcnt(5)
    v_mfma_f32_16x16x32_bf16 v[60:63], v[24:27], v[28:31], v[60:63]
    v_mfma_f32_16x16x32_bf16 v[92:95], v[8:11], v[28:31], v[92:95]
    ds_read_b128 v[28:31], v4 offset:57856
    s_waitcnt lgkmcnt(5)
    v_mfma_f32_16x16x32_bf16 v[64:67], v[24:27], v[20:23], v[64:67]
    v_mfma_f32_16x16x32_bf16 v[96:99], v[8:11], v[20:23], v[96:99]
    ds_read_b128 v[20:23], v4 offset:58368
    s_waitcnt lgkmcnt(4)
    v_mfma_f32_16x16x32_bf16 v[68:71], v[24:27], v[16:19], v[68:71]
    ds_read_b128 v[24:27], v4 offset:58880
    v_mfma_f32_16x16x32_bf16 v[100:103], v[8:11], v[16:19], v[100:103]
    s_waitcnt lgkmcnt(4)
    v_mfma_f32_16x16x32_bf16 v[40:43], v[36:39], v[32:35], v[40:43]
    ds_read_b128 v[8:11], v5 offset:57344
    s_waitcnt lgkmcnt(4)
    v_mfma_f32_16x16x32_bf16 v[72:75], v[12:15], v[32:35], v[72:75]
    s_waitcnt lgkmcnt(3)
    v_mfma_f32_16x16x32_bf16 v[44:47], v[36:39], v[28:31], v[44:47]
    ds_read_b128 v[32:35], v5 offset:57856
    v_mfma_f32_16x16x32_bf16 v[76:79], v[12:15], v[28:31], v[76:79]
    s_waitcnt lgkmcnt(3)
    v_mfma_f32_16x16x32_bf16 v[48:51], v[36:39], v[20:23], v[48:51]
    ds_read_b128 v[28:31], v5 offset:58368
    v_mfma_f32_16x16x32_bf16 v[80:83], v[12:15], v[20:23], v[80:83]
    ds_read_b128 v[16:19], v1 offset:4096
    s_waitcnt lgkmcnt(4)
    v_mfma_f32_16x16x32_bf16 v[52:55], v[36:39], v[24:27], v[52:55]
    ds_read_b128 v[20:23], v5 offset:58880
    v_mfma_f32_16x16x32_bf16 v[84:87], v[12:15], v[24:27], v[84:87]
    s_waitcnt lgkmcnt(4)
    v_mfma_f32_16x16x32_bf16 v[56:59], v[36:39], v[8:11], v[56:59]
    ds_read_b128 v[24:27], v4 offset:0
    v_mfma_f32_16x16x32_bf16 v[88:91], v[12:15], v[8:11], v[88:91]
    ds_read_b128 v[8:11], v1 offset:6144
    s_waitcnt lgkmcnt(5)
    v_mfma_f32_16x16x32_bf16 v[60:63], v[36:39], v[32:35], v[60:63]
    v_mfma_f32_16x16x32_bf16 v[92:95], v[12:15], v[32:35], v[92:95]
    ds_read_b128 v[32:35], v4 offset:512
    s_waitcnt lgkmcnt(5)
    v_mfma_f32_16x16x32_bf16 v[64:67], v[36:39], v[28:31], v[64:67]
    v_mfma_f32_16x16x32_bf16 v[96:99], v[12:15], v[28:31], v[96:99]
    ds_read_b128 v[28:31], v4 offset:1024
    s_waitcnt lgkmcnt(4)
    v_mfma_f32_16x16x32_bf16 v[68:71], v[36:39], v[20:23], v[68:71]
    ds_read_b128 v[36:39], v4 offset:1536
    v_mfma_f32_16x16x32_bf16 v[100:103], v[12:15], v[20:23], v[100:103]
    s_waitcnt lgkmcnt(4)
    v_mfma_f32_16x16x32_bf16 v[104:107], v[16:19], v[24:27], v[104:107]
    ds_read_b128 v[12:15], v5 offset:0
    s_waitcnt lgkmcnt(4)
    v_mfma_f32_16x16x32_bf16 v[136:139], v[8:11], v[24:27], v[136:139]
    s_waitcnt lgkmcnt(3)
    v_mfma_f32_16x16x32_bf16 v[108:111], v[16:19], v[32:35], v[108:111]
    ds_read_b128 v[24:27], v5 offset:512
    v_mfma_f32_16x16x32_bf16 v[140:143], v[8:11], v[32:35], v[140:143]
    s_waitcnt lgkmcnt(3)
    v_mfma_f32_16x16x32_bf16 v[112:115], v[16:19], v[28:31], v[112:115]
    ds_read_b128 v[20:23], v5 offset:1024
    v_cvt_pk_bf16_f32 v32, v40, v44
    v_cvt_pk_bf16_f32 v33, v48, v52
    v_mfma_f32_16x16x32_bf16 v[144:147], v[8:11], v[28:31], v[144:147]
    v_cvt_pk_bf16_f32 v34, v56, v60
    v_cvt_pk_bf16_f32 v35, v64, v68
    s_waitcnt lgkmcnt(3)
    v_mfma_f32_16x16x32_bf16 v[116:119], v[16:19], v[36:39], v[116:119]
    ds_read_b128 v[28:31], v5 offset:1536
    buffer_store_dwordx4 v[32:35], v6, s[28:31], s36 offen sc1 nt
    s_add_u32 s36, s36, 7168
    v_mfma_f32_16x16x32_bf16 v[148:151], v[8:11], v[36:39], v[148:151]
    ds_read_b128 v[36:39], v3 offset:4096
    v_cvt_pk_bf16_f32 v32, v41, v45
    v_cvt_pk_bf16_f32 v33, v49, v53
    s_waitcnt lgkmcnt(4)
    v_mfma_f32_16x16x32_bf16 v[120:123], v[16:19], v[12:15], v[120:123]
    v_cvt_pk_bf16_f32 v34, v57, v61
    v_cvt_pk_bf16_f32 v35, v65, v69
    v_mfma_f32_16x16x32_bf16 v[152:155], v[8:11], v[12:15], v[152:155]
    ds_read_b128 v[12:15], v4 offset:8192
    buffer_store_dwordx4 v[32:35], v6, s[28:31], s36 offen sc1 nt
    s_add_u32 s36, s36, 7168
    s_waitcnt lgkmcnt(4)
    v_mfma_f32_16x16x32_bf16 v[124:127], v[16:19], v[24:27], v[124:127]
    v_cvt_pk_bf16_f32 v32, v42, v46
    v_cvt_pk_bf16_f32 v33, v50, v54
    v_mfma_f32_16x16x32_bf16 v[156:159], v[8:11], v[24:27], v[156:159]
    ds_read_b128 v[24:27], v3 offset:6144
    v_cvt_pk_bf16_f32 v34, v58, v62
    v_cvt_pk_bf16_f32 v35, v66, v70
    s_waitcnt lgkmcnt(4)
    v_mfma_f32_16x16x32_bf16 v[128:131], v[16:19], v[20:23], v[128:131]
    buffer_store_dwordx4 v[32:35], v6, s[28:31], s36 offen sc1 nt
    s_add_u32 s36, s36, 7168
    v_mfma_f32_16x16x32_bf16 v[160:163], v[8:11], v[20:23], v[160:163]
    ds_read_b128 v[20:23], v4 offset:8704
    v_cvt_pk_bf16_f32 v32, v43, v47
    v_cvt_pk_bf16_f32 v33, v51, v55
    s_waitcnt lgkmcnt(4)
    v_mfma_f32_16x16x32_bf16 v[132:135], v[16:19], v[28:31], v[132:135]
    ds_read_b128 v[16:19], v4 offset:9216
    v_cvt_pk_bf16_f32 v34, v59, v63
    v_cvt_pk_bf16_f32 v35, v67, v71
    v_mfma_f32_16x16x32_bf16 v[164:167], v[8:11], v[28:31], v[164:167]
    ds_read_b128 v[8:11], v4 offset:9728
    buffer_store_dwordx4 v[32:35], v6, s[28:31], s36 offen sc1 nt
    s_add_u32 s36, s36, 93184
    s_waitcnt lgkmcnt(4)
    v_mfma_f32_16x16x32_bf16 v[104:107], v[36:39], v[12:15], v[104:107]
    ds_read_b128 v[32:35], v5 offset:8192
    v_cvt_pk_bf16_f32 v40, v72, v76
    v_cvt_pk_bf16_f32 v41, v80, v84
    s_waitcnt lgkmcnt(4)
    v_mfma_f32_16x16x32_bf16 v[136:139], v[24:27], v[12:15], v[136:139]
    v_cvt_pk_bf16_f32 v42, v88, v92
    v_cvt_pk_bf16_f32 v43, v96, v100
    s_waitcnt lgkmcnt(3)
    v_mfma_f32_16x16x32_bf16 v[108:111], v[36:39], v[20:23], v[108:111]
    ds_read_b128 v[12:15], v5 offset:8704
    buffer_store_dwordx4 v[40:43], v6, s[28:31], s36 offen sc1 nt
    s_add_u32 s36, s36, 7168
    v_mfma_f32_16x16x32_bf16 v[140:143], v[24:27], v[20:23], v[140:143]
    v_cvt_pk_bf16_f32 v44, v73, v77
    v_cvt_pk_bf16_f32 v45, v81, v85
    s_waitcnt lgkmcnt(3)
    v_mfma_f32_16x16x32_bf16 v[112:115], v[36:39], v[16:19], v[112:115]
    ds_read_b128 v[20:23], v5 offset:9216
    v_cvt_pk_bf16_f32 v46, v89, v93
    v_cvt_pk_bf16_f32 v47, v97, v101
    v_mfma_f32_16x16x32_bf16 v[144:147], v[24:27], v[16:19], v[144:147]
    ds_read_b128 v[28:31], v1 offset:36864
    buffer_store_dwordx4 v[44:47], v6, s[28:31], s36 offen sc1 nt
    s_add_u32 s36, s36, 7168
    s_waitcnt lgkmcnt(4)
    v_mfma_f32_16x16x32_bf16 v[116:119], v[36:39], v[8:11], v[116:119]
    ds_read_b128 v[16:19], v5 offset:9728
    v_cvt_pk_bf16_f32 v40, v74, v78
    v_cvt_pk_bf16_f32 v41, v82, v86
    v_mfma_f32_16x16x32_bf16 v[148:151], v[24:27], v[8:11], v[148:151]
    ds_read_b128 v[48:51], v1 offset:38912
    v_cvt_pk_bf16_f32 v42, v90, v94
    v_cvt_pk_bf16_f32 v43, v98, v102
    s_waitcnt lgkmcnt(5)
    v_mfma_f32_16x16x32_bf16 v[120:123], v[36:39], v[32:35], v[120:123]
    ds_read_b128 v[8:11], v4 offset:16384
    buffer_store_dwordx4 v[40:43], v6, s[28:31], s36 offen sc1 nt
    s_add_u32 s36, s36, 7168
    v_mfma_f32_16x16x32_bf16 v[152:155], v[24:27], v[32:35], v[152:155]
    v_cvt_pk_bf16_f32 v44, v75, v79
    v_cvt_pk_bf16_f32 v45, v83, v87
    s_waitcnt lgkmcnt(5)
    v_mfma_f32_16x16x32_bf16 v[124:127], v[36:39], v[12:15], v[124:127]
    ds_read_b128 v[32:35], v4 offset:16896
    v_cvt_pk_bf16_f32 v46, v91, v95
    v_cvt_pk_bf16_f32 v47, v99, v103
    v_mfma_f32_16x16x32_bf16 v[156:159], v[24:27], v[12:15], v[156:159]
    buffer_store_dwordx4 v[44:47], v6, s[28:31], s36 offen sc1 nt
    s_add_u32 s36, s36, 93184
    s_waitcnt lgkmcnt(5)
    v_mfma_f32_16x16x32_bf16 v[128:131], v[36:39], v[20:23], v[128:131]
    ds_read_b128 v[80:83], v4 offset:17408
    v_mfma_f32_16x16x32_bf16 v[160:163], v[24:27], v[20:23], v[160:163]
    s_waitcnt lgkmcnt(4)
    v_mfma_f32_16x16x32_bf16 v[132:135], v[36:39], v[16:19], v[132:135]
    ds_read_b128 v[36:39], v4 offset:17920
    v_mfma_f32_16x16x32_bf16 v[164:167], v[24:27], v[16:19], v[164:167]
    s_waitcnt lgkmcnt(3)
    v_mfma_f32_16x16x32_bf16 v[104:107], v[28:31], v[8:11], v[104:107]
    ds_read_b128 v[24:27], v5 offset:16384
    v_mfma_f32_16x16x32_bf16 v[136:139], v[48:51], v[8:11], v[136:139]
    s_waitcnt lgkmcnt(3)
    v_mfma_f32_16x16x32_bf16 v[108:111], v[28:31], v[32:35], v[108:111]
    ds_read_b128 v[8:11], v5 offset:16896
    v_mfma_f32_16x16x32_bf16 v[140:143], v[48:51], v[32:35], v[140:143]
    s_waitcnt lgkmcnt(3)
    v_mfma_f32_16x16x32_bf16 v[112:115], v[28:31], v[80:83], v[112:115]
    ds_read_b128 v[32:35], v5 offset:17408
    v_mfma_f32_16x16x32_bf16 v[144:147], v[48:51], v[80:83], v[144:147]
    ds_read_b128 v[12:15], v3 offset:36864
    s_waitcnt lgkmcnt(4)
    v_mfma_f32_16x16x32_bf16 v[116:119], v[28:31], v[36:39], v[116:119]
    ds_read_b128 v[80:83], v5 offset:17920
    v_mfma_f32_16x16x32_bf16 v[148:151], v[48:51], v[36:39], v[148:151]
    ds_read_b128 v[16:19], v3 offset:38912
    s_waitcnt lgkmcnt(5)
    v_mfma_f32_16x16x32_bf16 v[120:123], v[28:31], v[24:27], v[120:123]
    ds_read_b128 v[36:39], v4 offset:24576
    v_mfma_f32_16x16x32_bf16 v[152:155], v[48:51], v[24:27], v[152:155]
    s_waitcnt lgkmcnt(5)
    v_mfma_f32_16x16x32_bf16 v[124:127], v[28:31], v[8:11], v[124:127]
    ds_read_b128 v[24:27], v4 offset:25088
    v_mfma_f32_16x16x32_bf16 v[156:159], v[48:51], v[8:11], v[156:159]
    s_waitcnt lgkmcnt(5)
    v_mfma_f32_16x16x32_bf16 v[128:131], v[28:31], v[32:35], v[128:131]
    ds_read_b128 v[8:11], v4 offset:25600
    v_mfma_f32_16x16x32_bf16 v[160:163], v[48:51], v[32:35], v[160:163]
    s_waitcnt lgkmcnt(4)
    v_mfma_f32_16x16x32_bf16 v[132:135], v[28:31], v[80:83], v[132:135]
    ds_read_b128 v[28:31], v4 offset:26112
    v_mfma_f32_16x16x32_bf16 v[164:167], v[48:51], v[80:83], v[164:167]
    s_waitcnt lgkmcnt(3)
    v_mfma_f32_16x16x32_bf16 v[104:107], v[12:15], v[36:39], v[104:107]
    ds_read_b128 v[48:51], v5 offset:24576
    v_mfma_f32_16x16x32_bf16 v[136:139], v[16:19], v[36:39], v[136:139]
    s_waitcnt lgkmcnt(3)
    v_mfma_f32_16x16x32_bf16 v[108:111], v[12:15], v[24:27], v[108:111]
    ds_read_b128 v[36:39], v5 offset:25088
    v_mfma_f32_16x16x32_bf16 v[140:143], v[16:19], v[24:27], v[140:143]
    ds_read_b128 v[56:59], v4 offset:49152
    s_waitcnt lgkmcnt(4)
    v_mfma_f32_16x16x32_bf16 v[112:115], v[12:15], v[8:11], v[112:115]
    ds_read_b128 v[24:27], v5 offset:25600
    v_mfma_f32_16x16x32_bf16 v[144:147], v[16:19], v[8:11], v[144:147]
    ds_read_b128 v[20:23], v7 offset:4096
    s_waitcnt lgkmcnt(5)
    v_mfma_f32_16x16x32_bf16 v[116:119], v[12:15], v[28:31], v[116:119]
    ds_read_b128 v[8:11], v5 offset:26112
    v_mfma_f32_16x16x32_bf16 v[148:151], v[16:19], v[28:31], v[148:151]
    ds_read_b128 v[52:55], v0 offset:4096
    s_waitcnt lgkmcnt(6)
    v_mfma_f32_16x16x32_bf16 v[120:123], v[12:15], v[48:51], v[120:123]
    ds_read_b128 v[28:31], v4 offset:32768
    v_mfma_f32_16x16x32_bf16 v[152:155], v[16:19], v[48:51], v[152:155]
    ds_read_b128 v[48:51], v4 offset:33280
    s_waitcnt lgkmcnt(7)
    v_mfma_f32_16x16x32_bf16 v[124:127], v[12:15], v[36:39], v[124:127]
    ds_read_b128 v[80:83], v4 offset:33792
    v_mfma_f32_16x16x32_bf16 v[156:159], v[16:19], v[36:39], v[156:159]
    ds_read_b128 v[36:39], v4 offset:34304
    s_waitcnt lgkmcnt(7)
    v_mfma_f32_16x16x32_bf16 v[128:131], v[12:15], v[24:27], v[128:131]
    ds_read_b128 v[32:35], v5 offset:32768
    v_mfma_f32_16x16x32_bf16 v[160:163], v[16:19], v[24:27], v[160:163]
    ds_read_b128 v[24:27], v5 offset:33280
    s_waitcnt lgkmcnt(7)
    v_mfma_f32_16x16x32_bf16 v[132:135], v[12:15], v[8:11], v[132:135]
    ds_read_b128 v[12:15], v5 offset:33792
    v_mfma_f32_16x16x32_bf16 v[164:167], v[16:19], v[8:11], v[164:167]
    ds_read_b128 v[8:11], v5 offset:34304
    s_waitcnt lgkmcnt(7)
    v_mfma_f32_16x16x32_bf16 v[104:107], v[20:23], v[28:31], v[104:107]
    ds_read_b128 v[28:31], v4 offset:40960
    s_waitcnt lgkmcnt(7)
    v_mfma_f32_16x16x32_bf16 v[108:111], v[20:23], v[48:51], v[108:111]
    ds_read_b128 v[48:51], v4 offset:41472
    s_waitcnt lgkmcnt(7)
    v_mfma_f32_16x16x32_bf16 v[112:115], v[20:23], v[80:83], v[112:115]
    ds_read_b128 v[80:83], v4 offset:41984
    s_waitcnt lgkmcnt(7)
    v_mfma_f32_16x16x32_bf16 v[116:119], v[20:23], v[36:39], v[116:119]
    ds_read_b128 v[36:39], v4 offset:42496
    s_waitcnt lgkmcnt(7)
    v_mfma_f32_16x16x32_bf16 v[120:123], v[20:23], v[32:35], v[120:123]
    ds_read_b128 v[32:35], v5 offset:40960
    s_waitcnt lgkmcnt(7)
    v_mfma_f32_16x16x32_bf16 v[124:127], v[20:23], v[24:27], v[124:127]
    s_barrier
    ds_read_b128 v[24:27], v5 offset:41472
    s_waitcnt lgkmcnt(7)
    v_mfma_f32_16x16x32_bf16 v[128:131], v[20:23], v[12:15], v[128:131]
    ds_read_b128 v[12:15], v5 offset:41984
    s_waitcnt lgkmcnt(7)
    v_mfma_f32_16x16x32_bf16 v[132:135], v[20:23], v[8:11], v[132:135]
    ds_read_b128 v[8:11], v5 offset:42496
    s_waitcnt lgkmcnt(7)
    v_mfma_f32_16x16x32_bf16 v[104:107], v[52:55], v[28:31], v[104:107]
    ds_read_b128 v[16:19], v1 offset:32768
    s_waitcnt lgkmcnt(7)
    v_mfma_f32_16x16x32_bf16 v[108:111], v[52:55], v[48:51], v[108:111]
    ds_read_b128 v[48:51], v4 offset:49664
    s_waitcnt lgkmcnt(7)
    v_mfma_f32_16x16x32_bf16 v[112:115], v[52:55], v[80:83], v[112:115]
    ds_read_b128 v[80:83], v4 offset:50176
    s_waitcnt lgkmcnt(7)
    v_mfma_f32_16x16x32_bf16 v[116:119], v[52:55], v[36:39], v[116:119]
    ds_read_b128 v[36:39], v4 offset:50688
    s_waitcnt lgkmcnt(7)
    v_mfma_f32_16x16x32_bf16 v[120:123], v[52:55], v[32:35], v[120:123]
    ds_read_b128 v[32:35], v5 offset:49152
    s_waitcnt lgkmcnt(7)
    v_mfma_f32_16x16x32_bf16 v[124:127], v[52:55], v[24:27], v[124:127]
    ds_read_b128 v[24:27], v5 offset:49664
    s_waitcnt lgkmcnt(7)
    v_mfma_f32_16x16x32_bf16 v[128:131], v[52:55], v[12:15], v[128:131]
    ds_read_b128 v[12:15], v5 offset:50176
    s_waitcnt lgkmcnt(7)
    v_mfma_f32_16x16x32_bf16 v[132:135], v[52:55], v[8:11], v[132:135]
    ds_read_b128 v[8:11], v5 offset:50688
    s_waitcnt lgkmcnt(7)
    v_mfma_f32_16x16x32_bf16 v[104:107], v[16:19], v[56:59], v[104:107]
    ds_read_b128 v[28:31], v3 offset:32768
    s_waitcnt lgkmcnt(7)
    v_mfma_f32_16x16x32_bf16 v[108:111], v[16:19], v[48:51], v[108:111]
    ds_read_b128 v[52:55], v4 offset:57344
    s_waitcnt lgkmcnt(7)
    v_mfma_f32_16x16x32_bf16 v[112:115], v[16:19], v[80:83], v[112:115]
    ds_read_b128 v[20:23], v4 offset:57856
    s_waitcnt lgkmcnt(7)
    v_mfma_f32_16x16x32_bf16 v[116:119], v[16:19], v[36:39], v[116:119]
    ds_read_b128 v[84:87], v4 offset:58368
    s_waitcnt lgkmcnt(7)
    v_mfma_f32_16x16x32_bf16 v[120:123], v[16:19], v[32:35], v[120:123]
    ds_read_b128 v[88:91], v4 offset:58880
    s_waitcnt lgkmcnt(7)
    v_mfma_f32_16x16x32_bf16 v[124:127], v[16:19], v[24:27], v[124:127]
    ds_read_b128 v[92:95], v5 offset:57344
    s_waitcnt lgkmcnt(7)
    v_mfma_f32_16x16x32_bf16 v[128:131], v[16:19], v[12:15], v[128:131]
    ds_read_b128 v[96:99], v5 offset:57856
    s_waitcnt lgkmcnt(7)
    v_mfma_f32_16x16x32_bf16 v[132:135], v[16:19], v[8:11], v[132:135]
    ds_read_b128 v[100:103], v5 offset:58368
    s_waitcnt lgkmcnt(6)
    v_mfma_f32_16x16x32_bf16 v[104:107], v[28:31], v[52:55], v[104:107]
    ds_read_b128 v[16:19], v5 offset:58880
    s_waitcnt lgkmcnt(6)
    v_mfma_f32_16x16x32_bf16 v[108:111], v[28:31], v[20:23], v[108:111]
    ds_read_b128 v[60:63], v1 offset:34816
    s_waitcnt lgkmcnt(6)
    v_mfma_f32_16x16x32_bf16 v[112:115], v[28:31], v[84:87], v[112:115]
    s_waitcnt lgkmcnt(5)
    v_mfma_f32_16x16x32_bf16 v[116:119], v[28:31], v[88:91], v[116:119]
    s_waitcnt lgkmcnt(4)
    v_mfma_f32_16x16x32_bf16 v[120:123], v[28:31], v[92:95], v[120:123]
    s_waitcnt lgkmcnt(3)
    v_mfma_f32_16x16x32_bf16 v[124:127], v[28:31], v[96:99], v[124:127]
    s_waitcnt lgkmcnt(2)
    v_mfma_f32_16x16x32_bf16 v[128:131], v[28:31], v[100:103], v[128:131]
    ds_read_b128 v[64:67], v3 offset:34816
    s_waitcnt lgkmcnt(2)
    v_mfma_f32_16x16x32_bf16 v[132:135], v[28:31], v[16:19], v[132:135]
    s_waitcnt lgkmcnt(1)
    v_mfma_f32_16x16x32_bf16 v[136:139], v[60:63], v[56:59], v[136:139]
    v_mfma_f32_16x16x32_bf16 v[140:143], v[60:63], v[48:51], v[140:143]
    v_mfma_f32_16x16x32_bf16 v[144:147], v[60:63], v[80:83], v[144:147]
    v_mfma_f32_16x16x32_bf16 v[148:151], v[60:63], v[36:39], v[148:151]
    v_mfma_f32_16x16x32_bf16 v[152:155], v[60:63], v[32:35], v[152:155]
    v_mfma_f32_16x16x32_bf16 v[156:159], v[60:63], v[24:27], v[156:159]
    v_cvt_pk_bf16_f32 v72, v104, v108
    v_cvt_pk_bf16_f32 v73, v112, v116
    v_mfma_f32_16x16x32_bf16 v[160:163], v[60:63], v[12:15], v[160:163]
    ds_read_b128 v[12:15], v7 offset:6144
    v_cvt_pk_bf16_f32 v74, v120, v124
    v_cvt_pk_bf16_f32 v75, v128, v132
    v_mfma_f32_16x16x32_bf16 v[164:167], v[60:63], v[8:11], v[164:167]
    ds_read_b128 v[8:11], v0 offset:6144
    buffer_store_dwordx4 v[72:75], v6, s[28:31], s36 offen sc1 nt
    s_add_u32 s36, s36, 7168
    s_waitcnt lgkmcnt(2)
    v_mfma_f32_16x16x32_bf16 v[136:139], v[64:67], v[52:55], v[136:139]
    ds_read_b128 v[52:55], v4 offset:32768
    v_cvt_pk_bf16_f32 v76, v105, v109
    v_cvt_pk_bf16_f32 v77, v113, v117
    v_mfma_f32_16x16x32_bf16 v[140:143], v[64:67], v[20:23], v[140:143]
    ds_read_b128 v[20:23], v4 offset:33280
    v_cvt_pk_bf16_f32 v78, v121, v125
    v_cvt_pk_bf16_f32 v79, v129, v133
    v_mfma_f32_16x16x32_bf16 v[144:147], v[64:67], v[84:87], v[144:147]
    ds_read_b128 v[84:87], v4 offset:33792
    buffer_store_dwordx4 v[76:79], v6, s[28:31], s36 offen sc1 nt
    s_add_u32 s36, s36, 7168
    v_mfma_f32_16x16x32_bf16 v[148:151], v[64:67], v[88:91], v[148:151]
    ds_read_b128 v[88:91], v4 offset:34304
    v_cvt_pk_bf16_f32 v72, v106, v110
    v_cvt_pk_bf16_f32 v73, v114, v118
    v_mfma_f32_16x16x32_bf16 v[152:155], v[64:67], v[92:95], v[152:155]
    ds_read_b128 v[92:95], v5 offset:32768
    v_cvt_pk_bf16_f32 v74, v122, v126
    v_cvt_pk_bf16_f32 v75, v130, v134
    v_mfma_f32_16x16x32_bf16 v[156:159], v[64:67], v[96:99], v[156:159]
    ds_read_b128 v[96:99], v5 offset:33280
    buffer_store_dwordx4 v[72:75], v6, s[28:31], s36 offen sc1 nt
    s_add_u32 s36, s36, 7168
    v_mfma_f32_16x16x32_bf16 v[160:163], v[64:67], v[100:103], v[160:163]
    ds_read_b128 v[100:103], v5 offset:33792
    v_cvt_pk_bf16_f32 v76, v107, v111
    v_cvt_pk_bf16_f32 v77, v115, v119
    v_mfma_f32_16x16x32_bf16 v[164:167], v[64:67], v[16:19], v[164:167]
    ds_read_b128 v[16:19], v5 offset:34304
    v_cvt_pk_bf16_f32 v78, v123, v127
    v_cvt_pk_bf16_f32 v79, v131, v135
    s_waitcnt lgkmcnt(7)
    v_mfma_f32_16x16x32_bf16 v[136:139], v[12:15], v[52:55], v[136:139]
    ds_read_b128 v[52:55], v4 offset:40960
    buffer_store_dwordx4 v[76:79], v6, s[28:31], s36 offen sc1 nt
    s_add_u32 s36, s36, 93184
    s_waitcnt lgkmcnt(7)
    v_mfma_f32_16x16x32_bf16 v[140:143], v[12:15], v[20:23], v[140:143]
    ds_read_b128 v[20:23], v4 offset:41472
    s_waitcnt lgkmcnt(7)
    v_mfma_f32_16x16x32_bf16 v[144:147], v[12:15], v[84:87], v[144:147]
    ds_read_b128 v[84:87], v4 offset:41984
    s_waitcnt lgkmcnt(7)
    v_mfma_f32_16x16x32_bf16 v[148:151], v[12:15], v[88:91], v[148:151]
    ds_read_b128 v[88:91], v4 offset:42496
    s_waitcnt lgkmcnt(7)
    v_mfma_f32_16x16x32_bf16 v[152:155], v[12:15], v[92:95], v[152:155]
    ds_read_b128 v[92:95], v5 offset:40960
    s_waitcnt lgkmcnt(7)
    v_mfma_f32_16x16x32_bf16 v[156:159], v[12:15], v[96:99], v[156:159]
    ds_read_b128 v[96:99], v5 offset:41472
    s_waitcnt lgkmcnt(7)
    v_mfma_f32_16x16x32_bf16 v[160:163], v[12:15], v[100:103], v[160:163]
    ds_read_b128 v[100:103], v5 offset:41984
    s_waitcnt lgkmcnt(7)
    v_mfma_f32_16x16x32_bf16 v[164:167], v[12:15], v[16:19], v[164:167]
    ds_read_b128 v[12:15], v5 offset:42496
    s_waitcnt lgkmcnt(7)
    v_mfma_f32_16x16x32_bf16 v[136:139], v[8:11], v[52:55], v[136:139]
    s_waitcnt lgkmcnt(6)
    v_mfma_f32_16x16x32_bf16 v[140:143], v[8:11], v[20:23], v[140:143]
    s_waitcnt lgkmcnt(5)
    v_mfma_f32_16x16x32_bf16 v[144:147], v[8:11], v[84:87], v[144:147]
    s_waitcnt lgkmcnt(4)
    v_mfma_f32_16x16x32_bf16 v[148:151], v[8:11], v[88:91], v[148:151]
    s_waitcnt lgkmcnt(3)
    v_mfma_f32_16x16x32_bf16 v[152:155], v[8:11], v[92:95], v[152:155]
    s_waitcnt lgkmcnt(2)
    v_mfma_f32_16x16x32_bf16 v[156:159], v[8:11], v[96:99], v[156:159]
    s_waitcnt lgkmcnt(1)
    v_mfma_f32_16x16x32_bf16 v[160:163], v[8:11], v[100:103], v[160:163]
    s_waitcnt lgkmcnt(0)
    v_mfma_f32_16x16x32_bf16 v[164:167], v[8:11], v[12:15], v[164:167]
    s_nop 7
    v_cvt_pk_bf16_f32 v32, v136, v140
    v_cvt_pk_bf16_f32 v33, v144, v148
    v_cvt_pk_bf16_f32 v34, v152, v156
    v_cvt_pk_bf16_f32 v35, v160, v164
    buffer_store_dwordx4 v[32:35], v6, s[28:31], s36 offen sc1 nt
    s_add_u32 s36, s36, 7168
    v_cvt_pk_bf16_f32 v36, v137, v141
    v_cvt_pk_bf16_f32 v37, v145, v149
    v_cvt_pk_bf16_f32 v38, v153, v157
    v_cvt_pk_bf16_f32 v39, v161, v165
    buffer_store_dwordx4 v[36:39], v6, s[28:31], s36 offen sc1 nt
    s_add_u32 s36, s36, 7168
    v_cvt_pk_bf16_f32 v32, v138, v142
    v_cvt_pk_bf16_f32 v33, v146, v150
    v_cvt_pk_bf16_f32 v34, v154, v158
    v_cvt_pk_bf16_f32 v35, v162, v166
    buffer_store_dwordx4 v[32:35], v6, s[28:31], s36 offen sc1 nt
    s_add_u32 s36, s36, 7168
    v_cvt_pk_bf16_f32 v36, v139, v143
    v_cvt_pk_bf16_f32 v37, v147, v151
    v_cvt_pk_bf16_f32 v38, v155, v159
    v_cvt_pk_bf16_f32 v39, v163, v167
    buffer_store_dwordx4 v[36:39], v6, s[28:31], s36 offen sc1 nt
    s_add_u32 s36, s36, 93184
L_done:
    s_endpgm
L_e2:
    s_getpc_b64 s[86:87]
L_pcX:
    s_cmp_lt_u32 s13, 4
    s_cselect_b32 s35, 16, 0
    s_cselect_b32 s49, 8, 0
    s_add_u32 s35, s35, s48
    s_lshl_b32 s35, s35, 3
    s_add_u32 s35, s35, L_sched-L_pcX
    s_add_u32 s86, s86, s35
    s_addc_u32 s87, s87, 0
    s_load_dwordx2 s[82:83], s[86:87], 0
    s_lshr_b32 s35, s32, 3
    s_add_u32 s49, s49, s35
    s_lshl_b32 s35, s15, 2
    s_add_u32 s35, s35, s33
    s_lshl_b32 s35, s35, 7
    s_add_u32 s35, s35, 524288
    v_and_b32 v12, 15, v2
    v_lshlrev_b32 v12, 2, v12
    v_add_u32 v12, s35, v12
    s_mov_b64 s[68:69], s[56:57]
    s_mov_b32 s70, 268435456
    s_mov_b32 s71, 0x20000
    buffer_load_dword v13, v12, s[68:71], 0 offen sc0 sc1
    s_mov_b64 s[16:17], s[4:5]
    s_mov_b64 s[20:21], s[6:7]
    s_mov_b32 s22, 14680064
    s_mov_b32 s23, 0x20000
    s_mov_b32 s18, 4194304
    s_mov_b32 s19, 0x20000
    s_movk_i32 s97, 14336
    s_movk_i32 s98, 15360
    s_movk_i32 s99, 19456
    v_lshrrev_b32 v3, 5, v2
    s_lshl_b32 s35, s33, 1
    v_add_u32 v4, s35, v3
    v_and_b32 v6, 31, v2
    v_mul_u32_u24 v8, 114688, v4
    v_lshl_add_u32 v8, v6, 4, v8
    s_lshl_b32 s35, s15, 9
    v_add_u32 v8, s35, v8
    v_lshrrev_b32 v5, 3, v2
    v_lshrrev_b32 v7, 4, v2
    v_and_b32 v10, 7, v2
    v_xor_b32 v7, v7, v10
    v_lshlrev_b32 v7, 4, v7
    s_lshl_b32 s35, s14, 19
    s_lshl_b32 s36, s33, 17
    s_add_u32 s35, s35, s36
    v_lshl_add_u32 v7, v5, 11, v7
    v_add_u32 v9, s35, v7
    v_xor_b32 v10, 64, v9
    s_lshl_b32 s44, s33, 13
    s_add_u32 s44, s44, 65536
    s_lshl_b32 s36, s15, 18
    s_add_u32 s96, s36, 1048576
    v_xor_b32 v5, v6, v3
    v_lshlrev_b32 v5, 4, v5
    v_lshl_add_u32 v11, v4, 11, v5
    v_lshlrev_b32 v7, 4, v6
    v_add_u32 v7, 131072, v7
    s_lshl_b32 s45, s33, 12
    s_add_u32 s36, s96, s45
    v_lshlrev_b32 v15, 4, v2
    v_add_u32 v15, s36, v15
    v_add_u32 v20, s96, v11
    s_mov_b32 s46, 0x05010400
    s_mov_b32 s47, 0x07030602
    s_mov_b32 s58, 0x08080808
    s_mov_b32 s84, 0x05040100
    s_mov_b32 s85, 0x07060302
    s_mov_b32 s38, 0
    s_mov_b32 s39, 0
    s_mov_b32 s91, 0
    s_mov_b32 s90, 40
    s_waitcnt lgkmcnt(0)
    s_barrier
    ds_read_b128 v[40:43], v7 offset:0
    ds_read_b128 v[44:47], v7 offset:512
    ds_read_b128 v[48:51], v7 offset:1024
    ds_read_b128 v[52:55], v7 offset:1536
    ds_read_b128 v[56:59], v7 offset:2048
    ds_read_b128 v[60:63], v7 offset:2560
    ds_read_b128 v[64:67], v7 offset:3072
    ds_read_b128 v[68:71], v7 offset:3584
    s_cmp_lt_u32 s13, 4
    s_cbranch_scc1 L_prod
    s_lshl_b32 s41, s49, 14
    v_add_u32 v17, s41, v11
    s_cmp_eq_u32 s49, 0
    s_cbranch_scc1 L_p2
    s_lshl_b32 s50, s49, 2
    s_lshr_b64 s[50:51], s[82:83], s50
    s_and_b32 s50, s50, 15
    s_mul_i32 s43, s50, 917504
    tbuffer_load_format_d16_xyzw v[72:73], v8, s[20:23], s43 format:[BUF_DATA_FORMAT_32_32_32_32,BUF_NUM_FORMAT_UINT] offen
    s_add_u32 s43, s43, s97
    tbuffer_load_format_d16_xyzw v[74:75], v8, s[20:23], s43 format:[BUF_DATA_FORMAT_32_32_32_32,BUF_NUM_FORMAT_UINT] offen
    s_add_u32 s43, s43, s97
    tbuffer_load_format_d16_xyzw v[76:77], v8, s[20:23], s43 format:[BUF_DATA_FORMAT_32_32_32_32,BUF_NUM_FORMAT_UINT] offen
    s_add_u32 s43, s43, s97
    tbuffer_load_format_d16_xyzw v[78:79], v8, s[20:23], s43 format:[BUF_DATA_FORMAT_32_32_32_32,BUF_NUM_FORMAT_UINT] offen
    s_add_u32 s43, s43, s97
    tbuffer_load_format_d16_xyzw v[80:81], v8, s[20:23], s43 format:[BUF_DATA_FORMAT_32_32_32_32,BUF_NUM_FORMAT_UINT] offen
    s_add_u32 s43, s43, s97
    tbuffer_load_format_d16_xyzw v[82:83], v8, s[20:23], s43 format:[BUF_DATA_FORMAT_32_32_32_32,BUF_NUM_FORMAT_UINT] offen
    s_add_u32 s43, s43, s97
    tbuffer_load_format_d16_xyzw v[84:85], v8, s[20:23], s43 format:[BUF_DATA_FORMAT_32_32_32_32,BUF_NUM_FORMAT_UINT] offen
    s_add_u32 s43, s43, s97
    tbuffer_load_format_d16_xyzw v[86:87], v8, s[20:23], s43 format:[BUF_DATA_FORMAT_32_32_32_32,BUF_NUM_FORMAT_UINT] offen
    s_waitcnt vmcnt(8) lgkmcnt(0)
    s_barrier
    s_setprio 3
    s_add_u32 s53, s44, 32768
    s_mov_b32 m0, s53
    s_lshl_b32 s42, s50, 7
    buffer_load_dwordx4 v9, s[16:19], s42 offen offset:0 lds
    s_add_u32 s42, s42, s98
    buffer_load_dwordx4 v10, s[16:19], s42 offen offset:1024 lds
    s_add_u32 s42, s42, s98
    buffer_load_dwordx4 v9, s[16:19], s42 offen offset:2048 lds
    s_add_u32 s42, s42, s98
    buffer_load_dwordx4 v10, s[16:19], s42 offen offset:3072 lds
    s_add_u32 m0, s53, 4096
    s_add_u32 s42, s42, s99
    buffer_load_dwordx4 v9, s[16:19], s42 offen offset:0 lds
    s_add_u32 s42, s42, s98
    buffer_load_dwordx4 v10, s[16:19], s42 offen offset:1024 lds
    s_add_u32 s42, s42, s98
    buffer_load_dwordx4 v9, s[16:19], s42 offen offset:2048 lds
    s_add_u32 s42, s42, s98
    buffer_load_dwordx4 v10, s[16:19], s42 offen offset:3072 lds
    s_waitcnt vmcnt(8)
    v_lshl_or_b32 v88, v74, 8, v72
    v_lshl_or_b32 v89, v78, 8, v76
    v_perm_b32 v104, v89, v88, s84
    v_perm_b32 v110, v89, v88, s85
    v_xor_b32 v105, s58, v104
    v_xor_b32 v111, s58, v110
    v_perm_b32 v106, v41, v40, v104
    v_perm_b32 v112, v49, v48, v110
    v_perm_b32 v108, v45, v44, v104
    v_perm_b32 v114, v53, v52, v110
    v_perm_b32 v107, v43, v42, v105
    v_perm_b32 v113, v51, v50, v111
    v_perm_b32 v109, v47, v46, v105
    v_perm_b32 v115, v55, v54, v111
    v_xor_b32 v106, v106, v107
    v_xor_b32 v112, v112, v113
    v_xor_b32 v108, v108, v109
    v_xor_b32 v114, v114, v115
    v_perm_b32 v24, v108, v106, s46
    v_perm_b32 v28, v114, v112, s46
    v_perm_b32 v25, v108, v106, s47
    v_perm_b32 v29, v114, v112, s47
    v_lshl_or_b32 v88, v75, 8, v73
    v_lshl_or_b32 v89, v79, 8, v77
    v_perm_b32 v104, v89, v88, s84
    v_perm_b32 v110, v89, v88, s85
    v_xor_b32 v105, s58, v104
    v_xor_b32 v111, s58, v110
    v_perm_b32 v106, v57, v56, v104
    v_perm_b32 v112, v65, v64, v110
    v_perm_b32 v108, v61, v60, v104
    v_perm_b32 v114, v69, v68, v110
    v_perm_b32 v107, v59, v58, v105
    v_perm_b32 v113, v67, v66, v111
    v_perm_b32 v109, v63, v62, v105
    v_perm_b32 v115, v71, v70, v111
    v_xor_b32 v106, v106, v107
    v_xor_b32 v112, v112, v113
    v_xor_b32 v108, v108, v109
    v_xor_b32 v114, v114, v115
    v_perm_b32 v32, v108, v106, s46
    v_perm_b32 v36, v114, v112, s46
    v_perm_b32 v33, v108, v106, s47
    v_perm_b32 v37, v114, v112, s47
    s_branch L_p2b
L_p2:
    s_waitcnt vmcnt(5) lgkmcnt(0)
    v_lshl_or_b32 v88, v74, 8, v72
    v_lshl_or_b32 v89, v78, 8, v76
    v_perm_b32 v104, v89, v88, s84
    v_perm_b32 v110, v89, v88, s85
    v_xor_b32 v105, s58, v104
    v_xor_b32 v111, s58, v110
    v_perm_b32 v106, v41, v40, v104
    v_perm_b32 v112, v49, v48, v110
    v_perm_b32 v108, v45, v44, v104
    v_perm_b32 v114, v53, v52, v110
    v_perm_b32 v107, v43, v42, v105
    v_perm_b32 v113, v51, v50, v111
    v_perm_b32 v109, v47, v46, v105
    v_perm_b32 v115, v55, v54, v111
    v_xor_b32 v106, v106, v107
    v_xor_b32 v112, v112, v113
    v_xor_b32 v108, v108, v109
    v_xor_b32 v114, v114, v115
    v_perm_b32 v24, v108, v106, s46
    v_perm_b32 v28, v114, v112, s46
    v_perm_b32 v25, v108, v106, s47
    v_perm_b32 v29, v114, v112, s47
    v_lshl_or_b32 v88, v75, 8, v73
    v_lshl_or_b32 v89, v79, 8, v77
    v_perm_b32 v104, v89, v88, s84
    v_perm_b32 v110, v89, v88, s85
    v_xor_b32 v105, s58, v104
    v_xor_b32 v111, s58, v110
    v_perm_b32 v106, v57, v56, v104
    v_perm_b32 v112, v65, v64, v110
    v_perm_b32 v108, v61, v60, v104
    v_perm_b32 v114, v69, v68, v110
    v_perm_b32 v107, v59, v58, v105
    v_perm_b32 v113, v67, v66, v111
    v_perm_b32 v109, v63, v62, v105
    v_perm_b32 v115, v71, v70, v111
    v_xor_b32 v106, v106, v107
    v_xor_b32 v112, v112, v113
    v_xor_b32 v108, v108, v109
    v_xor_b32 v114, v114, v115
    v_perm_b32 v32, v108, v106, s46
    v_perm_b32 v36, v114, v112, s46
    v_perm_b32 v33, v108, v106, s47
    v_perm_b32 v37, v114, v112, s47
    s_waitcnt vmcnt(1)
L_p2b:
    v_lshl_or_b32 v90, v82, 8, v80
    v_lshl_or_b32 v91, v86, 8, v84
    v_perm_b32 v104, v91, v90, s84
    v_perm_b32 v110, v91, v90, s85
    v_xor_b32 v105, s58, v104
    v_xor_b32 v111, s58, v110
    v_perm_b32 v106, v41, v40, v104
    v_perm_b32 v112, v49, v48, v110
    v_perm_b32 v108, v45, v44, v104
    v_perm_b32 v114, v53, v52, v110
    v_perm_b32 v107, v43, v42, v105
    v_perm_b32 v113, v51, v50, v111
    v_perm_b32 v109, v47, v46, v105
    v_perm_b32 v115, v55, v54, v111
    v_xor_b32 v106, v106, v107
    v_xor_b32 v112, v112, v113
    v_xor_b32 v108, v108, v109
    v_xor_b32 v114, v114, v115
    v_perm_b32 v26, v108, v106, s46
    v_perm_b32 v30, v114, v112, s46
    v_perm_b32 v27, v108, v106, s47
    v_perm_b32 v31, v114, v112, s47
    v_lshl_or_b32 v90, v83, 8, v81
    v_lshl_or_b32 v91, v87, 8, v85
    v_perm_b32 v104, v91, v90, s84
    v_perm_b32 v110, v91, v90, s85
    v_xor_b32 v105, s58, v104
    v_xor_b32 v111, s58, v110
    v_perm_b32 v106, v57, v56, v104
    v_perm_b32 v112, v65, v64, v110
    v_perm_b32 v108, v61, v60, v104
    v_perm_b32 v114, v69, v68, v110
    v_perm_b32 v107, v59, v58, v105
    v_perm_b32 v113, v67, v66, v111
    v_perm_b32 v109, v63, v62, v105
    v_perm_b32 v115, v71, v70, v111
    v_xor_b32 v106, v106, v107
    v_xor_b32 v112, v112, v113
    v_xor_b32 v108, v108, v109
    v_xor_b32 v114, v114, v115
    v_perm_b32 v34, v108, v106, s46
    v_perm_b32 v38, v114, v112, s46
    v_perm_b32 v35, v108, v106, s47
    v_perm_b32 v39, v114, v112, s47
    ds_write_b128 v17, v[24:27] offset:0
    ds_write_b128 v17, v[28:31] offset:512
    ds_write_b128 v17, v[32:35] offset:1024
    ds_write_b128 v17, v[36:39] offset:1536
    s_add_u32 s55, s49, 2
    s_cmp_eq_u32 s55, 3
    s_cselect_b32 s55, 0, s55
    s_waitcnt vmcnt(0) lgkmcnt(0)
    s_barrier
    s_add_u32 s49, s49, 2
    .p2align 6
L_hloop:
    s_setprio 1
    s_lshl_b32 s50, s49, 2
    s_lshr_b64 s[50:51], s[82:83], s50
    s_and_b32 s50, s50, 15
    s_lshl_b32 s53, s55, 15
    s_add_u32 s53, s53, s44
    s_and_b32 s41, s49, 3
    s_lshl_b32 s41, s41, 14
    s_sub_u32 s35, s55, 1
    s_cselect_b32 s55, 2, s35
    s_add_u32 s92, s49, 2
    s_lshl_b32 s86, s92, 2
    s_lshr_b64 s[86:87], s[82:83], s86
    s_and_b32 s86, s86, 15
    s_xor_b32 s88, s41, 32768
    s_cmp_eq_u32 s91, 1
    s_cbranch_scc1 L_hx1
    s_bitcmp1_b32 s38, s50
    s_cbranch_scc1 L_hx
    s_cmp_lt_u32 s49, 8
    s_cbranch_scc1 L_hn
    buffer_load_dword v14, v12, s[68:71], 0 offen sc0 sc1
    s_mov_b32 m0, s53
    s_lshl_b32 s42, s50, 7
    buffer_load_dwordx4 v9, s[16:19], s42 offen offset:0 lds
    s_add_u32 s42, s42, s98
    buffer_load_dwordx4 v10, s[16:19], s42 offen offset:1024 lds
    s_add_u32 s42, s42, s98
    buffer_load_dwordx4 v9, s[16:19], s42 offen offset:2048 lds
    s_add_u32 s42, s42, s98
    buffer_load_dwordx4 v10, s[16:19], s42 offen offset:3072 lds
    s_waitcnt vmcnt(4)
    v_cmp_ne_u32 vcc, v14, v13
    s_nop 4
    s_and_b32 s35, vcc_lo, 0xffff
    s_or_b32 s38, s38, s35
    s_bitcmp1_b32 s38, s50
    s_cbranch_scc1 L_hw
    s_branch L_hn1
L_hn:
    s_mov_b32 m0, s53
    s_lshl_b32 s42, s50, 7
    buffer_load_dwordx4 v9, s[16:19], s42 offen offset:0 lds
    s_add_u32 s42, s42, s98
    buffer_load_dwordx4 v10, s[16:19], s42 offen offset:1024 lds
    s_add_u32 s42, s42, s98
    buffer_load_dwordx4 v9, s[16:19], s42 offen offset:2048 lds
    s_add_u32 s42, s42, s98
    buffer_load_dwordx4 v10, s[16:19], s42 offen offset:3072 lds
L_hn1:
    s_cmp_ge_u32 s49, 14
    s_cbranch_scc1 L_hn2
    s_add_u32 m0, s53, 4096
    s_add_u32 s42, s42, s99
    buffer_load_dwordx4 v9, s[16:19], s42 offen offset:0 lds
    s_add_u32 s42, s42, s98
    buffer_load_dwordx4 v10, s[16:19], s42 offen offset:1024 lds
    s_add_u32 s42, s42, s98
    buffer_load_dwordx4 v9, s[16:19], s42 offen offset:2048 lds
    s_add_u32 s42, s42, s98
    buffer_load_dwordx4 v10, s[16:19], s42 offen offset:3072 lds
L_hn2:
    s_mov_b32 s54, 2
    s_mul_i32 s43, s50, 917504
    tbuffer_load_format_d16_xyzw v[72:73], v8, s[20:23], s43 format:[BUF_DATA_FORMAT_32_32_32_32,BUF_NUM_FORMAT_UINT] offen
    s_add_u32 s43, s43, s97
    tbuffer_load_format_d16_xyzw v[74:75], v8, s[20:23], s43 format:[BUF_DATA_FORMAT_32_32_32_32,BUF_NUM_FORMAT_UINT] offen
    s_add_u32 s43, s43, s97
    tbuffer_load_format_d16_xyzw v[76:77], v8, s[20:23], s43 format:[BUF_DATA_FORMAT_32_32_32_32,BUF_NUM_FORMAT_UINT] offen
    s_add_u32 s43, s43, s97
    tbuffer_load_format_d16_xyzw v[78:79], v8, s[20:23], s43 format:[BUF_DATA_FORMAT_32_32_32_32,BUF_NUM_FORMAT_UINT] offen
    s_add_u32 s43, s43, s97
    tbuffer_load_format_d16_xyzw v[80:81], v8, s[20:23], s43 format:[BUF_DATA_FORMAT_32_32_32_32,BUF_NUM_FORMAT_UINT] offen
    s_add_u32 s43, s43, s97
    tbuffer_load_format_d16_xyzw v[82:83], v8, s[20:23], s43 format:[BUF_DATA_FORMAT_32_32_32_32,BUF_NUM_FORMAT_UINT] offen
    s_add_u32 s43, s43, s97
    tbuffer_load_format_d16_xyzw v[84:85], v8, s[20:23], s43 format:[BUF_DATA_FORMAT_32_32_32_32,BUF_NUM_FORMAT_UINT] offen
    s_add_u32 s43, s43, s97
    tbuffer_load_format_d16_xyzw v[86:87], v8, s[20:23], s43 format:[BUF_DATA_FORMAT_32_32_32_32,BUF_NUM_FORMAT_UINT] offen
    s_branch L_hp
L_hx:
    s_lshl_b32 s43, s50, 14
    s_add_u32 m0, s45, s41
    s_nop 0
    buffer_load_dwordx4 v15, s[68:71], s43 offen offset:0 sc1 lds
    buffer_load_dwordx4 v15, s[68:71], s43 offen offset:1024 sc1 lds
    buffer_load_dwordx4 v15, s[68:71], s43 offen offset:2048 sc1 lds
    buffer_load_dwordx4 v15, s[68:71], s43 offen offset:3072 sc1 lds
L_hx1:
    s_mov_b32 m0, s53
    s_lshl_b32 s42, s50, 7
    buffer_load_dwordx4 v9, s[16:19], s42 offen offset:0 lds
    s_add_u32 s42, s42, s98
    buffer_load_dwordx4 v10, s[16:19], s42 offen offset:1024 lds
    s_add_u32 s42, s42, s98
    buffer_load_dwordx4 v9, s[16:19], s42 offen offset:2048 lds
    s_add_u32 s42, s42, s98
    buffer_load_dwordx4 v10, s[16:19], s42 offen offset:3072 lds
    s_branch L_hw1
L_hw:
    s_lshl_b32 s43, s50, 14
    s_add_u32 m0, s45, s41
    s_nop 0
    buffer_load_dwordx4 v15, s[68:71], s43 offen offset:0 sc1 lds
    buffer_load_dwordx4 v15, s[68:71], s43 offen offset:1024 sc1 lds
    buffer_load_dwordx4 v15, s[68:71], s43 offen offset:2048 sc1 lds
    buffer_load_dwordx4 v15, s[68:71], s43 offen offset:3072 sc1 lds
L_hw1:
    s_mov_b32 s54, 0
L_hy:
    s_cmp_ge_u32 s49, 14
    s_cbranch_scc1 L_hb
    s_add_u32 m0, s53, 4096
    s_add_u32 s42, s42, s99
    buffer_load_dwordx4 v9, s[16:19], s42 offen offset:0 lds
    s_add_u32 s42, s42, s98
    buffer_load_dwordx4 v10, s[16:19], s42 offen offset:1024 lds
    s_add_u32 s42, s42, s98
    buffer_load_dwordx4 v9, s[16:19], s42 offen offset:2048 lds
    s_add_u32 s42, s42, s98
    buffer_load_dwordx4 v10, s[16:19], s42 offen offset:3072 lds
L_hp:
    s_sub_u32 s35, s92, 8
    s_cmp_ge_u32 s35, 8
    s_cbranch_scc1 L_hb
    s_bitcmp1_b32 s38, s86
    s_cbranch_scc1 L_hb
    buffer_load_dword v14, v12, s[68:71], 0 offen sc0 sc1
    s_or_b32 s54, s54, 4
L_hb:
    s_barrier
    s_mov_b32 s91, 0
    s_cmp_lt_u32 s49, 14
    s_cbranch_scc1 L_hb2
    s_cmp_lg_u32 s54, 0
    s_cbranch_scc1 L_hb2
    s_cmp_eq_u32 s49, 15
    s_cselect_b32 s35, 28672, 0
    s_add_u32 s53, s53, s35
    s_add_u32 m0, s53, 4096
    s_add_u32 s42, s42, s99
    buffer_load_dwordx4 v9, s[16:19], s42 offen offset:0 lds
    s_add_u32 s42, s42, s98
    buffer_load_dwordx4 v10, s[16:19], s42 offen offset:1024 lds
    s_add_u32 s42, s42, s98
    buffer_load_dwordx4 v9, s[16:19], s42 offen offset:2048 lds
    s_add_u32 s42, s42, s98
    buffer_load_dwordx4 v10, s[16:19], s42 offen offset:3072 lds
    s_waitcnt vmcnt(4)
    s_barrier
    s_waitcnt vmcnt(0)
    s_barrier
    s_branch L_hend
L_hb2:
    s_and_b32 s35, s54, 3
    s_cbranch_scc0 L_hf
L_hq:
    v_add_u32 v17, s41, v11
    s_setprio 2
    s_waitcnt vmcnt(4)
    v_lshl_or_b32 v88, v74, 8, v72
    v_lshl_or_b32 v89, v78, 8, v76
    v_perm_b32 v104, v89, v88, s84
    v_perm_b32 v110, v89, v88, s85
    v_xor_b32 v105, s58, v104
    v_xor_b32 v111, s58, v110
    v_perm_b32 v106, v41, v40, v104
    v_perm_b32 v112, v49, v48, v110
    v_perm_b32 v108, v45, v44, v104
    v_perm_b32 v114, v53, v52, v110
    v_perm_b32 v107, v43, v42, v105
    v_perm_b32 v113, v51, v50, v111
    v_perm_b32 v109, v47, v46, v105
    v_perm_b32 v115, v55, v54, v111
    v_xor_b32 v106, v106, v107
    v_xor_b32 v112, v112, v113
    v_xor_b32 v108, v108, v109
    v_xor_b32 v114, v114, v115
    v_perm_b32 v24, v108, v106, s46
    v_perm_b32 v28, v114, v112, s46
    v_perm_b32 v25, v108, v106, s47
    v_perm_b32 v29, v114, v112, s47
    v_lshl_or_b32 v88, v75, 8, v73
    v_lshl_or_b32 v89, v79, 8, v77
    v_perm_b32 v104, v89, v88, s84
    v_perm_b32 v110, v89, v88, s85
    v_xor_b32 v105, s58, v104
    v_xor_b32 v111, s58, v110
    v_perm_b32 v106, v57, v56, v104
    v_perm_b32 v112, v65, v64, v110
    v_perm_b32 v108, v61, v60, v104
    v_perm_b32 v114, v69, v68, v110
    v_perm_b32 v107, v59, v58, v105
    v_perm_b32 v113, v67, v66, v111
    v_perm_b32 v109, v63, v62, v105
    v_perm_b32 v115, v71, v70, v111
    v_xor_b32 v106, v106, v107
    v_xor_b32 v112, v112, v113
    v_xor_b32 v108, v108, v109
    v_xor_b32 v114, v114, v115
    v_perm_b32 v32, v108, v106, s46
    v_perm_b32 v36, v114, v112, s46
    v_perm_b32 v33, v108, v106, s47
    v_perm_b32 v37, v114, v112, s47
    s_bitcmp1_b32 s54, 2
    s_cbranch_scc1 L_hq1
    s_waitcnt vmcnt(0)
L_hq1:
    s_waitcnt vmcnt(1)
    v_lshl_or_b32 v90, v82, 8, v80
    v_lshl_or_b32 v91, v86, 8, v84
    v_perm_b32 v104, v91, v90, s84
    v_perm_b32 v110, v91, v90, s85
    v_xor_b32 v105, s58, v104
    v_xor_b32 v111, s58, v110
    v_perm_b32 v106, v41, v40, v104
    v_perm_b32 v112, v49, v48, v110
    v_perm_b32 v108, v45, v44, v104
    v_perm_b32 v114, v53, v52, v110
    v_perm_b32 v107, v43, v42, v105
    v_perm_b32 v113, v51, v50, v111
    v_perm_b32 v109, v47, v46, v105
    v_perm_b32 v115, v55, v54, v111
    v_xor_b32 v106, v106, v107
    v_xor_b32 v112, v112, v113
    v_xor_b32 v108, v108, v109
    v_xor_b32 v114, v114, v115
    v_perm_b32 v26, v108, v106, s46
    v_perm_b32 v30, v114, v112, s46
    v_perm_b32 v27, v108, v106, s47
    v_perm_b32 v31, v114, v112, s47
    v_lshl_or_b32 v90, v83, 8, v81
    v_lshl_or_b32 v91, v87, 8, v85
    v_perm_b32 v104, v91, v90, s84
    v_perm_b32 v110, v91, v90, s85
    v_xor_b32 v105, s58, v104
    v_xor_b32 v111, s58, v110
    v_perm_b32 v106, v57, v56, v104
    v_perm_b32 v112, v65, v64, v110
    v_perm_b32 v108, v61, v60, v104
    v_perm_b32 v114, v69, v68, v110
    v_perm_b32 v107, v59, v58, v105
    v_perm_b32 v113, v67, v66, v111
    v_perm_b32 v109, v63, v62, v105
    v_perm_b32 v115, v71, v70, v111
    v_xor_b32 v106, v106, v107
    v_xor_b32 v112, v112, v113
    v_xor_b32 v108, v108, v109
    v_xor_b32 v114, v114, v115
    v_perm_b32 v34, v108, v106, s46
    v_perm_b32 v38, v114, v112, s46
    v_perm_b32 v35, v108, v106, s47
    v_perm_b32 v39, v114, v112, s47
    ds_write_b128 v17, v[24:27] offset:0
    ds_write_b128 v17, v[28:31] offset:512
    ds_write_b128 v17, v[32:35] offset:1024
    ds_write_b128 v17, v[36:39] offset:1536
L_hg:
    s_bitcmp1_b32 s54, 2
    s_cbranch_scc0 L_hf0
    s_waitcnt vmcnt(0)
    v_cmp_ne_u32 vcc, v14, v13
    s_nop 4
    s_and_b32 s35, vcc_lo, 0xffff
    s_or_b32 s38, s38, s35
    s_branch L_hf0
L_hf:
    s_bitcmp1_b32 s54, 2
    s_cbranch_scc0 L_hf1
    s_waitcnt vmcnt(0)
    v_cmp_ne_u32 vcc, v14, v13
    s_nop 4
    s_and_b32 s35, vcc_lo, 0xffff
    s_or_b32 s38, s38, s35
L_hf1:
    s_cmp_ge_u32 s92, 16
    s_cbranch_scc1 L_hf0
    s_bitcmp1_b32 s38, s86
    s_cbranch_scc0 L_hf0
    s_lshl_b32 s43, s86, 14
    s_add_u32 m0, s45, s88
    s_nop 0
    buffer_load_dwordx4 v15, s[68:71], s43 offen offset:0 sc1 lds
    buffer_load_dwordx4 v15, s[68:71], s43 offen offset:1024 sc1 lds
    buffer_load_dwordx4 v15, s[68:71], s43 offen offset:2048 sc1 lds
    buffer_load_dwordx4 v15, s[68:71], s43 offen offset:3072 sc1 lds
    s_mov_b32 s91, 1
    s_waitcnt vmcnt(4) lgkmcnt(0)
    s_branch L_hz
L_hf0:
    s_waitcnt vmcnt(0) lgkmcnt(0)
L_hz:
    s_barrier
    s_mov_b32 s49, s92
    s_cmp_lt_u32 s49, 16
    s_cbranch_scc1 L_hloop
    s_cmp_eq_u32 s49, 17
    s_cselect_b32 s35, 28672, 0
    s_add_u32 s53, s53, s35
    s_add_u32 m0, s53, 4096
    s_add_u32 s42, s42, s99
    buffer_load_dwordx4 v9, s[16:19], s42 offen offset:0 lds
    s_add_u32 s42, s42, s98
    buffer_load_dwordx4 v10, s[16:19], s42 offen offset:1024 lds
    s_add_u32 s42, s42, s98
    buffer_load_dwordx4 v9, s[16:19], s42 offen offset:2048 lds
    s_add_u32 s42, s42, s98
    buffer_load_dwordx4 v10, s[16:19], s42 offen offset:3072 lds
    s_waitcnt vmcnt(0)
    s_barrier
L_hend:
    s_endpgm
L_prod:
    s_lshl_b32 s50, s49, 2
    s_lshr_b64 s[50:51], s[82:83], s50
    s_and_b32 s50, s50, 15
    s_mul_i32 s43, s50, 917504
    tbuffer_load_format_d16_xyzw v[72:73], v8, s[20:23], s43 format:[BUF_DATA_FORMAT_32_32_32_32,BUF_NUM_FORMAT_UINT] offen
    s_add_u32 s43, s43, s97
    tbuffer_load_format_d16_xyzw v[74:75], v8, s[20:23], s43 format:[BUF_DATA_FORMAT_32_32_32_32,BUF_NUM_FORMAT_UINT] offen
    s_add_u32 s43, s43, s97
    tbuffer_load_format_d16_xyzw v[76:77], v8, s[20:23], s43 format:[BUF_DATA_FORMAT_32_32_32_32,BUF_NUM_FORMAT_UINT] offen
    s_add_u32 s43, s43, s97
    tbuffer_load_format_d16_xyzw v[78:79], v8, s[20:23], s43 format:[BUF_DATA_FORMAT_32_32_32_32,BUF_NUM_FORMAT_UINT] offen
    s_add_u32 s43, s43, s97
    tbuffer_load_format_d16_xyzw v[80:81], v8, s[20:23], s43 format:[BUF_DATA_FORMAT_32_32_32_32,BUF_NUM_FORMAT_UINT] offen
    s_add_u32 s43, s43, s97
    tbuffer_load_format_d16_xyzw v[82:83], v8, s[20:23], s43 format:[BUF_DATA_FORMAT_32_32_32_32,BUF_NUM_FORMAT_UINT] offen
    s_add_u32 s43, s43, s97
    tbuffer_load_format_d16_xyzw v[84:85], v8, s[20:23], s43 format:[BUF_DATA_FORMAT_32_32_32_32,BUF_NUM_FORMAT_UINT] offen
    s_add_u32 s43, s43, s97
    tbuffer_load_format_d16_xyzw v[86:87], v8, s[20:23], s43 format:[BUF_DATA_FORMAT_32_32_32_32,BUF_NUM_FORMAT_UINT] offen
    s_waitcnt vmcnt(4) lgkmcnt(0)
    v_lshl_or_b32 v88, v74, 8, v72
    v_lshl_or_b32 v89, v78, 8, v76
    v_perm_b32 v104, v89, v88, s84
    v_perm_b32 v110, v89, v88, s85
    v_xor_b32 v105, s58, v104
    v_xor_b32 v111, s58, v110
    v_perm_b32 v106, v41, v40, v104
    v_perm_b32 v112, v49, v48, v110
    v_perm_b32 v108, v45, v44, v104
    v_perm_b32 v114, v53, v52, v110
    v_perm_b32 v107, v43, v42, v105
    v_perm_b32 v113, v51, v50, v111
    v_perm_b32 v109, v47, v46, v105
    v_perm_b32 v115, v55, v54, v111
    v_xor_b32 v106, v106, v107
    v_xor_b32 v112, v112, v113
    v_xor_b32 v108, v108, v109
    v_xor_b32 v114, v114, v115
    v_perm_b32 v24, v108, v106, s46
    v_perm_b32 v28, v114, v112, s46
    v_perm_b32 v25, v108, v106, s47
    v_perm_b32 v29, v114, v112, s47
    v_lshl_or_b32 v88, v75, 8, v73
    v_lshl_or_b32 v89, v79, 8, v77
    v_perm_b32 v104, v89, v88, s84
    v_perm_b32 v110, v89, v88, s85
    v_xor_b32 v105, s58, v104
    v_xor_b32 v111, s58, v110
    v_perm_b32 v106, v57, v56, v104
    v_perm_b32 v112, v65, v64, v110
    v_perm_b32 v108, v61, v60, v104
    v_perm_b32 v114, v69, v68, v110
    v_perm_b32 v107, v59, v58, v105
    v_perm_b32 v113, v67, v66, v111
    v_perm_b32 v109, v63, v62, v105
    v_perm_b32 v115, v71, v70, v111
    v_xor_b32 v106, v106, v107
    v_xor_b32 v112, v112, v113
    v_xor_b32 v108, v108, v109
    v_xor_b32 v114, v114, v115
    v_perm_b32 v32, v108, v106, s46
    v_perm_b32 v36, v114, v112, s46
    v_perm_b32 v33, v108, v106, s47
    v_perm_b32 v37, v114, v112, s47
    s_waitcnt vmcnt(0)
L_ploop:
    v_lshl_or_b32 v90, v82, 8, v80
    v_lshl_or_b32 v91, v86, 8, v84
    v_perm_b32 v104, v91, v90, s84
    v_perm_b32 v110, v91, v90, s85
    v_xor_b32 v105, s58, v104
    v_xor_b32 v111, s58, v110
    v_perm_b32 v106, v41, v40, v104
    v_perm_b32 v112, v49, v48, v110
    v_perm_b32 v108, v45, v44, v104
    v_perm_b32 v114, v53, v52, v110
    v_perm_b32 v107, v43, v42, v105
    v_perm_b32 v113, v51, v50, v111
    v_perm_b32 v109, v47, v46, v105
    v_perm_b32 v115, v55, v54, v111
    v_xor_b32 v106, v106, v107
    v_xor_b32 v112, v112, v113
    v_xor_b32 v108, v108, v109
    v_xor_b32 v114, v114, v115
    v_perm_b32 v26, v108, v106, s46
    v_perm_b32 v30, v114, v112, s46
    v_perm_b32 v27, v108, v106, s47
    v_perm_b32 v31, v114, v112, s47
    v_lshl_or_b32 v90, v83, 8, v81
    v_lshl_or_b32 v91, v87, 8, v85
    v_perm_b32 v104, v91, v90, s84
    v_perm_b32 v110, v91, v90, s85
    v_xor_b32 v105, s58, v104
    v_xor_b32 v111, s58, v110
    v_perm_b32 v106, v57, v56, v104
    v_perm_b32 v112, v65, v64, v110
    v_perm_b32 v108, v61, v60, v104
    v_perm_b32 v114, v69, v68, v110
    v_perm_b32 v107, v59, v58, v105
    v_perm_b32 v113, v67, v66, v111
    v_perm_b32 v109, v63, v62, v105
    v_perm_b32 v115, v71, v70, v111
    v_xor_b32 v106, v106, v107
    v_xor_b32 v112, v112, v113
    v_xor_b32 v108, v108, v109
    v_xor_b32 v114, v114, v115
    v_perm_b32 v34, v108, v106, s46
    v_perm_b32 v38, v114, v112, s46
    v_perm_b32 v35, v108, v106, s47
    v_perm_b32 v39, v114, v112, s47
    s_lshl_b32 s52, s50, 14
    s_lshl_b64 s[36:37], 1, s50
    buffer_store_dwordx4 v[24:27], v20, s[68:71], s52 offen offset:0 sc1
    buffer_store_dwordx4 v[28:31], v20, s[68:71], s52 offen offset:512 sc1
    buffer_store_dwordx4 v[32:35], v20, s[68:71], s52 offen offset:1024 sc1
    buffer_store_dwordx4 v[36:39], v20, s[68:71], s52 offen offset:1536 sc1
    v_not_b32 v16, v13
    s_add_u32 s49, s49, 2
    s_cmp_ge_u32 s49, 16
    s_cbranch_scc1 L_plast
    s_lshl_b32 s50, s49, 2
    s_lshr_b64 s[50:51], s[82:83], s50
    s_and_b32 s50, s50, 15
    s_mul_i32 s43, s50, 917504
    tbuffer_load_format_d16_xyzw v[72:73], v8, s[20:23], s43 format:[BUF_DATA_FORMAT_32_32_32_32,BUF_NUM_FORMAT_UINT] offen
    s_add_u32 s43, s43, s97
    tbuffer_load_format_d16_xyzw v[74:75], v8, s[20:23], s43 format:[BUF_DATA_FORMAT_32_32_32_32,BUF_NUM_FORMAT_UINT] offen
    s_add_u32 s43, s43, s97
    tbuffer_load_format_d16_xyzw v[76:77], v8, s[20:23], s43 format:[BUF_DATA_FORMAT_32_32_32_32,BUF_NUM_FORMAT_UINT] offen
    s_add_u32 s43, s43, s97
    tbuffer_load_format_d16_xyzw v[78:79], v8, s[20:23], s43 format:[BUF_DATA_FORMAT_32_32_32_32,BUF_NUM_FORMAT_UINT] offen
    s_add_u32 s43, s43, s97
    tbuffer_load_format_d16_xyzw v[80:81], v8, s[20:23], s43 format:[BUF_DATA_FORMAT_32_32_32_32,BUF_NUM_FORMAT_UINT] offen
    s_add_u32 s43, s43, s97
    tbuffer_load_format_d16_xyzw v[82:83], v8, s[20:23], s43 format:[BUF_DATA_FORMAT_32_32_32_32,BUF_NUM_FORMAT_UINT] offen
    s_add_u32 s43, s43, s97
    tbuffer_load_format_d16_xyzw v[84:85], v8, s[20:23], s43 format:[BUF_DATA_FORMAT_32_32_32_32,BUF_NUM_FORMAT_UINT] offen
    s_add_u32 s43, s43, s97
    tbuffer_load_format_d16_xyzw v[86:87], v8, s[20:23], s43 format:[BUF_DATA_FORMAT_32_32_32_32,BUF_NUM_FORMAT_UINT] offen
    s_waitcnt vmcnt(8)
    s_mov_b64 exec, s[36:37]
    buffer_store_dword v16, v12, s[68:71], 0 offen  sc0 sc1
    s_mov_b64 exec, -1
    s_waitcnt vmcnt(5)
    v_lshl_or_b32 v88, v74, 8, v72
    v_lshl_or_b32 v89, v78, 8, v76
    v_perm_b32 v104, v89, v88, s84
    v_perm_b32 v110, v89, v88, s85
    v_xor_b32 v105, s58, v104
    v_xor_b32 v111, s58, v110
    v_perm_b32 v106, v41, v40, v104
    v_perm_b32 v112, v49, v48, v110
    v_perm_b32 v108, v45, v44, v104
    v_perm_b32 v114, v53, v52, v110
    v_perm_b32 v107, v43, v42, v105
    v_perm_b32 v113, v51, v50, v111
    v_perm_b32 v109, v47, v46, v105
    v_perm_b32 v115, v55, v54, v111
    v_xor_b32 v106, v106, v107
    v_xor_b32 v112, v112, v113
    v_xor_b32 v108, v108, v109
    v_xor_b32 v114, v114, v115
    v_perm_b32 v24, v108, v106, s46
    v_perm_b32 v28, v114, v112, s46
    v_perm_b32 v25, v108, v106, s47
    v_perm_b32 v29, v114, v112, s47
    v_lshl_or_b32 v88, v75, 8, v73
    v_lshl_or_b32 v89, v79, 8, v77
    v_perm_b32 v104, v89, v88, s84
    v_perm_b32 v110, v89, v88, s85
    v_xor_b32 v105, s58, v104
    v_xor_b32 v111, s58, v110
    v_perm_b32 v106, v57, v56, v104
    v_perm_b32 v112, v65, v64, v110
    v_perm_b32 v108, v61, v60, v104
    v_perm_b32 v114, v69, v68, v110
    v_perm_b32 v107, v59, v58, v105
    v_perm_b32 v113, v67, v66, v111
    v_perm_b32 v109, v63, v62, v105
    v_perm_b32 v115, v71, v70, v111
    v_xor_b32 v106, v106, v107
    v_xor_b32 v112, v112, v113
    v_xor_b32 v108, v108, v109
    v_xor_b32 v114, v114, v115
    v_perm_b32 v32, v108, v106, s46
    v_perm_b32 v36, v114, v112, s46
    v_perm_b32 v33, v108, v106, s47
    v_perm_b32 v37, v114, v112, s47
    s_waitcnt vmcnt(1)
    s_branch L_ploop
L_plast:
    s_waitcnt vmcnt(0)
    s_mov_b64 exec, s[36:37]
    buffer_store_dword v16, v12, s[68:71], 0 offen  sc0 sc1
    s_mov_b64 exec, -1
    s_endpgm
    .p2align 7
    .type L_sched,@object
L_sched:
    .size L_sched, 256
    .long 0x76543210, 0xfedcba98
    .long 0x47650321, 0xefcdab89
    .long 0x54761032, 0xfedcba98
    .long 0x65472103, 0xefcdab89
    .long 0x76543210, 0xefcdab89
    .long 0x73654021, 0xfedcba98
    .long 0x74365102, 0xefcdab89
    .long 0x75436210, 0xfedcba98
    .long 0x76543210, 0xfedcba98
    .long 0x67254301, 0xefcdab89
    .long 0x76325410, 0xfedcba98
    .long 0x67432501, 0xefcdab89
    .long 0x76543210, 0xefcdab89
    .long 0x57614320, 0xfedcba98
    .long 0x65721430, 0xefcdab89
    .long 0x76532140, 0xfedcba98
    .long 0x76543210, 0xfedcba98
    .long 0x47650321, 0xfedcba98
    .long 0x54761032, 0xfedcba98
    .long 0x65472103, 0xfedcba98
    .long 0x76543210, 0xfedcba98
    .long 0x73654021, 0xfedcba98
    .long 0x74365102, 0xfedcba98
    .long 0x75436210, 0xfedcba98
    .long 0x76543210, 0xfedcba98
    .long 0x67254301, 0xfedcba98
    .long 0x76325410, 0xfedcba98
    .long 0x67432501, 0xfedcba98
    .long 0x76543210, 0xfedcba98
    .long 0x57614320, 0xfedcba98
    .long 0x65721430, 0xfedcba98
    .long 0x76532140, 0xfedcba98
    .fill 64, 4, 0xbf800000
.section .rodata,"a"
.p2align 6
.amdhsa_kernel standalone__weight_only_int_squeezellm__prompt_kernel
  .amdhsa_next_free_vgpr 168
  .amdhsa_next_free_sgpr 102
  .amdhsa_accum_offset 168
  .amdhsa_group_segment_fixed_size 0
  .amdhsa_kernarg_size 48
  .amdhsa_user_sgpr_count 2
  .amdhsa_user_sgpr_kernarg_segment_ptr 1
  .amdhsa_system_sgpr_workgroup_id_x 1
.end_amdhsa_kernel
```

```asm
; @launch grid=(256,1,1) block=(768,1,1) lds=163840
.amdgcn_target "amdgcn-amd-amdhsa--gfx950"
.text
.p2align 9
.fill 64, 4, 0xbf800000
.globl standalone__weight_only_int_squeezellm__prompt_kernel
.p2align 8
.type standalone__weight_only_int_squeezellm__prompt_kernel,@function
standalone__weight_only_int_squeezellm__prompt_kernel:
    v_lshrrev_b32 v1, 6, v0
    s_load_dwordx8 s[4:11], s[0:1], 0
    v_readfirstlane_b32 s32, v1
    s_lshr_b32 s13, s2, 3
    s_cmp_ge_u32 s13, 32
    s_cbranch_scc1 L_done
    s_load_dwordx2 s[56:57], s[0:1], 40
    v_and_b32 v2, 63, v0
    s_cmp_ge_u32 s32, 8
    s_cbranch_scc1 L_h1
    s_sub_u32 s14, s13, 4
    s_lshr_b32 s15, s14, 2
    s_and_b32 s14, s14, 3
    s_and_b32 s16, s2, 1
    s_lshl2_add_u32 s14, s16, s14
    s_cmp_lt_u32 s13, 4
    s_cselect_b32 s15, s14, s15
    s_cmp_eq_u32 s15, 7
    s_cbranch_scc1 L_done
    s_bfe_u32 s16, s2, 0x20001
    s_mul_i32 s16, s16, 7
    s_add_u32 s15, s15, s16
    s_and_b32 s33, s32, 3
    s_cmp_ge_u32 s32, 4
    s_cbranch_scc1 L_h0
    s_getpc_b64 s[50:51]
    s_and_b32 s12, s13, 7
    s_mul_i32 s12, s12, 13
    v_add_lshl_u32 v1, v0, s12, 7
    v_cmp_gt_u32 vcc, 13, v0
    s_and_saveexec_b64 s[54:55], vcc
    s_cbranch_execz L_cw
    global_load_dword v39, v1, s[50:51] offset:512
L_cw:
    s_mov_b64 exec, s[54:55]
    v_lshrrev_b32 v5, 3, v2
    v_and_b32 v7, 7, v2
    v_mul_u32_u24 v5, 7168, v5
    v_lshl_add_u32 v5, v7, 4, v5
    s_and_b32 s36, s32, 1
    s_lshl1_add_u32 s35, s15, s36
    s_lshl_b32 s35, s35, 7
    s_add_u32 s36, s35, 56320
    s_lshl_b32 s37, s32, 11
    s_add_u32 m0, s37, 135168
    s_mov_b32 s26, 114688
    s_mov_b32 s27, 0x20000
    s_setprio 3
    s_waitcnt lgkmcnt(0)
    s_mov_b64 s[24:25], s[8:9]
    buffer_load_dwordx4 v5, s[24:27], s35 offen lds
    buffer_load_dwordx4 v5, s[24:27], s36 offen offset:1024 lds
    s_branch L_mfma
L_h0:
    s_and_b32 s48, s15, 3
    s_lshr_b32 s59, s15, 2
    s_add_u32 s59, s59, s14
    s_and_b32 s59, s59, 3
    s_lshl2_add_u32 s48, s48, s59
    s_lshl_b32 s50, s48, 1
    s_lshr_b32 s50, 0x4424e4, s50
    s_and_b32 s50, s50, 3
    v_lshrrev_b32 v3, 5, v2
    s_lshl_b32 s35, s33, 1
    v_add_u32 v4, s35, v3
    v_and_b32 v6, 31, v2
    v_mul_u32_u24 v8, 114688, v4
    v_lshl_add_u32 v8, v6, 4, v8
    s_lshl_b32 s35, s15, 9
    v_add_u32 v8, s35, v8
    s_mov_b32 s22, 14680064
    s_mov_b32 s23, 0x20000
    s_movk_i32 s97, 14336
    s_mul_i32 s43, s50, 917504
    s_setprio 2
    s_waitcnt lgkmcnt(0)
    s_mov_b64 s[20:21], s[6:7]
    s_cmp_lt_u32 s13, 4
    s_cbranch_scc1 L_e2
    tbuffer_load_format_d16_xyzw v[72:73], v8, s[20:23], s43 format:[BUF_DATA_FORMAT_32_32_32_32,BUF_NUM_FORMAT_UINT] offen
    s_add_u32 s43, s43, s97
    tbuffer_load_format_d16_xyzw v[74:75], v8, s[20:23], s43 format:[BUF_DATA_FORMAT_32_32_32_32,BUF_NUM_FORMAT_UINT] offen
    s_add_u32 s43, s43, s97
    tbuffer_load_format_d16_xyzw v[76:77], v8, s[20:23], s43 format:[BUF_DATA_FORMAT_32_32_32_32,BUF_NUM_FORMAT_UINT] offen
    s_add_u32 s43, s43, s97
    tbuffer_load_format_d16_xyzw v[78:79], v8, s[20:23], s43 format:[BUF_DATA_FORMAT_32_32_32_32,BUF_NUM_FORMAT_UINT] offen
    s_add_u32 s43, s43, s97
    tbuffer_load_format_d16_xyzw v[80:81], v8, s[20:23], s43 format:[BUF_DATA_FORMAT_32_32_32_32,BUF_NUM_FORMAT_UINT] offen
    s_add_u32 s43, s43, s97
    tbuffer_load_format_d16_xyzw v[82:83], v8, s[20:23], s43 format:[BUF_DATA_FORMAT_32_32_32_32,BUF_NUM_FORMAT_UINT] offen
    s_add_u32 s43, s43, s97
    tbuffer_load_format_d16_xyzw v[84:85], v8, s[20:23], s43 format:[BUF_DATA_FORMAT_32_32_32_32,BUF_NUM_FORMAT_UINT] offen
    s_add_u32 s43, s43, s97
    tbuffer_load_format_d16_xyzw v[86:87], v8, s[20:23], s43 format:[BUF_DATA_FORMAT_32_32_32_32,BUF_NUM_FORMAT_UINT] offen
    s_branch L_e2
    .p2align 9
L_h1:
    s_sub_u32 s14, s13, 4
    s_lshr_b32 s15, s14, 2
    s_and_b32 s14, s14, 3
    s_and_b32 s16, s2, 1
    s_lshl2_add_u32 s14, s16, s14
    s_cmp_lt_u32 s13, 4
    s_cselect_b32 s15, s14, s15
    s_cmp_eq_u32 s15, 7
    s_cbranch_scc1 L_done
    s_bfe_u32 s16, s2, 0x20001
    s_mul_i32 s16, s16, 7
    s_add_u32 s15, s15, s16
    s_and_b32 s33, s32, 3
    s_and_b32 s48, s15, 3
    s_lshr_b32 s59, s15, 2
    s_add_u32 s59, s59, s14
    s_and_b32 s59, s59, 3
    s_lshl2_add_u32 s48, s48, s59
    s_lshl_b32 s50, s48, 1
    s_lshr_b32 s50, 0x4424e4, s50
    s_and_b32 s50, s50, 3
    v_lshrrev_b32 v5, 3, v2
    v_lshrrev_b32 v7, 4, v2
    v_and_b32 v10, 7, v2
    v_xor_b32 v7, v7, v10
    v_lshlrev_b32 v7, 4, v7
    s_lshl_b32 s35, s14, 19
    s_lshl_b32 s36, s33, 17
    s_add_u32 s35, s35, s36
    v_lshl_add_u32 v7, v5, 11, v7
    v_add_u32 v9, s35, v7
    v_xor_b32 v10, 64, v9
    s_lshl_b32 s44, s33, 13
    s_add_u32 s44, s44, 65536
    s_mov_b32 s18, 4194304
    s_mov_b32 s19, 0x20000
    s_movk_i32 s98, 15360
    s_movk_i32 s99, 19456
    s_mov_b32 s53, s44
    s_mov_b32 m0, s53
    s_lshl_b32 s42, s50, 7
    s_setprio 1
    s_waitcnt lgkmcnt(0)
    s_mov_b64 s[16:17], s[4:5]
    s_cmp_lt_u32 s13, 4
    s_cbranch_scc1 L_e2
    buffer_load_dwordx4 v9, s[16:19], s42 offen offset:0 lds
    s_add_u32 s42, s42, s98
    buffer_load_dwordx4 v10, s[16:19], s42 offen offset:1024 lds
    s_add_u32 s42, s42, s98
    buffer_load_dwordx4 v9, s[16:19], s42 offen offset:2048 lds
    s_add_u32 s42, s42, s98
    buffer_load_dwordx4 v10, s[16:19], s42 offen offset:3072 lds
    s_add_u32 m0, s53, 4096
    s_add_u32 s42, s42, s99
    buffer_load_dwordx4 v9, s[16:19], s42 offen offset:0 lds
    s_add_u32 s42, s42, s98
    buffer_load_dwordx4 v10, s[16:19], s42 offen offset:1024 lds
    s_add_u32 s42, s42, s98
    buffer_load_dwordx4 v9, s[16:19], s42 offen offset:2048 lds
    s_add_u32 s42, s42, s98
    buffer_load_dwordx4 v10, s[16:19], s42 offen offset:3072 lds
    s_branch L_e2
L_mfma:
    s_mov_b32 s36, m0
    s_lshr_b32 s37, s32, 1
    s_add_u32 s36, s36, s37
    v_lshlrev_b32 v7, 1, v2
    v_add_u32 v7, s36, v7
    v_and_b32 v3, 127, v0
    v_and_b32 v6, 3, v3
    v_lshlrev_b32 v6, 1, v6
    v_add_u32 v6, s37, v6
    v_lshrrev_b32 v3, 2, v3
    v_lshl_add_u32 v6, v6, 5, v3
    v_lshlrev_b32 v6, 4, v6
    v_add_u32 v6, 131072, v6
    s_mov_b32 s45, 0x0b0a0908
    s_mov_b32 s54, 0xffffff00
    s_waitcnt vmcnt(0)
    ds_read_u8 v40, v7 offset:0
    ds_read_u8 v41, v7 offset:128
    ds_read_u8 v42, v7 offset:256
    ds_read_u8 v43, v7 offset:384
    ds_read_u8 v44, v7 offset:512
    ds_read_u8 v45, v7 offset:640
    ds_read_u8 v46, v7 offset:768
    ds_read_u8 v47, v7 offset:896
    ds_read_u8 v48, v7 offset:1024
    ds_read_u8 v49, v7 offset:1152
    ds_read_u8 v50, v7 offset:1280
    ds_read_u8 v51, v7 offset:1408
    ds_read_u8 v52, v7 offset:1536
    ds_read_u8 v53, v7 offset:1664
    ds_read_u8 v54, v7 offset:1792
    ds_read_u8 v55, v7 offset:1920
    s_waitcnt lgkmcnt(0)
    v_lshl_or_b32 v24, v41, 8, v40
    v_lshl_or_b32 v56, v43, 8, v42
    v_lshl_or_b32 v25, v45, 8, v44
    v_lshl_or_b32 v57, v47, 8, v46
    v_lshl_or_b32 v26, v49, 8, v48
    v_lshl_or_b32 v58, v51, 8, v50
    v_lshl_or_b32 v27, v53, 8, v52
    v_lshl_or_b32 v59, v55, 8, v54
    v_lshl_or_b32 v24, v56, 16, v24
    v_lshl_or_b32 v25, v57, 16, v25
    v_lshl_or_b32 v26, v58, 16, v26
    v_lshl_or_b32 v27, v59, 16, v27
    v_xor_b32 v25, s54, v25
    v_xor_b32 v27, s54, v27
    v_mov_b32 v28, v24
    v_mov_b32 v29, v26
    v_perm_b32 v30, v27, v26, s45
    v_perm_b32 v31, v25, v24, s45
    v_xor_b32 v24, v28, v30
    v_xor_b32 v26, v29, v31
    v_perm_b32 v30, v27, v26, s45
    v_perm_b32 v31, v25, v24, s45
    v_xor_b32 v24, v28, v30
    v_xor_b32 v26, v29, v31
    v_perm_b32 v30, v27, v26, s45
    v_perm_b32 v31, v25, v24, s45
    v_xor_b32 v24, v28, v30
    v_xor_b32 v26, v29, v31
    ds_write_b128 v6, v[24:27]
    s_waitcnt lgkmcnt(0)
    s_barrier
    s_cmp_lt_u32 s13, 4
    s_cbranch_scc1 L_done
    s_branch L_m2
L_e2:
    s_getpc_b64 s[86:87]
L_pcX:
    s_cmp_lt_u32 s13, 4
    s_cselect_b32 s35, 16, 0
    s_cselect_b32 s49, 8, 0
    s_add_u32 s35, s35, s48
    s_lshl_b32 s35, s35, 3
    s_add_u32 s35, s35, L_sched-L_pcX
    s_add_u32 s86, s86, s35
    s_addc_u32 s87, s87, 0
    s_load_dwordx2 s[82:83], s[86:87], 0
    s_lshr_b32 s35, s32, 3
    s_add_u32 s49, s49, s35
    s_lshl_b32 s35, s15, 2
    s_add_u32 s35, s35, s33
    s_lshl_b32 s35, s35, 7
    s_add_u32 s35, s35, 524288
    v_and_b32 v12, 15, v2
    v_lshlrev_b32 v12, 2, v12
    v_add_u32 v12, s35, v12
    s_mov_b64 s[68:69], s[56:57]
    s_mov_b32 s70, 268435456
    s_mov_b32 s71, 0x20000
    buffer_load_dword v13, v12, s[68:71], 0 offen sc0 sc1
    s_mov_b64 s[16:17], s[4:5]
    s_mov_b64 s[20:21], s[6:7]
    s_mov_b32 s22, 14680064
    s_mov_b32 s23, 0x20000
    s_mov_b32 s18, 4194304
    s_mov_b32 s19, 0x20000
    s_movk_i32 s97, 14336
    s_movk_i32 s98, 15360
    s_movk_i32 s99, 19456
    v_lshrrev_b32 v3, 5, v2
    s_lshl_b32 s35, s33, 1
    v_add_u32 v4, s35, v3
    v_and_b32 v6, 31, v2
    v_mul_u32_u24 v8, 114688, v4
    v_lshl_add_u32 v8, v6, 4, v8
    s_lshl_b32 s35, s15, 9
    v_add_u32 v8, s35, v8
    v_lshrrev_b32 v5, 3, v2
    v_lshrrev_b32 v7, 4, v2
    v_and_b32 v10, 7, v2
    v_xor_b32 v7, v7, v10
    v_lshlrev_b32 v7, 4, v7
    s_lshl_b32 s35, s14, 19
    s_lshl_b32 s36, s33, 17
    s_add_u32 s35, s35, s36
    v_lshl_add_u32 v7, v5, 11, v7
    v_add_u32 v9, s35, v7
    v_xor_b32 v10, 64, v9
    s_lshl_b32 s44, s33, 13
    s_add_u32 s44, s44, 65536
    s_lshl_b32 s36, s15, 18
    s_add_u32 s96, s36, 1048576
    v_xor_b32 v5, v6, v3
    v_lshlrev_b32 v5, 4, v5
    v_lshl_add_u32 v11, v4, 11, v5
    v_lshlrev_b32 v7, 4, v6
    v_add_u32 v7, 131072, v7
    s_lshl_b32 s45, s33, 12
    s_add_u32 s36, s96, s45
    v_lshlrev_b32 v15, 4, v2
    v_add_u32 v15, s36, v15
    v_add_u32 v20, s96, v11
    s_mov_b32 s46, 0x05010400
    s_mov_b32 s47, 0x07030602
    s_mov_b32 s58, 0x08080808
    s_mov_b32 s84, 0x05040100
    s_mov_b32 s85, 0x07060302
    s_mov_b32 s38, 0
    s_mov_b32 s39, 0
    s_mov_b32 s91, 0
    s_cmp_lt_u32 s32, 8
    s_cselect_b32 s93, 8, 9
    s_mov_b32 s90, 40
    s_mov_b64 exec, 0
    s_cmp_lt_u32 s13, 4
    s_cbranch_scc1 L_hopq
    s_cmp_eq_u32 s32, 4
    s_cbranch_scc1 L_hq0
    s_cmp_eq_u32 s32, 5
    s_cbranch_scc1 L_hq2
    s_cmp_eq_u32 s32, 6
    s_cbranch_scc1 L_hg
    s_cmp_eq_u32 s32, 7
    s_cbranch_scc1 L_hloop
    s_cmp_eq_u32 s32, 8
    s_cbranch_scc1 L_hx
    s_branch L_hopret
L_hopq:
    s_cmp_eq_u32 s32, 4
    s_cbranch_scc1 L_prod
    s_cmp_eq_u32 s32, 5
    s_cbranch_scc1 L_ploop
    s_cmp_eq_u32 s32, 6
    s_cbranch_scc1 L_pmid
    s_cmp_eq_u32 s32, 7
    s_cbranch_scc1 L_ppub
L_hopret:
    s_mov_b64 exec, -1
    s_waitcnt lgkmcnt(0)
    s_barrier
    ds_read_b128 v[40:43], v7 offset:0
    ds_read_b128 v[44:47], v7 offset:512
    ds_read_b128 v[48:51], v7 offset:1024
    ds_read_b128 v[52:55], v7 offset:1536
    ds_read_b128 v[56:59], v7 offset:2048
    ds_read_b128 v[60:63], v7 offset:2560
    ds_read_b128 v[64:67], v7 offset:3072
    ds_read_b128 v[68:71], v7 offset:3584
    s_cmp_lt_u32 s13, 4
    s_cbranch_scc1 L_prod
    s_lshl_b32 s41, s49, 14
    s_add_u32 s92, s49, 2
    s_mov_b32 s55, 2
    s_mov_b32 s54, 2
    s_cmp_eq_u32 s49, 0
    s_waitcnt lgkmcnt(0)
    s_cbranch_scc1 L_hq
    s_lshl_b32 s50, s49, 2
    s_lshr_b64 s[50:51], s[82:83], s50
    s_and_b32 s50, s50, 15
    s_mul_i32 s43, s50, 917504
    tbuffer_load_format_d16_xyzw v[72:73], v8, s[20:23], s43 format:[BUF_DATA_FORMAT_32_32_32_32,BUF_NUM_FORMAT_UINT] offen
    s_add_u32 s43, s43, s97
    tbuffer_load_format_d16_xyzw v[74:75], v8, s[20:23], s43 format:[BUF_DATA_FORMAT_32_32_32_32,BUF_NUM_FORMAT_UINT] offen
    s_add_u32 s43, s43, s97
    tbuffer_load_format_d16_xyzw v[76:77], v8, s[20:23], s43 format:[BUF_DATA_FORMAT_32_32_32_32,BUF_NUM_FORMAT_UINT] offen
    s_add_u32 s43, s43, s97
    tbuffer_load_format_d16_xyzw v[78:79], v8, s[20:23], s43 format:[BUF_DATA_FORMAT_32_32_32_32,BUF_NUM_FORMAT_UINT] offen
    s_add_u32 s43, s43, s97
    tbuffer_load_format_d16_xyzw v[80:81], v8, s[20:23], s43 format:[BUF_DATA_FORMAT_32_32_32_32,BUF_NUM_FORMAT_UINT] offen
    s_add_u32 s43, s43, s97
    tbuffer_load_format_d16_xyzw v[82:83], v8, s[20:23], s43 format:[BUF_DATA_FORMAT_32_32_32_32,BUF_NUM_FORMAT_UINT] offen
    s_add_u32 s43, s43, s97
    tbuffer_load_format_d16_xyzw v[84:85], v8, s[20:23], s43 format:[BUF_DATA_FORMAT_32_32_32_32,BUF_NUM_FORMAT_UINT] offen
    s_add_u32 s43, s43, s97
    tbuffer_load_format_d16_xyzw v[86:87], v8, s[20:23], s43 format:[BUF_DATA_FORMAT_32_32_32_32,BUF_NUM_FORMAT_UINT] offen
    s_waitcnt vmcnt(8)
    s_barrier
    s_setprio 3
    s_add_u32 s53, s44, 32768
    s_mov_b32 m0, s53
    s_lshl_b32 s42, s50, 7
    buffer_load_dwordx4 v9, s[16:19], s42 offen offset:0 lds
    s_add_u32 s42, s42, s98
    buffer_load_dwordx4 v10, s[16:19], s42 offen offset:1024 lds
    s_add_u32 s42, s42, s98
    buffer_load_dwordx4 v9, s[16:19], s42 offen offset:2048 lds
    s_add_u32 s42, s42, s98
    buffer_load_dwordx4 v10, s[16:19], s42 offen offset:3072 lds
    s_add_u32 m0, s53, 4096
    s_add_u32 s42, s42, s99
    buffer_load_dwordx4 v9, s[16:19], s42 offen offset:0 lds
    s_add_u32 s42, s42, s98
    buffer_load_dwordx4 v10, s[16:19], s42 offen offset:1024 lds
    s_add_u32 s42, s42, s98
    buffer_load_dwordx4 v9, s[16:19], s42 offen offset:2048 lds
    s_add_u32 s42, s42, s98
    buffer_load_dwordx4 v10, s[16:19], s42 offen offset:3072 lds
    s_mov_b32 s55, 0
    s_mov_b32 s54, 8
    v_add_u32 v17, s41, v11
    s_waitcnt vmcnt(8)
    s_branch L_hq0
L_m2:
    s_mov_b64 s[28:29], s[10:11]
    s_mov_b32 s30, 14680064
    s_mov_b32 s31, 0x20000
    v_and_b32 v7, 15, v2
    v_lshrrev_b32 v6, 4, v2
    v_lshrrev_b32 v4, 1, v7
    v_xor_b32 v4, v4, v6
    v_lshlrev_b32 v4, 4, v4
    v_lshl_add_u32 v4, v7, 7, v4
    s_lshl_b32 s35, s32, 13
    s_add_u32 s35, s35, 65536
    v_add_u32 v1, s35, v4
    v_xor_b32 v3, 64, v1
    v_and_b32 v4, 1, v6
    v_lshl_add_u32 v4, v7, 1, v4
    v_lshlrev_b32 v4, 4, v4
    v_lshl_add_u32 v4, v6, 11, v4
    v_xor_b32 v5, 16, v4
    v_mul_u32_u24 v6, 28672, v6
    v_lshl_add_u32 v6, v7, 4, v6
    s_lshl_b32 s36, s14, 2
    s_add_u32 s36, s36, s32
    s_mul_i32 s36, s36, 458752
    s_lshl_b32 s37, s15, 8
    s_add_u32 s36, s36, s37
    s_mov_b32 s40, 0
    s_mov_b32 s41, 0
    s_mov_b32 s46, 32768
    s_mov_b32 s47, 16384
    s_mov_b64 exec, 0
    s_cmp_eq_u32 s32, 0
    s_cbranch_scc1 L_mh0
    s_cmp_eq_u32 s32, 1
    s_cbranch_scc1 L_mh6
    s_cmp_eq_u32 s32, 2
    s_cbranch_scc1 L_mh12
    s_cmp_eq_u32 s32, 3
    s_cbranch_scc1 L_mh18
L_mhret:
    s_mov_b64 exec, -1
    s_setprio 3
    s_barrier
    ds_read_b128 v[24:27], v4 offset:0
    ds_read_b128 v[28:31], v4 offset:512
    ds_read_b128 v[8:11], v1 offset:0
    ds_read_b128 v[12:15], v1 offset:2048
    ds_read_b128 v[16:19], v1 offset:4096
    ds_read_b128 v[32:35], v4 offset:1024
    ds_read_b128 v[20:23], v1 offset:6144
    ds_read_b128 v[36:39], v4 offset:1536
    s_waitcnt lgkmcnt(5)
    v_mfma_f32_16x16x32_bf16 v[40:43], v[8:11], v[24:27], 0
    v_mfma_f32_16x16x32_bf16 v[44:47], v[8:11], v[28:31], 0
    s_waitcnt lgkmcnt(4)
    v_mfma_f32_16x16x32_bf16 v[72:75], v[12:15], v[24:27], 0
    v_mfma_f32_16x16x32_bf16 v[76:79], v[12:15], v[28:31], 0
    s_waitcnt lgkmcnt(3)
    v_mfma_f32_16x16x32_bf16 v[104:107], v[16:19], v[24:27], 0
    v_mfma_f32_16x16x32_bf16 v[108:111], v[16:19], v[28:31], 0
    s_waitcnt lgkmcnt(1)
    v_mfma_f32_16x16x32_bf16 v[136:139], v[20:23], v[24:27], 0
    ds_read_b128 v[24:27], v5 offset:0
    v_mfma_f32_16x16x32_bf16 v[140:143], v[20:23], v[28:31], 0
    ds_read_b128 v[28:31], v5 offset:512
    v_mfma_f32_16x16x32_bf16 v[48:51], v[8:11], v[32:35], 0
    s_add_u32 s40, s40, 1
L_mh0:
    s_cbranch_execz L_mh1
    s_waitcnt lgkmcnt(2)
    v_mfma_f32_16x16x32_bf16 v[52:55], v[8:11], v[36:39], 0
    s_and_b32 s42, s40, 3
    v_mfma_f32_16x16x32_bf16 v[80:83], v[12:15], v[32:35], 0
    s_cselect_b32 s42, s47, 0xffff4000
    v_mfma_f32_16x16x32_bf16 v[84:87], v[12:15], v[36:39], 0
    s_add_u32 s41, s41, 1
    v_mfma_f32_16x16x32_bf16 v[112:115], v[16:19], v[32:35], 0
    s_cmp_eq_u32 s41, 3
    v_mfma_f32_16x16x32_bf16 v[116:119], v[16:19], v[36:39], 0
    s_cselect_b32 s43, 0xffff0000, s46
    v_mfma_f32_16x16x32_bf16 v[144:147], v[20:23], v[32:35], 0
    s_cselect_b32 s41, 0, s41
    ds_read_b128 v[32:35], v5 offset:1024
    v_mfma_f32_16x16x32_bf16 v[148:151], v[20:23], v[36:39], 0
    ds_read_b128 v[36:39], v5 offset:1536
    s_waitcnt lgkmcnt(3)
    v_mfma_f32_16x16x32_bf16 v[56:59], v[8:11], v[24:27], 0
    s_waitcnt lgkmcnt(2)
    v_mfma_f32_16x16x32_bf16 v[60:63], v[8:11], v[28:31], 0
    v_mfma_f32_16x16x32_bf16 v[88:91], v[12:15], v[24:27], 0
    v_mfma_f32_16x16x32_bf16 v[92:95], v[12:15], v[28:31], 0
    v_mfma_f32_16x16x32_bf16 v[120:123], v[16:19], v[24:27], 0
    v_mfma_f32_16x16x32_bf16 v[124:127], v[16:19], v[28:31], 0
    v_mfma_f32_16x16x32_bf16 v[152:155], v[20:23], v[24:27], 0
    ds_read_b128 v[24:27], v4 offset:8192
    v_mfma_f32_16x16x32_bf16 v[156:159], v[20:23], v[28:31], 0
    ds_read_b128 v[28:31], v4 offset:8704
    s_waitcnt lgkmcnt(3)
    v_mfma_f32_16x16x32_bf16 v[64:67], v[8:11], v[32:35], 0
    s_waitcnt lgkmcnt(2)
    v_mfma_f32_16x16x32_bf16 v[68:71], v[8:11], v[36:39], 0
    ds_read_b128 v[8:11], v3 offset:0
    v_mfma_f32_16x16x32_bf16 v[96:99], v[12:15], v[32:35], 0
    v_mfma_f32_16x16x32_bf16 v[100:103], v[12:15], v[36:39], 0
    ds_read_b128 v[12:15], v3 offset:2048
    v_mfma_f32_16x16x32_bf16 v[128:131], v[16:19], v[32:35], 0
    v_mfma_f32_16x16x32_bf16 v[132:135], v[16:19], v[36:39], 0
    ds_read_b128 v[16:19], v3 offset:4096
    v_mfma_f32_16x16x32_bf16 v[160:163], v[20:23], v[32:35], 0
    ds_read_b128 v[32:35], v4 offset:9216
    v_mfma_f32_16x16x32_bf16 v[164:167], v[20:23], v[36:39], 0
    ds_read_b128 v[20:23], v3 offset:6144
    ds_read_b128 v[36:39], v4 offset:9728
    s_waitcnt lgkmcnt(5)
    v_mfma_f32_16x16x32_bf16 v[40:43], v[8:11], v[24:27], v[40:43]
    v_mfma_f32_16x16x32_bf16 v[44:47], v[8:11], v[28:31], v[44:47]
    s_waitcnt lgkmcnt(4)
L_mh1:
    s_cbranch_execz L_mh2
    v_mfma_f32_16x16x32_bf16 v[72:75], v[12:15], v[24:27], v[72:75]
    v_mfma_f32_16x16x32_bf16 v[76:79], v[12:15], v[28:31], v[76:79]
    s_waitcnt lgkmcnt(3)
    v_mfma_f32_16x16x32_bf16 v[104:107], v[16:19], v[24:27], v[104:107]
    v_mfma_f32_16x16x32_bf16 v[108:111], v[16:19], v[28:31], v[108:111]
    s_waitcnt lgkmcnt(1)
    v_mfma_f32_16x16x32_bf16 v[136:139], v[20:23], v[24:27], v[136:139]
    ds_read_b128 v[24:27], v5 offset:8192
    v_mfma_f32_16x16x32_bf16 v[140:143], v[20:23], v[28:31], v[140:143]
    ds_read_b128 v[28:31], v5 offset:8704
    v_mfma_f32_16x16x32_bf16 v[48:51], v[8:11], v[32:35], v[48:51]
    s_waitcnt lgkmcnt(2)
    v_mfma_f32_16x16x32_bf16 v[52:55], v[8:11], v[36:39], v[52:55]
    v_mfma_f32_16x16x32_bf16 v[80:83], v[12:15], v[32:35], v[80:83]
    v_mfma_f32_16x16x32_bf16 v[84:87], v[12:15], v[36:39], v[84:87]
    v_mfma_f32_16x16x32_bf16 v[112:115], v[16:19], v[32:35], v[112:115]
    v_mfma_f32_16x16x32_bf16 v[116:119], v[16:19], v[36:39], v[116:119]
    v_mfma_f32_16x16x32_bf16 v[144:147], v[20:23], v[32:35], v[144:147]
    ds_read_b128 v[32:35], v5 offset:9216
    v_mfma_f32_16x16x32_bf16 v[148:151], v[20:23], v[36:39], v[148:151]
    ds_read_b128 v[36:39], v5 offset:9728
    s_waitcnt lgkmcnt(3)
    v_mfma_f32_16x16x32_bf16 v[56:59], v[8:11], v[24:27], v[56:59]
    s_waitcnt lgkmcnt(2)
    v_mfma_f32_16x16x32_bf16 v[60:63], v[8:11], v[28:31], v[60:63]
    v_mfma_f32_16x16x32_bf16 v[88:91], v[12:15], v[24:27], v[88:91]
    v_mfma_f32_16x16x32_bf16 v[92:95], v[12:15], v[28:31], v[92:95]
    v_mfma_f32_16x16x32_bf16 v[120:123], v[16:19], v[24:27], v[120:123]
    v_mfma_f32_16x16x32_bf16 v[124:127], v[16:19], v[28:31], v[124:127]
    s_waitcnt lgkmcnt(0)
    s_barrier
    v_add_u32 v4, s42, v4
    v_mfma_f32_16x16x32_bf16 v[152:155], v[20:23], v[24:27], v[152:155]
    v_add_u32 v1, s43, v1
    ds_read_b128 v[24:27], v4 offset:0
    v_mfma_f32_16x16x32_bf16 v[156:159], v[20:23], v[28:31], v[156:159]
    v_add_u32 v5, s42, v5
    ds_read_b128 v[28:31], v4 offset:512
    v_mfma_f32_16x16x32_bf16 v[64:67], v[8:11], v[32:35], v[64:67]
    v_add_u32 v3, s43, v3
    v_mfma_f32_16x16x32_bf16 v[68:71], v[8:11], v[36:39], v[68:71]
    ds_read_b128 v[8:11], v1 offset:0
    v_mfma_f32_16x16x32_bf16 v[96:99], v[12:15], v[32:35], v[96:99]
    v_mfma_f32_16x16x32_bf16 v[100:103], v[12:15], v[36:39], v[100:103]
    ds_read_b128 v[12:15], v1 offset:2048
    v_mfma_f32_16x16x32_bf16 v[128:131], v[16:19], v[32:35], v[128:131]
    v_mfma_f32_16x16x32_bf16 v[132:135], v[16:19], v[36:39], v[132:135]
    ds_read_b128 v[16:19], v1 offset:4096
L_mh2:
    s_cbranch_execz L_mh3
    v_mfma_f32_16x16x32_bf16 v[160:163], v[20:23], v[32:35], v[160:163]
    ds_read_b128 v[32:35], v4 offset:1024
    v_mfma_f32_16x16x32_bf16 v[164:167], v[20:23], v[36:39], v[164:167]
    ds_read_b128 v[20:23], v1 offset:6144
    ds_read_b128 v[36:39], v4 offset:1536
    .p2align 6
L_mloop:
    s_waitcnt lgkmcnt(5)
    v_mfma_f32_16x16x32_bf16 v[40:43], v[8:11], v[24:27], v[40:43]
    v_mfma_f32_16x16x32_bf16 v[44:47], v[8:11], v[28:31], v[44:47]
    s_waitcnt lgkmcnt(4)
    v_mfma_f32_16x16x32_bf16 v[72:75], v[12:15], v[24:27], v[72:75]
    v_mfma_f32_16x16x32_bf16 v[76:79], v[12:15], v[28:31], v[76:79]
    s_waitcnt lgkmcnt(3)
    v_mfma_f32_16x16x32_bf16 v[104:107], v[16:19], v[24:27], v[104:107]
    v_mfma_f32_16x16x32_bf16 v[108:111], v[16:19], v[28:31], v[108:111]
    s_waitcnt lgkmcnt(1)
    v_mfma_f32_16x16x32_bf16 v[136:139], v[20:23], v[24:27], v[136:139]
    ds_read_b128 v[24:27], v5 offset:0
    v_mfma_f32_16x16x32_bf16 v[140:143], v[20:23], v[28:31], v[140:143]
    ds_read_b128 v[28:31], v5 offset:512
    v_mfma_f32_16x16x32_bf16 v[48:51], v[8:11], v[32:35], v[48:51]
    s_add_u32 s40, s40, 1
    s_waitcnt lgkmcnt(2)
    v_mfma_f32_16x16x32_bf16 v[52:55], v[8:11], v[36:39], v[52:55]
    s_and_b32 s42, s40, 3
    v_mfma_f32_16x16x32_bf16 v[80:83], v[12:15], v[32:35], v[80:83]
    s_cselect_b32 s42, s47, 0xffff4000
    v_mfma_f32_16x16x32_bf16 v[84:87], v[12:15], v[36:39], v[84:87]
    s_add_u32 s41, s41, 1
    v_mfma_f32_16x16x32_bf16 v[112:115], v[16:19], v[32:35], v[112:115]
    s_cmp_eq_u32 s41, 3
    v_mfma_f32_16x16x32_bf16 v[116:119], v[16:19], v[36:39], v[116:119]
    s_cselect_b32 s43, 0xffff0000, s46
    v_mfma_f32_16x16x32_bf16 v[144:147], v[20:23], v[32:35], v[144:147]
    s_cselect_b32 s41, 0, s41
    ds_read_b128 v[32:35], v5 offset:1024
    v_mfma_f32_16x16x32_bf16 v[148:151], v[20:23], v[36:39], v[148:151]
    ds_read_b128 v[36:39], v5 offset:1536
    s_waitcnt lgkmcnt(3)
    v_mfma_f32_16x16x32_bf16 v[56:59], v[8:11], v[24:27], v[56:59]
    s_waitcnt lgkmcnt(2)
    v_mfma_f32_16x16x32_bf16 v[60:63], v[8:11], v[28:31], v[60:63]
    v_mfma_f32_16x16x32_bf16 v[88:91], v[12:15], v[24:27], v[88:91]
    v_mfma_f32_16x16x32_bf16 v[92:95], v[12:15], v[28:31], v[92:95]
    v_mfma_f32_16x16x32_bf16 v[120:123], v[16:19], v[24:27], v[120:123]
    v_mfma_f32_16x16x32_bf16 v[124:127], v[16:19], v[28:31], v[124:127]
    v_mfma_f32_16x16x32_bf16 v[152:155], v[20:23], v[24:27], v[152:155]
L_mh3:
    s_cbranch_execz L_mh4
    ds_read_b128 v[24:27], v4 offset:8192
    v_mfma_f32_16x16x32_bf16 v[156:159], v[20:23], v[28:31], v[156:159]
    ds_read_b128 v[28:31], v4 offset:8704
    s_waitcnt lgkmcnt(3)
    v_mfma_f32_16x16x32_bf16 v[64:67], v[8:11], v[32:35], v[64:67]
    s_waitcnt lgkmcnt(2)
    v_mfma_f32_16x16x32_bf16 v[68:71], v[8:11], v[36:39], v[68:71]
    ds_read_b128 v[8:11], v3 offset:0
    v_mfma_f32_16x16x32_bf16 v[96:99], v[12:15], v[32:35], v[96:99]
    v_mfma_f32_16x16x32_bf16 v[100:103], v[12:15], v[36:39], v[100:103]
    ds_read_b128 v[12:15], v3 offset:2048
    v_mfma_f32_16x16x32_bf16 v[128:131], v[16:19], v[32:35], v[128:131]
    v_mfma_f32_16x16x32_bf16 v[132:135], v[16:19], v[36:39], v[132:135]
    ds_read_b128 v[16:19], v3 offset:4096
    v_mfma_f32_16x16x32_bf16 v[160:163], v[20:23], v[32:35], v[160:163]
    ds_read_b128 v[32:35], v4 offset:9216
    v_mfma_f32_16x16x32_bf16 v[164:167], v[20:23], v[36:39], v[164:167]
    ds_read_b128 v[20:23], v3 offset:6144
    ds_read_b128 v[36:39], v4 offset:9728
    s_waitcnt lgkmcnt(5)
    v_mfma_f32_16x16x32_bf16 v[40:43], v[8:11], v[24:27], v[40:43]
    v_mfma_f32_16x16x32_bf16 v[44:47], v[8:11], v[28:31], v[44:47]
    s_waitcnt lgkmcnt(4)
    v_mfma_f32_16x16x32_bf16 v[72:75], v[12:15], v[24:27], v[72:75]
    v_mfma_f32_16x16x32_bf16 v[76:79], v[12:15], v[28:31], v[76:79]
    s_waitcnt lgkmcnt(3)
    v_mfma_f32_16x16x32_bf16 v[104:107], v[16:19], v[24:27], v[104:107]
    v_mfma_f32_16x16x32_bf16 v[108:111], v[16:19], v[28:31], v[108:111]
    s_waitcnt lgkmcnt(1)
    v_mfma_f32_16x16x32_bf16 v[136:139], v[20:23], v[24:27], v[136:139]
    ds_read_b128 v[24:27], v5 offset:8192
    v_mfma_f32_16x16x32_bf16 v[140:143], v[20:23], v[28:31], v[140:143]
    ds_read_b128 v[28:31], v5 offset:8704
    v_mfma_f32_16x16x32_bf16 v[48:51], v[8:11], v[32:35], v[48:51]
    s_waitcnt lgkmcnt(2)
    v_mfma_f32_16x16x32_bf16 v[52:55], v[8:11], v[36:39], v[52:55]
    v_mfma_f32_16x16x32_bf16 v[80:83], v[12:15], v[32:35], v[80:83]
    v_mfma_f32_16x16x32_bf16 v[84:87], v[12:15], v[36:39], v[84:87]
    v_mfma_f32_16x16x32_bf16 v[112:115], v[16:19], v[32:35], v[112:115]
    v_mfma_f32_16x16x32_bf16 v[116:119], v[16:19], v[36:39], v[116:119]
    v_mfma_f32_16x16x32_bf16 v[144:147], v[20:23], v[32:35], v[144:147]
    ds_read_b128 v[32:35], v5 offset:9216
    v_mfma_f32_16x16x32_bf16 v[148:151], v[20:23], v[36:39], v[148:151]
    ds_read_b128 v[36:39], v5 offset:9728
    s_waitcnt lgkmcnt(3)
    v_mfma_f32_16x16x32_bf16 v[56:59], v[8:11], v[24:27], v[56:59]
    s_waitcnt lgkmcnt(2)
    v_mfma_f32_16x16x32_bf16 v[60:63], v[8:11], v[28:31], v[60:63]
L_mh4:
    s_cbranch_execz L_mh5
    v_mfma_f32_16x16x32_bf16 v[88:91], v[12:15], v[24:27], v[88:91]
    v_mfma_f32_16x16x32_bf16 v[92:95], v[12:15], v[28:31], v[92:95]
    v_mfma_f32_16x16x32_bf16 v[120:123], v[16:19], v[24:27], v[120:123]
    v_mfma_f32_16x16x32_bf16 v[124:127], v[16:19], v[28:31], v[124:127]
    s_waitcnt lgkmcnt(0)
    s_barrier
    v_add_u32 v4, s42, v4
    v_mfma_f32_16x16x32_bf16 v[152:155], v[20:23], v[24:27], v[152:155]
    v_add_u32 v1, s43, v1
    ds_read_b128 v[24:27], v4 offset:0
    v_mfma_f32_16x16x32_bf16 v[156:159], v[20:23], v[28:31], v[156:159]
    v_add_u32 v5, s42, v5
    ds_read_b128 v[28:31], v4 offset:512
    v_mfma_f32_16x16x32_bf16 v[64:67], v[8:11], v[32:35], v[64:67]
    v_add_u32 v3, s43, v3
    v_mfma_f32_16x16x32_bf16 v[68:71], v[8:11], v[36:39], v[68:71]
    ds_read_b128 v[8:11], v1 offset:0
    v_mfma_f32_16x16x32_bf16 v[96:99], v[12:15], v[32:35], v[96:99]
    v_mfma_f32_16x16x32_bf16 v[100:103], v[12:15], v[36:39], v[100:103]
    ds_read_b128 v[12:15], v1 offset:2048
    v_mfma_f32_16x16x32_bf16 v[128:131], v[16:19], v[32:35], v[128:131]
    v_mfma_f32_16x16x32_bf16 v[132:135], v[16:19], v[36:39], v[132:135]
    ds_read_b128 v[16:19], v1 offset:4096
    v_mfma_f32_16x16x32_bf16 v[160:163], v[20:23], v[32:35], v[160:163]
    ds_read_b128 v[32:35], v4 offset:1024
    v_mfma_f32_16x16x32_bf16 v[164:167], v[20:23], v[36:39], v[164:167]
    ds_read_b128 v[20:23], v1 offset:6144
    ds_read_b128 v[36:39], v4 offset:1536
    s_cmp_lt_u32 s40, 11
    s_cbranch_scc1 L_mloop
    s_waitcnt lgkmcnt(5)
    v_mfma_f32_16x16x32_bf16 v[40:43], v[8:11], v[24:27], v[40:43]
    v_mfma_f32_16x16x32_bf16 v[44:47], v[8:11], v[28:31], v[44:47]
    s_waitcnt lgkmcnt(4)
    v_mfma_f32_16x16x32_bf16 v[72:75], v[12:15], v[24:27], v[72:75]
    v_mfma_f32_16x16x32_bf16 v[76:79], v[12:15], v[28:31], v[76:79]
    s_waitcnt lgkmcnt(3)
    v_mfma_f32_16x16x32_bf16 v[104:107], v[16:19], v[24:27], v[104:107]
    v_mfma_f32_16x16x32_bf16 v[108:111], v[16:19], v[28:31], v[108:111]
    s_waitcnt lgkmcnt(1)
    v_mfma_f32_16x16x32_bf16 v[136:139], v[20:23], v[24:27], v[136:139]
    ds_read_b128 v[24:27], v5 offset:0
    v_mfma_f32_16x16x32_bf16 v[140:143], v[20:23], v[28:31], v[140:143]
    ds_read_b128 v[28:31], v5 offset:512
    v_mfma_f32_16x16x32_bf16 v[48:51], v[8:11], v[32:35], v[48:51]
    s_waitcnt lgkmcnt(2)
    v_mfma_f32_16x16x32_bf16 v[52:55], v[8:11], v[36:39], v[52:55]
    v_mfma_f32_16x16x32_bf16 v[80:83], v[12:15], v[32:35], v[80:83]
L_mh5:
    s_cbranch_execz L_mhret
    v_mfma_f32_16x16x32_bf16 v[84:87], v[12:15], v[36:39], v[84:87]
    v_mfma_f32_16x16x32_bf16 v[112:115], v[16:19], v[32:35], v[112:115]
    v_mfma_f32_16x16x32_bf16 v[116:119], v[16:19], v[36:39], v[116:119]
    v_mfma_f32_16x16x32_bf16 v[144:147], v[20:23], v[32:35], v[144:147]
    ds_read_b128 v[32:35], v5 offset:1024
    v_mfma_f32_16x16x32_bf16 v[148:151], v[20:23], v[36:39], v[148:151]
    ds_read_b128 v[36:39], v5 offset:1536
    s_waitcnt lgkmcnt(3)
    v_mfma_f32_16x16x32_bf16 v[56:59], v[8:11], v[24:27], v[56:59]
    s_waitcnt lgkmcnt(2)
    v_mfma_f32_16x16x32_bf16 v[60:63], v[8:11], v[28:31], v[60:63]
    v_mfma_f32_16x16x32_bf16 v[88:91], v[12:15], v[24:27], v[88:91]
    v_mfma_f32_16x16x32_bf16 v[92:95], v[12:15], v[28:31], v[92:95]
    v_mfma_f32_16x16x32_bf16 v[120:123], v[16:19], v[24:27], v[120:123]
    v_mfma_f32_16x16x32_bf16 v[124:127], v[16:19], v[28:31], v[124:127]
    v_mfma_f32_16x16x32_bf16 v[152:155], v[20:23], v[24:27], v[152:155]
    ds_read_b128 v[24:27], v4 offset:8192
    v_mfma_f32_16x16x32_bf16 v[156:159], v[20:23], v[28:31], v[156:159]
    ds_read_b128 v[28:31], v4 offset:8704
    s_waitcnt lgkmcnt(3)
    v_mfma_f32_16x16x32_bf16 v[64:67], v[8:11], v[32:35], v[64:67]
    s_waitcnt lgkmcnt(2)
    v_mfma_f32_16x16x32_bf16 v[68:71], v[8:11], v[36:39], v[68:71]
    ds_read_b128 v[8:11], v3 offset:0
    v_mfma_f32_16x16x32_bf16 v[96:99], v[12:15], v[32:35], v[96:99]
    v_mfma_f32_16x16x32_bf16 v[100:103], v[12:15], v[36:39], v[100:103]
    ds_read_b128 v[12:15], v3 offset:2048
    v_mfma_f32_16x16x32_bf16 v[128:131], v[16:19], v[32:35], v[128:131]
    v_mfma_f32_16x16x32_bf16 v[132:135], v[16:19], v[36:39], v[132:135]
    ds_read_b128 v[16:19], v3 offset:4096
    v_mfma_f32_16x16x32_bf16 v[160:163], v[20:23], v[32:35], v[160:163]
    ds_read_b128 v[32:35], v4 offset:9216
    v_mfma_f32_16x16x32_bf16 v[164:167], v[20:23], v[36:39], v[164:167]
    ds_read_b128 v[20:23], v3 offset:6144
    ds_read_b128 v[36:39], v4 offset:9728
    s_waitcnt lgkmcnt(5)
    v_mfma_f32_16x16x32_bf16 v[40:43], v[8:11], v[24:27], v[40:43]
    v_mfma_f32_16x16x32_bf16 v[44:47], v[8:11], v[28:31], v[44:47]
    s_waitcnt lgkmcnt(4)
    v_mfma_f32_16x16x32_bf16 v[72:75], v[12:15], v[24:27], v[72:75]
    v_mfma_f32_16x16x32_bf16 v[76:79], v[12:15], v[28:31], v[76:79]
    s_waitcnt lgkmcnt(3)
    v_mfma_f32_16x16x32_bf16 v[104:107], v[16:19], v[24:27], v[104:107]
    v_mfma_f32_16x16x32_bf16 v[108:111], v[16:19], v[28:31], v[108:111]
    s_waitcnt lgkmcnt(1)
    v_mfma_f32_16x16x32_bf16 v[136:139], v[20:23], v[24:27], v[136:139]
    ds_read_b128 v[24:27], v5 offset:8192
    v_mfma_f32_16x16x32_bf16 v[140:143], v[20:23], v[28:31], v[140:143]
L_mh6:
    s_cbranch_execz L_mh7
    ds_read_b128 v[28:31], v5 offset:8704
    v_mfma_f32_16x16x32_bf16 v[48:51], v[8:11], v[32:35], v[48:51]
    s_waitcnt lgkmcnt(2)
    v_mfma_f32_16x16x32_bf16 v[52:55], v[8:11], v[36:39], v[52:55]
    v_mfma_f32_16x16x32_bf16 v[80:83], v[12:15], v[32:35], v[80:83]
    v_mfma_f32_16x16x32_bf16 v[84:87], v[12:15], v[36:39], v[84:87]
    v_mfma_f32_16x16x32_bf16 v[112:115], v[16:19], v[32:35], v[112:115]
    v_mfma_f32_16x16x32_bf16 v[116:119], v[16:19], v[36:39], v[116:119]
    v_mfma_f32_16x16x32_bf16 v[144:147], v[20:23], v[32:35], v[144:147]
    ds_read_b128 v[32:35], v5 offset:9216
    v_mfma_f32_16x16x32_bf16 v[148:151], v[20:23], v[36:39], v[148:151]
    ds_read_b128 v[36:39], v5 offset:9728
    s_waitcnt lgkmcnt(3)
    v_mfma_f32_16x16x32_bf16 v[56:59], v[8:11], v[24:27], v[56:59]
    s_waitcnt lgkmcnt(2)
    v_mfma_f32_16x16x32_bf16 v[60:63], v[8:11], v[28:31], v[60:63]
    v_mfma_f32_16x16x32_bf16 v[88:91], v[12:15], v[24:27], v[88:91]
    v_mfma_f32_16x16x32_bf16 v[92:95], v[12:15], v[28:31], v[92:95]
    v_mfma_f32_16x16x32_bf16 v[120:123], v[16:19], v[24:27], v[120:123]
    v_mfma_f32_16x16x32_bf16 v[124:127], v[16:19], v[28:31], v[124:127]
    s_waitcnt lgkmcnt(0)
    s_barrier
    v_add_u32 v4, 0xffff4000, v4
    v_mfma_f32_16x16x32_bf16 v[152:155], v[20:23], v[24:27], v[152:155]
    v_add_u32 v7, 0x0, v1
    v_add_u32 v1, 0xffff0000, v1
    ds_read_b128 v[24:27], v1 offset:0
    v_mfma_f32_16x16x32_bf16 v[156:159], v[20:23], v[28:31], v[156:159]
    v_add_u32 v5, 0xffff4000, v5
    v_mfma_f32_16x16x32_bf16 v[64:67], v[8:11], v[32:35], v[64:67]
    v_add_u32 v0, 0x0, v3
    ds_read_b128 v[28:31], v4 offset:0
    v_mfma_f32_16x16x32_bf16 v[68:71], v[8:11], v[36:39], v[68:71]
    v_add_u32 v3, 0xffff0000, v3
    ds_read_b128 v[8:11], v1 offset:2048
    v_mfma_f32_16x16x32_bf16 v[96:99], v[12:15], v[32:35], v[96:99]
    v_mfma_f32_16x16x32_bf16 v[100:103], v[12:15], v[36:39], v[100:103]
    ds_read_b128 v[12:15], v4 offset:512
    v_mfma_f32_16x16x32_bf16 v[128:131], v[16:19], v[32:35], v[128:131]
    v_mfma_f32_16x16x32_bf16 v[132:135], v[16:19], v[36:39], v[132:135]
    ds_read_b128 v[16:19], v4 offset:1024
    v_mfma_f32_16x16x32_bf16 v[160:163], v[20:23], v[32:35], v[160:163]
    ds_read_b128 v[32:35], v4 offset:1536
    v_mfma_f32_16x16x32_bf16 v[164:167], v[20:23], v[36:39], v[164:167]
    s_waitcnt lgkmcnt(4)
    v_mfma_f32_16x16x32_bf16 v[40:43], v[24:27], v[28:31], v[40:43]
    ds_read_b128 v[20:23], v5 offset:0
    s_waitcnt lgkmcnt(4)
L_mh7:
    s_cbranch_execz L_mh8
    v_mfma_f32_16x16x32_bf16 v[72:75], v[8:11], v[28:31], v[72:75]
    s_waitcnt lgkmcnt(3)
    v_mfma_f32_16x16x32_bf16 v[44:47], v[24:27], v[12:15], v[44:47]
    ds_read_b128 v[28:31], v5 offset:512
    v_mfma_f32_16x16x32_bf16 v[76:79], v[8:11], v[12:15], v[76:79]
    s_waitcnt lgkmcnt(3)
    v_mfma_f32_16x16x32_bf16 v[48:51], v[24:27], v[16:19], v[48:51]
    ds_read_b128 v[12:15], v5 offset:1024
    v_mfma_f32_16x16x32_bf16 v[80:83], v[8:11], v[16:19], v[80:83]
    ds_read_b128 v[36:39], v3 offset:0
    s_waitcnt lgkmcnt(4)
    v_mfma_f32_16x16x32_bf16 v[52:55], v[24:27], v[32:35], v[52:55]
    ds_read_b128 v[16:19], v5 offset:1536
    v_mfma_f32_16x16x32_bf16 v[84:87], v[8:11], v[32:35], v[84:87]
    s_waitcnt lgkmcnt(4)
    v_mfma_f32_16x16x32_bf16 v[56:59], v[24:27], v[20:23], v[56:59]
    ds_read_b128 v[32:35], v4 offset:8192
    v_mfma_f32_16x16x32_bf16 v[88:91], v[8:11], v[20:23], v[88:91]
    ds_read_b128 v[20:23], v3 offset:2048
    s_waitcnt lgkmcnt(5)
    v_mfma_f32_16x16x32_bf16 v[60:63], v[24:27], v[28:31], v[60:63]
    v_mfma_f32_16x16x32_bf16 v[92:95], v[8:11], v[28:31], v[92:95]
    ds_read_b128 v[28:31], v4 offset:8704
    s_waitcnt lgkmcnt(5)
    v_mfma_f32_16x16x32_bf16 v[64:67], v[24:27], v[12:15], v[64:67]
    v_mfma_f32_16x16x32_bf16 v[96:99], v[8:11], v[12:15], v[96:99]
    ds_read_b128 v[12:15], v4 offset:9216
    s_waitcnt lgkmcnt(4)
    v_mfma_f32_16x16x32_bf16 v[68:71], v[24:27], v[16:19], v[68:71]
    ds_read_b128 v[24:27], v4 offset:9728
    v_mfma_f32_16x16x32_bf16 v[100:103], v[8:11], v[16:19], v[100:103]
    s_waitcnt lgkmcnt(4)
    v_mfma_f32_16x16x32_bf16 v[40:43], v[36:39], v[32:35], v[40:43]
    ds_read_b128 v[8:11], v5 offset:8192
    s_waitcnt lgkmcnt(4)
    v_mfma_f32_16x16x32_bf16 v[72:75], v[20:23], v[32:35], v[72:75]
    s_waitcnt lgkmcnt(3)
    v_mfma_f32_16x16x32_bf16 v[44:47], v[36:39], v[28:31], v[44:47]
    ds_read_b128 v[32:35], v5 offset:8704
    v_mfma_f32_16x16x32_bf16 v[76:79], v[20:23], v[28:31], v[76:79]
    s_waitcnt lgkmcnt(3)
    v_mfma_f32_16x16x32_bf16 v[48:51], v[36:39], v[12:15], v[48:51]
    ds_read_b128 v[28:31], v5 offset:9216
    v_mfma_f32_16x16x32_bf16 v[80:83], v[20:23], v[12:15], v[80:83]
    s_barrier
    ds_read_b128 v[16:19], v1 offset:32768
    s_waitcnt lgkmcnt(4)
    v_mfma_f32_16x16x32_bf16 v[52:55], v[36:39], v[24:27], v[52:55]
L_mh8:
    s_cbranch_execz L_mh9
    ds_read_b128 v[12:15], v5 offset:9728
    v_mfma_f32_16x16x32_bf16 v[84:87], v[20:23], v[24:27], v[84:87]
    s_waitcnt lgkmcnt(4)
    v_mfma_f32_16x16x32_bf16 v[56:59], v[36:39], v[8:11], v[56:59]
    ds_read_b128 v[24:27], v4 offset:16384
    v_mfma_f32_16x16x32_bf16 v[88:91], v[20:23], v[8:11], v[88:91]
    ds_read_b128 v[8:11], v1 offset:34816
    s_waitcnt lgkmcnt(5)
    v_mfma_f32_16x16x32_bf16 v[60:63], v[36:39], v[32:35], v[60:63]
    v_mfma_f32_16x16x32_bf16 v[92:95], v[20:23], v[32:35], v[92:95]
    ds_read_b128 v[32:35], v4 offset:16896
    s_waitcnt lgkmcnt(5)
    v_mfma_f32_16x16x32_bf16 v[64:67], v[36:39], v[28:31], v[64:67]
    v_mfma_f32_16x16x32_bf16 v[96:99], v[20:23], v[28:31], v[96:99]
    ds_read_b128 v[28:31], v4 offset:17408
    s_waitcnt lgkmcnt(4)
    v_mfma_f32_16x16x32_bf16 v[68:71], v[36:39], v[12:15], v[68:71]
    ds_read_b128 v[36:39], v4 offset:17920
    v_mfma_f32_16x16x32_bf16 v[100:103], v[20:23], v[12:15], v[100:103]
    s_waitcnt lgkmcnt(4)
    v_mfma_f32_16x16x32_bf16 v[40:43], v[16:19], v[24:27], v[40:43]
    ds_read_b128 v[12:15], v5 offset:16384
    s_waitcnt lgkmcnt(4)
    v_mfma_f32_16x16x32_bf16 v[72:75], v[8:11], v[24:27], v[72:75]
    s_waitcnt lgkmcnt(3)
    v_mfma_f32_16x16x32_bf16 v[44:47], v[16:19], v[32:35], v[44:47]
    ds_read_b128 v[24:27], v5 offset:16896
    v_mfma_f32_16x16x32_bf16 v[76:79], v[8:11], v[32:35], v[76:79]
    s_waitcnt lgkmcnt(3)
    v_mfma_f32_16x16x32_bf16 v[48:51], v[16:19], v[28:31], v[48:51]
    ds_read_b128 v[32:35], v5 offset:17408
    v_mfma_f32_16x16x32_bf16 v[80:83], v[8:11], v[28:31], v[80:83]
    ds_read_b128 v[20:23], v3 offset:32768
    s_waitcnt lgkmcnt(4)
    v_mfma_f32_16x16x32_bf16 v[52:55], v[16:19], v[36:39], v[52:55]
    ds_read_b128 v[28:31], v5 offset:17920
    v_mfma_f32_16x16x32_bf16 v[84:87], v[8:11], v[36:39], v[84:87]
    s_waitcnt lgkmcnt(4)
    v_mfma_f32_16x16x32_bf16 v[56:59], v[16:19], v[12:15], v[56:59]
    ds_read_b128 v[36:39], v4 offset:24576
    v_mfma_f32_16x16x32_bf16 v[88:91], v[8:11], v[12:15], v[88:91]
    ds_read_b128 v[12:15], v3 offset:34816
    s_waitcnt lgkmcnt(5)
    v_mfma_f32_16x16x32_bf16 v[60:63], v[16:19], v[24:27], v[60:63]
    v_mfma_f32_16x16x32_bf16 v[92:95], v[8:11], v[24:27], v[92:95]
    ds_read_b128 v[24:27], v4 offset:25088
    s_waitcnt lgkmcnt(5)
    v_mfma_f32_16x16x32_bf16 v[64:67], v[16:19], v[32:35], v[64:67]
L_mh9:
    s_cbranch_execz L_mh10
    v_mfma_f32_16x16x32_bf16 v[96:99], v[8:11], v[32:35], v[96:99]
    ds_read_b128 v[32:35], v4 offset:25600
    s_waitcnt lgkmcnt(4)
    v_mfma_f32_16x16x32_bf16 v[68:71], v[16:19], v[28:31], v[68:71]
    ds_read_b128 v[16:19], v4 offset:26112
    v_mfma_f32_16x16x32_bf16 v[100:103], v[8:11], v[28:31], v[100:103]
    s_waitcnt lgkmcnt(4)
    v_mfma_f32_16x16x32_bf16 v[40:43], v[20:23], v[36:39], v[40:43]
    ds_read_b128 v[8:11], v5 offset:24576
    s_waitcnt lgkmcnt(4)
    v_mfma_f32_16x16x32_bf16 v[72:75], v[12:15], v[36:39], v[72:75]
    s_waitcnt lgkmcnt(3)
    v_mfma_f32_16x16x32_bf16 v[44:47], v[20:23], v[24:27], v[44:47]
    ds_read_b128 v[36:39], v5 offset:25088
    v_mfma_f32_16x16x32_bf16 v[76:79], v[12:15], v[24:27], v[76:79]
    s_waitcnt lgkmcnt(3)
    v_mfma_f32_16x16x32_bf16 v[48:51], v[20:23], v[32:35], v[48:51]
    ds_read_b128 v[24:27], v5 offset:25600
    v_mfma_f32_16x16x32_bf16 v[80:83], v[12:15], v[32:35], v[80:83]
    s_barrier
    ds_read_b128 v[28:31], v7 offset:0
    s_waitcnt lgkmcnt(4)
    v_mfma_f32_16x16x32_bf16 v[52:55], v[20:23], v[16:19], v[52:55]
    ds_read_b128 v[32:35], v5 offset:26112
    v_mfma_f32_16x16x32_bf16 v[84:87], v[12:15], v[16:19], v[84:87]
    s_waitcnt lgkmcnt(4)
    v_mfma_f32_16x16x32_bf16 v[56:59], v[20:23], v[8:11], v[56:59]
    ds_read_b128 v[16:19], v4 offset:32768
    v_mfma_f32_16x16x32_bf16 v[88:91], v[12:15], v[8:11], v[88:91]
    ds_read_b128 v[8:11], v7 offset:2048
    s_waitcnt lgkmcnt(5)
    v_mfma_f32_16x16x32_bf16 v[60:63], v[20:23], v[36:39], v[60:63]
    v_mfma_f32_16x16x32_bf16 v[92:95], v[12:15], v[36:39], v[92:95]
    ds_read_b128 v[36:39], v4 offset:33280
    s_waitcnt lgkmcnt(5)
    v_mfma_f32_16x16x32_bf16 v[64:67], v[20:23], v[24:27], v[64:67]
    v_mfma_f32_16x16x32_bf16 v[96:99], v[12:15], v[24:27], v[96:99]
    ds_read_b128 v[24:27], v4 offset:33792
    s_waitcnt lgkmcnt(4)
    v_mfma_f32_16x16x32_bf16 v[68:71], v[20:23], v[32:35], v[68:71]
    ds_read_b128 v[20:23], v4 offset:34304
    v_mfma_f32_16x16x32_bf16 v[100:103], v[12:15], v[32:35], v[100:103]
    s_waitcnt lgkmcnt(4)
    v_mfma_f32_16x16x32_bf16 v[40:43], v[28:31], v[16:19], v[40:43]
    ds_read_b128 v[12:15], v5 offset:32768
    s_waitcnt lgkmcnt(4)
    v_mfma_f32_16x16x32_bf16 v[72:75], v[8:11], v[16:19], v[72:75]
    s_waitcnt lgkmcnt(3)
L_mh10:
    s_cbranch_execz L_mh11
    v_mfma_f32_16x16x32_bf16 v[44:47], v[28:31], v[36:39], v[44:47]
    ds_read_b128 v[16:19], v5 offset:33280
    v_mfma_f32_16x16x32_bf16 v[76:79], v[8:11], v[36:39], v[76:79]
    s_waitcnt lgkmcnt(3)
    v_mfma_f32_16x16x32_bf16 v[48:51], v[28:31], v[24:27], v[48:51]
    ds_read_b128 v[36:39], v5 offset:33792
    v_mfma_f32_16x16x32_bf16 v[80:83], v[8:11], v[24:27], v[80:83]
    ds_read_b128 v[32:35], v0 offset:0
    s_waitcnt lgkmcnt(4)
    v_mfma_f32_16x16x32_bf16 v[52:55], v[28:31], v[20:23], v[52:55]
    ds_read_b128 v[24:27], v5 offset:34304
    v_mfma_f32_16x16x32_bf16 v[84:87], v[8:11], v[20:23], v[84:87]
    s_waitcnt lgkmcnt(4)
    v_mfma_f32_16x16x32_bf16 v[56:59], v[28:31], v[12:15], v[56:59]
    ds_read_b128 v[20:23], v4 offset:40960
    v_mfma_f32_16x16x32_bf16 v[88:91], v[8:11], v[12:15], v[88:91]
    ds_read_b128 v[12:15], v0 offset:2048
    s_waitcnt lgkmcnt(5)
    v_mfma_f32_16x16x32_bf16 v[60:63], v[28:31], v[16:19], v[60:63]
    v_mfma_f32_16x16x32_bf16 v[92:95], v[8:11], v[16:19], v[92:95]
    ds_read_b128 v[16:19], v4 offset:41472
    s_waitcnt lgkmcnt(5)
    v_mfma_f32_16x16x32_bf16 v[64:67], v[28:31], v[36:39], v[64:67]
    v_mfma_f32_16x16x32_bf16 v[96:99], v[8:11], v[36:39], v[96:99]
    ds_read_b128 v[36:39], v4 offset:41984
    s_waitcnt lgkmcnt(4)
    v_mfma_f32_16x16x32_bf16 v[68:71], v[28:31], v[24:27], v[68:71]
    ds_read_b128 v[28:31], v4 offset:42496
    v_mfma_f32_16x16x32_bf16 v[100:103], v[8:11], v[24:27], v[100:103]
    s_waitcnt lgkmcnt(4)
    v_mfma_f32_16x16x32_bf16 v[40:43], v[32:35], v[20:23], v[40:43]
    ds_read_b128 v[8:11], v5 offset:40960
    s_waitcnt lgkmcnt(4)
    v_mfma_f32_16x16x32_bf16 v[72:75], v[12:15], v[20:23], v[72:75]
    s_waitcnt lgkmcnt(3)
    v_mfma_f32_16x16x32_bf16 v[44:47], v[32:35], v[16:19], v[44:47]
    ds_read_b128 v[20:23], v5 offset:41472
    v_mfma_f32_16x16x32_bf16 v[76:79], v[12:15], v[16:19], v[76:79]
    s_waitcnt lgkmcnt(3)
    v_mfma_f32_16x16x32_bf16 v[48:51], v[32:35], v[36:39], v[48:51]
    ds_read_b128 v[16:19], v5 offset:41984
    v_mfma_f32_16x16x32_bf16 v[80:83], v[12:15], v[36:39], v[80:83]
    s_barrier
    ds_read_b128 v[24:27], v1 offset:0
    s_waitcnt lgkmcnt(4)
    v_mfma_f32_16x16x32_bf16 v[52:55], v[32:35], v[28:31], v[52:55]
    ds_read_b128 v[36:39], v5 offset:42496
    v_mfma_f32_16x16x32_bf16 v[84:87], v[12:15], v[28:31], v[84:87]
L_mh11:
    s_cbranch_execz L_mhret
    s_waitcnt lgkmcnt(4)
    v_mfma_f32_16x16x32_bf16 v[56:59], v[32:35], v[8:11], v[56:59]
    ds_read_b128 v[28:31], v4 offset:49152
    v_mfma_f32_16x16x32_bf16 v[88:91], v[12:15], v[8:11], v[88:91]
    ds_read_b128 v[8:11], v1 offset:2048
    s_waitcnt lgkmcnt(5)
    v_mfma_f32_16x16x32_bf16 v[60:63], v[32:35], v[20:23], v[60:63]
    v_mfma_f32_16x16x32_bf16 v[92:95], v[12:15], v[20:23], v[92:95]
    ds_read_b128 v[20:23], v4 offset:49664
    s_waitcnt lgkmcnt(5)
    v_mfma_f32_16x16x32_bf16 v[64:67], v[32:35], v[16:19], v[64:67]
    v_mfma_f32_16x16x32_bf16 v[96:99], v[12:15], v[16:19], v[96:99]
    ds_read_b128 v[16:19], v4 offset:50176
    s_waitcnt lgkmcnt(4)
    v_mfma_f32_16x16x32_bf16 v[68:71], v[32:35], v[36:39], v[68:71]
    ds_read_b128 v[32:35], v4 offset:50688
    v_mfma_f32_16x16x32_bf16 v[100:103], v[12:15], v[36:39], v[100:103]
    s_waitcnt lgkmcnt(4)
    v_mfma_f32_16x16x32_bf16 v[40:43], v[24:27], v[28:31], v[40:43]
    ds_read_b128 v[12:15], v5 offset:49152
    s_waitcnt lgkmcnt(4)
    v_mfma_f32_16x16x32_bf16 v[72:75], v[8:11], v[28:31], v[72:75]
    s_waitcnt lgkmcnt(3)
    v_mfma_f32_16x16x32_bf16 v[44:47], v[24:27], v[20:23], v[44:47]
    ds_read_b128 v[28:31], v5 offset:49664
    v_mfma_f32_16x16x32_bf16 v[76:79], v[8:11], v[20:23], v[76:79]
    s_waitcnt lgkmcnt(3)
    v_mfma_f32_16x16x32_bf16 v[48:51], v[24:27], v[16:19], v[48:51]
    ds_read_b128 v[20:23], v5 offset:50176
    v_mfma_f32_16x16x32_bf16 v[80:83], v[8:11], v[16:19], v[80:83]
    ds_read_b128 v[36:39], v3 offset:0
    s_waitcnt lgkmcnt(4)
    v_mfma_f32_16x16x32_bf16 v[52:55], v[24:27], v[32:35], v[52:55]
    ds_read_b128 v[16:19], v5 offset:50688
    v_mfma_f32_16x16x32_bf16 v[84:87], v[8:11], v[32:35], v[84:87]
    s_waitcnt lgkmcnt(4)
    v_mfma_f32_16x16x32_bf16 v[56:59], v[24:27], v[12:15], v[56:59]
    ds_read_b128 v[32:35], v4 offset:57344
    v_mfma_f32_16x16x32_bf16 v[88:91], v[8:11], v[12:15], v[88:91]
    ds_read_b128 v[12:15], v3 offset:2048
    s_waitcnt lgkmcnt(5)
    v_mfma_f32_16x16x32_bf16 v[60:63], v[24:27], v[28:31], v[60:63]
    v_mfma_f32_16x16x32_bf16 v[92:95], v[8:11], v[28:31], v[92:95]
    ds_read_b128 v[28:31], v4 offset:57856
    s_waitcnt lgkmcnt(5)
    v_mfma_f32_16x16x32_bf16 v[64:67], v[24:27], v[20:23], v[64:67]
    v_mfma_f32_16x16x32_bf16 v[96:99], v[8:11], v[20:23], v[96:99]
    ds_read_b128 v[20:23], v4 offset:58368
L_mh12:
    s_cbranch_execz L_mh13
    s_waitcnt lgkmcnt(4)
    v_mfma_f32_16x16x32_bf16 v[68:71], v[24:27], v[16:19], v[68:71]
    ds_read_b128 v[24:27], v4 offset:58880
    v_mfma_f32_16x16x32_bf16 v[100:103], v[8:11], v[16:19], v[100:103]
    s_waitcnt lgkmcnt(4)
    v_mfma_f32_16x16x32_bf16 v[40:43], v[36:39], v[32:35], v[40:43]
    ds_read_b128 v[8:11], v5 offset:57344
    s_waitcnt lgkmcnt(4)
    v_mfma_f32_16x16x32_bf16 v[72:75], v[12:15], v[32:35], v[72:75]
    s_waitcnt lgkmcnt(3)
    v_mfma_f32_16x16x32_bf16 v[44:47], v[36:39], v[28:31], v[44:47]
    ds_read_b128 v[32:35], v5 offset:57856
    v_mfma_f32_16x16x32_bf16 v[76:79], v[12:15], v[28:31], v[76:79]
    s_waitcnt lgkmcnt(3)
    v_mfma_f32_16x16x32_bf16 v[48:51], v[36:39], v[20:23], v[48:51]
    ds_read_b128 v[28:31], v5 offset:58368
    v_mfma_f32_16x16x32_bf16 v[80:83], v[12:15], v[20:23], v[80:83]
    ds_read_b128 v[16:19], v1 offset:4096
    s_waitcnt lgkmcnt(4)
    v_mfma_f32_16x16x32_bf16 v[52:55], v[36:39], v[24:27], v[52:55]
    ds_read_b128 v[20:23], v5 offset:58880
    v_mfma_f32_16x16x32_bf16 v[84:87], v[12:15], v[24:27], v[84:87]
    s_waitcnt lgkmcnt(4)
    v_mfma_f32_16x16x32_bf16 v[56:59], v[36:39], v[8:11], v[56:59]
    ds_read_b128 v[24:27], v4 offset:0
    v_mfma_f32_16x16x32_bf16 v[88:91], v[12:15], v[8:11], v[88:91]
    ds_read_b128 v[8:11], v1 offset:6144
    s_waitcnt lgkmcnt(5)
    v_mfma_f32_16x16x32_bf16 v[60:63], v[36:39], v[32:35], v[60:63]
    v_mfma_f32_16x16x32_bf16 v[92:95], v[12:15], v[32:35], v[92:95]
    ds_read_b128 v[32:35], v4 offset:512
    s_waitcnt lgkmcnt(5)
    v_mfma_f32_16x16x32_bf16 v[64:67], v[36:39], v[28:31], v[64:67]
    v_mfma_f32_16x16x32_bf16 v[96:99], v[12:15], v[28:31], v[96:99]
    ds_read_b128 v[28:31], v4 offset:1024
    s_waitcnt lgkmcnt(4)
    v_mfma_f32_16x16x32_bf16 v[68:71], v[36:39], v[20:23], v[68:71]
    ds_read_b128 v[36:39], v4 offset:1536
    v_mfma_f32_16x16x32_bf16 v[100:103], v[12:15], v[20:23], v[100:103]
    s_waitcnt lgkmcnt(4)
    v_mfma_f32_16x16x32_bf16 v[104:107], v[16:19], v[24:27], v[104:107]
    ds_read_b128 v[12:15], v5 offset:0
    s_waitcnt lgkmcnt(4)
    v_mfma_f32_16x16x32_bf16 v[136:139], v[8:11], v[24:27], v[136:139]
    s_waitcnt lgkmcnt(3)
    v_mfma_f32_16x16x32_bf16 v[108:111], v[16:19], v[32:35], v[108:111]
    ds_read_b128 v[24:27], v5 offset:512
    v_mfma_f32_16x16x32_bf16 v[140:143], v[8:11], v[32:35], v[140:143]
L_mh13:
    s_cbranch_execz L_mh14
    s_waitcnt lgkmcnt(3)
    v_mfma_f32_16x16x32_bf16 v[112:115], v[16:19], v[28:31], v[112:115]
    ds_read_b128 v[20:23], v5 offset:1024
    v_cvt_pk_bf16_f32 v32, v40, v44
    v_cvt_pk_bf16_f32 v33, v48, v52
    v_mfma_f32_16x16x32_bf16 v[144:147], v[8:11], v[28:31], v[144:147]
    v_cvt_pk_bf16_f32 v34, v56, v60
    v_cvt_pk_bf16_f32 v35, v64, v68
    s_waitcnt lgkmcnt(3)
    v_mfma_f32_16x16x32_bf16 v[116:119], v[16:19], v[36:39], v[116:119]
    ds_read_b128 v[28:31], v5 offset:1536
    buffer_store_dwordx4 v[32:35], v6, s[28:31], s36 offen sc1 nt
    s_add_u32 s36, s36, 7168
    v_mfma_f32_16x16x32_bf16 v[148:151], v[8:11], v[36:39], v[148:151]
    ds_read_b128 v[36:39], v3 offset:4096
    v_cvt_pk_bf16_f32 v32, v41, v45
    v_cvt_pk_bf16_f32 v33, v49, v53
    s_waitcnt lgkmcnt(4)
    v_mfma_f32_16x16x32_bf16 v[120:123], v[16:19], v[12:15], v[120:123]
    v_cvt_pk_bf16_f32 v34, v57, v61
    v_cvt_pk_bf16_f32 v35, v65, v69
    v_mfma_f32_16x16x32_bf16 v[152:155], v[8:11], v[12:15], v[152:155]
    ds_read_b128 v[12:15], v4 offset:8192
    buffer_store_dwordx4 v[32:35], v6, s[28:31], s36 offen sc1 nt
    s_add_u32 s36, s36, 7168
    s_waitcnt lgkmcnt(4)
    v_mfma_f32_16x16x32_bf16 v[124:127], v[16:19], v[24:27], v[124:127]
    v_cvt_pk_bf16_f32 v32, v42, v46
    v_cvt_pk_bf16_f32 v33, v50, v54
    v_mfma_f32_16x16x32_bf16 v[156:159], v[8:11], v[24:27], v[156:159]
    ds_read_b128 v[24:27], v3 offset:6144
    v_cvt_pk_bf16_f32 v34, v58, v62
    v_cvt_pk_bf16_f32 v35, v66, v70
    s_waitcnt lgkmcnt(4)
    v_mfma_f32_16x16x32_bf16 v[128:131], v[16:19], v[20:23], v[128:131]
    buffer_store_dwordx4 v[32:35], v6, s[28:31], s36 offen sc1 nt
    s_add_u32 s36, s36, 7168
    v_mfma_f32_16x16x32_bf16 v[160:163], v[8:11], v[20:23], v[160:163]
    ds_read_b128 v[20:23], v4 offset:8704
    v_cvt_pk_bf16_f32 v32, v43, v47
    v_cvt_pk_bf16_f32 v33, v51, v55
    s_waitcnt lgkmcnt(4)
    v_mfma_f32_16x16x32_bf16 v[132:135], v[16:19], v[28:31], v[132:135]
    ds_read_b128 v[16:19], v4 offset:9216
    v_cvt_pk_bf16_f32 v34, v59, v63
    v_cvt_pk_bf16_f32 v35, v67, v71
    v_mfma_f32_16x16x32_bf16 v[164:167], v[8:11], v[28:31], v[164:167]
    ds_read_b128 v[8:11], v4 offset:9728
L_mh14:
    s_cbranch_execz L_mh15
    buffer_store_dwordx4 v[32:35], v6, s[28:31], s36 offen sc1 nt
    s_add_u32 s36, s36, 93184
    s_waitcnt lgkmcnt(4)
    v_mfma_f32_16x16x32_bf16 v[104:107], v[36:39], v[12:15], v[104:107]
    ds_read_b128 v[32:35], v5 offset:8192
    v_cvt_pk_bf16_f32 v40, v72, v76
    v_cvt_pk_bf16_f32 v41, v80, v84
    s_waitcnt lgkmcnt(4)
    v_mfma_f32_16x16x32_bf16 v[136:139], v[24:27], v[12:15], v[136:139]
    v_cvt_pk_bf16_f32 v42, v88, v92
    v_cvt_pk_bf16_f32 v43, v96, v100
    s_waitcnt lgkmcnt(3)
    v_mfma_f32_16x16x32_bf16 v[108:111], v[36:39], v[20:23], v[108:111]
    ds_read_b128 v[12:15], v5 offset:8704
    buffer_store_dwordx4 v[40:43], v6, s[28:31], s36 offen sc1 nt
    s_add_u32 s36, s36, 7168
    v_mfma_f32_16x16x32_bf16 v[140:143], v[24:27], v[20:23], v[140:143]
    v_cvt_pk_bf16_f32 v44, v73, v77
    v_cvt_pk_bf16_f32 v45, v81, v85
    s_waitcnt lgkmcnt(3)
    v_mfma_f32_16x16x32_bf16 v[112:115], v[36:39], v[16:19], v[112:115]
    ds_read_b128 v[20:23], v5 offset:9216
    v_cvt_pk_bf16_f32 v46, v89, v93
    v_cvt_pk_bf16_f32 v47, v97, v101
    v_mfma_f32_16x16x32_bf16 v[144:147], v[24:27], v[16:19], v[144:147]
    ds_read_b128 v[28:31], v1 offset:36864
    buffer_store_dwordx4 v[44:47], v6, s[28:31], s36 offen sc1 nt
    s_add_u32 s36, s36, 7168
    s_waitcnt lgkmcnt(4)
    v_mfma_f32_16x16x32_bf16 v[116:119], v[36:39], v[8:11], v[116:119]
    ds_read_b128 v[16:19], v5 offset:9728
    v_cvt_pk_bf16_f32 v40, v74, v78
    v_cvt_pk_bf16_f32 v41, v82, v86
    v_mfma_f32_16x16x32_bf16 v[148:151], v[24:27], v[8:11], v[148:151]
    ds_read_b128 v[48:51], v1 offset:38912
    v_cvt_pk_bf16_f32 v42, v90, v94
    v_cvt_pk_bf16_f32 v43, v98, v102
    s_waitcnt lgkmcnt(5)
    v_mfma_f32_16x16x32_bf16 v[120:123], v[36:39], v[32:35], v[120:123]
    ds_read_b128 v[8:11], v4 offset:16384
    buffer_store_dwordx4 v[40:43], v6, s[28:31], s36 offen sc1 nt
    s_add_u32 s36, s36, 7168
    v_mfma_f32_16x16x32_bf16 v[152:155], v[24:27], v[32:35], v[152:155]
    v_cvt_pk_bf16_f32 v44, v75, v79
    v_cvt_pk_bf16_f32 v45, v83, v87
    s_waitcnt lgkmcnt(5)
    v_mfma_f32_16x16x32_bf16 v[124:127], v[36:39], v[12:15], v[124:127]
    ds_read_b128 v[32:35], v4 offset:16896
L_mh15:
    s_cbranch_execz L_mh16
    v_cvt_pk_bf16_f32 v46, v91, v95
    v_cvt_pk_bf16_f32 v47, v99, v103
    v_mfma_f32_16x16x32_bf16 v[156:159], v[24:27], v[12:15], v[156:159]
    buffer_store_dwordx4 v[44:47], v6, s[28:31], s36 offen sc1 nt
    s_add_u32 s36, s36, 93184
    s_waitcnt lgkmcnt(5)
    v_mfma_f32_16x16x32_bf16 v[128:131], v[36:39], v[20:23], v[128:131]
    ds_read_b128 v[80:83], v4 offset:17408
    v_mfma_f32_16x16x32_bf16 v[160:163], v[24:27], v[20:23], v[160:163]
    s_waitcnt lgkmcnt(4)
    v_mfma_f32_16x16x32_bf16 v[132:135], v[36:39], v[16:19], v[132:135]
    ds_read_b128 v[36:39], v4 offset:17920
    v_mfma_f32_16x16x32_bf16 v[164:167], v[24:27], v[16:19], v[164:167]
    s_waitcnt lgkmcnt(3)
    v_mfma_f32_16x16x32_bf16 v[104:107], v[28:31], v[8:11], v[104:107]
    ds_read_b128 v[24:27], v5 offset:16384
    v_mfma_f32_16x16x32_bf16 v[136:139], v[48:51], v[8:11], v[136:139]
    s_waitcnt lgkmcnt(3)
    v_mfma_f32_16x16x32_bf16 v[108:111], v[28:31], v[32:35], v[108:111]
    ds_read_b128 v[8:11], v5 offset:16896
    v_mfma_f32_16x16x32_bf16 v[140:143], v[48:51], v[32:35], v[140:143]
    s_waitcnt lgkmcnt(3)
    v_mfma_f32_16x16x32_bf16 v[112:115], v[28:31], v[80:83], v[112:115]
    ds_read_b128 v[32:35], v5 offset:17408
    v_mfma_f32_16x16x32_bf16 v[144:147], v[48:51], v[80:83], v[144:147]
    ds_read_b128 v[12:15], v3 offset:36864
    s_waitcnt lgkmcnt(4)
    v_mfma_f32_16x16x32_bf16 v[116:119], v[28:31], v[36:39], v[116:119]
    ds_read_b128 v[80:83], v5 offset:17920
    v_mfma_f32_16x16x32_bf16 v[148:151], v[48:51], v[36:39], v[148:151]
    ds_read_b128 v[16:19], v3 offset:38912
    s_waitcnt lgkmcnt(5)
    v_mfma_f32_16x16x32_bf16 v[120:123], v[28:31], v[24:27], v[120:123]
    ds_read_b128 v[36:39], v4 offset:24576
    v_mfma_f32_16x16x32_bf16 v[152:155], v[48:51], v[24:27], v[152:155]
    s_waitcnt lgkmcnt(5)
    v_mfma_f32_16x16x32_bf16 v[124:127], v[28:31], v[8:11], v[124:127]
    ds_read_b128 v[24:27], v4 offset:25088
    v_mfma_f32_16x16x32_bf16 v[156:159], v[48:51], v[8:11], v[156:159]
    s_waitcnt lgkmcnt(5)
    v_mfma_f32_16x16x32_bf16 v[128:131], v[28:31], v[32:35], v[128:131]
    ds_read_b128 v[8:11], v4 offset:25600
    v_mfma_f32_16x16x32_bf16 v[160:163], v[48:51], v[32:35], v[160:163]
    s_waitcnt lgkmcnt(4)
    v_mfma_f32_16x16x32_bf16 v[132:135], v[28:31], v[80:83], v[132:135]
    ds_read_b128 v[28:31], v4 offset:26112
    v_mfma_f32_16x16x32_bf16 v[164:167], v[48:51], v[80:83], v[164:167]
    s_waitcnt lgkmcnt(3)
L_mh16:
    s_cbranch_execz L_mh17
    v_mfma_f32_16x16x32_bf16 v[104:107], v[12:15], v[36:39], v[104:107]
    ds_read_b128 v[48:51], v5 offset:24576
    v_mfma_f32_16x16x32_bf16 v[136:139], v[16:19], v[36:39], v[136:139]
    s_waitcnt lgkmcnt(3)
    v_mfma_f32_16x16x32_bf16 v[108:111], v[12:15], v[24:27], v[108:111]
    ds_read_b128 v[36:39], v5 offset:25088
    v_mfma_f32_16x16x32_bf16 v[140:143], v[16:19], v[24:27], v[140:143]
    s_waitcnt lgkmcnt(3)
    v_mfma_f32_16x16x32_bf16 v[112:115], v[12:15], v[8:11], v[112:115]
    ds_read_b128 v[24:27], v5 offset:25600
    v_mfma_f32_16x16x32_bf16 v[144:147], v[16:19], v[8:11], v[144:147]
    s_barrier
    ds_read_b128 v[20:23], v7 offset:4096
    s_waitcnt lgkmcnt(4)
    v_mfma_f32_16x16x32_bf16 v[116:119], v[12:15], v[28:31], v[116:119]
    ds_read_b128 v[8:11], v5 offset:26112
    v_mfma_f32_16x16x32_bf16 v[148:151], v[16:19], v[28:31], v[148:151]
    ds_read_b128 v[80:83], v7 offset:6144
    s_waitcnt lgkmcnt(5)
    v_mfma_f32_16x16x32_bf16 v[120:123], v[12:15], v[48:51], v[120:123]
    ds_read_b128 v[28:31], v4 offset:32768
    v_mfma_f32_16x16x32_bf16 v[152:155], v[16:19], v[48:51], v[152:155]
    s_waitcnt lgkmcnt(5)
    v_mfma_f32_16x16x32_bf16 v[124:127], v[12:15], v[36:39], v[124:127]
    ds_read_b128 v[48:51], v4 offset:33280
    v_mfma_f32_16x16x32_bf16 v[156:159], v[16:19], v[36:39], v[156:159]
    s_waitcnt lgkmcnt(5)
    v_mfma_f32_16x16x32_bf16 v[128:131], v[12:15], v[24:27], v[128:131]
    ds_read_b128 v[36:39], v4 offset:33792
    v_mfma_f32_16x16x32_bf16 v[160:163], v[16:19], v[24:27], v[160:163]
    s_waitcnt lgkmcnt(4)
    v_mfma_f32_16x16x32_bf16 v[132:135], v[12:15], v[8:11], v[132:135]
    ds_read_b128 v[12:15], v4 offset:34304
    v_mfma_f32_16x16x32_bf16 v[164:167], v[16:19], v[8:11], v[164:167]
    s_waitcnt lgkmcnt(3)
    v_mfma_f32_16x16x32_bf16 v[104:107], v[20:23], v[28:31], v[104:107]
    ds_read_b128 v[8:11], v5 offset:32768
    v_mfma_f32_16x16x32_bf16 v[136:139], v[80:83], v[28:31], v[136:139]
    s_waitcnt lgkmcnt(3)
    v_mfma_f32_16x16x32_bf16 v[108:111], v[20:23], v[48:51], v[108:111]
    ds_read_b128 v[28:31], v5 offset:33280
    v_mfma_f32_16x16x32_bf16 v[140:143], v[80:83], v[48:51], v[140:143]
    s_waitcnt lgkmcnt(3)
    v_mfma_f32_16x16x32_bf16 v[112:115], v[20:23], v[36:39], v[112:115]
    ds_read_b128 v[48:51], v5 offset:33792
    v_mfma_f32_16x16x32_bf16 v[144:147], v[80:83], v[36:39], v[144:147]
    ds_read_b128 v[24:27], v0 offset:4096
    s_waitcnt lgkmcnt(4)
L_mh17:
    s_cbranch_execz L_mhret
    v_mfma_f32_16x16x32_bf16 v[116:119], v[20:23], v[12:15], v[116:119]
    ds_read_b128 v[36:39], v5 offset:34304
    v_mfma_f32_16x16x32_bf16 v[148:151], v[80:83], v[12:15], v[148:151]
    ds_read_b128 v[16:19], v0 offset:6144
    s_waitcnt lgkmcnt(5)
    v_mfma_f32_16x16x32_bf16 v[120:123], v[20:23], v[8:11], v[120:123]
    ds_read_b128 v[12:15], v4 offset:40960
    v_mfma_f32_16x16x32_bf16 v[152:155], v[80:83], v[8:11], v[152:155]
    s_waitcnt lgkmcnt(5)
    v_mfma_f32_16x16x32_bf16 v[124:127], v[20:23], v[28:31], v[124:127]
    ds_read_b128 v[8:11], v4 offset:41472
    v_mfma_f32_16x16x32_bf16 v[156:159], v[80:83], v[28:31], v[156:159]
    s_waitcnt lgkmcnt(5)
    v_mfma_f32_16x16x32_bf16 v[128:131], v[20:23], v[48:51], v[128:131]
    ds_read_b128 v[28:31], v4 offset:41984
    v_mfma_f32_16x16x32_bf16 v[160:163], v[80:83], v[48:51], v[160:163]
    s_waitcnt lgkmcnt(4)
    v_mfma_f32_16x16x32_bf16 v[132:135], v[20:23], v[36:39], v[132:135]
    ds_read_b128 v[20:23], v4 offset:42496
    v_mfma_f32_16x16x32_bf16 v[164:167], v[80:83], v[36:39], v[164:167]
    s_waitcnt lgkmcnt(3)
    v_mfma_f32_16x16x32_bf16 v[104:107], v[24:27], v[12:15], v[104:107]
    ds_read_b128 v[36:39], v5 offset:40960
    v_mfma_f32_16x16x32_bf16 v[136:139], v[16:19], v[12:15], v[136:139]
    s_waitcnt lgkmcnt(3)
    v_mfma_f32_16x16x32_bf16 v[108:111], v[24:27], v[8:11], v[108:111]
    ds_read_b128 v[12:15], v5 offset:41472
    v_mfma_f32_16x16x32_bf16 v[140:143], v[16:19], v[8:11], v[140:143]
    ds_read_b128 v[60:63], v1 offset:34816
    s_waitcnt lgkmcnt(4)
    v_mfma_f32_16x16x32_bf16 v[112:115], v[24:27], v[28:31], v[112:115]
    ds_read_b128 v[8:11], v5 offset:41984
    v_mfma_f32_16x16x32_bf16 v[144:147], v[16:19], v[28:31], v[144:147]
    ds_read_b128 v[32:35], v1 offset:32768
    s_waitcnt lgkmcnt(5)
    v_mfma_f32_16x16x32_bf16 v[116:119], v[24:27], v[20:23], v[116:119]
    ds_read_b128 v[28:31], v5 offset:42496
    v_mfma_f32_16x16x32_bf16 v[148:151], v[16:19], v[20:23], v[148:151]
    ds_read_b128 v[52:55], v3 offset:32768
    s_waitcnt lgkmcnt(6)
    v_mfma_f32_16x16x32_bf16 v[120:123], v[24:27], v[36:39], v[120:123]
    ds_read_b128 v[20:23], v4 offset:49152
    v_mfma_f32_16x16x32_bf16 v[152:155], v[16:19], v[36:39], v[152:155]
    ds_read_b128 v[36:39], v4 offset:49664
    s_waitcnt lgkmcnt(7)
    v_mfma_f32_16x16x32_bf16 v[124:127], v[24:27], v[12:15], v[124:127]
    ds_read_b128 v[80:83], v4 offset:50176
    v_mfma_f32_16x16x32_bf16 v[156:159], v[16:19], v[12:15], v[156:159]
L_mh18:
    s_cbranch_execz L_mh19
    ds_read_b128 v[12:15], v4 offset:50688
    s_waitcnt lgkmcnt(7)
    v_mfma_f32_16x16x32_bf16 v[128:131], v[24:27], v[8:11], v[128:131]
    ds_read_b128 v[48:51], v5 offset:49152
    v_mfma_f32_16x16x32_bf16 v[160:163], v[16:19], v[8:11], v[160:163]
    ds_read_b128 v[8:11], v5 offset:49664
    s_waitcnt lgkmcnt(7)
    v_mfma_f32_16x16x32_bf16 v[132:135], v[24:27], v[28:31], v[132:135]
    ds_read_b128 v[24:27], v5 offset:50176
    v_mfma_f32_16x16x32_bf16 v[164:167], v[16:19], v[28:31], v[164:167]
    ds_read_b128 v[28:31], v5 offset:50688
    s_waitcnt lgkmcnt(7)
    v_mfma_f32_16x16x32_bf16 v[104:107], v[32:35], v[20:23], v[104:107]
    ds_read_b128 v[16:19], v4 offset:57344
    s_waitcnt lgkmcnt(7)
    v_mfma_f32_16x16x32_bf16 v[108:111], v[32:35], v[36:39], v[108:111]
    ds_read_b128 v[84:87], v4 offset:57856
    s_waitcnt lgkmcnt(7)
    v_mfma_f32_16x16x32_bf16 v[112:115], v[32:35], v[80:83], v[112:115]
    ds_read_b128 v[88:91], v4 offset:58368
    s_waitcnt lgkmcnt(7)
    v_mfma_f32_16x16x32_bf16 v[116:119], v[32:35], v[12:15], v[116:119]
    ds_read_b128 v[92:95], v4 offset:58880
    s_waitcnt lgkmcnt(7)
    v_mfma_f32_16x16x32_bf16 v[120:123], v[32:35], v[48:51], v[120:123]
    ds_read_b128 v[96:99], v5 offset:57344
    s_waitcnt lgkmcnt(7)
    v_mfma_f32_16x16x32_bf16 v[124:127], v[32:35], v[8:11], v[124:127]
    ds_read_b128 v[100:103], v5 offset:57856
    s_waitcnt lgkmcnt(7)
    v_mfma_f32_16x16x32_bf16 v[128:131], v[32:35], v[24:27], v[128:131]
    ds_read_b128 v[56:59], v5 offset:58368
    s_waitcnt lgkmcnt(7)
    v_mfma_f32_16x16x32_bf16 v[132:135], v[32:35], v[28:31], v[132:135]
    ds_read_b128 v[32:35], v5 offset:58880
    s_waitcnt lgkmcnt(7)
    v_mfma_f32_16x16x32_bf16 v[104:107], v[52:55], v[16:19], v[104:107]
    s_waitcnt lgkmcnt(6)
    v_mfma_f32_16x16x32_bf16 v[108:111], v[52:55], v[84:87], v[108:111]
    s_waitcnt lgkmcnt(5)
    v_mfma_f32_16x16x32_bf16 v[112:115], v[52:55], v[88:91], v[112:115]
    s_waitcnt lgkmcnt(4)
    v_mfma_f32_16x16x32_bf16 v[116:119], v[52:55], v[92:95], v[116:119]
    s_waitcnt lgkmcnt(3)
    v_mfma_f32_16x16x32_bf16 v[120:123], v[52:55], v[96:99], v[120:123]
    s_waitcnt lgkmcnt(2)
    v_mfma_f32_16x16x32_bf16 v[124:127], v[52:55], v[100:103], v[124:127]
    s_waitcnt lgkmcnt(1)
L_mh19:
    s_cbranch_execz L_mh20
    v_mfma_f32_16x16x32_bf16 v[128:131], v[52:55], v[56:59], v[128:131]
    ds_read_b128 v[64:67], v3 offset:34816
    s_waitcnt lgkmcnt(1)
    v_mfma_f32_16x16x32_bf16 v[132:135], v[52:55], v[32:35], v[132:135]
    v_mfma_f32_16x16x32_bf16 v[136:139], v[60:63], v[20:23], v[136:139]
    v_mfma_f32_16x16x32_bf16 v[140:143], v[60:63], v[36:39], v[140:143]
    v_mfma_f32_16x16x32_bf16 v[144:147], v[60:63], v[80:83], v[144:147]
    v_mfma_f32_16x16x32_bf16 v[148:151], v[60:63], v[12:15], v[148:151]
    v_mfma_f32_16x16x32_bf16 v[152:155], v[60:63], v[48:51], v[152:155]
    v_mfma_f32_16x16x32_bf16 v[156:159], v[60:63], v[8:11], v[156:159]
    v_cvt_pk_bf16_f32 v72, v104, v108
    v_cvt_pk_bf16_f32 v73, v112, v116
    v_cvt_pk_bf16_f32 v74, v120, v124
    v_mfma_f32_16x16x32_bf16 v[160:163], v[60:63], v[24:27], v[160:163]
    v_cvt_pk_bf16_f32 v75, v128, v132
    buffer_store_dwordx4 v[72:75], v6, s[28:31], s36 offen sc1 nt
    s_add_u32 s36, s36, 7168
    v_mfma_f32_16x16x32_bf16 v[164:167], v[60:63], v[28:31], v[164:167]
    v_cvt_pk_bf16_f32 v76, v105, v109
    v_cvt_pk_bf16_f32 v77, v113, v117
    v_cvt_pk_bf16_f32 v78, v121, v125
    s_waitcnt lgkmcnt(0)
    v_mfma_f32_16x16x32_bf16 v[136:139], v[64:67], v[16:19], v[136:139]
    v_cvt_pk_bf16_f32 v79, v129, v133
    buffer_store_dwordx4 v[76:79], v6, s[28:31], s36 offen sc1 nt
    s_add_u32 s36, s36, 7168
    v_mfma_f32_16x16x32_bf16 v[140:143], v[64:67], v[84:87], v[140:143]
    v_cvt_pk_bf16_f32 v72, v106, v110
    v_cvt_pk_bf16_f32 v73, v114, v118
    v_cvt_pk_bf16_f32 v74, v122, v126
    v_mfma_f32_16x16x32_bf16 v[144:147], v[64:67], v[88:91], v[144:147]
    v_cvt_pk_bf16_f32 v75, v130, v134
    buffer_store_dwordx4 v[72:75], v6, s[28:31], s36 offen sc1 nt
    s_add_u32 s36, s36, 7168
    v_mfma_f32_16x16x32_bf16 v[148:151], v[64:67], v[92:95], v[148:151]
    v_cvt_pk_bf16_f32 v76, v107, v111
    v_cvt_pk_bf16_f32 v77, v115, v119
    v_cvt_pk_bf16_f32 v78, v123, v127
    v_mfma_f32_16x16x32_bf16 v[152:155], v[64:67], v[96:99], v[152:155]
    v_cvt_pk_bf16_f32 v79, v131, v135
    buffer_store_dwordx4 v[76:79], v6, s[28:31], s36 offen sc1 nt
    s_add_u32 s36, s36, 93184
    v_mfma_f32_16x16x32_bf16 v[156:159], v[64:67], v[100:103], v[156:159]
    v_mfma_f32_16x16x32_bf16 v[160:163], v[64:67], v[56:59], v[160:163]
    v_mfma_f32_16x16x32_bf16 v[164:167], v[64:67], v[32:35], v[164:167]
    s_nop 7
    v_cvt_pk_bf16_f32 v32, v136, v140
    v_cvt_pk_bf16_f32 v33, v144, v148
L_mh20:
    s_cbranch_execz L_mhret
    v_cvt_pk_bf16_f32 v34, v152, v156
    v_cvt_pk_bf16_f32 v35, v160, v164
    buffer_store_dwordx4 v[32:35], v6, s[28:31], s36 offen sc1 nt
    s_add_u32 s36, s36, 7168
    v_cvt_pk_bf16_f32 v36, v137, v141
    v_cvt_pk_bf16_f32 v37, v145, v149
    v_cvt_pk_bf16_f32 v38, v153, v157
    v_cvt_pk_bf16_f32 v39, v161, v165
    buffer_store_dwordx4 v[36:39], v6, s[28:31], s36 offen sc1 nt
    s_add_u32 s36, s36, 7168
    v_cvt_pk_bf16_f32 v32, v138, v142
    v_cvt_pk_bf16_f32 v33, v146, v150
    v_cvt_pk_bf16_f32 v34, v154, v158
    v_cvt_pk_bf16_f32 v35, v162, v166
    buffer_store_dwordx4 v[32:35], v6, s[28:31], s36 offen sc1 nt
    s_add_u32 s36, s36, 7168
    v_cvt_pk_bf16_f32 v36, v139, v143
    v_cvt_pk_bf16_f32 v37, v147, v151
    v_cvt_pk_bf16_f32 v38, v155, v159
    v_cvt_pk_bf16_f32 v39, v163, v167
    buffer_store_dwordx4 v[36:39], v6, s[28:31], s36 offen sc1 nt
    s_add_u32 s36, s36, 93184
L_done:
    s_endpgm
    .p2align 6
L_hloop:
    s_cbranch_execz L_hopret
    s_setprio 1
    s_lshl_b32 s50, s49, 2
    s_lshr_b64 s[50:51], s[82:83], s50
    s_and_b32 s50, s50, 15
    s_lshl_b32 s53, s55, 15
    s_add_u32 s53, s53, s44
    s_and_b32 s41, s49, 3
    s_lshl_b32 s41, s41, 14
    s_sub_u32 s35, s55, 1
    s_cselect_b32 s55, 2, s35
    s_add_u32 s92, s49, 2
    s_lshl_b32 s86, s92, 2
    s_lshr_b64 s[86:87], s[82:83], s86
    s_and_b32 s86, s86, 15
    s_xor_b32 s88, s41, 32768
    s_cmp_eq_u32 s91, 1
    s_cbranch_scc1 L_hx1
    s_bitcmp1_b32 s38, s50
    s_cbranch_scc1 L_hx
    s_cmp_lt_u32 s49, s93
    s_cbranch_scc1 L_hn
    buffer_load_dword v14, v12, s[68:71], 0 offen sc0 sc1
    s_mov_b32 m0, s53
    s_lshl_b32 s42, s50, 7
    buffer_load_dwordx4 v9, s[16:19], s42 offen offset:0 lds
    s_add_u32 s42, s42, s98
    buffer_load_dwordx4 v10, s[16:19], s42 offen offset:1024 lds
    s_add_u32 s42, s42, s98
    buffer_load_dwordx4 v9, s[16:19], s42 offen offset:2048 lds
    s_add_u32 s42, s42, s98
    buffer_load_dwordx4 v10, s[16:19], s42 offen offset:3072 lds
    s_waitcnt vmcnt(4)
    v_cmp_ne_u32 vcc, v14, v13
    s_nop 4
    s_and_b32 s35, vcc_lo, 0xffff
    s_or_b32 s38, s38, s35
    s_bitcmp1_b32 s38, s50
    s_cbranch_scc1 L_hw
    s_branch L_hn1
L_hn:
    s_mov_b32 m0, s53
    s_lshl_b32 s42, s50, 7
    buffer_load_dwordx4 v9, s[16:19], s42 offen offset:0 lds
    s_add_u32 s42, s42, s98
    buffer_load_dwordx4 v10, s[16:19], s42 offen offset:1024 lds
    s_add_u32 s42, s42, s98
    buffer_load_dwordx4 v9, s[16:19], s42 offen offset:2048 lds
    s_add_u32 s42, s42, s98
    buffer_load_dwordx4 v10, s[16:19], s42 offen offset:3072 lds
L_hn1:
    s_cmp_ge_u32 s49, 14
    s_cbranch_scc1 L_hn2
    s_add_u32 m0, s53, 4096
    s_add_u32 s42, s42, s99
    buffer_load_dwordx4 v9, s[16:19], s42 offen offset:0 lds
    s_add_u32 s42, s42, s98
    buffer_load_dwordx4 v10, s[16:19], s42 offen offset:1024 lds
    s_add_u32 s42, s42, s98
    buffer_load_dwordx4 v9, s[16:19], s42 offen offset:2048 lds
    s_add_u32 s42, s42, s98
    buffer_load_dwordx4 v10, s[16:19], s42 offen offset:3072 lds
L_hn2:
    s_mov_b32 s54, 2
    s_mul_i32 s43, s50, 917504
    tbuffer_load_format_d16_xyzw v[72:73], v8, s[20:23], s43 format:[BUF_DATA_FORMAT_32_32_32_32,BUF_NUM_FORMAT_UINT] offen
    s_add_u32 s43, s43, s97
    tbuffer_load_format_d16_xyzw v[74:75], v8, s[20:23], s43 format:[BUF_DATA_FORMAT_32_32_32_32,BUF_NUM_FORMAT_UINT] offen
    s_add_u32 s43, s43, s97
    tbuffer_load_format_d16_xyzw v[76:77], v8, s[20:23], s43 format:[BUF_DATA_FORMAT_32_32_32_32,BUF_NUM_FORMAT_UINT] offen
    s_add_u32 s43, s43, s97
    tbuffer_load_format_d16_xyzw v[78:79], v8, s[20:23], s43 format:[BUF_DATA_FORMAT_32_32_32_32,BUF_NUM_FORMAT_UINT] offen
    s_add_u32 s43, s43, s97
    tbuffer_load_format_d16_xyzw v[80:81], v8, s[20:23], s43 format:[BUF_DATA_FORMAT_32_32_32_32,BUF_NUM_FORMAT_UINT] offen
    s_add_u32 s43, s43, s97
    tbuffer_load_format_d16_xyzw v[82:83], v8, s[20:23], s43 format:[BUF_DATA_FORMAT_32_32_32_32,BUF_NUM_FORMAT_UINT] offen
    s_add_u32 s43, s43, s97
    tbuffer_load_format_d16_xyzw v[84:85], v8, s[20:23], s43 format:[BUF_DATA_FORMAT_32_32_32_32,BUF_NUM_FORMAT_UINT] offen
    s_add_u32 s43, s43, s97
    tbuffer_load_format_d16_xyzw v[86:87], v8, s[20:23], s43 format:[BUF_DATA_FORMAT_32_32_32_32,BUF_NUM_FORMAT_UINT] offen
    s_branch L_hp
L_hx:
    s_cbranch_execz L_hopret
    s_lshl_b32 s43, s50, 14
    s_add_u32 m0, s45, s41
    s_nop 0
    buffer_load_dwordx4 v15, s[68:71], s43 offen offset:0 sc1 lds
    buffer_load_dwordx4 v15, s[68:71], s43 offen offset:1024 sc1 lds
    buffer_load_dwordx4 v15, s[68:71], s43 offen offset:2048 sc1 lds
    buffer_load_dwordx4 v15, s[68:71], s43 offen offset:3072 sc1 lds
L_hx1:
    s_mov_b32 m0, s53
    s_lshl_b32 s42, s50, 7
    buffer_load_dwordx4 v9, s[16:19], s42 offen offset:0 lds
    s_add_u32 s42, s42, s98
    buffer_load_dwordx4 v10, s[16:19], s42 offen offset:1024 lds
    s_add_u32 s42, s42, s98
    buffer_load_dwordx4 v9, s[16:19], s42 offen offset:2048 lds
    s_add_u32 s42, s42, s98
    buffer_load_dwordx4 v10, s[16:19], s42 offen offset:3072 lds
    s_branch L_hw1
L_hw:
    s_lshl_b32 s43, s50, 14
    s_add_u32 m0, s45, s41
    s_nop 0
    buffer_load_dwordx4 v15, s[68:71], s43 offen offset:0 sc1 lds
    buffer_load_dwordx4 v15, s[68:71], s43 offen offset:1024 sc1 lds
    buffer_load_dwordx4 v15, s[68:71], s43 offen offset:2048 sc1 lds
    buffer_load_dwordx4 v15, s[68:71], s43 offen offset:3072 sc1 lds
L_hw1:
    s_mov_b32 s54, 0
L_hy:
    s_cmp_ge_u32 s49, 14
    s_cbranch_scc1 L_hb
    s_add_u32 m0, s53, 4096
    s_add_u32 s42, s42, s99
    buffer_load_dwordx4 v9, s[16:19], s42 offen offset:0 lds
    s_add_u32 s42, s42, s98
    buffer_load_dwordx4 v10, s[16:19], s42 offen offset:1024 lds
    s_add_u32 s42, s42, s98
    buffer_load_dwordx4 v9, s[16:19], s42 offen offset:2048 lds
    s_add_u32 s42, s42, s98
    buffer_load_dwordx4 v10, s[16:19], s42 offen offset:3072 lds
L_hp:
    s_cmp_lt_u32 s92, s93
    s_cbranch_scc1 L_hb
    s_cmp_ge_u32 s92, 16
    s_cbranch_scc1 L_hb
    s_bitcmp1_b32 s38, s86
    s_cbranch_scc1 L_hb
    buffer_load_dword v14, v12, s[68:71], 0 offen sc0 sc1
    s_or_b32 s54, s54, 4
L_hb:
    s_barrier
    s_mov_b32 s91, 0
    s_cmp_lt_u32 s49, 14
    s_cbranch_scc1 L_hb2
    s_cmp_lg_u32 s54, 0
    s_cbranch_scc1 L_hb2
    s_cmp_eq_u32 s49, 15
    s_cselect_b32 s35, 28672, 0
    s_add_u32 s53, s53, s35
    s_add_u32 m0, s53, 4096
    s_add_u32 s42, s42, s99
    buffer_load_dwordx4 v9, s[16:19], s42 offen offset:0 lds
    s_add_u32 s42, s42, s98
    buffer_load_dwordx4 v10, s[16:19], s42 offen offset:1024 lds
    s_add_u32 s42, s42, s98
    buffer_load_dwordx4 v9, s[16:19], s42 offen offset:2048 lds
    s_add_u32 s42, s42, s98
    buffer_load_dwordx4 v10, s[16:19], s42 offen offset:3072 lds
    s_waitcnt vmcnt(4)
    s_barrier
    s_cmp_eq_u32 s49, 15
    s_cbranch_scc1 L_hb3
    s_barrier
L_hb3:
    s_waitcnt vmcnt(0)
    s_barrier
    s_branch L_hend
L_hb2:
    s_and_b32 s35, s54, 3
    s_cbranch_scc0 L_hf
L_hq:
    v_add_u32 v17, s41, v11
    s_setprio 2
    s_waitcnt vmcnt(4)
L_hq0:
    s_cbranch_execz L_hopret
    v_lshl_or_b32 v88, v74, 8, v72
    v_lshl_or_b32 v89, v78, 8, v76
    v_perm_b32 v96, v89, v88, s84
    v_perm_b32 v102, v89, v88, s85
    v_xor_b32 v97, s58, v96
    v_xor_b32 v103, s58, v102
    v_perm_b32 v98, v41, v40, v96
    v_perm_b32 v104, v49, v48, v102
    v_perm_b32 v100, v45, v44, v96
    v_perm_b32 v106, v53, v52, v102
    v_perm_b32 v99, v43, v42, v97
    v_perm_b32 v105, v51, v50, v103
    v_perm_b32 v101, v47, v46, v97
    v_perm_b32 v107, v55, v54, v103
    v_xor_b32 v98, v98, v99
    v_xor_b32 v104, v104, v105
    v_xor_b32 v100, v100, v101
    v_xor_b32 v106, v106, v107
    v_perm_b32 v24, v100, v98, s46
    v_perm_b32 v28, v106, v104, s46
    v_perm_b32 v25, v100, v98, s47
    v_perm_b32 v29, v106, v104, s47
    v_lshl_or_b32 v88, v75, 8, v73
    v_lshl_or_b32 v89, v79, 8, v77
    v_perm_b32 v96, v89, v88, s84
    v_perm_b32 v102, v89, v88, s85
    v_xor_b32 v97, s58, v96
    v_xor_b32 v103, s58, v102
    v_perm_b32 v98, v57, v56, v96
    v_perm_b32 v104, v65, v64, v102
    v_perm_b32 v100, v61, v60, v96
    v_perm_b32 v106, v69, v68, v102
    v_perm_b32 v99, v59, v58, v97
    v_perm_b32 v105, v67, v66, v103
    v_perm_b32 v101, v63, v62, v97
    v_perm_b32 v107, v71, v70, v103
    v_xor_b32 v98, v98, v99
    v_xor_b32 v104, v104, v105
    v_xor_b32 v100, v100, v101
    v_xor_b32 v106, v106, v107
    v_perm_b32 v32, v100, v98, s46
    v_perm_b32 v36, v106, v104, s46
    v_perm_b32 v33, v100, v98, s47
    v_perm_b32 v37, v106, v104, s47
    s_bitcmp1_b32 s54, 3
    s_cbranch_scc1 L_hq2
    s_bitcmp1_b32 s54, 2
    s_cbranch_scc1 L_hq1
    s_waitcnt vmcnt(0)
L_hq1:
    s_waitcnt vmcnt(1)
L_hq2:
    s_cbranch_execz L_hopret
    v_lshl_or_b32 v90, v82, 8, v80
    v_lshl_or_b32 v91, v86, 8, v84
    v_perm_b32 v96, v91, v90, s84
    v_perm_b32 v102, v91, v90, s85
    v_xor_b32 v97, s58, v96
    v_xor_b32 v103, s58, v102
    v_perm_b32 v98, v41, v40, v96
    v_perm_b32 v104, v49, v48, v102
    v_perm_b32 v100, v45, v44, v96
    v_perm_b32 v106, v53, v52, v102
    v_perm_b32 v99, v43, v42, v97
    v_perm_b32 v105, v51, v50, v103
    v_perm_b32 v101, v47, v46, v97
    v_perm_b32 v107, v55, v54, v103
    v_xor_b32 v98, v98, v99
    v_xor_b32 v104, v104, v105
    v_xor_b32 v100, v100, v101
    v_xor_b32 v106, v106, v107
    v_perm_b32 v26, v100, v98, s46
    v_perm_b32 v30, v106, v104, s46
    v_perm_b32 v27, v100, v98, s47
    v_perm_b32 v31, v106, v104, s47
    v_lshl_or_b32 v90, v83, 8, v81
    v_lshl_or_b32 v91, v87, 8, v85
    v_perm_b32 v96, v91, v90, s84
    v_perm_b32 v102, v91, v90, s85
    v_xor_b32 v97, s58, v96
    v_xor_b32 v103, s58, v102
    v_perm_b32 v98, v57, v56, v96
    v_perm_b32 v104, v65, v64, v102
    v_perm_b32 v100, v61, v60, v96
    v_perm_b32 v106, v69, v68, v102
    v_perm_b32 v99, v59, v58, v97
    v_perm_b32 v105, v67, v66, v103
    v_perm_b32 v101, v63, v62, v97
    v_perm_b32 v107, v71, v70, v103
    v_xor_b32 v98, v98, v99
    v_xor_b32 v104, v104, v105
    v_xor_b32 v100, v100, v101
    v_xor_b32 v106, v106, v107
    v_perm_b32 v34, v100, v98, s46
    v_perm_b32 v38, v106, v104, s46
    v_perm_b32 v35, v100, v98, s47
    v_perm_b32 v39, v106, v104, s47
    ds_write_b128 v17, v[24:27] offset:0
    ds_write_b128 v17, v[28:31] offset:512
    ds_write_b128 v17, v[32:35] offset:1024
    ds_write_b128 v17, v[36:39] offset:1536
L_hg:
    s_cbranch_execz L_hopret
    s_bitcmp1_b32 s54, 2
    s_cbranch_scc0 L_hf0
    s_waitcnt vmcnt(0)
    v_cmp_ne_u32 vcc, v14, v13
    s_nop 4
    s_and_b32 s35, vcc_lo, 0xffff
    s_or_b32 s38, s38, s35
    s_branch L_hf0
L_hf:
    s_bitcmp1_b32 s54, 2
    s_cbranch_scc0 L_hf1
    s_waitcnt vmcnt(0)
    v_cmp_ne_u32 vcc, v14, v13
    s_nop 4
    s_and_b32 s35, vcc_lo, 0xffff
    s_or_b32 s38, s38, s35
L_hf1:
    s_sub_u32 s35, s92, 0
    s_cmp_ge_u32 s35, 16
    s_cbranch_scc1 L_hf0
    s_bitcmp1_b32 s38, s86
    s_cbranch_scc0 L_hf0
    s_lshl_b32 s43, s86, 14
    s_add_u32 m0, s45, s88
    s_nop 0
    buffer_load_dwordx4 v15, s[68:71], s43 offen offset:0 sc1 lds
    buffer_load_dwordx4 v15, s[68:71], s43 offen offset:1024 sc1 lds
    buffer_load_dwordx4 v15, s[68:71], s43 offen offset:2048 sc1 lds
    buffer_load_dwordx4 v15, s[68:71], s43 offen offset:3072 sc1 lds
    s_mov_b32 s91, 1
    s_waitcnt vmcnt(4) lgkmcnt(0)
    s_branch L_hz
L_hf0:
    s_waitcnt vmcnt(0) lgkmcnt(0)
L_hz:
    s_barrier
    s_mov_b32 s49, s92
    s_cmp_lt_u32 s49, 16
    s_cbranch_scc1 L_hloop
    s_cmp_eq_u32 s49, 17
    s_cselect_b32 s35, 28672, 0
    s_add_u32 s53, s53, s35
    s_add_u32 m0, s53, 4096
    s_add_u32 s42, s42, s99
    buffer_load_dwordx4 v9, s[16:19], s42 offen offset:0 lds
    s_add_u32 s42, s42, s98
    buffer_load_dwordx4 v10, s[16:19], s42 offen offset:1024 lds
    s_add_u32 s42, s42, s98
    buffer_load_dwordx4 v9, s[16:19], s42 offen offset:2048 lds
    s_add_u32 s42, s42, s98
    buffer_load_dwordx4 v10, s[16:19], s42 offen offset:3072 lds
    s_cmp_eq_u32 s49, 17
    s_cbranch_scc1 L_hb4
    s_barrier
L_hb4:
    s_waitcnt vmcnt(0)
    s_barrier
L_hend:
    s_endpgm
L_prod:
    s_cbranch_execz L_hopret
    s_lshl_b32 s50, s49, 2
    s_lshr_b64 s[50:51], s[82:83], s50
    s_and_b32 s50, s50, 15
    s_mul_i32 s43, s50, 917504
    tbuffer_load_format_d16_xyzw v[72:73], v8, s[20:23], s43 format:[BUF_DATA_FORMAT_32_32_32_32,BUF_NUM_FORMAT_UINT] offen
    s_add_u32 s43, s43, s97
    tbuffer_load_format_d16_xyzw v[74:75], v8, s[20:23], s43 format:[BUF_DATA_FORMAT_32_32_32_32,BUF_NUM_FORMAT_UINT] offen
    s_add_u32 s43, s43, s97
    tbuffer_load_format_d16_xyzw v[76:77], v8, s[20:23], s43 format:[BUF_DATA_FORMAT_32_32_32_32,BUF_NUM_FORMAT_UINT] offen
    s_add_u32 s43, s43, s97
    tbuffer_load_format_d16_xyzw v[78:79], v8, s[20:23], s43 format:[BUF_DATA_FORMAT_32_32_32_32,BUF_NUM_FORMAT_UINT] offen
    s_add_u32 s43, s43, s97
    tbuffer_load_format_d16_xyzw v[80:81], v8, s[20:23], s43 format:[BUF_DATA_FORMAT_32_32_32_32,BUF_NUM_FORMAT_UINT] offen
    s_add_u32 s43, s43, s97
    tbuffer_load_format_d16_xyzw v[82:83], v8, s[20:23], s43 format:[BUF_DATA_FORMAT_32_32_32_32,BUF_NUM_FORMAT_UINT] offen
    s_add_u32 s43, s43, s97
    tbuffer_load_format_d16_xyzw v[84:85], v8, s[20:23], s43 format:[BUF_DATA_FORMAT_32_32_32_32,BUF_NUM_FORMAT_UINT] offen
    s_add_u32 s43, s43, s97
    tbuffer_load_format_d16_xyzw v[86:87], v8, s[20:23], s43 format:[BUF_DATA_FORMAT_32_32_32_32,BUF_NUM_FORMAT_UINT] offen
    s_waitcnt vmcnt(4) lgkmcnt(0)
L_ploop:
    s_cbranch_execz L_hopret
    v_lshl_or_b32 v88, v74, 8, v72
    v_lshl_or_b32 v89, v78, 8, v76
    v_perm_b32 v96, v89, v88, s84
    v_perm_b32 v102, v89, v88, s85
    v_xor_b32 v97, s58, v96
    v_xor_b32 v103, s58, v102
    v_perm_b32 v98, v41, v40, v96
    v_perm_b32 v104, v49, v48, v102
    v_perm_b32 v100, v45, v44, v96
    v_perm_b32 v106, v53, v52, v102
    v_perm_b32 v99, v43, v42, v97
    v_perm_b32 v105, v51, v50, v103
    v_perm_b32 v101, v47, v46, v97
    v_perm_b32 v107, v55, v54, v103
    v_xor_b32 v98, v98, v99
    v_xor_b32 v104, v104, v105
    v_xor_b32 v100, v100, v101
    v_xor_b32 v106, v106, v107
    v_perm_b32 v24, v100, v98, s46
    v_perm_b32 v28, v106, v104, s46
    v_perm_b32 v25, v100, v98, s47
    v_perm_b32 v29, v106, v104, s47
    v_lshl_or_b32 v88, v75, 8, v73
    v_lshl_or_b32 v89, v79, 8, v77
    v_perm_b32 v96, v89, v88, s84
    v_perm_b32 v102, v89, v88, s85
    v_xor_b32 v97, s58, v96
    v_xor_b32 v103, s58, v102
    v_perm_b32 v98, v57, v56, v96
    v_perm_b32 v104, v65, v64, v102
    v_perm_b32 v100, v61, v60, v96
    v_perm_b32 v106, v69, v68, v102
    v_perm_b32 v99, v59, v58, v97
    v_perm_b32 v105, v67, v66, v103
    v_perm_b32 v101, v63, v62, v97
    v_perm_b32 v107, v71, v70, v103
    v_xor_b32 v98, v98, v99
    v_xor_b32 v104, v104, v105
    v_xor_b32 v100, v100, v101
    v_xor_b32 v106, v106, v107
    v_perm_b32 v32, v100, v98, s46
    v_perm_b32 v36, v106, v104, s46
    v_perm_b32 v33, v100, v98, s47
    v_perm_b32 v37, v106, v104, s47
    s_waitcnt vmcnt(0)
L_pmid:
    s_cbranch_execz L_hopret
    v_lshl_or_b32 v90, v82, 8, v80
    v_lshl_or_b32 v91, v86, 8, v84
    v_perm_b32 v96, v91, v90, s84
    v_perm_b32 v102, v91, v90, s85
    v_xor_b32 v97, s58, v96
    v_xor_b32 v103, s58, v102
    v_perm_b32 v98, v41, v40, v96
    v_perm_b32 v104, v49, v48, v102
    v_perm_b32 v100, v45, v44, v96
    v_perm_b32 v106, v53, v52, v102
    v_perm_b32 v99, v43, v42, v97
    v_perm_b32 v105, v51, v50, v103
    v_perm_b32 v101, v47, v46, v97
    v_perm_b32 v107, v55, v54, v103
    v_xor_b32 v98, v98, v99
    v_xor_b32 v104, v104, v105
    v_xor_b32 v100, v100, v101
    v_xor_b32 v106, v106, v107
    v_perm_b32 v26, v100, v98, s46
    v_perm_b32 v30, v106, v104, s46
    v_perm_b32 v27, v100, v98, s47
    v_perm_b32 v31, v106, v104, s47
    v_lshl_or_b32 v90, v83, 8, v81
    v_lshl_or_b32 v91, v87, 8, v85
    v_perm_b32 v96, v91, v90, s84
    v_perm_b32 v102, v91, v90, s85
    v_xor_b32 v97, s58, v96
    v_xor_b32 v103, s58, v102
    v_perm_b32 v98, v57, v56, v96
    v_perm_b32 v104, v65, v64, v102
    v_perm_b32 v100, v61, v60, v96
    v_perm_b32 v106, v69, v68, v102
    v_perm_b32 v99, v59, v58, v97
    v_perm_b32 v105, v67, v66, v103
    v_perm_b32 v101, v63, v62, v97
    v_perm_b32 v107, v71, v70, v103
    v_xor_b32 v98, v98, v99
    v_xor_b32 v104, v104, v105
    v_xor_b32 v100, v100, v101
    v_xor_b32 v106, v106, v107
    v_perm_b32 v34, v100, v98, s46
    v_perm_b32 v38, v106, v104, s46
    v_perm_b32 v35, v100, v98, s47
    v_perm_b32 v39, v106, v104, s47
L_ppub:
    s_cbranch_execz L_hopret
    s_lshl_b32 s52, s50, 14
    s_lshl_b64 s[36:37], 1, s50
    buffer_store_dwordx4 v[24:27], v20, s[68:71], s52 offen offset:0 sc1
    buffer_store_dwordx4 v[28:31], v20, s[68:71], s52 offen offset:512 sc1
    buffer_store_dwordx4 v[32:35], v20, s[68:71], s52 offen offset:1024 sc1
    buffer_store_dwordx4 v[36:39], v20, s[68:71], s52 offen offset:1536 sc1
    v_not_b32 v16, v13
    s_add_u32 s49, s49, 2
    s_cmp_ge_u32 s49, 16
    s_cbranch_scc1 L_plast
    s_lshl_b32 s50, s49, 2
    s_lshr_b64 s[50:51], s[82:83], s50
    s_and_b32 s50, s50, 15
    s_mul_i32 s43, s50, 917504
    tbuffer_load_format_d16_xyzw v[72:73], v8, s[20:23], s43 format:[BUF_DATA_FORMAT_32_32_32_32,BUF_NUM_FORMAT_UINT] offen
    s_add_u32 s43, s43, s97
    tbuffer_load_format_d16_xyzw v[74:75], v8, s[20:23], s43 format:[BUF_DATA_FORMAT_32_32_32_32,BUF_NUM_FORMAT_UINT] offen
    s_add_u32 s43, s43, s97
    tbuffer_load_format_d16_xyzw v[76:77], v8, s[20:23], s43 format:[BUF_DATA_FORMAT_32_32_32_32,BUF_NUM_FORMAT_UINT] offen
    s_add_u32 s43, s43, s97
    tbuffer_load_format_d16_xyzw v[78:79], v8, s[20:23], s43 format:[BUF_DATA_FORMAT_32_32_32_32,BUF_NUM_FORMAT_UINT] offen
    s_add_u32 s43, s43, s97
    tbuffer_load_format_d16_xyzw v[80:81], v8, s[20:23], s43 format:[BUF_DATA_FORMAT_32_32_32_32,BUF_NUM_FORMAT_UINT] offen
    s_add_u32 s43, s43, s97
    tbuffer_load_format_d16_xyzw v[82:83], v8, s[20:23], s43 format:[BUF_DATA_FORMAT_32_32_32_32,BUF_NUM_FORMAT_UINT] offen
    s_add_u32 s43, s43, s97
    tbuffer_load_format_d16_xyzw v[84:85], v8, s[20:23], s43 format:[BUF_DATA_FORMAT_32_32_32_32,BUF_NUM_FORMAT_UINT] offen
    s_add_u32 s43, s43, s97
    tbuffer_load_format_d16_xyzw v[86:87], v8, s[20:23], s43 format:[BUF_DATA_FORMAT_32_32_32_32,BUF_NUM_FORMAT_UINT] offen
    s_waitcnt vmcnt(8)
    s_mov_b64 exec, s[36:37]
    buffer_store_dword v16, v12, s[68:71], 0 offen  sc0 sc1
    s_mov_b64 exec, -1
    s_waitcnt vmcnt(5)
    s_branch L_ploop
L_plast:
    s_waitcnt vmcnt(0)
    s_mov_b64 exec, s[36:37]
    buffer_store_dword v16, v12, s[68:71], 0 offen  sc0 sc1
    s_mov_b64 exec, -1
    s_endpgm
    .p2align 7
    .type L_sched,@object
L_sched:
    .size L_sched, 256
    .long 0x76543210, 0xfedcba98
    .long 0x47650321, 0xfedcba98
    .long 0x54761032, 0xfedcba98
    .long 0x65472103, 0xfedcba98
    .long 0x76543210, 0xcfed8ba9
    .long 0x73654021, 0xcfed8ba9
    .long 0x74365102, 0xcfed8ba9
    .long 0x75436210, 0xcfed8ba9
    .long 0x76543210, 0xdcfe98ba
    .long 0x67254301, 0xdcfe98ba
    .long 0x76325410, 0xdcfe98ba
    .long 0x67432501, 0xdcfe98ba
    .long 0x76543210, 0xedcfa98b
    .long 0x57614320, 0xedcfa98b
    .long 0x65721430, 0xedcfa98b
    .long 0x76532140, 0xedcfa98b
    .long 0x76543210, 0xfedcba98
    .long 0x47650321, 0xfedcba98
    .long 0x54761032, 0xfedcba98
    .long 0x65472103, 0xfedcba98
    .long 0x76543210, 0xcfed8ba9
    .long 0x73654021, 0xcfed8ba9
    .long 0x74365102, 0xcfed8ba9
    .long 0x75436210, 0xcfed8ba9
    .long 0x76543210, 0xdcfe98ba
    .long 0x67254301, 0xdcfe98ba
    .long 0x76325410, 0xdcfe98ba
    .long 0x67432501, 0xdcfe98ba
    .long 0x76543210, 0xedcfa98b
    .long 0x57614320, 0xedcfa98b
    .long 0x65721430, 0xedcfa98b
    .long 0x76532140, 0xedcfa98b
    .fill 64, 4, 0xbf800000
.section .rodata,"a"
.p2align 6
.amdhsa_kernel standalone__weight_only_int_squeezellm__prompt_kernel
  .amdhsa_next_free_vgpr 168
  .amdhsa_next_free_sgpr 102
  .amdhsa_accum_offset 168
  .amdhsa_group_segment_fixed_size 0
  .amdhsa_kernarg_size 48
  .amdhsa_user_sgpr_count 2
  .amdhsa_user_sgpr_kernarg_segment_ptr 1
  .amdhsa_system_sgpr_workgroup_id_x 1
.end_amdhsa_kernel
```

```asm
; @launch grid=(256,1,1) block=(768,1,1) lds=163840
.amdgcn_target "amdgcn-amd-amdhsa--gfx950"
.text
.p2align 9
.fill 64, 4, 0xbf800000
.globl standalone__weight_only_int_squeezellm__prompt_kernel
.p2align 8
.type standalone__weight_only_int_squeezellm__prompt_kernel,@function
standalone__weight_only_int_squeezellm__prompt_kernel:
    v_lshrrev_b32 v1, 6, v0
    s_load_dwordx8 s[4:11], s[0:1], 0
    v_readfirstlane_b32 s32, v1
    s_lshr_b32 s13, s2, 3
    s_cmp_ge_u32 s13, 32
    s_cbranch_scc1 L_done
    s_load_dwordx2 s[56:57], s[0:1], 40
    v_and_b32 v2, 63, v0
    s_cmp_ge_u32 s32, 8
    s_cbranch_scc1 L_h1
    s_sub_u32 s14, s13, 4
    s_lshr_b32 s15, s14, 2
    s_and_b32 s14, s14, 3
    s_and_b32 s16, s2, 1
    s_lshl2_add_u32 s14, s16, s14
    s_cmp_lt_u32 s13, 4
    s_cselect_b32 s15, s14, s15
    s_cmp_eq_u32 s15, 7
    s_cbranch_scc1 L_done
    s_bfe_u32 s16, s2, 0x20001
    s_mul_i32 s16, s16, 7
    s_add_u32 s15, s15, s16
    s_and_b32 s33, s32, 3
    s_cmp_ge_u32 s32, 4
    s_cbranch_scc1 L_h0
    s_getpc_b64 s[50:51]
    s_and_b32 s12, s13, 7
    s_mul_i32 s12, s12, 13
    v_add_lshl_u32 v1, v0, s12, 7
    v_cmp_gt_u32 vcc, 13, v0
    s_and_saveexec_b64 s[54:55], vcc
    s_cbranch_execz L_cw
    global_load_dword v39, v1, s[50:51] offset:512
L_cw:
    s_mov_b64 exec, s[54:55]
    v_lshrrev_b32 v5, 3, v2
    v_and_b32 v7, 7, v2
    v_mul_u32_u24 v5, 7168, v5
    v_lshl_add_u32 v5, v7, 4, v5
    s_and_b32 s36, s32, 1
    s_lshl1_add_u32 s35, s15, s36
    s_lshl_b32 s35, s35, 7
    s_add_u32 s36, s35, 56320
    s_lshl_b32 s37, s32, 11
    s_add_u32 m0, s37, 135168
    s_mov_b32 s26, 114688
    s_mov_b32 s27, 0x20000
    s_setprio 3
    s_waitcnt lgkmcnt(0)
    s_mov_b64 s[24:25], s[8:9]
    buffer_load_dwordx4 v5, s[24:27], s35 offen lds
    buffer_load_dwordx4 v5, s[24:27], s36 offen offset:1024 lds
    s_branch L_mfma
L_h0:
    s_and_b32 s48, s15, 3
    s_lshr_b32 s59, s15, 2
    s_add_u32 s59, s59, s14
    s_and_b32 s59, s59, 3
    s_lshl2_add_u32 s48, s48, s59
    s_lshl_b32 s50, s48, 1
    s_lshr_b32 s50, 0x4424e4, s50
    s_and_b32 s50, s50, 3
    v_lshrrev_b32 v3, 5, v2
    s_lshl_b32 s35, s33, 1
    v_add_u32 v4, s35, v3
    v_and_b32 v6, 31, v2
    v_mul_u32_u24 v8, 114688, v4
    v_lshl_add_u32 v8, v6, 4, v8
    s_lshl_b32 s35, s15, 9
    v_add_u32 v8, s35, v8
    s_mov_b32 s22, 14680064
    s_mov_b32 s23, 0x20000
    s_movk_i32 s97, 14336
    s_mul_i32 s43, s50, 917504
    s_setprio 2
    s_waitcnt lgkmcnt(0)
    s_mov_b64 s[20:21], s[6:7]
    s_cmp_lt_u32 s13, 4
    s_cbranch_scc1 L_e2
    tbuffer_load_format_d16_xyzw v[72:73], v8, s[20:23], s43 format:[BUF_DATA_FORMAT_32_32_32_32,BUF_NUM_FORMAT_UINT] offen
    s_add_u32 s43, s43, s97
    tbuffer_load_format_d16_xyzw v[74:75], v8, s[20:23], s43 format:[BUF_DATA_FORMAT_32_32_32_32,BUF_NUM_FORMAT_UINT] offen
    s_add_u32 s43, s43, s97
    tbuffer_load_format_d16_xyzw v[76:77], v8, s[20:23], s43 format:[BUF_DATA_FORMAT_32_32_32_32,BUF_NUM_FORMAT_UINT] offen
    s_add_u32 s43, s43, s97
    tbuffer_load_format_d16_xyzw v[78:79], v8, s[20:23], s43 format:[BUF_DATA_FORMAT_32_32_32_32,BUF_NUM_FORMAT_UINT] offen
    s_add_u32 s43, s43, s97
    tbuffer_load_format_d16_xyzw v[80:81], v8, s[20:23], s43 format:[BUF_DATA_FORMAT_32_32_32_32,BUF_NUM_FORMAT_UINT] offen
    s_add_u32 s43, s43, s97
    tbuffer_load_format_d16_xyzw v[82:83], v8, s[20:23], s43 format:[BUF_DATA_FORMAT_32_32_32_32,BUF_NUM_FORMAT_UINT] offen
    s_add_u32 s43, s43, s97
    tbuffer_load_format_d16_xyzw v[84:85], v8, s[20:23], s43 format:[BUF_DATA_FORMAT_32_32_32_32,BUF_NUM_FORMAT_UINT] offen
    s_add_u32 s43, s43, s97
    tbuffer_load_format_d16_xyzw v[86:87], v8, s[20:23], s43 format:[BUF_DATA_FORMAT_32_32_32_32,BUF_NUM_FORMAT_UINT] offen
    s_branch L_e2
    .p2align 9
L_h1:
    s_sub_u32 s14, s13, 4
    s_lshr_b32 s15, s14, 2
    s_and_b32 s14, s14, 3
    s_and_b32 s16, s2, 1
    s_lshl2_add_u32 s14, s16, s14
    s_cmp_lt_u32 s13, 4
    s_cselect_b32 s15, s14, s15
    s_cmp_eq_u32 s15, 7
    s_cbranch_scc1 L_done
    s_bfe_u32 s16, s2, 0x20001
    s_mul_i32 s16, s16, 7
    s_add_u32 s15, s15, s16
    s_and_b32 s33, s32, 3
    s_and_b32 s48, s15, 3
    s_lshr_b32 s59, s15, 2
    s_add_u32 s59, s59, s14
    s_and_b32 s59, s59, 3
    s_lshl2_add_u32 s48, s48, s59
    s_lshl_b32 s50, s48, 1
    s_lshr_b32 s50, 0x4424e4, s50
    s_and_b32 s50, s50, 3
    v_lshrrev_b32 v5, 3, v2
    v_lshrrev_b32 v7, 4, v2
    v_and_b32 v10, 7, v2
    v_xor_b32 v7, v7, v10
    v_lshlrev_b32 v7, 4, v7
    s_lshl_b32 s35, s14, 19
    s_lshl_b32 s36, s33, 17
    s_add_u32 s35, s35, s36
    v_lshl_add_u32 v7, v5, 11, v7
    v_add_u32 v9, s35, v7
    v_xor_b32 v10, 64, v9
    s_lshl_b32 s44, s33, 13
    s_add_u32 s44, s44, 65536
    s_mov_b32 s18, 4194304
    s_mov_b32 s19, 0x20000
    s_movk_i32 s98, 15360
    s_movk_i32 s99, 19456
    s_mov_b32 s53, s44
    s_mov_b32 m0, s53
    s_lshl_b32 s42, s50, 7
    s_setprio 1
    s_waitcnt lgkmcnt(0)
    s_mov_b64 s[16:17], s[4:5]
    s_cmp_lt_u32 s13, 4
    s_cbranch_scc1 L_e2
    buffer_load_dwordx4 v9, s[16:19], s42 offen offset:0 lds
    s_add_u32 s42, s42, s98
    buffer_load_dwordx4 v10, s[16:19], s42 offen offset:1024 lds
    s_add_u32 s42, s42, s98
    buffer_load_dwordx4 v9, s[16:19], s42 offen offset:2048 lds
    s_add_u32 s42, s42, s98
    buffer_load_dwordx4 v10, s[16:19], s42 offen offset:3072 lds
    s_add_u32 m0, s53, 4096
    s_add_u32 s42, s42, s99
    buffer_load_dwordx4 v9, s[16:19], s42 offen offset:0 lds
    s_add_u32 s42, s42, s98
    buffer_load_dwordx4 v10, s[16:19], s42 offen offset:1024 lds
    s_branch L_e2
L_mfma:
    s_mov_b32 s36, m0
    s_lshr_b32 s37, s32, 1
    s_add_u32 s36, s36, s37
    v_lshlrev_b32 v7, 1, v2
    v_add_u32 v7, s36, v7
    v_and_b32 v3, 127, v0
    v_and_b32 v6, 3, v3
    v_lshlrev_b32 v6, 1, v6
    v_add_u32 v6, s37, v6
    v_lshrrev_b32 v3, 2, v3
    v_lshl_add_u32 v6, v6, 5, v3
    v_lshlrev_b32 v6, 4, v6
    v_add_u32 v6, 131072, v6
    s_mov_b32 s45, 0x0b0a0908
    s_mov_b32 s54, 0xffffff00
    s_waitcnt vmcnt(0)
    ds_read_u8 v40, v7 offset:0
    ds_read_u8 v41, v7 offset:128
    ds_read_u8 v42, v7 offset:256
    ds_read_u8 v43, v7 offset:384
    ds_read_u8 v44, v7 offset:512
    ds_read_u8 v45, v7 offset:640
    ds_read_u8 v46, v7 offset:768
    ds_read_u8 v47, v7 offset:896
    ds_read_u8 v48, v7 offset:1024
    ds_read_u8 v49, v7 offset:1152
    ds_read_u8 v50, v7 offset:1280
    ds_read_u8 v51, v7 offset:1408
    ds_read_u8 v52, v7 offset:1536
    ds_read_u8 v53, v7 offset:1664
    ds_read_u8 v54, v7 offset:1792
    ds_read_u8 v55, v7 offset:1920
    s_waitcnt lgkmcnt(0)
    v_lshl_or_b32 v24, v41, 8, v40
    v_lshl_or_b32 v56, v43, 8, v42
    v_lshl_or_b32 v25, v45, 8, v44
    v_lshl_or_b32 v57, v47, 8, v46
    v_lshl_or_b32 v26, v49, 8, v48
    v_lshl_or_b32 v58, v51, 8, v50
    v_lshl_or_b32 v27, v53, 8, v52
    v_lshl_or_b32 v59, v55, 8, v54
    v_lshl_or_b32 v24, v56, 16, v24
    v_lshl_or_b32 v25, v57, 16, v25
    v_lshl_or_b32 v26, v58, 16, v26
    v_lshl_or_b32 v27, v59, 16, v27
    v_xor_b32 v25, s54, v25
    v_xor_b32 v27, s54, v27
    v_mov_b32 v28, v24
    v_mov_b32 v29, v26
    v_perm_b32 v30, v27, v26, s45
    v_perm_b32 v31, v25, v24, s45
    v_xor_b32 v24, v28, v30
    v_xor_b32 v26, v29, v31
    v_perm_b32 v30, v27, v26, s45
    v_perm_b32 v31, v25, v24, s45
    v_xor_b32 v24, v28, v30
    v_xor_b32 v26, v29, v31
    v_perm_b32 v30, v27, v26, s45
    v_perm_b32 v31, v25, v24, s45
    v_xor_b32 v24, v28, v30
    v_xor_b32 v26, v29, v31
    ds_write_b128 v6, v[24:27]
    s_waitcnt lgkmcnt(0)
    s_barrier
    s_cmp_lt_u32 s13, 4
    s_cbranch_scc1 L_done
    s_branch L_m2
L_e2:
    s_getpc_b64 s[86:87]
L_pcX:
    s_cmp_lt_u32 s13, 4
    s_cselect_b32 s35, 16, 0
    s_cselect_b32 s49, 8, 0
    s_add_u32 s35, s35, s48
    s_lshl_b32 s35, s35, 3
    s_add_u32 s35, s35, L_sched-L_pcX
    s_add_u32 s86, s86, s35
    s_addc_u32 s87, s87, 0
    s_load_dwordx2 s[82:83], s[86:87], 0
    s_lshr_b32 s35, s32, 3
    s_add_u32 s49, s49, s35
    s_lshl_b32 s35, s15, 2
    s_add_u32 s35, s35, s33
    s_lshl_b32 s35, s35, 7
    s_add_u32 s35, s35, 524288
    v_and_b32 v12, 15, v2
    v_lshlrev_b32 v12, 2, v12
    v_add_u32 v12, s35, v12
    s_mov_b64 s[68:69], s[56:57]
    s_mov_b32 s70, 268435456
    s_mov_b32 s71, 0x20000
    buffer_load_dword v13, v12, s[68:71], 0 offen sc0 sc1
    s_mov_b64 s[16:17], s[4:5]
    s_mov_b64 s[20:21], s[6:7]
    s_mov_b32 s22, 14680064
    s_mov_b32 s23, 0x20000
    s_mov_b32 s18, 4194304
    s_mov_b32 s19, 0x20000
    s_movk_i32 s97, 14336
    s_movk_i32 s98, 15360
    s_movk_i32 s99, 19456
    v_lshrrev_b32 v3, 5, v2
    s_lshl_b32 s35, s33, 1
    v_add_u32 v4, s35, v3
    v_and_b32 v6, 31, v2
    v_mul_u32_u24 v8, 114688, v4
    v_lshl_add_u32 v8, v6, 4, v8
    s_lshl_b32 s35, s15, 9
    v_add_u32 v8, s35, v8
    v_lshrrev_b32 v5, 3, v2
    v_lshrrev_b32 v7, 4, v2
    v_and_b32 v10, 7, v2
    v_xor_b32 v7, v7, v10
    v_lshlrev_b32 v7, 4, v7
    s_lshl_b32 s35, s14, 19
    s_lshl_b32 s36, s33, 17
    s_add_u32 s35, s35, s36
    v_lshl_add_u32 v7, v5, 11, v7
    v_add_u32 v9, s35, v7
    v_xor_b32 v10, 64, v9
    s_lshl_b32 s44, s33, 13
    s_add_u32 s44, s44, 65536
    s_lshl_b32 s36, s15, 18
    s_add_u32 s96, s36, 1048576
    v_xor_b32 v5, v6, v3
    v_lshlrev_b32 v5, 4, v5
    v_lshl_add_u32 v11, v4, 11, v5
    v_lshlrev_b32 v7, 4, v6
    v_add_u32 v7, 131072, v7
    s_lshl_b32 s45, s33, 12
    s_add_u32 s36, s96, s45
    v_lshlrev_b32 v15, 4, v2
    v_add_u32 v15, s36, v15
    v_add_u32 v20, s96, v11
    s_mov_b32 s46, 0x05010400
    s_mov_b32 s47, 0x07030602
    s_mov_b32 s58, 0x08080808
    s_mov_b32 s84, 0x05040100
    s_mov_b32 s85, 0x07060302
    s_mov_b32 s38, 0
    s_mov_b32 s39, 0
    s_mov_b32 s91, 0
    s_cmp_lt_u32 s32, 8
    s_cselect_b32 s93, 8, 9
    s_mov_b32 s90, 40
    s_mov_b64 exec, 0
    s_cmp_lt_u32 s13, 4
    s_cbranch_scc1 L_hopq
    s_cmp_eq_u32 s32, 4
    s_cbranch_scc1 L_hq0
    s_cmp_eq_u32 s32, 5
    s_cbranch_scc1 L_hq2
    s_cmp_eq_u32 s32, 6
    s_cbranch_scc1 L_hg
    s_cmp_eq_u32 s32, 7
    s_cbranch_scc1 L_hloop
    s_cmp_eq_u32 s32, 8
    s_cbranch_scc1 L_hx
    s_branch L_hopret
L_hopq:
    s_cmp_eq_u32 s32, 4
    s_cbranch_scc1 L_prod
    s_cmp_eq_u32 s32, 5
    s_cbranch_scc1 L_ploop
    s_cmp_eq_u32 s32, 6
    s_cbranch_scc1 L_pmid
    s_cmp_eq_u32 s32, 7
    s_cbranch_scc1 L_ppub
L_hopret:
    s_mov_b64 exec, -1
    s_waitcnt lgkmcnt(0)
    s_barrier
    ds_read_b128 v[40:43], v7 offset:0
    ds_read_b128 v[44:47], v7 offset:512
    ds_read_b128 v[48:51], v7 offset:1024
    ds_read_b128 v[52:55], v7 offset:1536
    ds_read_b128 v[56:59], v7 offset:2048
    ds_read_b128 v[60:63], v7 offset:2560
    ds_read_b128 v[64:67], v7 offset:3072
    ds_read_b128 v[68:71], v7 offset:3584
    s_cmp_lt_u32 s13, 4
    s_cbranch_scc1 L_prod
    s_lshl_b32 s41, s49, 14
    s_add_u32 s92, s49, 2
    s_mov_b32 s55, 2
    s_mov_b32 s54, 2
    s_cmp_eq_u32 s49, 0
    s_waitcnt lgkmcnt(0)
    s_cbranch_scc1 L_hq
    s_add_u32 m0, s53, 4096
    s_add_u32 s42, s42, s98
    buffer_load_dwordx4 v9, s[16:19], s42 offen offset:2048 lds
    s_add_u32 s42, s42, s98
    buffer_load_dwordx4 v10, s[16:19], s42 offen offset:3072 lds
    s_lshl_b32 s50, s49, 2
    s_lshr_b64 s[50:51], s[82:83], s50
    s_and_b32 s50, s50, 15
    s_mul_i32 s43, s50, 917504
    tbuffer_load_format_d16_xyzw v[72:73], v8, s[20:23], s43 format:[BUF_DATA_FORMAT_32_32_32_32,BUF_NUM_FORMAT_UINT] offen
    s_add_u32 s43, s43, s97
    tbuffer_load_format_d16_xyzw v[74:75], v8, s[20:23], s43 format:[BUF_DATA_FORMAT_32_32_32_32,BUF_NUM_FORMAT_UINT] offen
    s_add_u32 s43, s43, s97
    tbuffer_load_format_d16_xyzw v[76:77], v8, s[20:23], s43 format:[BUF_DATA_FORMAT_32_32_32_32,BUF_NUM_FORMAT_UINT] offen
    s_add_u32 s43, s43, s97
    tbuffer_load_format_d16_xyzw v[78:79], v8, s[20:23], s43 format:[BUF_DATA_FORMAT_32_32_32_32,BUF_NUM_FORMAT_UINT] offen
    s_add_u32 s43, s43, s97
    tbuffer_load_format_d16_xyzw v[80:81], v8, s[20:23], s43 format:[BUF_DATA_FORMAT_32_32_32_32,BUF_NUM_FORMAT_UINT] offen
    s_add_u32 s43, s43, s97
    tbuffer_load_format_d16_xyzw v[82:83], v8, s[20:23], s43 format:[BUF_DATA_FORMAT_32_32_32_32,BUF_NUM_FORMAT_UINT] offen
    s_add_u32 s43, s43, s97
    tbuffer_load_format_d16_xyzw v[84:85], v8, s[20:23], s43 format:[BUF_DATA_FORMAT_32_32_32_32,BUF_NUM_FORMAT_UINT] offen
    s_add_u32 s43, s43, s97
    tbuffer_load_format_d16_xyzw v[86:87], v8, s[20:23], s43 format:[BUF_DATA_FORMAT_32_32_32_32,BUF_NUM_FORMAT_UINT] offen
    s_waitcnt vmcnt(8)
    s_barrier
    s_setprio 3
    s_add_u32 s53, s44, 32768
    s_mov_b32 m0, s53
    s_lshl_b32 s42, s50, 7
    buffer_load_dwordx4 v9, s[16:19], s42 offen offset:0 lds
    s_add_u32 s42, s42, s98
    buffer_load_dwordx4 v10, s[16:19], s42 offen offset:1024 lds
    s_add_u32 s42, s42, s98
    buffer_load_dwordx4 v9, s[16:19], s42 offen offset:2048 lds
    s_add_u32 s42, s42, s98
    buffer_load_dwordx4 v10, s[16:19], s42 offen offset:3072 lds
    s_add_u32 m0, s53, 4096
    s_add_u32 s42, s42, s99
    buffer_load_dwordx4 v9, s[16:19], s42 offen offset:0 lds
    s_add_u32 s42, s42, s98
    buffer_load_dwordx4 v10, s[16:19], s42 offen offset:1024 lds
    s_add_u32 s42, s42, s98
    buffer_load_dwordx4 v9, s[16:19], s42 offen offset:2048 lds
    s_add_u32 s42, s42, s98
    buffer_load_dwordx4 v10, s[16:19], s42 offen offset:3072 lds
    s_mov_b32 s55, 0
    s_mov_b32 s54, 8
    v_add_u32 v17, s41, v11
    s_waitcnt vmcnt(8)
    s_branch L_hq0
L_m2:
    s_mov_b64 s[28:29], s[10:11]
    s_mov_b32 s30, 14680064
    s_mov_b32 s31, 0x20000
    v_and_b32 v7, 15, v2
    v_lshrrev_b32 v6, 4, v2
    v_lshrrev_b32 v4, 1, v7
    v_xor_b32 v4, v4, v6
    v_lshlrev_b32 v4, 4, v4
    v_lshl_add_u32 v4, v7, 7, v4
    s_lshl_b32 s35, s32, 13
    s_add_u32 s35, s35, 65536
    v_add_u32 v1, s35, v4
    v_xor_b32 v3, 64, v1
    v_and_b32 v4, 1, v6
    v_lshl_add_u32 v4, v7, 1, v4
    v_lshlrev_b32 v4, 4, v4
    v_lshl_add_u32 v4, v6, 11, v4
    v_xor_b32 v5, 16, v4
    v_mul_u32_u24 v6, 28672, v6
    v_lshl_add_u32 v6, v7, 4, v6
    s_lshl_b32 s36, s14, 2
    s_add_u32 s36, s36, s32
    s_mul_i32 s36, s36, 458752
    s_lshl_b32 s37, s15, 8
    s_add_u32 s36, s36, s37
    s_mov_b32 s40, 0
    s_mov_b32 s41, 0
    s_mov_b32 s46, 32768
    s_mov_b32 s47, 16384
    s_mov_b64 exec, 0
    s_cmp_eq_u32 s32, 0
    s_cbranch_scc1 L_mh0
    s_cmp_eq_u32 s32, 1
    s_cbranch_scc1 L_mh6
    s_cmp_eq_u32 s32, 2
    s_cbranch_scc1 L_mh12
    s_cmp_eq_u32 s32, 3
    s_cbranch_scc1 L_mh18
L_mhret:
    s_mov_b64 exec, -1
    s_setprio 3
    s_barrier
    ds_read_b128 v[24:27], v4 offset:0
    ds_read_b128 v[28:31], v4 offset:512
    ds_read_b128 v[8:11], v1 offset:0
    ds_read_b128 v[12:15], v1 offset:2048
    ds_read_b128 v[16:19], v1 offset:4096
    ds_read_b128 v[32:35], v4 offset:1024
    ds_read_b128 v[20:23], v1 offset:6144
    ds_read_b128 v[36:39], v4 offset:1536
    s_waitcnt lgkmcnt(5)
    v_mfma_f32_16x16x32_bf16 v[40:43], v[8:11], v[24:27], 0
    v_mfma_f32_16x16x32_bf16 v[44:47], v[8:11], v[28:31], 0
    s_waitcnt lgkmcnt(4)
    v_mfma_f32_16x16x32_bf16 v[72:75], v[12:15], v[24:27], 0
    v_mfma_f32_16x16x32_bf16 v[76:79], v[12:15], v[28:31], 0
    s_waitcnt lgkmcnt(3)
    v_mfma_f32_16x16x32_bf16 v[104:107], v[16:19], v[24:27], 0
    v_mfma_f32_16x16x32_bf16 v[108:111], v[16:19], v[28:31], 0
    s_waitcnt lgkmcnt(1)
    v_mfma_f32_16x16x32_bf16 v[136:139], v[20:23], v[24:27], 0
    ds_read_b128 v[24:27], v5 offset:0
    v_mfma_f32_16x16x32_bf16 v[140:143], v[20:23], v[28:31], 0
    ds_read_b128 v[28:31], v5 offset:512
    v_mfma_f32_16x16x32_bf16 v[48:51], v[8:11], v[32:35], 0
    s_add_u32 s40, s40, 1
L_mh0:
    s_cbranch_execz L_mh1
    s_waitcnt lgkmcnt(2)
    v_mfma_f32_16x16x32_bf16 v[52:55], v[8:11], v[36:39], 0
    s_and_b32 s42, s40, 3
    v_mfma_f32_16x16x32_bf16 v[80:83], v[12:15], v[32:35], 0
    s_cselect_b32 s42, s47, 0xffff4000
    v_mfma_f32_16x16x32_bf16 v[84:87], v[12:15], v[36:39], 0
    s_add_u32 s41, s41, 1
    v_mfma_f32_16x16x32_bf16 v[112:115], v[16:19], v[32:35], 0
    s_cmp_eq_u32 s41, 3
    v_mfma_f32_16x16x32_bf16 v[116:119], v[16:19], v[36:39], 0
    s_cselect_b32 s43, 0xffff0000, s46
    v_mfma_f32_16x16x32_bf16 v[144:147], v[20:23], v[32:35], 0
    s_cselect_b32 s41, 0, s41
    ds_read_b128 v[32:35], v5 offset:1024
    v_mfma_f32_16x16x32_bf16 v[148:151], v[20:23], v[36:39], 0
    ds_read_b128 v[36:39], v5 offset:1536
    s_waitcnt lgkmcnt(3)
    v_mfma_f32_16x16x32_bf16 v[56:59], v[8:11], v[24:27], 0
    s_waitcnt lgkmcnt(2)
    v_mfma_f32_16x16x32_bf16 v[60:63], v[8:11], v[28:31], 0
    v_mfma_f32_16x16x32_bf16 v[88:91], v[12:15], v[24:27], 0
    v_mfma_f32_16x16x32_bf16 v[92:95], v[12:15], v[28:31], 0
    v_mfma_f32_16x16x32_bf16 v[120:123], v[16:19], v[24:27], 0
    v_mfma_f32_16x16x32_bf16 v[124:127], v[16:19], v[28:31], 0
    v_mfma_f32_16x16x32_bf16 v[152:155], v[20:23], v[24:27], 0
    ds_read_b128 v[24:27], v4 offset:8192
    v_mfma_f32_16x16x32_bf16 v[156:159], v[20:23], v[28:31], 0
    ds_read_b128 v[28:31], v4 offset:8704
    s_waitcnt lgkmcnt(3)
    v_mfma_f32_16x16x32_bf16 v[64:67], v[8:11], v[32:35], 0
    s_waitcnt lgkmcnt(2)
    v_mfma_f32_16x16x32_bf16 v[68:71], v[8:11], v[36:39], 0
    ds_read_b128 v[8:11], v3 offset:0
    v_mfma_f32_16x16x32_bf16 v[96:99], v[12:15], v[32:35], 0
    v_mfma_f32_16x16x32_bf16 v[100:103], v[12:15], v[36:39], 0
    ds_read_b128 v[12:15], v3 offset:2048
    v_mfma_f32_16x16x32_bf16 v[128:131], v[16:19], v[32:35], 0
    v_mfma_f32_16x16x32_bf16 v[132:135], v[16:19], v[36:39], 0
    ds_read_b128 v[16:19], v3 offset:4096
    v_mfma_f32_16x16x32_bf16 v[160:163], v[20:23], v[32:35], 0
    ds_read_b128 v[32:35], v4 offset:9216
    v_mfma_f32_16x16x32_bf16 v[164:167], v[20:23], v[36:39], 0
    ds_read_b128 v[20:23], v3 offset:6144
    ds_read_b128 v[36:39], v4 offset:9728
    s_waitcnt lgkmcnt(5)
    v_mfma_f32_16x16x32_bf16 v[40:43], v[8:11], v[24:27], v[40:43]
    v_mfma_f32_16x16x32_bf16 v[44:47], v[8:11], v[28:31], v[44:47]
    s_waitcnt lgkmcnt(4)
L_mh1:
    s_cbranch_execz L_mh2
    v_mfma_f32_16x16x32_bf16 v[72:75], v[12:15], v[24:27], v[72:75]
    v_mfma_f32_16x16x32_bf16 v[76:79], v[12:15], v[28:31], v[76:79]
    s_waitcnt lgkmcnt(3)
    v_mfma_f32_16x16x32_bf16 v[104:107], v[16:19], v[24:27], v[104:107]
    v_mfma_f32_16x16x32_bf16 v[108:111], v[16:19], v[28:31], v[108:111]
    s_waitcnt lgkmcnt(1)
    v_mfma_f32_16x16x32_bf16 v[136:139], v[20:23], v[24:27], v[136:139]
    ds_read_b128 v[24:27], v5 offset:8192
    v_mfma_f32_16x16x32_bf16 v[140:143], v[20:23], v[28:31], v[140:143]
    ds_read_b128 v[28:31], v5 offset:8704
    v_mfma_f32_16x16x32_bf16 v[48:51], v[8:11], v[32:35], v[48:51]
    s_waitcnt lgkmcnt(2)
    v_mfma_f32_16x16x32_bf16 v[52:55], v[8:11], v[36:39], v[52:55]
    v_mfma_f32_16x16x32_bf16 v[80:83], v[12:15], v[32:35], v[80:83]
    v_mfma_f32_16x16x32_bf16 v[84:87], v[12:15], v[36:39], v[84:87]
    v_mfma_f32_16x16x32_bf16 v[112:115], v[16:19], v[32:35], v[112:115]
    v_mfma_f32_16x16x32_bf16 v[116:119], v[16:19], v[36:39], v[116:119]
    v_mfma_f32_16x16x32_bf16 v[144:147], v[20:23], v[32:35], v[144:147]
    ds_read_b128 v[32:35], v5 offset:9216
    v_mfma_f32_16x16x32_bf16 v[148:151], v[20:23], v[36:39], v[148:151]
    ds_read_b128 v[36:39], v5 offset:9728
    s_waitcnt lgkmcnt(3)
    v_mfma_f32_16x16x32_bf16 v[56:59], v[8:11], v[24:27], v[56:59]
    s_waitcnt lgkmcnt(2)
    v_mfma_f32_16x16x32_bf16 v[60:63], v[8:11], v[28:31], v[60:63]
    v_mfma_f32_16x16x32_bf16 v[88:91], v[12:15], v[24:27], v[88:91]
    v_mfma_f32_16x16x32_bf16 v[92:95], v[12:15], v[28:31], v[92:95]
    s_waitcnt lgkmcnt(0)
    s_barrier
    v_add_u32 v4, s42, v4
    v_mfma_f32_16x16x32_bf16 v[120:123], v[16:19], v[24:27], v[120:123]
    v_add_u32 v1, s43, v1
    v_mfma_f32_16x16x32_bf16 v[124:127], v[16:19], v[28:31], v[124:127]
    v_add_u32 v5, s42, v5
    v_mfma_f32_16x16x32_bf16 v[152:155], v[20:23], v[24:27], v[152:155]
    v_add_u32 v3, s43, v3
    ds_read_b128 v[24:27], v4 offset:0
    v_mfma_f32_16x16x32_bf16 v[156:159], v[20:23], v[28:31], v[156:159]
    ds_read_b128 v[28:31], v4 offset:512
    v_mfma_f32_16x16x32_bf16 v[64:67], v[8:11], v[32:35], v[64:67]
    v_mfma_f32_16x16x32_bf16 v[68:71], v[8:11], v[36:39], v[68:71]
    ds_read_b128 v[8:11], v1 offset:0
    v_mfma_f32_16x16x32_bf16 v[96:99], v[12:15], v[32:35], v[96:99]
    v_mfma_f32_16x16x32_bf16 v[100:103], v[12:15], v[36:39], v[100:103]
    ds_read_b128 v[12:15], v1 offset:2048
    v_mfma_f32_16x16x32_bf16 v[128:131], v[16:19], v[32:35], v[128:131]
    v_mfma_f32_16x16x32_bf16 v[132:135], v[16:19], v[36:39], v[132:135]
    ds_read_b128 v[16:19], v1 offset:4096
L_mh2:
    s_cbranch_execz L_mh3
    v_mfma_f32_16x16x32_bf16 v[160:163], v[20:23], v[32:35], v[160:163]
    ds_read_b128 v[32:35], v4 offset:1024
    v_mfma_f32_16x16x32_bf16 v[164:167], v[20:23], v[36:39], v[164:167]
    ds_read_b128 v[20:23], v1 offset:6144
    ds_read_b128 v[36:39], v4 offset:1536
    .p2align 6
L_mloop:
    s_waitcnt lgkmcnt(5)
    v_mfma_f32_16x16x32_bf16 v[40:43], v[8:11], v[24:27], v[40:43]
    v_mfma_f32_16x16x32_bf16 v[44:47], v[8:11], v[28:31], v[44:47]
    s_waitcnt lgkmcnt(4)
    v_mfma_f32_16x16x32_bf16 v[72:75], v[12:15], v[24:27], v[72:75]
    v_mfma_f32_16x16x32_bf16 v[76:79], v[12:15], v[28:31], v[76:79]
    s_waitcnt lgkmcnt(3)
    v_mfma_f32_16x16x32_bf16 v[104:107], v[16:19], v[24:27], v[104:107]
    v_mfma_f32_16x16x32_bf16 v[108:111], v[16:19], v[28:31], v[108:111]
    s_waitcnt lgkmcnt(1)
    v_mfma_f32_16x16x32_bf16 v[136:139], v[20:23], v[24:27], v[136:139]
    ds_read_b128 v[24:27], v5 offset:0
    v_mfma_f32_16x16x32_bf16 v[140:143], v[20:23], v[28:31], v[140:143]
    ds_read_b128 v[28:31], v5 offset:512
    v_mfma_f32_16x16x32_bf16 v[48:51], v[8:11], v[32:35], v[48:51]
    s_add_u32 s40, s40, 1
    s_waitcnt lgkmcnt(2)
    v_mfma_f32_16x16x32_bf16 v[52:55], v[8:11], v[36:39], v[52:55]
    s_and_b32 s42, s40, 3
    v_mfma_f32_16x16x32_bf16 v[80:83], v[12:15], v[32:35], v[80:83]
    s_cselect_b32 s42, s47, 0xffff4000
    v_mfma_f32_16x16x32_bf16 v[84:87], v[12:15], v[36:39], v[84:87]
    s_add_u32 s41, s41, 1
    v_mfma_f32_16x16x32_bf16 v[112:115], v[16:19], v[32:35], v[112:115]
    s_cmp_eq_u32 s41, 3
    v_mfma_f32_16x16x32_bf16 v[116:119], v[16:19], v[36:39], v[116:119]
    s_cselect_b32 s43, 0xffff0000, s46
    v_mfma_f32_16x16x32_bf16 v[144:147], v[20:23], v[32:35], v[144:147]
    s_cselect_b32 s41, 0, s41
    ds_read_b128 v[32:35], v5 offset:1024
    v_mfma_f32_16x16x32_bf16 v[148:151], v[20:23], v[36:39], v[148:151]
    ds_read_b128 v[36:39], v5 offset:1536
    s_waitcnt lgkmcnt(3)
    v_mfma_f32_16x16x32_bf16 v[56:59], v[8:11], v[24:27], v[56:59]
    s_waitcnt lgkmcnt(2)
    v_mfma_f32_16x16x32_bf16 v[60:63], v[8:11], v[28:31], v[60:63]
    v_mfma_f32_16x16x32_bf16 v[88:91], v[12:15], v[24:27], v[88:91]
    v_mfma_f32_16x16x32_bf16 v[92:95], v[12:15], v[28:31], v[92:95]
    v_mfma_f32_16x16x32_bf16 v[120:123], v[16:19], v[24:27], v[120:123]
    v_mfma_f32_16x16x32_bf16 v[124:127], v[16:19], v[28:31], v[124:127]
    v_mfma_f32_16x16x32_bf16 v[152:155], v[20:23], v[24:27], v[152:155]
L_mh3:
    s_cbranch_execz L_mh4
    ds_read_b128 v[24:27], v4 offset:8192
    v_mfma_f32_16x16x32_bf16 v[156:159], v[20:23], v[28:31], v[156:159]
    ds_read_b128 v[28:31], v4 offset:8704
    s_waitcnt lgkmcnt(3)
    v_mfma_f32_16x16x32_bf16 v[64:67], v[8:11], v[32:35], v[64:67]
    s_waitcnt lgkmcnt(2)
    v_mfma_f32_16x16x32_bf16 v[68:71], v[8:11], v[36:39], v[68:71]
    ds_read_b128 v[8:11], v3 offset:0
    v_mfma_f32_16x16x32_bf16 v[96:99], v[12:15], v[32:35], v[96:99]
    v_mfma_f32_16x16x32_bf16 v[100:103], v[12:15], v[36:39], v[100:103]
    ds_read_b128 v[12:15], v3 offset:2048
    v_mfma_f32_16x16x32_bf16 v[128:131], v[16:19], v[32:35], v[128:131]
    v_mfma_f32_16x16x32_bf16 v[132:135], v[16:19], v[36:39], v[132:135]
    ds_read_b128 v[16:19], v3 offset:4096
    v_mfma_f32_16x16x32_bf16 v[160:163], v[20:23], v[32:35], v[160:163]
    ds_read_b128 v[32:35], v4 offset:9216
    v_mfma_f32_16x16x32_bf16 v[164:167], v[20:23], v[36:39], v[164:167]
    ds_read_b128 v[20:23], v3 offset:6144
    ds_read_b128 v[36:39], v4 offset:9728
    s_waitcnt lgkmcnt(5)
    v_mfma_f32_16x16x32_bf16 v[40:43], v[8:11], v[24:27], v[40:43]
    v_mfma_f32_16x16x32_bf16 v[44:47], v[8:11], v[28:31], v[44:47]
    s_waitcnt lgkmcnt(4)
    v_mfma_f32_16x16x32_bf16 v[72:75], v[12:15], v[24:27], v[72:75]
    v_mfma_f32_16x16x32_bf16 v[76:79], v[12:15], v[28:31], v[76:79]
    s_waitcnt lgkmcnt(3)
    v_mfma_f32_16x16x32_bf16 v[104:107], v[16:19], v[24:27], v[104:107]
    v_mfma_f32_16x16x32_bf16 v[108:111], v[16:19], v[28:31], v[108:111]
    s_waitcnt lgkmcnt(1)
    v_mfma_f32_16x16x32_bf16 v[136:139], v[20:23], v[24:27], v[136:139]
    ds_read_b128 v[24:27], v5 offset:8192
    v_mfma_f32_16x16x32_bf16 v[140:143], v[20:23], v[28:31], v[140:143]
    ds_read_b128 v[28:31], v5 offset:8704
    v_mfma_f32_16x16x32_bf16 v[48:51], v[8:11], v[32:35], v[48:51]
    s_waitcnt lgkmcnt(2)
    v_mfma_f32_16x16x32_bf16 v[52:55], v[8:11], v[36:39], v[52:55]
    v_mfma_f32_16x16x32_bf16 v[80:83], v[12:15], v[32:35], v[80:83]
    v_mfma_f32_16x16x32_bf16 v[84:87], v[12:15], v[36:39], v[84:87]
    v_mfma_f32_16x16x32_bf16 v[112:115], v[16:19], v[32:35], v[112:115]
    v_mfma_f32_16x16x32_bf16 v[116:119], v[16:19], v[36:39], v[116:119]
    v_mfma_f32_16x16x32_bf16 v[144:147], v[20:23], v[32:35], v[144:147]
    ds_read_b128 v[32:35], v5 offset:9216
    v_mfma_f32_16x16x32_bf16 v[148:151], v[20:23], v[36:39], v[148:151]
    ds_read_b128 v[36:39], v5 offset:9728
    s_waitcnt lgkmcnt(3)
    v_mfma_f32_16x16x32_bf16 v[56:59], v[8:11], v[24:27], v[56:59]
    s_waitcnt lgkmcnt(2)
    v_mfma_f32_16x16x32_bf16 v[60:63], v[8:11], v[28:31], v[60:63]
L_mh4:
    s_cbranch_execz L_mh5
    v_mfma_f32_16x16x32_bf16 v[88:91], v[12:15], v[24:27], v[88:91]
    v_mfma_f32_16x16x32_bf16 v[92:95], v[12:15], v[28:31], v[92:95]
    s_waitcnt lgkmcnt(0)
    s_barrier
    v_add_u32 v4, s42, v4
    v_mfma_f32_16x16x32_bf16 v[120:123], v[16:19], v[24:27], v[120:123]
    v_add_u32 v1, s43, v1
    v_mfma_f32_16x16x32_bf16 v[124:127], v[16:19], v[28:31], v[124:127]
    v_add_u32 v5, s42, v5
    v_mfma_f32_16x16x32_bf16 v[152:155], v[20:23], v[24:27], v[152:155]
    v_add_u32 v3, s43, v3
    ds_read_b128 v[24:27], v4 offset:0
    v_mfma_f32_16x16x32_bf16 v[156:159], v[20:23], v[28:31], v[156:159]
    ds_read_b128 v[28:31], v4 offset:512
    v_mfma_f32_16x16x32_bf16 v[64:67], v[8:11], v[32:35], v[64:67]
    v_mfma_f32_16x16x32_bf16 v[68:71], v[8:11], v[36:39], v[68:71]
    ds_read_b128 v[8:11], v1 offset:0
    v_mfma_f32_16x16x32_bf16 v[96:99], v[12:15], v[32:35], v[96:99]
    v_mfma_f32_16x16x32_bf16 v[100:103], v[12:15], v[36:39], v[100:103]
    ds_read_b128 v[12:15], v1 offset:2048
    v_mfma_f32_16x16x32_bf16 v[128:131], v[16:19], v[32:35], v[128:131]
    v_mfma_f32_16x16x32_bf16 v[132:135], v[16:19], v[36:39], v[132:135]
    ds_read_b128 v[16:19], v1 offset:4096
    v_mfma_f32_16x16x32_bf16 v[160:163], v[20:23], v[32:35], v[160:163]
    ds_read_b128 v[32:35], v4 offset:1024
    v_mfma_f32_16x16x32_bf16 v[164:167], v[20:23], v[36:39], v[164:167]
    ds_read_b128 v[20:23], v1 offset:6144
    ds_read_b128 v[36:39], v4 offset:1536
    s_cmp_lt_u32 s40, 11
    s_cbranch_scc1 L_mloop
    s_waitcnt lgkmcnt(5)
    v_mfma_f32_16x16x32_bf16 v[40:43], v[8:11], v[24:27], v[40:43]
    v_mfma_f32_16x16x32_bf16 v[44:47], v[8:11], v[28:31], v[44:47]
    s_waitcnt lgkmcnt(4)
    v_mfma_f32_16x16x32_bf16 v[72:75], v[12:15], v[24:27], v[72:75]
    v_mfma_f32_16x16x32_bf16 v[76:79], v[12:15], v[28:31], v[76:79]
    s_waitcnt lgkmcnt(3)
    v_mfma_f32_16x16x32_bf16 v[104:107], v[16:19], v[24:27], v[104:107]
    v_mfma_f32_16x16x32_bf16 v[108:111], v[16:19], v[28:31], v[108:111]
    s_waitcnt lgkmcnt(1)
    v_mfma_f32_16x16x32_bf16 v[136:139], v[20:23], v[24:27], v[136:139]
    ds_read_b128 v[24:27], v5 offset:0
    v_mfma_f32_16x16x32_bf16 v[140:143], v[20:23], v[28:31], v[140:143]
    ds_read_b128 v[28:31], v5 offset:512
    v_mfma_f32_16x16x32_bf16 v[48:51], v[8:11], v[32:35], v[48:51]
    s_waitcnt lgkmcnt(2)
    v_mfma_f32_16x16x32_bf16 v[52:55], v[8:11], v[36:39], v[52:55]
    v_mfma_f32_16x16x32_bf16 v[80:83], v[12:15], v[32:35], v[80:83]
L_mh5:
    s_cbranch_execz L_mhret
    v_mfma_f32_16x16x32_bf16 v[84:87], v[12:15], v[36:39], v[84:87]
    v_mfma_f32_16x16x32_bf16 v[112:115], v[16:19], v[32:35], v[112:115]
    v_mfma_f32_16x16x32_bf16 v[116:119], v[16:19], v[36:39], v[116:119]
    v_mfma_f32_16x16x32_bf16 v[144:147], v[20:23], v[32:35], v[144:147]
    ds_read_b128 v[32:35], v5 offset:1024
    v_mfma_f32_16x16x32_bf16 v[148:151], v[20:23], v[36:39], v[148:151]
    ds_read_b128 v[36:39], v5 offset:1536
    s_waitcnt lgkmcnt(3)
    v_mfma_f32_16x16x32_bf16 v[56:59], v[8:11], v[24:27], v[56:59]
    s_waitcnt lgkmcnt(2)
    v_mfma_f32_16x16x32_bf16 v[60:63], v[8:11], v[28:31], v[60:63]
    v_mfma_f32_16x16x32_bf16 v[88:91], v[12:15], v[24:27], v[88:91]
    v_mfma_f32_16x16x32_bf16 v[92:95], v[12:15], v[28:31], v[92:95]
    v_mfma_f32_16x16x32_bf16 v[120:123], v[16:19], v[24:27], v[120:123]
    v_mfma_f32_16x16x32_bf16 v[124:127], v[16:19], v[28:31], v[124:127]
    v_mfma_f32_16x16x32_bf16 v[152:155], v[20:23], v[24:27], v[152:155]
    ds_read_b128 v[24:27], v4 offset:8192
    v_mfma_f32_16x16x32_bf16 v[156:159], v[20:23], v[28:31], v[156:159]
    ds_read_b128 v[28:31], v4 offset:8704
    s_waitcnt lgkmcnt(3)
    v_mfma_f32_16x16x32_bf16 v[64:67], v[8:11], v[32:35], v[64:67]
    s_waitcnt lgkmcnt(2)
    v_mfma_f32_16x16x32_bf16 v[68:71], v[8:11], v[36:39], v[68:71]
    ds_read_b128 v[8:11], v3 offset:0
    v_mfma_f32_16x16x32_bf16 v[96:99], v[12:15], v[32:35], v[96:99]
    v_mfma_f32_16x16x32_bf16 v[100:103], v[12:15], v[36:39], v[100:103]
    ds_read_b128 v[12:15], v3 offset:2048
    v_mfma_f32_16x16x32_bf16 v[128:131], v[16:19], v[32:35], v[128:131]
    v_mfma_f32_16x16x32_bf16 v[132:135], v[16:19], v[36:39], v[132:135]
    ds_read_b128 v[16:19], v3 offset:4096
    v_mfma_f32_16x16x32_bf16 v[160:163], v[20:23], v[32:35], v[160:163]
    ds_read_b128 v[32:35], v4 offset:9216
    v_mfma_f32_16x16x32_bf16 v[164:167], v[20:23], v[36:39], v[164:167]
    ds_read_b128 v[20:23], v3 offset:6144
    ds_read_b128 v[36:39], v4 offset:9728
    s_waitcnt lgkmcnt(5)
    v_mfma_f32_16x16x32_bf16 v[40:43], v[8:11], v[24:27], v[40:43]
    v_mfma_f32_16x16x32_bf16 v[44:47], v[8:11], v[28:31], v[44:47]
    s_waitcnt lgkmcnt(4)
    v_mfma_f32_16x16x32_bf16 v[72:75], v[12:15], v[24:27], v[72:75]
    v_mfma_f32_16x16x32_bf16 v[76:79], v[12:15], v[28:31], v[76:79]
    s_waitcnt lgkmcnt(3)
    v_mfma_f32_16x16x32_bf16 v[104:107], v[16:19], v[24:27], v[104:107]
    v_mfma_f32_16x16x32_bf16 v[108:111], v[16:19], v[28:31], v[108:111]
    s_waitcnt lgkmcnt(1)
    v_mfma_f32_16x16x32_bf16 v[136:139], v[20:23], v[24:27], v[136:139]
    ds_read_b128 v[24:27], v5 offset:8192
    v_mfma_f32_16x16x32_bf16 v[140:143], v[20:23], v[28:31], v[140:143]
L_mh6:
    s_cbranch_execz L_mh7
    ds_read_b128 v[28:31], v5 offset:8704
    v_mfma_f32_16x16x32_bf16 v[48:51], v[8:11], v[32:35], v[48:51]
    s_waitcnt lgkmcnt(2)
    v_mfma_f32_16x16x32_bf16 v[52:55], v[8:11], v[36:39], v[52:55]
    v_mfma_f32_16x16x32_bf16 v[80:83], v[12:15], v[32:35], v[80:83]
    v_mfma_f32_16x16x32_bf16 v[84:87], v[12:15], v[36:39], v[84:87]
    v_mfma_f32_16x16x32_bf16 v[112:115], v[16:19], v[32:35], v[112:115]
    v_mfma_f32_16x16x32_bf16 v[116:119], v[16:19], v[36:39], v[116:119]
    v_mfma_f32_16x16x32_bf16 v[144:147], v[20:23], v[32:35], v[144:147]
    ds_read_b128 v[32:35], v5 offset:9216
    v_mfma_f32_16x16x32_bf16 v[148:151], v[20:23], v[36:39], v[148:151]
    ds_read_b128 v[36:39], v5 offset:9728
    s_waitcnt lgkmcnt(3)
    v_mfma_f32_16x16x32_bf16 v[56:59], v[8:11], v[24:27], v[56:59]
    s_waitcnt lgkmcnt(2)
    v_mfma_f32_16x16x32_bf16 v[60:63], v[8:11], v[28:31], v[60:63]
    v_mfma_f32_16x16x32_bf16 v[88:91], v[12:15], v[24:27], v[88:91]
    v_mfma_f32_16x16x32_bf16 v[92:95], v[12:15], v[28:31], v[92:95]
    s_waitcnt lgkmcnt(0)
    s_barrier
    v_add_u32 v4, 0xffff4000, v4
    v_mfma_f32_16x16x32_bf16 v[120:123], v[16:19], v[24:27], v[120:123]
    v_add_u32 v7, 0x0, v1
    v_mfma_f32_16x16x32_bf16 v[124:127], v[16:19], v[28:31], v[124:127]
    v_add_u32 v1, 0xffff0000, v1
    v_mfma_f32_16x16x32_bf16 v[152:155], v[20:23], v[24:27], v[152:155]
    v_add_u32 v5, 0xffff4000, v5
    ds_read_b128 v[24:27], v1 offset:0
    v_mfma_f32_16x16x32_bf16 v[156:159], v[20:23], v[28:31], v[156:159]
    v_add_u32 v0, 0x0, v3
    v_mfma_f32_16x16x32_bf16 v[64:67], v[8:11], v[32:35], v[64:67]
    v_add_u32 v3, 0xffff0000, v3
    ds_read_b128 v[28:31], v4 offset:0
    v_mfma_f32_16x16x32_bf16 v[68:71], v[8:11], v[36:39], v[68:71]
    ds_read_b128 v[8:11], v1 offset:2048
    v_mfma_f32_16x16x32_bf16 v[96:99], v[12:15], v[32:35], v[96:99]
    v_mfma_f32_16x16x32_bf16 v[100:103], v[12:15], v[36:39], v[100:103]
    ds_read_b128 v[12:15], v4 offset:512
    v_mfma_f32_16x16x32_bf16 v[128:131], v[16:19], v[32:35], v[128:131]
    v_mfma_f32_16x16x32_bf16 v[132:135], v[16:19], v[36:39], v[132:135]
    ds_read_b128 v[16:19], v4 offset:1024
    v_mfma_f32_16x16x32_bf16 v[160:163], v[20:23], v[32:35], v[160:163]
    ds_read_b128 v[32:35], v4 offset:1536
    v_mfma_f32_16x16x32_bf16 v[164:167], v[20:23], v[36:39], v[164:167]
    s_waitcnt lgkmcnt(4)
    v_mfma_f32_16x16x32_bf16 v[40:43], v[24:27], v[28:31], v[40:43]
    ds_read_b128 v[20:23], v5 offset:0
    s_waitcnt lgkmcnt(4)
L_mh7:
    s_cbranch_execz L_mh8
    v_mfma_f32_16x16x32_bf16 v[72:75], v[8:11], v[28:31], v[72:75]
    s_waitcnt lgkmcnt(3)
    v_mfma_f32_16x16x32_bf16 v[44:47], v[24:27], v[12:15], v[44:47]
    ds_read_b128 v[28:31], v5 offset:512
    v_mfma_f32_16x16x32_bf16 v[76:79], v[8:11], v[12:15], v[76:79]
    s_waitcnt lgkmcnt(3)
    v_mfma_f32_16x16x32_bf16 v[48:51], v[24:27], v[16:19], v[48:51]
    ds_read_b128 v[12:15], v5 offset:1024
    v_mfma_f32_16x16x32_bf16 v[80:83], v[8:11], v[16:19], v[80:83]
    ds_read_b128 v[36:39], v3 offset:0
    s_waitcnt lgkmcnt(4)
    v_mfma_f32_16x16x32_bf16 v[52:55], v[24:27], v[32:35], v[52:55]
    ds_read_b128 v[16:19], v5 offset:1536
    v_mfma_f32_16x16x32_bf16 v[84:87], v[8:11], v[32:35], v[84:87]
    s_waitcnt lgkmcnt(4)
    v_mfma_f32_16x16x32_bf16 v[56:59], v[24:27], v[20:23], v[56:59]
    ds_read_b128 v[32:35], v4 offset:8192
    v_mfma_f32_16x16x32_bf16 v[88:91], v[8:11], v[20:23], v[88:91]
    ds_read_b128 v[20:23], v3 offset:2048
    s_waitcnt lgkmcnt(5)
    v_mfma_f32_16x16x32_bf16 v[60:63], v[24:27], v[28:31], v[60:63]
    v_mfma_f32_16x16x32_bf16 v[92:95], v[8:11], v[28:31], v[92:95]
    ds_read_b128 v[28:31], v4 offset:8704
    s_waitcnt lgkmcnt(5)
    v_mfma_f32_16x16x32_bf16 v[64:67], v[24:27], v[12:15], v[64:67]
    v_mfma_f32_16x16x32_bf16 v[96:99], v[8:11], v[12:15], v[96:99]
    ds_read_b128 v[12:15], v4 offset:9216
    s_waitcnt lgkmcnt(4)
    v_mfma_f32_16x16x32_bf16 v[68:71], v[24:27], v[16:19], v[68:71]
    ds_read_b128 v[24:27], v4 offset:9728
    v_mfma_f32_16x16x32_bf16 v[100:103], v[8:11], v[16:19], v[100:103]
    s_waitcnt lgkmcnt(4)
    v_mfma_f32_16x16x32_bf16 v[40:43], v[36:39], v[32:35], v[40:43]
    ds_read_b128 v[8:11], v5 offset:8192
    s_waitcnt lgkmcnt(4)
    v_mfma_f32_16x16x32_bf16 v[72:75], v[20:23], v[32:35], v[72:75]
    s_waitcnt lgkmcnt(3)
    v_mfma_f32_16x16x32_bf16 v[44:47], v[36:39], v[28:31], v[44:47]
    ds_read_b128 v[32:35], v5 offset:8704
    v_mfma_f32_16x16x32_bf16 v[76:79], v[20:23], v[28:31], v[76:79]
    s_waitcnt lgkmcnt(3)
    v_mfma_f32_16x16x32_bf16 v[48:51], v[36:39], v[12:15], v[48:51]
    ds_read_b128 v[28:31], v5 offset:9216
    v_mfma_f32_16x16x32_bf16 v[80:83], v[20:23], v[12:15], v[80:83]
    s_barrier
    ds_read_b128 v[16:19], v1 offset:32768
    s_waitcnt lgkmcnt(4)
    v_mfma_f32_16x16x32_bf16 v[52:55], v[36:39], v[24:27], v[52:55]
L_mh8:
    s_cbranch_execz L_mh9
    ds_read_b128 v[12:15], v5 offset:9728
    v_mfma_f32_16x16x32_bf16 v[84:87], v[20:23], v[24:27], v[84:87]
    s_waitcnt lgkmcnt(4)
    v_mfma_f32_16x16x32_bf16 v[56:59], v[36:39], v[8:11], v[56:59]
    ds_read_b128 v[24:27], v4 offset:16384
    v_mfma_f32_16x16x32_bf16 v[88:91], v[20:23], v[8:11], v[88:91]
    ds_read_b128 v[8:11], v1 offset:34816
    s_waitcnt lgkmcnt(5)
    v_mfma_f32_16x16x32_bf16 v[60:63], v[36:39], v[32:35], v[60:63]
    v_mfma_f32_16x16x32_bf16 v[92:95], v[20:23], v[32:35], v[92:95]
    ds_read_b128 v[32:35], v4 offset:16896
    s_waitcnt lgkmcnt(5)
    v_mfma_f32_16x16x32_bf16 v[64:67], v[36:39], v[28:31], v[64:67]
    v_mfma_f32_16x16x32_bf16 v[96:99], v[20:23], v[28:31], v[96:99]
    ds_read_b128 v[28:31], v4 offset:17408
    s_waitcnt lgkmcnt(4)
    v_mfma_f32_16x16x32_bf16 v[68:71], v[36:39], v[12:15], v[68:71]
    ds_read_b128 v[36:39], v4 offset:17920
    v_mfma_f32_16x16x32_bf16 v[100:103], v[20:23], v[12:15], v[100:103]
    s_waitcnt lgkmcnt(4)
    v_mfma_f32_16x16x32_bf16 v[40:43], v[16:19], v[24:27], v[40:43]
    ds_read_b128 v[12:15], v5 offset:16384
    s_waitcnt lgkmcnt(4)
    v_mfma_f32_16x16x32_bf16 v[72:75], v[8:11], v[24:27], v[72:75]
    s_waitcnt lgkmcnt(3)
    v_mfma_f32_16x16x32_bf16 v[44:47], v[16:19], v[32:35], v[44:47]
    ds_read_b128 v[24:27], v5 offset:16896
    v_mfma_f32_16x16x32_bf16 v[76:79], v[8:11], v[32:35], v[76:79]
    s_waitcnt lgkmcnt(3)
    v_mfma_f32_16x16x32_bf16 v[48:51], v[16:19], v[28:31], v[48:51]
    ds_read_b128 v[32:35], v5 offset:17408
    v_mfma_f32_16x16x32_bf16 v[80:83], v[8:11], v[28:31], v[80:83]
    ds_read_b128 v[20:23], v3 offset:32768
    s_waitcnt lgkmcnt(4)
    v_mfma_f32_16x16x32_bf16 v[52:55], v[16:19], v[36:39], v[52:55]
    ds_read_b128 v[28:31], v5 offset:17920
    v_mfma_f32_16x16x32_bf16 v[84:87], v[8:11], v[36:39], v[84:87]
    s_waitcnt lgkmcnt(4)
    v_mfma_f32_16x16x32_bf16 v[56:59], v[16:19], v[12:15], v[56:59]
    ds_read_b128 v[36:39], v4 offset:24576
    v_mfma_f32_16x16x32_bf16 v[88:91], v[8:11], v[12:15], v[88:91]
    ds_read_b128 v[12:15], v3 offset:34816
    s_waitcnt lgkmcnt(5)
    v_mfma_f32_16x16x32_bf16 v[60:63], v[16:19], v[24:27], v[60:63]
    v_mfma_f32_16x16x32_bf16 v[92:95], v[8:11], v[24:27], v[92:95]
    ds_read_b128 v[24:27], v4 offset:25088
    s_waitcnt lgkmcnt(5)
    v_mfma_f32_16x16x32_bf16 v[64:67], v[16:19], v[32:35], v[64:67]
L_mh9:
    s_cbranch_execz L_mh10
    v_mfma_f32_16x16x32_bf16 v[96:99], v[8:11], v[32:35], v[96:99]
    ds_read_b128 v[32:35], v4 offset:25600
    s_waitcnt lgkmcnt(4)
    v_mfma_f32_16x16x32_bf16 v[68:71], v[16:19], v[28:31], v[68:71]
    ds_read_b128 v[16:19], v4 offset:26112
    v_mfma_f32_16x16x32_bf16 v[100:103], v[8:11], v[28:31], v[100:103]
    s_waitcnt lgkmcnt(4)
    v_mfma_f32_16x16x32_bf16 v[40:43], v[20:23], v[36:39], v[40:43]
    ds_read_b128 v[8:11], v5 offset:24576
    s_waitcnt lgkmcnt(4)
    v_mfma_f32_16x16x32_bf16 v[72:75], v[12:15], v[36:39], v[72:75]
    s_waitcnt lgkmcnt(3)
    v_mfma_f32_16x16x32_bf16 v[44:47], v[20:23], v[24:27], v[44:47]
    ds_read_b128 v[36:39], v5 offset:25088
    v_mfma_f32_16x16x32_bf16 v[76:79], v[12:15], v[24:27], v[76:79]
    s_waitcnt lgkmcnt(3)
    v_mfma_f32_16x16x32_bf16 v[48:51], v[20:23], v[32:35], v[48:51]
    ds_read_b128 v[24:27], v5 offset:25600
    v_mfma_f32_16x16x32_bf16 v[80:83], v[12:15], v[32:35], v[80:83]
    s_barrier
    ds_read_b128 v[28:31], v7 offset:0
    s_waitcnt lgkmcnt(4)
    v_mfma_f32_16x16x32_bf16 v[52:55], v[20:23], v[16:19], v[52:55]
    ds_read_b128 v[32:35], v5 offset:26112
    v_mfma_f32_16x16x32_bf16 v[84:87], v[12:15], v[16:19], v[84:87]
    s_waitcnt lgkmcnt(4)
    v_mfma_f32_16x16x32_bf16 v[56:59], v[20:23], v[8:11], v[56:59]
    ds_read_b128 v[16:19], v4 offset:32768
    v_mfma_f32_16x16x32_bf16 v[88:91], v[12:15], v[8:11], v[88:91]
    ds_read_b128 v[8:11], v7 offset:2048
    s_waitcnt lgkmcnt(5)
    v_mfma_f32_16x16x32_bf16 v[60:63], v[20:23], v[36:39], v[60:63]
    v_mfma_f32_16x16x32_bf16 v[92:95], v[12:15], v[36:39], v[92:95]
    ds_read_b128 v[36:39], v4 offset:33280
    s_waitcnt lgkmcnt(5)
    v_mfma_f32_16x16x32_bf16 v[64:67], v[20:23], v[24:27], v[64:67]
    v_mfma_f32_16x16x32_bf16 v[96:99], v[12:15], v[24:27], v[96:99]
    ds_read_b128 v[24:27], v4 offset:33792
    s_waitcnt lgkmcnt(4)
    v_mfma_f32_16x16x32_bf16 v[68:71], v[20:23], v[32:35], v[68:71]
    ds_read_b128 v[20:23], v4 offset:34304
    v_mfma_f32_16x16x32_bf16 v[100:103], v[12:15], v[32:35], v[100:103]
    s_waitcnt lgkmcnt(4)
    v_mfma_f32_16x16x32_bf16 v[40:43], v[28:31], v[16:19], v[40:43]
    ds_read_b128 v[12:15], v5 offset:32768
    s_waitcnt lgkmcnt(4)
    v_mfma_f32_16x16x32_bf16 v[72:75], v[8:11], v[16:19], v[72:75]
    s_waitcnt lgkmcnt(3)
L_mh10:
    s_cbranch_execz L_mh11
    v_mfma_f32_16x16x32_bf16 v[44:47], v[28:31], v[36:39], v[44:47]
    ds_read_b128 v[16:19], v5 offset:33280
    v_mfma_f32_16x16x32_bf16 v[76:79], v[8:11], v[36:39], v[76:79]
    s_waitcnt lgkmcnt(3)
    v_mfma_f32_16x16x32_bf16 v[48:51], v[28:31], v[24:27], v[48:51]
    ds_read_b128 v[36:39], v5 offset:33792
    v_mfma_f32_16x16x32_bf16 v[80:83], v[8:11], v[24:27], v[80:83]
    ds_read_b128 v[32:35], v0 offset:0
    s_waitcnt lgkmcnt(4)
    v_mfma_f32_16x16x32_bf16 v[52:55], v[28:31], v[20:23], v[52:55]
    ds_read_b128 v[24:27], v5 offset:34304
    v_mfma_f32_16x16x32_bf16 v[84:87], v[8:11], v[20:23], v[84:87]
    s_waitcnt lgkmcnt(4)
    v_mfma_f32_16x16x32_bf16 v[56:59], v[28:31], v[12:15], v[56:59]
    ds_read_b128 v[20:23], v4 offset:40960
    v_mfma_f32_16x16x32_bf16 v[88:91], v[8:11], v[12:15], v[88:91]
    ds_read_b128 v[12:15], v0 offset:2048
    s_waitcnt lgkmcnt(5)
    v_mfma_f32_16x16x32_bf16 v[60:63], v[28:31], v[16:19], v[60:63]
    v_mfma_f32_16x16x32_bf16 v[92:95], v[8:11], v[16:19], v[92:95]
    ds_read_b128 v[16:19], v4 offset:41472
    s_waitcnt lgkmcnt(5)
    v_mfma_f32_16x16x32_bf16 v[64:67], v[28:31], v[36:39], v[64:67]
    v_mfma_f32_16x16x32_bf16 v[96:99], v[8:11], v[36:39], v[96:99]
    ds_read_b128 v[36:39], v4 offset:41984
    s_waitcnt lgkmcnt(4)
    v_mfma_f32_16x16x32_bf16 v[68:71], v[28:31], v[24:27], v[68:71]
    ds_read_b128 v[28:31], v4 offset:42496
    v_mfma_f32_16x16x32_bf16 v[100:103], v[8:11], v[24:27], v[100:103]
    s_waitcnt lgkmcnt(4)
    v_mfma_f32_16x16x32_bf16 v[40:43], v[32:35], v[20:23], v[40:43]
    ds_read_b128 v[8:11], v5 offset:40960
    s_waitcnt lgkmcnt(4)
    v_mfma_f32_16x16x32_bf16 v[72:75], v[12:15], v[20:23], v[72:75]
    s_waitcnt lgkmcnt(3)
    v_mfma_f32_16x16x32_bf16 v[44:47], v[32:35], v[16:19], v[44:47]
    ds_read_b128 v[20:23], v5 offset:41472
    v_mfma_f32_16x16x32_bf16 v[76:79], v[12:15], v[16:19], v[76:79]
    s_waitcnt lgkmcnt(3)
    v_mfma_f32_16x16x32_bf16 v[48:51], v[32:35], v[36:39], v[48:51]
    ds_read_b128 v[16:19], v5 offset:41984
    v_mfma_f32_16x16x32_bf16 v[80:83], v[12:15], v[36:39], v[80:83]
    s_barrier
    ds_read_b128 v[24:27], v1 offset:0
    s_waitcnt lgkmcnt(4)
    v_mfma_f32_16x16x32_bf16 v[52:55], v[32:35], v[28:31], v[52:55]
    ds_read_b128 v[36:39], v5 offset:42496
    v_mfma_f32_16x16x32_bf16 v[84:87], v[12:15], v[28:31], v[84:87]
L_mh11:
    s_cbranch_execz L_mhret
    s_waitcnt lgkmcnt(4)
    v_mfma_f32_16x16x32_bf16 v[56:59], v[32:35], v[8:11], v[56:59]
    ds_read_b128 v[28:31], v4 offset:49152
    v_mfma_f32_16x16x32_bf16 v[88:91], v[12:15], v[8:11], v[88:91]
    ds_read_b128 v[8:11], v1 offset:2048
    s_waitcnt lgkmcnt(5)
    v_mfma_f32_16x16x32_bf16 v[60:63], v[32:35], v[20:23], v[60:63]
    v_mfma_f32_16x16x32_bf16 v[92:95], v[12:15], v[20:23], v[92:95]
    ds_read_b128 v[20:23], v4 offset:49664
    s_waitcnt lgkmcnt(5)
    v_mfma_f32_16x16x32_bf16 v[64:67], v[32:35], v[16:19], v[64:67]
    v_mfma_f32_16x16x32_bf16 v[96:99], v[12:15], v[16:19], v[96:99]
    ds_read_b128 v[16:19], v4 offset:50176
    s_waitcnt lgkmcnt(4)
    v_mfma_f32_16x16x32_bf16 v[68:71], v[32:35], v[36:39], v[68:71]
    ds_read_b128 v[32:35], v4 offset:50688
    v_mfma_f32_16x16x32_bf16 v[100:103], v[12:15], v[36:39], v[100:103]
    s_waitcnt lgkmcnt(4)
    v_mfma_f32_16x16x32_bf16 v[40:43], v[24:27], v[28:31], v[40:43]
    ds_read_b128 v[12:15], v5 offset:49152
    s_waitcnt lgkmcnt(4)
    v_mfma_f32_16x16x32_bf16 v[72:75], v[8:11], v[28:31], v[72:75]
    s_waitcnt lgkmcnt(3)
    v_mfma_f32_16x16x32_bf16 v[44:47], v[24:27], v[20:23], v[44:47]
    ds_read_b128 v[28:31], v5 offset:49664
    v_mfma_f32_16x16x32_bf16 v[76:79], v[8:11], v[20:23], v[76:79]
    s_waitcnt lgkmcnt(3)
    v_mfma_f32_16x16x32_bf16 v[48:51], v[24:27], v[16:19], v[48:51]
    ds_read_b128 v[20:23], v5 offset:50176
    v_mfma_f32_16x16x32_bf16 v[80:83], v[8:11], v[16:19], v[80:83]
    ds_read_b128 v[36:39], v3 offset:0
    s_waitcnt lgkmcnt(4)
    v_mfma_f32_16x16x32_bf16 v[52:55], v[24:27], v[32:35], v[52:55]
    ds_read_b128 v[16:19], v5 offset:50688
    v_mfma_f32_16x16x32_bf16 v[84:87], v[8:11], v[32:35], v[84:87]
    s_waitcnt lgkmcnt(4)
    v_mfma_f32_16x16x32_bf16 v[56:59], v[24:27], v[12:15], v[56:59]
    ds_read_b128 v[32:35], v4 offset:57344
    v_mfma_f32_16x16x32_bf16 v[88:91], v[8:11], v[12:15], v[88:91]
    ds_read_b128 v[12:15], v3 offset:2048
    s_waitcnt lgkmcnt(5)
    v_mfma_f32_16x16x32_bf16 v[60:63], v[24:27], v[28:31], v[60:63]
    v_mfma_f32_16x16x32_bf16 v[92:95], v[8:11], v[28:31], v[92:95]
    ds_read_b128 v[28:31], v4 offset:57856
    s_waitcnt lgkmcnt(5)
    v_mfma_f32_16x16x32_bf16 v[64:67], v[24:27], v[20:23], v[64:67]
    v_mfma_f32_16x16x32_bf16 v[96:99], v[8:11], v[20:23], v[96:99]
    ds_read_b128 v[20:23], v4 offset:58368
L_mh12:
    s_cbranch_execz L_mh13
    s_waitcnt lgkmcnt(4)
    v_mfma_f32_16x16x32_bf16 v[68:71], v[24:27], v[16:19], v[68:71]
    ds_read_b128 v[24:27], v4 offset:58880
    v_mfma_f32_16x16x32_bf16 v[100:103], v[8:11], v[16:19], v[100:103]
    s_waitcnt lgkmcnt(4)
    v_mfma_f32_16x16x32_bf16 v[40:43], v[36:39], v[32:35], v[40:43]
    ds_read_b128 v[8:11], v5 offset:57344
    s_waitcnt lgkmcnt(4)
    v_mfma_f32_16x16x32_bf16 v[72:75], v[12:15], v[32:35], v[72:75]
    s_waitcnt lgkmcnt(3)
    v_mfma_f32_16x16x32_bf16 v[44:47], v[36:39], v[28:31], v[44:47]
    ds_read_b128 v[32:35], v5 offset:57856
    v_mfma_f32_16x16x32_bf16 v[76:79], v[12:15], v[28:31], v[76:79]
    s_waitcnt lgkmcnt(3)
    v_mfma_f32_16x16x32_bf16 v[48:51], v[36:39], v[20:23], v[48:51]
    ds_read_b128 v[28:31], v5 offset:58368
    v_mfma_f32_16x16x32_bf16 v[80:83], v[12:15], v[20:23], v[80:83]
    ds_read_b128 v[16:19], v1 offset:4096
    s_waitcnt lgkmcnt(4)
    v_mfma_f32_16x16x32_bf16 v[52:55], v[36:39], v[24:27], v[52:55]
    ds_read_b128 v[20:23], v5 offset:58880
    v_mfma_f32_16x16x32_bf16 v[84:87], v[12:15], v[24:27], v[84:87]
    s_waitcnt lgkmcnt(4)
    v_mfma_f32_16x16x32_bf16 v[56:59], v[36:39], v[8:11], v[56:59]
    ds_read_b128 v[24:27], v4 offset:0
    v_mfma_f32_16x16x32_bf16 v[88:91], v[12:15], v[8:11], v[88:91]
    ds_read_b128 v[8:11], v1 offset:6144
    s_waitcnt lgkmcnt(5)
    v_mfma_f32_16x16x32_bf16 v[60:63], v[36:39], v[32:35], v[60:63]
    v_mfma_f32_16x16x32_bf16 v[92:95], v[12:15], v[32:35], v[92:95]
    ds_read_b128 v[32:35], v4 offset:512
    s_waitcnt lgkmcnt(5)
    v_mfma_f32_16x16x32_bf16 v[64:67], v[36:39], v[28:31], v[64:67]
    v_mfma_f32_16x16x32_bf16 v[96:99], v[12:15], v[28:31], v[96:99]
    ds_read_b128 v[28:31], v4 offset:1024
    s_waitcnt lgkmcnt(4)
    v_mfma_f32_16x16x32_bf16 v[68:71], v[36:39], v[20:23], v[68:71]
    ds_read_b128 v[36:39], v4 offset:1536
    v_mfma_f32_16x16x32_bf16 v[100:103], v[12:15], v[20:23], v[100:103]
    s_waitcnt lgkmcnt(4)
    v_mfma_f32_16x16x32_bf16 v[104:107], v[16:19], v[24:27], v[104:107]
    ds_read_b128 v[12:15], v5 offset:0
    s_waitcnt lgkmcnt(4)
    v_mfma_f32_16x16x32_bf16 v[136:139], v[8:11], v[24:27], v[136:139]
    s_waitcnt lgkmcnt(3)
    v_mfma_f32_16x16x32_bf16 v[108:111], v[16:19], v[32:35], v[108:111]
    ds_read_b128 v[24:27], v5 offset:512
    v_mfma_f32_16x16x32_bf16 v[140:143], v[8:11], v[32:35], v[140:143]
L_mh13:
    s_cbranch_execz L_mh14
    s_waitcnt lgkmcnt(3)
    v_mfma_f32_16x16x32_bf16 v[112:115], v[16:19], v[28:31], v[112:115]
    ds_read_b128 v[20:23], v5 offset:1024
    v_cvt_pk_bf16_f32 v32, v40, v44
    v_mfma_f32_16x16x32_bf16 v[144:147], v[8:11], v[28:31], v[144:147]
    v_cvt_pk_bf16_f32 v33, v48, v52
    s_waitcnt lgkmcnt(3)
    v_mfma_f32_16x16x32_bf16 v[116:119], v[16:19], v[36:39], v[116:119]
    ds_read_b128 v[28:31], v5 offset:1536
    v_cvt_pk_bf16_f32 v34, v56, v60
    v_mfma_f32_16x16x32_bf16 v[148:151], v[8:11], v[36:39], v[148:151]
    ds_read_b128 v[36:39], v3 offset:4096
    v_cvt_pk_bf16_f32 v35, v64, v68
    s_waitcnt lgkmcnt(4)
    v_mfma_f32_16x16x32_bf16 v[120:123], v[16:19], v[12:15], v[120:123]
    buffer_store_dwordx4 v[32:35], v6, s[28:31], s36 offen sc1 nt
    v_mfma_f32_16x16x32_bf16 v[152:155], v[8:11], v[12:15], v[152:155]
    ds_read_b128 v[12:15], v4 offset:8192
    s_add_u32 s36, s36, 7168
    s_waitcnt lgkmcnt(4)
    v_mfma_f32_16x16x32_bf16 v[124:127], v[16:19], v[24:27], v[124:127]
    v_cvt_pk_bf16_f32 v32, v41, v45
    v_mfma_f32_16x16x32_bf16 v[156:159], v[8:11], v[24:27], v[156:159]
    ds_read_b128 v[24:27], v3 offset:6144
    v_cvt_pk_bf16_f32 v33, v49, v53
    s_waitcnt lgkmcnt(4)
    v_mfma_f32_16x16x32_bf16 v[128:131], v[16:19], v[20:23], v[128:131]
    v_cvt_pk_bf16_f32 v34, v57, v61
    v_mfma_f32_16x16x32_bf16 v[160:163], v[8:11], v[20:23], v[160:163]
    ds_read_b128 v[20:23], v4 offset:8704
    v_cvt_pk_bf16_f32 v35, v65, v69
    s_waitcnt lgkmcnt(4)
    v_mfma_f32_16x16x32_bf16 v[132:135], v[16:19], v[28:31], v[132:135]
    ds_read_b128 v[16:19], v4 offset:9216
    buffer_store_dwordx4 v[32:35], v6, s[28:31], s36 offen sc1 nt
    v_mfma_f32_16x16x32_bf16 v[164:167], v[8:11], v[28:31], v[164:167]
    ds_read_b128 v[8:11], v4 offset:9728
    s_add_u32 s36, s36, 7168
    s_waitcnt lgkmcnt(4)
    v_mfma_f32_16x16x32_bf16 v[104:107], v[36:39], v[12:15], v[104:107]
    ds_read_b128 v[28:31], v5 offset:8192
    v_cvt_pk_bf16_f32 v32, v42, v46
    s_waitcnt lgkmcnt(4)
    v_mfma_f32_16x16x32_bf16 v[136:139], v[24:27], v[12:15], v[136:139]
    v_cvt_pk_bf16_f32 v33, v50, v54
    s_waitcnt lgkmcnt(3)
    v_mfma_f32_16x16x32_bf16 v[108:111], v[36:39], v[20:23], v[108:111]
    ds_read_b128 v[12:15], v5 offset:8704
L_mh14:
    s_cbranch_execz L_mh15
    v_cvt_pk_bf16_f32 v34, v58, v62
    v_mfma_f32_16x16x32_bf16 v[140:143], v[24:27], v[20:23], v[140:143]
    v_cvt_pk_bf16_f32 v35, v66, v70
    s_waitcnt lgkmcnt(3)
    v_mfma_f32_16x16x32_bf16 v[112:115], v[36:39], v[16:19], v[112:115]
    ds_read_b128 v[20:23], v5 offset:9216
    buffer_store_dwordx4 v[32:35], v6, s[28:31], s36 offen sc1 nt
    v_mfma_f32_16x16x32_bf16 v[144:147], v[24:27], v[16:19], v[144:147]
    s_add_u32 s36, s36, 7168
    s_waitcnt lgkmcnt(3)
    v_mfma_f32_16x16x32_bf16 v[116:119], v[36:39], v[8:11], v[116:119]
    ds_read_b128 v[16:19], v5 offset:9728
    v_cvt_pk_bf16_f32 v32, v43, v47
    v_mfma_f32_16x16x32_bf16 v[148:151], v[24:27], v[8:11], v[148:151]
    ds_read_b128 v[8:11], v1 offset:36864
    v_cvt_pk_bf16_f32 v33, v51, v55
    s_waitcnt lgkmcnt(4)
    v_mfma_f32_16x16x32_bf16 v[120:123], v[36:39], v[28:31], v[120:123]
    v_cvt_pk_bf16_f32 v34, v59, v63
    v_mfma_f32_16x16x32_bf16 v[152:155], v[24:27], v[28:31], v[152:155]
    ds_read_b128 v[28:31], v4 offset:16384
    v_cvt_pk_bf16_f32 v35, v67, v71
    s_waitcnt lgkmcnt(4)
    v_mfma_f32_16x16x32_bf16 v[124:127], v[36:39], v[12:15], v[124:127]
    buffer_store_dwordx4 v[32:35], v6, s[28:31], s36 offen sc1 nt
    v_mfma_f32_16x16x32_bf16 v[156:159], v[24:27], v[12:15], v[156:159]
    ds_read_b128 v[12:15], v1 offset:38912
    s_add_u32 s36, s36, 93184
    s_waitcnt lgkmcnt(4)
    v_mfma_f32_16x16x32_bf16 v[128:131], v[36:39], v[20:23], v[128:131]
    ds_read_b128 v[32:35], v4 offset:16896
    v_cvt_pk_bf16_f32 v40, v72, v76
    v_mfma_f32_16x16x32_bf16 v[160:163], v[24:27], v[20:23], v[160:163]
    ds_read_b128 v[48:51], v4 offset:17408
    v_cvt_pk_bf16_f32 v41, v80, v84
    s_waitcnt lgkmcnt(5)
    v_mfma_f32_16x16x32_bf16 v[132:135], v[36:39], v[16:19], v[132:135]
    ds_read_b128 v[36:39], v4 offset:17920
    v_cvt_pk_bf16_f32 v42, v88, v92
    v_mfma_f32_16x16x32_bf16 v[164:167], v[24:27], v[16:19], v[164:167]
    v_cvt_pk_bf16_f32 v43, v96, v100
    s_waitcnt lgkmcnt(4)
    v_mfma_f32_16x16x32_bf16 v[104:107], v[8:11], v[28:31], v[104:107]
    ds_read_b128 v[24:27], v5 offset:16384
    buffer_store_dwordx4 v[40:43], v6, s[28:31], s36 offen sc1 nt
    s_waitcnt lgkmcnt(4)
    v_mfma_f32_16x16x32_bf16 v[136:139], v[12:15], v[28:31], v[136:139]
    s_add_u32 s36, s36, 7168
L_mh15:
    s_cbranch_execz L_mh16
    s_waitcnt lgkmcnt(3)
    v_mfma_f32_16x16x32_bf16 v[108:111], v[8:11], v[32:35], v[108:111]
    ds_read_b128 v[28:31], v5 offset:16896
    v_cvt_pk_bf16_f32 v44, v73, v77
    v_mfma_f32_16x16x32_bf16 v[140:143], v[12:15], v[32:35], v[140:143]
    v_cvt_pk_bf16_f32 v45, v81, v85
    s_waitcnt lgkmcnt(3)
    v_mfma_f32_16x16x32_bf16 v[112:115], v[8:11], v[48:51], v[112:115]
    ds_read_b128 v[32:35], v5 offset:17408
    v_cvt_pk_bf16_f32 v46, v89, v93
    v_mfma_f32_16x16x32_bf16 v[144:147], v[12:15], v[48:51], v[144:147]
    ds_read_b128 v[16:19], v3 offset:36864
    v_cvt_pk_bf16_f32 v47, v97, v101
    s_waitcnt lgkmcnt(4)
    v_mfma_f32_16x16x32_bf16 v[116:119], v[8:11], v[36:39], v[116:119]
    ds_read_b128 v[48:51], v5 offset:17920
    buffer_store_dwordx4 v[44:47], v6, s[28:31], s36 offen sc1 nt
    v_mfma_f32_16x16x32_bf16 v[148:151], v[12:15], v[36:39], v[148:151]
    ds_read_b128 v[20:23], v3 offset:38912
    s_add_u32 s36, s36, 7168
    s_waitcnt lgkmcnt(5)
    v_mfma_f32_16x16x32_bf16 v[120:123], v[8:11], v[24:27], v[120:123]
    ds_read_b128 v[36:39], v4 offset:24576
    v_cvt_pk_bf16_f32 v40, v74, v78
    v_mfma_f32_16x16x32_bf16 v[152:155], v[12:15], v[24:27], v[152:155]
    v_cvt_pk_bf16_f32 v41, v82, v86
    s_waitcnt lgkmcnt(5)
    v_mfma_f32_16x16x32_bf16 v[124:127], v[8:11], v[28:31], v[124:127]
    ds_read_b128 v[24:27], v4 offset:25088
    v_cvt_pk_bf16_f32 v42, v90, v94
    v_mfma_f32_16x16x32_bf16 v[156:159], v[12:15], v[28:31], v[156:159]
    v_cvt_pk_bf16_f32 v43, v98, v102
    s_waitcnt lgkmcnt(5)
    v_mfma_f32_16x16x32_bf16 v[128:131], v[8:11], v[32:35], v[128:131]
    ds_read_b128 v[28:31], v4 offset:25600
    buffer_store_dwordx4 v[40:43], v6, s[28:31], s36 offen sc1 nt
    v_mfma_f32_16x16x32_bf16 v[160:163], v[12:15], v[32:35], v[160:163]
    s_add_u32 s36, s36, 7168
    s_waitcnt lgkmcnt(4)
    v_mfma_f32_16x16x32_bf16 v[132:135], v[8:11], v[48:51], v[132:135]
    ds_read_b128 v[8:11], v4 offset:26112
    v_cvt_pk_bf16_f32 v44, v75, v79
    v_mfma_f32_16x16x32_bf16 v[164:167], v[12:15], v[48:51], v[164:167]
    v_cvt_pk_bf16_f32 v45, v83, v87
    s_waitcnt lgkmcnt(3)
    v_mfma_f32_16x16x32_bf16 v[104:107], v[16:19], v[36:39], v[104:107]
    ds_read_b128 v[12:15], v5 offset:24576
    v_cvt_pk_bf16_f32 v46, v91, v95
L_mh16:
    s_cbranch_execz L_mh17
    v_mfma_f32_16x16x32_bf16 v[136:139], v[20:23], v[36:39], v[136:139]
    v_cvt_pk_bf16_f32 v47, v99, v103
    s_waitcnt lgkmcnt(3)
    v_mfma_f32_16x16x32_bf16 v[108:111], v[16:19], v[24:27], v[108:111]
    ds_read_b128 v[36:39], v5 offset:25088
    buffer_store_dwordx4 v[44:47], v6, s[28:31], s36 offen sc1 nt
    v_mfma_f32_16x16x32_bf16 v[140:143], v[20:23], v[24:27], v[140:143]
    ds_read_b128 v[48:51], v4 offset:49152
    s_add_u32 s36, s36, 93184
    s_waitcnt lgkmcnt(4)
    v_mfma_f32_16x16x32_bf16 v[112:115], v[16:19], v[28:31], v[112:115]
    ds_read_b128 v[80:83], v5 offset:25600
    v_mfma_f32_16x16x32_bf16 v[144:147], v[20:23], v[28:31], v[144:147]
    s_barrier
    ds_read_b128 v[24:27], v7 offset:4096
    s_waitcnt lgkmcnt(5)
    v_mfma_f32_16x16x32_bf16 v[116:119], v[16:19], v[8:11], v[116:119]
    ds_read_b128 v[28:31], v5 offset:26112
    v_mfma_f32_16x16x32_bf16 v[148:151], v[20:23], v[8:11], v[148:151]
    ds_read_b128 v[32:35], v0 offset:4096
    s_waitcnt lgkmcnt(6)
    v_mfma_f32_16x16x32_bf16 v[120:123], v[16:19], v[12:15], v[120:123]
    ds_read_b128 v[8:11], v4 offset:32768
    v_mfma_f32_16x16x32_bf16 v[152:155], v[20:23], v[12:15], v[152:155]
    ds_read_b128 v[12:15], v4 offset:33280
    s_waitcnt lgkmcnt(7)
    v_mfma_f32_16x16x32_bf16 v[124:127], v[16:19], v[36:39], v[124:127]
    ds_read_b128 v[84:87], v4 offset:33792
    v_mfma_f32_16x16x32_bf16 v[156:159], v[20:23], v[36:39], v[156:159]
    ds_read_b128 v[36:39], v4 offset:34304
    s_waitcnt lgkmcnt(7)
    v_mfma_f32_16x16x32_bf16 v[128:131], v[16:19], v[80:83], v[128:131]
    ds_read_b128 v[88:91], v5 offset:32768
    v_mfma_f32_16x16x32_bf16 v[160:163], v[20:23], v[80:83], v[160:163]
    ds_read_b128 v[80:83], v5 offset:33280
    s_waitcnt lgkmcnt(7)
    v_mfma_f32_16x16x32_bf16 v[132:135], v[16:19], v[28:31], v[132:135]
    ds_read_b128 v[16:19], v5 offset:33792
    v_mfma_f32_16x16x32_bf16 v[164:167], v[20:23], v[28:31], v[164:167]
    ds_read_b128 v[28:31], v5 offset:34304
    s_waitcnt lgkmcnt(7)
    v_mfma_f32_16x16x32_bf16 v[104:107], v[24:27], v[8:11], v[104:107]
    ds_read_b128 v[8:11], v4 offset:40960
    s_waitcnt lgkmcnt(7)
    v_mfma_f32_16x16x32_bf16 v[108:111], v[24:27], v[12:15], v[108:111]
    ds_read_b128 v[12:15], v4 offset:41472
    s_waitcnt lgkmcnt(7)
    v_mfma_f32_16x16x32_bf16 v[112:115], v[24:27], v[84:87], v[112:115]
L_mh17:
    s_cbranch_execz L_mhret
    ds_read_b128 v[84:87], v4 offset:41984
    s_waitcnt lgkmcnt(7)
    v_mfma_f32_16x16x32_bf16 v[116:119], v[24:27], v[36:39], v[116:119]
    ds_read_b128 v[36:39], v4 offset:42496
    s_waitcnt lgkmcnt(7)
    v_mfma_f32_16x16x32_bf16 v[120:123], v[24:27], v[88:91], v[120:123]
    ds_read_b128 v[88:91], v5 offset:40960
    s_waitcnt lgkmcnt(7)
    v_mfma_f32_16x16x32_bf16 v[124:127], v[24:27], v[80:83], v[124:127]
    ds_read_b128 v[80:83], v5 offset:41472
    s_waitcnt lgkmcnt(7)
    v_mfma_f32_16x16x32_bf16 v[128:131], v[24:27], v[16:19], v[128:131]
    ds_read_b128 v[16:19], v5 offset:41984
    s_waitcnt lgkmcnt(7)
    v_mfma_f32_16x16x32_bf16 v[132:135], v[24:27], v[28:31], v[132:135]
    ds_read_b128 v[24:27], v5 offset:42496
    s_waitcnt lgkmcnt(7)
    v_mfma_f32_16x16x32_bf16 v[104:107], v[32:35], v[8:11], v[104:107]
    ds_read_b128 v[20:23], v1 offset:32768
    s_waitcnt lgkmcnt(7)
    v_mfma_f32_16x16x32_bf16 v[108:111], v[32:35], v[12:15], v[108:111]
    ds_read_b128 v[12:15], v4 offset:49664
    s_waitcnt lgkmcnt(7)
    v_mfma_f32_16x16x32_bf16 v[112:115], v[32:35], v[84:87], v[112:115]
    ds_read_b128 v[84:87], v4 offset:50176
    s_waitcnt lgkmcnt(7)
    v_mfma_f32_16x16x32_bf16 v[116:119], v[32:35], v[36:39], v[116:119]
    ds_read_b128 v[36:39], v4 offset:50688
    s_waitcnt lgkmcnt(7)
    v_mfma_f32_16x16x32_bf16 v[120:123], v[32:35], v[88:91], v[120:123]
    ds_read_b128 v[88:91], v5 offset:49152
    s_waitcnt lgkmcnt(7)
    v_mfma_f32_16x16x32_bf16 v[124:127], v[32:35], v[80:83], v[124:127]
    ds_read_b128 v[80:83], v5 offset:49664
    s_waitcnt lgkmcnt(7)
    v_mfma_f32_16x16x32_bf16 v[128:131], v[32:35], v[16:19], v[128:131]
    ds_read_b128 v[16:19], v5 offset:50176
    s_waitcnt lgkmcnt(7)
    v_mfma_f32_16x16x32_bf16 v[132:135], v[32:35], v[24:27], v[132:135]
    ds_read_b128 v[24:27], v5 offset:50688
    s_waitcnt lgkmcnt(7)
    v_mfma_f32_16x16x32_bf16 v[104:107], v[20:23], v[48:51], v[104:107]
    ds_read_b128 v[8:11], v3 offset:32768
    s_waitcnt lgkmcnt(7)
    v_mfma_f32_16x16x32_bf16 v[108:111], v[20:23], v[12:15], v[108:111]
    ds_read_b128 v[32:35], v4 offset:57344
    s_waitcnt lgkmcnt(7)
    v_mfma_f32_16x16x32_bf16 v[112:115], v[20:23], v[84:87], v[112:115]
L_mh18:
    s_cbranch_execz L_mh19
    ds_read_b128 v[28:31], v4 offset:57856
    s_waitcnt lgkmcnt(7)
    v_mfma_f32_16x16x32_bf16 v[116:119], v[20:23], v[36:39], v[116:119]
    ds_read_b128 v[92:95], v4 offset:58368
    s_waitcnt lgkmcnt(7)
    v_mfma_f32_16x16x32_bf16 v[120:123], v[20:23], v[88:91], v[120:123]
    ds_read_b128 v[96:99], v4 offset:58880
    s_waitcnt lgkmcnt(7)
    v_mfma_f32_16x16x32_bf16 v[124:127], v[20:23], v[80:83], v[124:127]
    ds_read_b128 v[100:103], v5 offset:57344
    s_waitcnt lgkmcnt(7)
    v_mfma_f32_16x16x32_bf16 v[128:131], v[20:23], v[16:19], v[128:131]
    ds_read_b128 v[52:55], v5 offset:57856
    s_waitcnt lgkmcnt(7)
    v_mfma_f32_16x16x32_bf16 v[132:135], v[20:23], v[24:27], v[132:135]
    ds_read_b128 v[56:59], v5 offset:58368
    s_waitcnt lgkmcnt(6)
    v_mfma_f32_16x16x32_bf16 v[104:107], v[8:11], v[32:35], v[104:107]
    ds_read_b128 v[20:23], v5 offset:58880
    s_waitcnt lgkmcnt(6)
    v_mfma_f32_16x16x32_bf16 v[108:111], v[8:11], v[28:31], v[108:111]
    ds_read_b128 v[60:63], v1 offset:34816
    s_waitcnt lgkmcnt(6)
    v_mfma_f32_16x16x32_bf16 v[112:115], v[8:11], v[92:95], v[112:115]
    s_waitcnt lgkmcnt(5)
    v_mfma_f32_16x16x32_bf16 v[116:119], v[8:11], v[96:99], v[116:119]
    s_waitcnt lgkmcnt(4)
    v_mfma_f32_16x16x32_bf16 v[120:123], v[8:11], v[100:103], v[120:123]
    s_waitcnt lgkmcnt(3)
    v_mfma_f32_16x16x32_bf16 v[124:127], v[8:11], v[52:55], v[124:127]
    s_waitcnt lgkmcnt(2)
    v_mfma_f32_16x16x32_bf16 v[128:131], v[8:11], v[56:59], v[128:131]
    ds_read_b128 v[64:67], v3 offset:34816
    s_waitcnt lgkmcnt(2)
    v_mfma_f32_16x16x32_bf16 v[132:135], v[8:11], v[20:23], v[132:135]
    s_waitcnt lgkmcnt(1)
    v_mfma_f32_16x16x32_bf16 v[136:139], v[60:63], v[48:51], v[136:139]
    v_mfma_f32_16x16x32_bf16 v[140:143], v[60:63], v[12:15], v[140:143]
    v_mfma_f32_16x16x32_bf16 v[144:147], v[60:63], v[84:87], v[144:147]
    v_mfma_f32_16x16x32_bf16 v[148:151], v[60:63], v[36:39], v[148:151]
    v_mfma_f32_16x16x32_bf16 v[152:155], v[60:63], v[88:91], v[152:155]
    v_mfma_f32_16x16x32_bf16 v[156:159], v[60:63], v[80:83], v[156:159]
    v_cvt_pk_bf16_f32 v72, v104, v108
    v_mfma_f32_16x16x32_bf16 v[160:163], v[60:63], v[16:19], v[160:163]
    ds_read_b128 v[16:19], v7 offset:6144
    v_cvt_pk_bf16_f32 v73, v112, v116
    v_mfma_f32_16x16x32_bf16 v[164:167], v[60:63], v[24:27], v[164:167]
    ds_read_b128 v[8:11], v0 offset:6144
L_mh19:
    s_cbranch_execz L_mh20
    v_cvt_pk_bf16_f32 v74, v120, v124
    s_waitcnt lgkmcnt(2)
    v_mfma_f32_16x16x32_bf16 v[136:139], v[64:67], v[32:35], v[136:139]
    ds_read_b128 v[32:35], v4 offset:32768
    v_cvt_pk_bf16_f32 v75, v128, v132
    v_mfma_f32_16x16x32_bf16 v[140:143], v[64:67], v[28:31], v[140:143]
    ds_read_b128 v[28:31], v4 offset:33280
    buffer_store_dwordx4 v[72:75], v6, s[28:31], s36 offen sc1 nt
    v_mfma_f32_16x16x32_bf16 v[144:147], v[64:67], v[92:95], v[144:147]
    ds_read_b128 v[92:95], v4 offset:33792
    s_add_u32 s36, s36, 7168
    v_mfma_f32_16x16x32_bf16 v[148:151], v[64:67], v[96:99], v[148:151]
    ds_read_b128 v[96:99], v4 offset:34304
    v_cvt_pk_bf16_f32 v76, v105, v109
    v_mfma_f32_16x16x32_bf16 v[152:155], v[64:67], v[100:103], v[152:155]
    ds_read_b128 v[100:103], v5 offset:32768
    v_cvt_pk_bf16_f32 v77, v113, v117
    v_mfma_f32_16x16x32_bf16 v[156:159], v[64:67], v[52:55], v[156:159]
    ds_read_b128 v[52:55], v5 offset:33280
    v_cvt_pk_bf16_f32 v78, v121, v125
    v_mfma_f32_16x16x32_bf16 v[160:163], v[64:67], v[56:59], v[160:163]
    ds_read_b128 v[56:59], v5 offset:33792
    v_cvt_pk_bf16_f32 v79, v129, v133
    v_mfma_f32_16x16x32_bf16 v[164:167], v[64:67], v[20:23], v[164:167]
    ds_read_b128 v[20:23], v5 offset:34304
    buffer_store_dwordx4 v[76:79], v6, s[28:31], s36 offen sc1 nt
    s_waitcnt lgkmcnt(7)
    v_mfma_f32_16x16x32_bf16 v[136:139], v[16:19], v[32:35], v[136:139]
    ds_read_b128 v[32:35], v4 offset:40960
    s_add_u32 s36, s36, 7168
    s_waitcnt lgkmcnt(7)
    v_mfma_f32_16x16x32_bf16 v[140:143], v[16:19], v[28:31], v[140:143]
    ds_read_b128 v[28:31], v4 offset:41472
    v_cvt_pk_bf16_f32 v72, v106, v110
    s_waitcnt lgkmcnt(7)
    v_mfma_f32_16x16x32_bf16 v[144:147], v[16:19], v[92:95], v[144:147]
    ds_read_b128 v[92:95], v4 offset:41984
    v_cvt_pk_bf16_f32 v73, v114, v118
    s_waitcnt lgkmcnt(7)
    v_mfma_f32_16x16x32_bf16 v[148:151], v[16:19], v[96:99], v[148:151]
    ds_read_b128 v[96:99], v4 offset:42496
    v_cvt_pk_bf16_f32 v74, v122, v126
    s_waitcnt lgkmcnt(7)
    v_mfma_f32_16x16x32_bf16 v[152:155], v[16:19], v[100:103], v[152:155]
    ds_read_b128 v[100:103], v5 offset:40960
    v_cvt_pk_bf16_f32 v75, v130, v134
    s_waitcnt lgkmcnt(7)
    v_mfma_f32_16x16x32_bf16 v[156:159], v[16:19], v[52:55], v[156:159]
L_mh20:
    s_cbranch_execz L_mh21
    ds_read_b128 v[52:55], v5 offset:41472
    buffer_store_dwordx4 v[72:75], v6, s[28:31], s36 offen sc1 nt
    s_waitcnt lgkmcnt(7)
    v_mfma_f32_16x16x32_bf16 v[160:163], v[16:19], v[56:59], v[160:163]
    ds_read_b128 v[56:59], v5 offset:41984
    s_add_u32 s36, s36, 7168
    s_waitcnt lgkmcnt(7)
    v_mfma_f32_16x16x32_bf16 v[164:167], v[16:19], v[20:23], v[164:167]
    ds_read_b128 v[16:19], v5 offset:42496
    v_cvt_pk_bf16_f32 v76, v107, v111
    s_waitcnt lgkmcnt(7)
    v_mfma_f32_16x16x32_bf16 v[136:139], v[8:11], v[32:35], v[136:139]
    v_cvt_pk_bf16_f32 v77, v115, v119
    s_waitcnt lgkmcnt(6)
    v_mfma_f32_16x16x32_bf16 v[140:143], v[8:11], v[28:31], v[140:143]
    v_cvt_pk_bf16_f32 v78, v123, v127
    s_waitcnt lgkmcnt(5)
    v_mfma_f32_16x16x32_bf16 v[144:147], v[8:11], v[92:95], v[144:147]
    v_cvt_pk_bf16_f32 v79, v131, v135
    s_waitcnt lgkmcnt(4)
    v_mfma_f32_16x16x32_bf16 v[148:151], v[8:11], v[96:99], v[148:151]
    buffer_store_dwordx4 v[76:79], v6, s[28:31], s36 offen sc1 nt
    s_waitcnt lgkmcnt(3)
    v_mfma_f32_16x16x32_bf16 v[152:155], v[8:11], v[100:103], v[152:155]
    s_add_u32 s36, s36, 93184
    s_waitcnt lgkmcnt(2)
    v_mfma_f32_16x16x32_bf16 v[156:159], v[8:11], v[52:55], v[156:159]
    s_waitcnt lgkmcnt(1)
    v_mfma_f32_16x16x32_bf16 v[160:163], v[8:11], v[56:59], v[160:163]
    s_waitcnt lgkmcnt(0)
    v_mfma_f32_16x16x32_bf16 v[164:167], v[8:11], v[16:19], v[164:167]
    s_nop 7
    v_cvt_pk_bf16_f32 v32, v136, v140
    v_cvt_pk_bf16_f32 v33, v144, v148
    v_cvt_pk_bf16_f32 v34, v152, v156
    v_cvt_pk_bf16_f32 v35, v160, v164
    buffer_store_dwordx4 v[32:35], v6, s[28:31], s36 offen sc1 nt
    s_add_u32 s36, s36, 7168
    v_cvt_pk_bf16_f32 v36, v137, v141
    v_cvt_pk_bf16_f32 v37, v145, v149
    v_cvt_pk_bf16_f32 v38, v153, v157
    v_cvt_pk_bf16_f32 v39, v161, v165
    buffer_store_dwordx4 v[36:39], v6, s[28:31], s36 offen sc1 nt
    s_add_u32 s36, s36, 7168
    v_cvt_pk_bf16_f32 v32, v138, v142
    v_cvt_pk_bf16_f32 v33, v146, v150
    v_cvt_pk_bf16_f32 v34, v154, v158
    v_cvt_pk_bf16_f32 v35, v162, v166
L_mh21:
    s_cbranch_execz L_mhret
    buffer_store_dwordx4 v[32:35], v6, s[28:31], s36 offen sc1 nt
    s_add_u32 s36, s36, 7168
    v_cvt_pk_bf16_f32 v36, v139, v143
    v_cvt_pk_bf16_f32 v37, v147, v151
    v_cvt_pk_bf16_f32 v38, v155, v159
    v_cvt_pk_bf16_f32 v39, v163, v167
    buffer_store_dwordx4 v[36:39], v6, s[28:31], s36 offen sc1 nt
    s_add_u32 s36, s36, 93184
L_done:
    s_endpgm
    .p2align 6
L_hloop:
    s_cbranch_execz L_hopret
    s_setprio 1
    s_lshl_b32 s50, s49, 2
    s_lshr_b64 s[50:51], s[82:83], s50
    s_and_b32 s50, s50, 15
    s_lshl_b32 s53, s55, 15
    s_add_u32 s53, s53, s44
    s_and_b32 s41, s49, 3
    s_lshl_b32 s41, s41, 14
    s_sub_u32 s35, s55, 1
    s_cselect_b32 s55, 2, s35
    s_add_u32 s92, s49, 2
    s_lshl_b32 s86, s92, 2
    s_lshr_b64 s[86:87], s[82:83], s86
    s_and_b32 s86, s86, 15
    s_xor_b32 s88, s41, 32768
    s_cmp_eq_u32 s91, 1
    s_cbranch_scc1 L_hx1
    s_bitcmp1_b32 s38, s50
    s_cbranch_scc1 L_hx
    s_cmp_lt_u32 s49, s93
    s_cbranch_scc1 L_hn
    buffer_load_dword v14, v12, s[68:71], 0 offen sc0 sc1
    s_mov_b32 m0, s53
    s_lshl_b32 s42, s50, 7
    buffer_load_dwordx4 v9, s[16:19], s42 offen offset:0 lds
    s_add_u32 s42, s42, s98
    buffer_load_dwordx4 v10, s[16:19], s42 offen offset:1024 lds
    s_add_u32 s42, s42, s98
    buffer_load_dwordx4 v9, s[16:19], s42 offen offset:2048 lds
    s_add_u32 s42, s42, s98
    buffer_load_dwordx4 v10, s[16:19], s42 offen offset:3072 lds
    s_waitcnt vmcnt(4)
    v_cmp_ne_u32 vcc, v14, v13
    s_nop 4
    s_and_b32 s35, vcc_lo, 0xffff
    s_or_b32 s38, s38, s35
    s_bitcmp1_b32 s38, s50
    s_cbranch_scc1 L_hw
    s_branch L_hn1
L_hn:
    s_mov_b32 m0, s53
    s_lshl_b32 s42, s50, 7
    buffer_load_dwordx4 v9, s[16:19], s42 offen offset:0 lds
    s_add_u32 s42, s42, s98
    buffer_load_dwordx4 v10, s[16:19], s42 offen offset:1024 lds
    s_add_u32 s42, s42, s98
    buffer_load_dwordx4 v9, s[16:19], s42 offen offset:2048 lds
    s_add_u32 s42, s42, s98
    buffer_load_dwordx4 v10, s[16:19], s42 offen offset:3072 lds
L_hn1:
    s_cmp_ge_u32 s49, 14
    s_cbranch_scc1 L_hn2
    s_add_u32 m0, s53, 4096
    s_add_u32 s42, s42, s99
    buffer_load_dwordx4 v9, s[16:19], s42 offen offset:0 lds
    s_add_u32 s42, s42, s98
    buffer_load_dwordx4 v10, s[16:19], s42 offen offset:1024 lds
    s_add_u32 s42, s42, s98
    buffer_load_dwordx4 v9, s[16:19], s42 offen offset:2048 lds
    s_add_u32 s42, s42, s98
    buffer_load_dwordx4 v10, s[16:19], s42 offen offset:3072 lds
L_hn2:
    s_mov_b32 s54, 2
    s_mul_i32 s43, s50, 917504
    tbuffer_load_format_d16_xyzw v[72:73], v8, s[20:23], s43 format:[BUF_DATA_FORMAT_32_32_32_32,BUF_NUM_FORMAT_UINT] offen
    s_add_u32 s43, s43, s97
    tbuffer_load_format_d16_xyzw v[74:75], v8, s[20:23], s43 format:[BUF_DATA_FORMAT_32_32_32_32,BUF_NUM_FORMAT_UINT] offen
    s_add_u32 s43, s43, s97
    tbuffer_load_format_d16_xyzw v[76:77], v8, s[20:23], s43 format:[BUF_DATA_FORMAT_32_32_32_32,BUF_NUM_FORMAT_UINT] offen
    s_add_u32 s43, s43, s97
    tbuffer_load_format_d16_xyzw v[78:79], v8, s[20:23], s43 format:[BUF_DATA_FORMAT_32_32_32_32,BUF_NUM_FORMAT_UINT] offen
    s_add_u32 s43, s43, s97
    tbuffer_load_format_d16_xyzw v[80:81], v8, s[20:23], s43 format:[BUF_DATA_FORMAT_32_32_32_32,BUF_NUM_FORMAT_UINT] offen
    s_add_u32 s43, s43, s97
    tbuffer_load_format_d16_xyzw v[82:83], v8, s[20:23], s43 format:[BUF_DATA_FORMAT_32_32_32_32,BUF_NUM_FORMAT_UINT] offen
    s_add_u32 s43, s43, s97
    tbuffer_load_format_d16_xyzw v[84:85], v8, s[20:23], s43 format:[BUF_DATA_FORMAT_32_32_32_32,BUF_NUM_FORMAT_UINT] offen
    s_add_u32 s43, s43, s97
    tbuffer_load_format_d16_xyzw v[86:87], v8, s[20:23], s43 format:[BUF_DATA_FORMAT_32_32_32_32,BUF_NUM_FORMAT_UINT] offen
    s_branch L_hp
L_hx:
    s_cbranch_execz L_hopret
    s_lshl_b32 s43, s50, 14
    s_add_u32 m0, s45, s41
    s_nop 0
    buffer_load_dwordx4 v15, s[68:71], s43 offen offset:0 sc1 lds
    buffer_load_dwordx4 v15, s[68:71], s43 offen offset:1024 sc1 lds
    buffer_load_dwordx4 v15, s[68:71], s43 offen offset:2048 sc1 lds
    buffer_load_dwordx4 v15, s[68:71], s43 offen offset:3072 sc1 lds
L_hx1:
    s_mov_b32 m0, s53
    s_lshl_b32 s42, s50, 7
    buffer_load_dwordx4 v9, s[16:19], s42 offen offset:0 lds
    s_add_u32 s42, s42, s98
    buffer_load_dwordx4 v10, s[16:19], s42 offen offset:1024 lds
    s_add_u32 s42, s42, s98
    buffer_load_dwordx4 v9, s[16:19], s42 offen offset:2048 lds
    s_add_u32 s42, s42, s98
    buffer_load_dwordx4 v10, s[16:19], s42 offen offset:3072 lds
    s_branch L_hw1
L_hw:
    s_lshl_b32 s43, s50, 14
    s_add_u32 m0, s45, s41
    s_nop 0
    buffer_load_dwordx4 v15, s[68:71], s43 offen offset:0 sc1 lds
    buffer_load_dwordx4 v15, s[68:71], s43 offen offset:1024 sc1 lds
    buffer_load_dwordx4 v15, s[68:71], s43 offen offset:2048 sc1 lds
    buffer_load_dwordx4 v15, s[68:71], s43 offen offset:3072 sc1 lds
L_hw1:
    s_mov_b32 s54, 0
L_hy:
    s_cmp_ge_u32 s49, 14
    s_cbranch_scc1 L_hb
    s_add_u32 m0, s53, 4096
    s_add_u32 s42, s42, s99
    buffer_load_dwordx4 v9, s[16:19], s42 offen offset:0 lds
    s_add_u32 s42, s42, s98
    buffer_load_dwordx4 v10, s[16:19], s42 offen offset:1024 lds
    s_add_u32 s42, s42, s98
    buffer_load_dwordx4 v9, s[16:19], s42 offen offset:2048 lds
    s_add_u32 s42, s42, s98
    buffer_load_dwordx4 v10, s[16:19], s42 offen offset:3072 lds
L_hp:
    s_cmp_lt_u32 s92, s93
    s_cbranch_scc1 L_hb
    s_cmp_ge_u32 s92, 16
    s_cbranch_scc1 L_hb
    s_bitcmp1_b32 s38, s86
    s_cbranch_scc1 L_hb
    buffer_load_dword v14, v12, s[68:71], 0 offen sc0 sc1
    s_or_b32 s54, s54, 4
L_hb:
    s_barrier
    s_mov_b32 s91, 0
    s_cmp_lt_u32 s49, 14
    s_cbranch_scc1 L_hb2
    s_cmp_lg_u32 s54, 0
    s_cbranch_scc1 L_hb2
    s_cmp_eq_u32 s49, 15
    s_cselect_b32 s35, 28672, 0
    s_add_u32 s53, s53, s35
    s_add_u32 m0, s53, 4096
    s_add_u32 s42, s42, s99
    buffer_load_dwordx4 v9, s[16:19], s42 offen offset:0 lds
    s_add_u32 s42, s42, s98
    buffer_load_dwordx4 v10, s[16:19], s42 offen offset:1024 lds
    s_add_u32 s42, s42, s98
    buffer_load_dwordx4 v9, s[16:19], s42 offen offset:2048 lds
    s_add_u32 s42, s42, s98
    buffer_load_dwordx4 v10, s[16:19], s42 offen offset:3072 lds
    s_waitcnt vmcnt(4)
    s_barrier
    s_cmp_eq_u32 s49, 15
    s_cbranch_scc1 L_hb3
    s_barrier
L_hb3:
    s_waitcnt vmcnt(0)
    s_barrier
    s_branch L_hend
L_hb2:
    s_and_b32 s35, s54, 3
    s_cbranch_scc0 L_hf
L_hq:
    v_add_u32 v17, s41, v11
    s_setprio 2
    s_waitcnt vmcnt(4)
L_hq0:
    s_cbranch_execz L_hopret
    v_lshl_or_b32 v88, v74, 8, v72
    v_lshl_or_b32 v89, v78, 8, v76
    v_perm_b32 v96, v89, v88, s84
    v_perm_b32 v102, v89, v88, s85
    v_xor_b32 v97, s58, v96
    v_xor_b32 v103, s58, v102
    v_perm_b32 v98, v41, v40, v96
    v_perm_b32 v104, v49, v48, v102
    v_perm_b32 v100, v45, v44, v96
    v_perm_b32 v106, v53, v52, v102
    v_perm_b32 v99, v43, v42, v97
    v_perm_b32 v105, v51, v50, v103
    v_perm_b32 v101, v47, v46, v97
    v_perm_b32 v107, v55, v54, v103
    v_xor_b32 v98, v98, v99
    v_xor_b32 v104, v104, v105
    v_xor_b32 v100, v100, v101
    v_xor_b32 v106, v106, v107
    v_perm_b32 v24, v100, v98, s46
    v_perm_b32 v28, v106, v104, s46
    v_perm_b32 v25, v100, v98, s47
    v_perm_b32 v29, v106, v104, s47
    v_lshl_or_b32 v88, v75, 8, v73
    v_lshl_or_b32 v89, v79, 8, v77
    v_perm_b32 v96, v89, v88, s84
    v_perm_b32 v102, v89, v88, s85
    v_xor_b32 v97, s58, v96
    v_xor_b32 v103, s58, v102
    v_perm_b32 v98, v57, v56, v96
    v_perm_b32 v104, v65, v64, v102
    v_perm_b32 v100, v61, v60, v96
    v_perm_b32 v106, v69, v68, v102
    v_perm_b32 v99, v59, v58, v97
    v_perm_b32 v105, v67, v66, v103
    v_perm_b32 v101, v63, v62, v97
    v_perm_b32 v107, v71, v70, v103
    v_xor_b32 v98, v98, v99
    v_xor_b32 v104, v104, v105
    v_xor_b32 v100, v100, v101
    v_xor_b32 v106, v106, v107
    v_perm_b32 v32, v100, v98, s46
    v_perm_b32 v36, v106, v104, s46
    v_perm_b32 v33, v100, v98, s47
    v_perm_b32 v37, v106, v104, s47
    s_bitcmp1_b32 s54, 3
    s_cbranch_scc1 L_hq2
    s_bitcmp1_b32 s54, 2
    s_cbranch_scc1 L_hq1
    s_waitcnt vmcnt(0)
L_hq1:
    s_waitcnt vmcnt(1)
L_hq2:
    s_cbranch_execz L_hopret
    v_lshl_or_b32 v90, v82, 8, v80
    v_lshl_or_b32 v91, v86, 8, v84
    v_perm_b32 v96, v91, v90, s84
    v_perm_b32 v102, v91, v90, s85
    v_xor_b32 v97, s58, v96
    v_xor_b32 v103, s58, v102
    v_perm_b32 v98, v41, v40, v96
    v_perm_b32 v104, v49, v48, v102
    v_perm_b32 v100, v45, v44, v96
    v_perm_b32 v106, v53, v52, v102
    v_perm_b32 v99, v43, v42, v97
    v_perm_b32 v105, v51, v50, v103
    v_perm_b32 v101, v47, v46, v97
    v_perm_b32 v107, v55, v54, v103
    v_xor_b32 v98, v98, v99
    v_xor_b32 v104, v104, v105
    v_xor_b32 v100, v100, v101
    v_xor_b32 v106, v106, v107
    v_perm_b32 v26, v100, v98, s46
    v_perm_b32 v30, v106, v104, s46
    v_perm_b32 v27, v100, v98, s47
    v_perm_b32 v31, v106, v104, s47
    v_lshl_or_b32 v90, v83, 8, v81
    v_lshl_or_b32 v91, v87, 8, v85
    v_perm_b32 v96, v91, v90, s84
    v_perm_b32 v102, v91, v90, s85
    v_xor_b32 v97, s58, v96
    v_xor_b32 v103, s58, v102
    v_perm_b32 v98, v57, v56, v96
    v_perm_b32 v104, v65, v64, v102
    v_perm_b32 v100, v61, v60, v96
    v_perm_b32 v106, v69, v68, v102
    v_perm_b32 v99, v59, v58, v97
    v_perm_b32 v105, v67, v66, v103
    v_perm_b32 v101, v63, v62, v97
    v_perm_b32 v107, v71, v70, v103
    v_xor_b32 v98, v98, v99
    v_xor_b32 v104, v104, v105
    v_xor_b32 v100, v100, v101
    v_xor_b32 v106, v106, v107
    v_perm_b32 v34, v100, v98, s46
    v_perm_b32 v38, v106, v104, s46
    v_perm_b32 v35, v100, v98, s47
    v_perm_b32 v39, v106, v104, s47
    ds_write_b128 v17, v[24:27] offset:0
    ds_write_b128 v17, v[28:31] offset:512
    ds_write_b128 v17, v[32:35] offset:1024
    ds_write_b128 v17, v[36:39] offset:1536
L_hg:
    s_cbranch_execz L_hopret
    s_bitcmp1_b32 s54, 2
    s_cbranch_scc0 L_hf0
    s_waitcnt vmcnt(0)
    v_cmp_ne_u32 vcc, v14, v13
    s_nop 4
    s_and_b32 s35, vcc_lo, 0xffff
    s_or_b32 s38, s38, s35
    s_branch L_hf0
L_hf:
    s_bitcmp1_b32 s54, 2
    s_cbranch_scc0 L_hf1
    s_waitcnt vmcnt(0)
    v_cmp_ne_u32 vcc, v14, v13
    s_nop 4
    s_and_b32 s35, vcc_lo, 0xffff
    s_or_b32 s38, s38, s35
L_hf1:
    s_sub_u32 s35, s92, 0
    s_cmp_ge_u32 s35, 16
    s_cbranch_scc1 L_hf0
    s_bitcmp1_b32 s38, s86
    s_cbranch_scc0 L_hf0
    s_lshl_b32 s43, s86, 14
    s_add_u32 m0, s45, s88
    s_nop 0
    buffer_load_dwordx4 v15, s[68:71], s43 offen offset:0 sc1 lds
    buffer_load_dwordx4 v15, s[68:71], s43 offen offset:1024 sc1 lds
    buffer_load_dwordx4 v15, s[68:71], s43 offen offset:2048 sc1 lds
    buffer_load_dwordx4 v15, s[68:71], s43 offen offset:3072 sc1 lds
    s_mov_b32 s91, 1
    s_waitcnt vmcnt(4) lgkmcnt(0)
    s_branch L_hz
L_hf0:
    s_waitcnt vmcnt(0) lgkmcnt(0)
L_hz:
    s_barrier
    s_mov_b32 s49, s92
    s_cmp_lt_u32 s49, 16
    s_cbranch_scc1 L_hloop
    s_cmp_eq_u32 s49, 17
    s_cselect_b32 s35, 28672, 0
    s_add_u32 s53, s53, s35
    s_add_u32 m0, s53, 4096
    s_add_u32 s42, s42, s99
    buffer_load_dwordx4 v9, s[16:19], s42 offen offset:0 lds
    s_add_u32 s42, s42, s98
    buffer_load_dwordx4 v10, s[16:19], s42 offen offset:1024 lds
    s_add_u32 s42, s42, s98
    buffer_load_dwordx4 v9, s[16:19], s42 offen offset:2048 lds
    s_add_u32 s42, s42, s98
    buffer_load_dwordx4 v10, s[16:19], s42 offen offset:3072 lds
    s_cmp_eq_u32 s49, 17
    s_cbranch_scc1 L_hb4
    s_barrier
L_hb4:
    s_waitcnt vmcnt(0)
    s_barrier
L_hend:
    s_endpgm
L_prod:
    s_cbranch_execz L_hopret
    s_lshl_b32 s50, s49, 2
    s_lshr_b64 s[50:51], s[82:83], s50
    s_and_b32 s50, s50, 15
    s_mul_i32 s43, s50, 917504
    tbuffer_load_format_d16_xyzw v[72:73], v8, s[20:23], s43 format:[BUF_DATA_FORMAT_32_32_32_32,BUF_NUM_FORMAT_UINT] offen
    s_add_u32 s43, s43, s97
    tbuffer_load_format_d16_xyzw v[74:75], v8, s[20:23], s43 format:[BUF_DATA_FORMAT_32_32_32_32,BUF_NUM_FORMAT_UINT] offen
    s_add_u32 s43, s43, s97
    tbuffer_load_format_d16_xyzw v[76:77], v8, s[20:23], s43 format:[BUF_DATA_FORMAT_32_32_32_32,BUF_NUM_FORMAT_UINT] offen
    s_add_u32 s43, s43, s97
    tbuffer_load_format_d16_xyzw v[78:79], v8, s[20:23], s43 format:[BUF_DATA_FORMAT_32_32_32_32,BUF_NUM_FORMAT_UINT] offen
    s_add_u32 s43, s43, s97
    tbuffer_load_format_d16_xyzw v[80:81], v8, s[20:23], s43 format:[BUF_DATA_FORMAT_32_32_32_32,BUF_NUM_FORMAT_UINT] offen
    s_add_u32 s43, s43, s97
    tbuffer_load_format_d16_xyzw v[82:83], v8, s[20:23], s43 format:[BUF_DATA_FORMAT_32_32_32_32,BUF_NUM_FORMAT_UINT] offen
    s_add_u32 s43, s43, s97
    tbuffer_load_format_d16_xyzw v[84:85], v8, s[20:23], s43 format:[BUF_DATA_FORMAT_32_32_32_32,BUF_NUM_FORMAT_UINT] offen
    s_add_u32 s43, s43, s97
    tbuffer_load_format_d16_xyzw v[86:87], v8, s[20:23], s43 format:[BUF_DATA_FORMAT_32_32_32_32,BUF_NUM_FORMAT_UINT] offen
    s_waitcnt vmcnt(4) lgkmcnt(0)
L_ploop:
    s_cbranch_execz L_hopret
    v_lshl_or_b32 v88, v74, 8, v72
    v_lshl_or_b32 v89, v78, 8, v76
    v_perm_b32 v96, v89, v88, s84
    v_perm_b32 v102, v89, v88, s85
    v_xor_b32 v97, s58, v96
    v_xor_b32 v103, s58, v102
    v_perm_b32 v98, v41, v40, v96
    v_perm_b32 v104, v49, v48, v102
    v_perm_b32 v100, v45, v44, v96
    v_perm_b32 v106, v53, v52, v102
    v_perm_b32 v99, v43, v42, v97
    v_perm_b32 v105, v51, v50, v103
    v_perm_b32 v101, v47, v46, v97
    v_perm_b32 v107, v55, v54, v103
    v_xor_b32 v98, v98, v99
    v_xor_b32 v104, v104, v105
    v_xor_b32 v100, v100, v101
    v_xor_b32 v106, v106, v107
    v_perm_b32 v24, v100, v98, s46
    v_perm_b32 v28, v106, v104, s46
    v_perm_b32 v25, v100, v98, s47
    v_perm_b32 v29, v106, v104, s47
    v_lshl_or_b32 v88, v75, 8, v73
    v_lshl_or_b32 v89, v79, 8, v77
    v_perm_b32 v96, v89, v88, s84
    v_perm_b32 v102, v89, v88, s85
    v_xor_b32 v97, s58, v96
    v_xor_b32 v103, s58, v102
    v_perm_b32 v98, v57, v56, v96
    v_perm_b32 v104, v65, v64, v102
    v_perm_b32 v100, v61, v60, v96
    v_perm_b32 v106, v69, v68, v102
    v_perm_b32 v99, v59, v58, v97
    v_perm_b32 v105, v67, v66, v103
    v_perm_b32 v101, v63, v62, v97
    v_perm_b32 v107, v71, v70, v103
    v_xor_b32 v98, v98, v99
    v_xor_b32 v104, v104, v105
    v_xor_b32 v100, v100, v101
    v_xor_b32 v106, v106, v107
    v_perm_b32 v32, v100, v98, s46
    v_perm_b32 v36, v106, v104, s46
    v_perm_b32 v33, v100, v98, s47
    v_perm_b32 v37, v106, v104, s47
    s_waitcnt vmcnt(0)
L_pmid:
    s_cbranch_execz L_hopret
    v_lshl_or_b32 v90, v82, 8, v80
    v_lshl_or_b32 v91, v86, 8, v84
    v_perm_b32 v96, v91, v90, s84
    v_perm_b32 v102, v91, v90, s85
    v_xor_b32 v97, s58, v96
    v_xor_b32 v103, s58, v102
    v_perm_b32 v98, v41, v40, v96
    v_perm_b32 v104, v49, v48, v102
    v_perm_b32 v100, v45, v44, v96
    v_perm_b32 v106, v53, v52, v102
    v_perm_b32 v99, v43, v42, v97
    v_perm_b32 v105, v51, v50, v103
    v_perm_b32 v101, v47, v46, v97
    v_perm_b32 v107, v55, v54, v103
    v_xor_b32 v98, v98, v99
    v_xor_b32 v104, v104, v105
    v_xor_b32 v100, v100, v101
    v_xor_b32 v106, v106, v107
    v_perm_b32 v26, v100, v98, s46
    v_perm_b32 v30, v106, v104, s46
    v_perm_b32 v27, v100, v98, s47
    v_perm_b32 v31, v106, v104, s47
    v_lshl_or_b32 v90, v83, 8, v81
    v_lshl_or_b32 v91, v87, 8, v85
    v_perm_b32 v96, v91, v90, s84
    v_perm_b32 v102, v91, v90, s85
    v_xor_b32 v97, s58, v96
    v_xor_b32 v103, s58, v102
    v_perm_b32 v98, v57, v56, v96
    v_perm_b32 v104, v65, v64, v102
    v_perm_b32 v100, v61, v60, v96
    v_perm_b32 v106, v69, v68, v102
    v_perm_b32 v99, v59, v58, v97
    v_perm_b32 v105, v67, v66, v103
    v_perm_b32 v101, v63, v62, v97
    v_perm_b32 v107, v71, v70, v103
    v_xor_b32 v98, v98, v99
    v_xor_b32 v104, v104, v105
    v_xor_b32 v100, v100, v101
    v_xor_b32 v106, v106, v107
    v_perm_b32 v34, v100, v98, s46
    v_perm_b32 v38, v106, v104, s46
    v_perm_b32 v35, v100, v98, s47
    v_perm_b32 v39, v106, v104, s47
L_ppub:
    s_cbranch_execz L_hopret
    s_lshl_b32 s52, s50, 14
    s_lshl_b64 s[36:37], 1, s50
    buffer_store_dwordx4 v[24:27], v20, s[68:71], s52 offen offset:0 sc1
    buffer_store_dwordx4 v[28:31], v20, s[68:71], s52 offen offset:512 sc1
    buffer_store_dwordx4 v[32:35], v20, s[68:71], s52 offen offset:1024 sc1
    buffer_store_dwordx4 v[36:39], v20, s[68:71], s52 offen offset:1536 sc1
    v_not_b32 v16, v13
    s_add_u32 s49, s49, 2
    s_cmp_ge_u32 s49, 16
    s_cbranch_scc1 L_plast
    s_lshl_b32 s50, s49, 2
    s_lshr_b64 s[50:51], s[82:83], s50
    s_and_b32 s50, s50, 15
    s_mul_i32 s43, s50, 917504
    tbuffer_load_format_d16_xyzw v[72:73], v8, s[20:23], s43 format:[BUF_DATA_FORMAT_32_32_32_32,BUF_NUM_FORMAT_UINT] offen
    s_add_u32 s43, s43, s97
    tbuffer_load_format_d16_xyzw v[74:75], v8, s[20:23], s43 format:[BUF_DATA_FORMAT_32_32_32_32,BUF_NUM_FORMAT_UINT] offen
    s_add_u32 s43, s43, s97
    tbuffer_load_format_d16_xyzw v[76:77], v8, s[20:23], s43 format:[BUF_DATA_FORMAT_32_32_32_32,BUF_NUM_FORMAT_UINT] offen
    s_add_u32 s43, s43, s97
    tbuffer_load_format_d16_xyzw v[78:79], v8, s[20:23], s43 format:[BUF_DATA_FORMAT_32_32_32_32,BUF_NUM_FORMAT_UINT] offen
    s_add_u32 s43, s43, s97
    tbuffer_load_format_d16_xyzw v[80:81], v8, s[20:23], s43 format:[BUF_DATA_FORMAT_32_32_32_32,BUF_NUM_FORMAT_UINT] offen
    s_add_u32 s43, s43, s97
    tbuffer_load_format_d16_xyzw v[82:83], v8, s[20:23], s43 format:[BUF_DATA_FORMAT_32_32_32_32,BUF_NUM_FORMAT_UINT] offen
    s_add_u32 s43, s43, s97
    tbuffer_load_format_d16_xyzw v[84:85], v8, s[20:23], s43 format:[BUF_DATA_FORMAT_32_32_32_32,BUF_NUM_FORMAT_UINT] offen
    s_add_u32 s43, s43, s97
    tbuffer_load_format_d16_xyzw v[86:87], v8, s[20:23], s43 format:[BUF_DATA_FORMAT_32_32_32_32,BUF_NUM_FORMAT_UINT] offen
    s_waitcnt vmcnt(8)
    s_mov_b64 exec, s[36:37]
    buffer_store_dword v16, v12, s[68:71], 0 offen  sc0 sc1
    s_mov_b64 exec, -1
    s_waitcnt vmcnt(5)
    s_branch L_ploop
L_plast:
    s_waitcnt vmcnt(0)
    s_mov_b64 exec, s[36:37]
    buffer_store_dword v16, v12, s[68:71], 0 offen  sc0 sc1
    s_mov_b64 exec, -1
    s_endpgm
    .p2align 7
    .type L_sched,@object
L_sched:
    .size L_sched, 256
    .long 0x76543210, 0xfedcba98
    .long 0x47650321, 0xfedcba98
    .long 0x54761032, 0xfedcba98
    .long 0x65472103, 0xfedcba98
    .long 0x76543210, 0xcfed8ba9
    .long 0x73654021, 0xcfed8ba9
    .long 0x74365102, 0xcfed8ba9
    .long 0x75436210, 0xcfed8ba9
    .long 0x76543210, 0xdcfe98ba
    .long 0x67254301, 0xdcfe98ba
    .long 0x76325410, 0xdcfe98ba
    .long 0x67432501, 0xdcfe98ba
    .long 0x76543210, 0xedcfa98b
    .long 0x57614320, 0xedcfa98b
    .long 0x65721430, 0xedcfa98b
    .long 0x76532140, 0xedcfa98b
    .long 0x76543210, 0xfedcba98
    .long 0x47650321, 0xfedcba98
    .long 0x54761032, 0xfedcba98
    .long 0x65472103, 0xfedcba98
    .long 0x76543210, 0xcfed8ba9
    .long 0x73654021, 0xcfed8ba9
    .long 0x74365102, 0xcfed8ba9
    .long 0x75436210, 0xcfed8ba9
    .long 0x76543210, 0xdcfe98ba
    .long 0x67254301, 0xdcfe98ba
    .long 0x76325410, 0xdcfe98ba
    .long 0x67432501, 0xdcfe98ba
    .long 0x76543210, 0xedcfa98b
    .long 0x57614320, 0xedcfa98b
    .long 0x65721430, 0xedcfa98b
    .long 0x76532140, 0xedcfa98b
    .fill 64, 4, 0xbf800000
.section .rodata,"a"
.p2align 6
.amdhsa_kernel standalone__weight_only_int_squeezellm__prompt_kernel
  .amdhsa_next_free_vgpr 168
  .amdhsa_next_free_sgpr 102
  .amdhsa_accum_offset 168
  .amdhsa_group_segment_fixed_size 0
  .amdhsa_kernarg_size 48
  .amdhsa_user_sgpr_count 2
  .amdhsa_user_sgpr_kernarg_segment_ptr 1
  .amdhsa_system_sgpr_workgroup_id_x 1
.end_amdhsa_kernel
```

```asm
; @launch grid=(256,1,1) block=(768,1,1) lds=163840
.amdgcn_target "amdgcn-amd-amdhsa--gfx950"
.text
.p2align 9
.fill 64, 4, 0xbf800000
.globl standalone__weight_only_int_squeezellm__prompt_kernel
.p2align 8
.type standalone__weight_only_int_squeezellm__prompt_kernel,@function
standalone__weight_only_int_squeezellm__prompt_kernel:
    v_lshrrev_b32 v1, 6, v0
    s_load_dwordx8 s[4:11], s[0:1], 0
    v_readfirstlane_b32 s32, v1
    s_lshr_b32 s13, s2, 3
    s_cmp_ge_u32 s13, 32
    s_cbranch_scc1 L_done
    s_load_dwordx2 s[56:57], s[0:1], 40
    v_and_b32 v2, 63, v0
    s_cmp_ge_u32 s32, 8
    s_cbranch_scc1 L_h1
    s_sub_u32 s14, s13, 4
    s_lshr_b32 s15, s14, 2
    s_and_b32 s14, s14, 3
    s_and_b32 s16, s2, 1
    s_lshl2_add_u32 s14, s16, s14
    s_cmp_lt_u32 s13, 4
    s_cselect_b32 s15, s14, s15
    s_cmp_eq_u32 s15, 7
    s_cbranch_scc1 L_done
    s_bfe_u32 s16, s2, 0x20001
    s_mul_i32 s16, s16, 7
    s_add_u32 s15, s15, s16
    s_and_b32 s33, s32, 3
    s_cmp_ge_u32 s32, 4
    s_cbranch_scc1 L_h0
    s_getpc_b64 s[50:51]
    s_and_b32 s12, s13, 7
    s_mul_i32 s12, s12, 13
    v_add_lshl_u32 v1, v0, s12, 7
    v_cmp_gt_u32 vcc, 13, v0
    s_and_saveexec_b64 s[54:55], vcc
    s_cbranch_execz L_cw
    global_load_dword v39, v1, s[50:51] offset:512
L_cw:
    s_mov_b64 exec, s[54:55]
    v_lshrrev_b32 v5, 3, v2
    v_and_b32 v7, 7, v2
    v_mul_u32_u24 v5, 7168, v5
    v_lshl_add_u32 v5, v7, 4, v5
    s_and_b32 s36, s32, 1
    s_lshl1_add_u32 s35, s15, s36
    s_lshl_b32 s35, s35, 7
    s_add_u32 s36, s35, 56320
    s_lshl_b32 s37, s32, 11
    s_add_u32 m0, s37, 135168
    s_mov_b32 s26, 114688
    s_mov_b32 s27, 0x20000
    s_setprio 3
    s_waitcnt lgkmcnt(0)
    s_mov_b64 s[24:25], s[8:9]
    buffer_load_dwordx4 v5, s[24:27], s35 offen lds
    buffer_load_dwordx4 v5, s[24:27], s36 offen offset:1024 lds
    s_branch L_mfma
L_h0:
    s_and_b32 s48, s15, 3
    s_lshr_b32 s59, s15, 2
    s_add_u32 s59, s59, s14
    s_and_b32 s59, s59, 3
    s_lshl2_add_u32 s48, s48, s59
    s_lshl_b32 s50, s48, 1
    s_lshr_b32 s50, 0x4424e4, s50
    s_and_b32 s50, s50, 3
    v_lshrrev_b32 v3, 5, v2
    s_lshl_b32 s35, s33, 1
    v_add_u32 v4, s35, v3
    v_and_b32 v6, 31, v2
    v_mul_u32_u24 v8, 114688, v4
    v_lshl_add_u32 v8, v6, 4, v8
    s_lshl_b32 s35, s15, 9
    v_add_u32 v8, s35, v8
    s_mov_b32 s22, 14680064
    s_mov_b32 s23, 0x20000
    s_movk_i32 s97, 14336
    s_and_b32 s16, s15, 3
    s_add_u32 s16, s16, 8
    s_cmp_lt_u32 s13, 4
    s_cselect_b32 s50, s16, s50
    s_mul_i32 s43, s50, 917504
    s_setprio 2
    s_waitcnt lgkmcnt(0)
    s_mov_b64 s[20:21], s[6:7]
    tbuffer_load_format_d16_xyzw v[72:73], v8, s[20:23], s43 format:[BUF_DATA_FORMAT_32_32_32_32,BUF_NUM_FORMAT_UINT] offen
    s_add_u32 s43, s43, s97
    tbuffer_load_format_d16_xyzw v[74:75], v8, s[20:23], s43 format:[BUF_DATA_FORMAT_32_32_32_32,BUF_NUM_FORMAT_UINT] offen
    s_add_u32 s43, s43, s97
    tbuffer_load_format_d16_xyzw v[76:77], v8, s[20:23], s43 format:[BUF_DATA_FORMAT_32_32_32_32,BUF_NUM_FORMAT_UINT] offen
    s_add_u32 s43, s43, s97
    tbuffer_load_format_d16_xyzw v[78:79], v8, s[20:23], s43 format:[BUF_DATA_FORMAT_32_32_32_32,BUF_NUM_FORMAT_UINT] offen
    s_add_u32 s43, s43, s97
    tbuffer_load_format_d16_xyzw v[80:81], v8, s[20:23], s43 format:[BUF_DATA_FORMAT_32_32_32_32,BUF_NUM_FORMAT_UINT] offen
    s_add_u32 s43, s43, s97
    tbuffer_load_format_d16_xyzw v[82:83], v8, s[20:23], s43 format:[BUF_DATA_FORMAT_32_32_32_32,BUF_NUM_FORMAT_UINT] offen
    s_add_u32 s43, s43, s97
    tbuffer_load_format_d16_xyzw v[84:85], v8, s[20:23], s43 format:[BUF_DATA_FORMAT_32_32_32_32,BUF_NUM_FORMAT_UINT] offen
    s_add_u32 s43, s43, s97
    tbuffer_load_format_d16_xyzw v[86:87], v8, s[20:23], s43 format:[BUF_DATA_FORMAT_32_32_32_32,BUF_NUM_FORMAT_UINT] offen
    s_branch L_e2
    .p2align 9
L_h1:
    s_sub_u32 s14, s13, 4
    s_lshr_b32 s15, s14, 2
    s_and_b32 s14, s14, 3
    s_and_b32 s16, s2, 1
    s_lshl2_add_u32 s14, s16, s14
    s_cmp_lt_u32 s13, 4
    s_cselect_b32 s15, s14, s15
    s_cmp_eq_u32 s15, 7
    s_cbranch_scc1 L_done
    s_bfe_u32 s16, s2, 0x20001
    s_mul_i32 s16, s16, 7
    s_add_u32 s15, s15, s16
    s_and_b32 s33, s32, 3
    s_and_b32 s48, s15, 3
    s_lshr_b32 s59, s15, 2
    s_add_u32 s59, s59, s14
    s_and_b32 s59, s59, 3
    s_lshl2_add_u32 s48, s48, s59
    s_lshl_b32 s50, s48, 1
    s_lshr_b32 s50, 0x4424e4, s50
    s_and_b32 s50, s50, 3
    v_lshrrev_b32 v5, 3, v2
    v_lshrrev_b32 v7, 4, v2
    v_and_b32 v10, 7, v2
    v_xor_b32 v7, v7, v10
    v_lshlrev_b32 v7, 4, v7
    s_lshl_b32 s35, s14, 19
    s_lshl_b32 s36, s33, 17
    s_add_u32 s35, s35, s36
    v_lshl_add_u32 v7, v5, 11, v7
    v_add_u32 v9, s35, v7
    v_xor_b32 v10, 64, v9
    s_lshl_b32 s44, s33, 13
    s_add_u32 s44, s44, 65536
    s_mov_b32 s18, 4194304
    s_mov_b32 s19, 0x20000
    s_movk_i32 s98, 15360
    s_movk_i32 s99, 19456
    s_mov_b32 s53, s44
    s_mov_b32 m0, s53
    s_lshl_b32 s42, s50, 7
    s_setprio 1
    s_waitcnt lgkmcnt(0)
    s_mov_b64 s[16:17], s[4:5]
    s_cmp_lt_u32 s13, 4
    s_cbranch_scc1 L_e2
    buffer_load_dwordx4 v9, s[16:19], s42 offen offset:0 lds
    s_add_u32 s42, s42, s98
    buffer_load_dwordx4 v10, s[16:19], s42 offen offset:1024 lds
    s_add_u32 s42, s42, s98
    buffer_load_dwordx4 v9, s[16:19], s42 offen offset:2048 lds
    s_add_u32 s42, s42, s98
    buffer_load_dwordx4 v10, s[16:19], s42 offen offset:3072 lds
    s_add_u32 m0, s53, 4096
    s_add_u32 s42, s42, s99
    buffer_load_dwordx4 v9, s[16:19], s42 offen offset:0 lds
    s_add_u32 s42, s42, s98
    buffer_load_dwordx4 v10, s[16:19], s42 offen offset:1024 lds
    s_branch L_e2
L_mfma:
    s_mov_b32 s36, m0
    s_lshr_b32 s37, s32, 1
    s_add_u32 s36, s36, s37
    v_lshlrev_b32 v7, 1, v2
    v_add_u32 v7, s36, v7
    v_and_b32 v3, 127, v0
    v_and_b32 v6, 3, v3
    v_lshlrev_b32 v6, 1, v6
    v_add_u32 v6, s37, v6
    v_lshrrev_b32 v3, 2, v3
    v_lshl_add_u32 v6, v6, 5, v3
    v_lshlrev_b32 v6, 4, v6
    v_add_u32 v6, 131072, v6
    s_mov_b32 s45, 0x0b0a0908
    s_mov_b32 s54, 0xffffff00
    s_waitcnt vmcnt(0)
    ds_read_u8 v40, v7 offset:0
    ds_read_u8 v41, v7 offset:128
    ds_read_u8 v42, v7 offset:256
    ds_read_u8 v43, v7 offset:384
    ds_read_u8 v44, v7 offset:512
    ds_read_u8 v45, v7 offset:640
    ds_read_u8 v46, v7 offset:768
    ds_read_u8 v47, v7 offset:896
    ds_read_u8 v48, v7 offset:1024
    ds_read_u8 v49, v7 offset:1152
    ds_read_u8 v50, v7 offset:1280
    ds_read_u8 v51, v7 offset:1408
    ds_read_u8 v52, v7 offset:1536
    ds_read_u8 v53, v7 offset:1664
    ds_read_u8 v54, v7 offset:1792
    ds_read_u8 v55, v7 offset:1920
    s_waitcnt lgkmcnt(0)
    v_lshl_or_b32 v24, v41, 8, v40
    v_lshl_or_b32 v56, v43, 8, v42
    v_lshl_or_b32 v25, v45, 8, v44
    v_lshl_or_b32 v57, v47, 8, v46
    v_lshl_or_b32 v26, v49, 8, v48
    v_lshl_or_b32 v58, v51, 8, v50
    v_lshl_or_b32 v27, v53, 8, v52
    v_lshl_or_b32 v59, v55, 8, v54
    v_lshl_or_b32 v24, v56, 16, v24
    v_lshl_or_b32 v25, v57, 16, v25
    v_lshl_or_b32 v26, v58, 16, v26
    v_lshl_or_b32 v27, v59, 16, v27
    v_xor_b32 v25, s54, v25
    v_xor_b32 v27, s54, v27
    v_mov_b32 v28, v24
    v_mov_b32 v29, v26
    v_perm_b32 v30, v27, v26, s45
    v_perm_b32 v31, v25, v24, s45
    v_xor_b32 v24, v28, v30
    v_xor_b32 v26, v29, v31
    v_perm_b32 v30, v27, v26, s45
    v_perm_b32 v31, v25, v24, s45
    v_xor_b32 v24, v28, v30
    v_xor_b32 v26, v29, v31
    v_perm_b32 v30, v27, v26, s45
    v_perm_b32 v31, v25, v24, s45
    v_xor_b32 v24, v28, v30
    v_xor_b32 v26, v29, v31
    ds_write_b128 v6, v[24:27]
    s_waitcnt lgkmcnt(0)
    s_barrier
    s_cmp_lt_u32 s13, 4
    s_cbranch_scc1 L_done
    s_branch L_m2
L_e2:
    s_getpc_b64 s[86:87]
L_pcX:
    s_cmp_lt_u32 s13, 4
    s_cselect_b32 s35, 16, 0
    s_cselect_b32 s49, 8, 0
    s_add_u32 s35, s35, s48
    s_lshl_b32 s35, s35, 3
    s_add_u32 s35, s35, L_sched-L_pcX
    s_add_u32 s86, s86, s35
    s_addc_u32 s87, s87, 0
    s_load_dwordx2 s[82:83], s[86:87], 0
    s_lshr_b32 s35, s32, 3
    s_add_u32 s49, s49, s35
    s_lshl_b32 s35, s15, 2
    s_add_u32 s35, s35, s33
    s_lshl_b32 s35, s35, 7
    s_add_u32 s35, s35, 524288
    v_and_b32 v12, 15, v2
    v_lshlrev_b32 v12, 2, v12
    v_add_u32 v12, s35, v12
    s_mov_b64 s[68:69], s[56:57]
    s_mov_b32 s70, 268435456
    s_mov_b32 s71, 0x20000
    buffer_load_dword v13, v12, s[68:71], 0 offen sc0 sc1
    s_mov_b64 s[16:17], s[4:5]
    s_mov_b64 s[20:21], s[6:7]
    s_mov_b32 s22, 14680064
    s_mov_b32 s23, 0x20000
    s_mov_b32 s18, 4194304
    s_mov_b32 s19, 0x20000
    s_movk_i32 s97, 14336
    s_movk_i32 s98, 15360
    s_movk_i32 s99, 19456
    v_lshrrev_b32 v3, 5, v2
    s_lshl_b32 s35, s33, 1
    v_add_u32 v4, s35, v3
    v_and_b32 v6, 31, v2
    v_mul_u32_u24 v8, 114688, v4
    v_lshl_add_u32 v8, v6, 4, v8
    s_lshl_b32 s35, s15, 9
    v_add_u32 v8, s35, v8
    v_lshrrev_b32 v5, 3, v2
    v_lshrrev_b32 v7, 4, v2
    v_and_b32 v10, 7, v2
    v_xor_b32 v7, v7, v10
    v_lshlrev_b32 v7, 4, v7
    s_lshl_b32 s35, s14, 19
    s_lshl_b32 s36, s33, 17
    s_add_u32 s35, s35, s36
    v_lshl_add_u32 v7, v5, 11, v7
    v_add_u32 v9, s35, v7
    v_xor_b32 v10, 64, v9
    s_lshl_b32 s44, s33, 13
    s_add_u32 s44, s44, 65536
    s_lshl_b32 s36, s15, 18
    s_add_u32 s96, s36, 1048576
    v_xor_b32 v5, v6, v3
    v_lshlrev_b32 v5, 4, v5
    v_lshl_add_u32 v11, v4, 11, v5
    v_lshlrev_b32 v7, 4, v6
    v_add_u32 v7, 131072, v7
    s_lshl_b32 s45, s33, 12
    s_add_u32 s36, s96, s45
    v_lshlrev_b32 v15, 4, v2
    v_add_u32 v15, s36, v15
    v_add_u32 v20, s96, v11
    s_mov_b32 s46, 0x05010400
    s_mov_b32 s47, 0x07030602
    s_mov_b32 s58, 0x08080808
    s_mov_b32 s84, 0x05040100
    s_mov_b32 s85, 0x07060302
    s_mov_b32 s38, 0
    s_mov_b32 s39, 0
    s_mov_b32 s91, 0
    s_cmp_lt_u32 s32, 8
    s_cselect_b32 s93, 8, 9
    s_mov_b32 s90, 40
    s_mov_b64 exec, 0
    s_cmp_lt_u32 s13, 4
    s_cbranch_scc1 L_hopq
    s_cmp_eq_u32 s32, 4
    s_cbranch_scc1 L_hq0
    s_cmp_eq_u32 s32, 5
    s_cbranch_scc1 L_hq2
    s_cmp_eq_u32 s32, 6
    s_cbranch_scc1 L_hg
    s_cmp_eq_u32 s32, 7
    s_cbranch_scc1 L_hloop
    s_cmp_eq_u32 s32, 8
    s_cbranch_scc1 L_hx
    s_branch L_hopret
L_hopq:
    s_cmp_eq_u32 s32, 4
    s_cbranch_scc1 L_prod
    s_cmp_eq_u32 s32, 5
    s_cbranch_scc1 L_ploop
    s_cmp_eq_u32 s32, 6
    s_cbranch_scc1 L_pmid
    s_cmp_eq_u32 s32, 7
    s_cbranch_scc1 L_ppub
L_hopret:
    s_mov_b64 exec, -1
    s_waitcnt lgkmcnt(0)
    s_barrier
    ds_read_b128 v[40:43], v7 offset:0
    ds_read_b128 v[44:47], v7 offset:512
    ds_read_b128 v[48:51], v7 offset:1024
    ds_read_b128 v[52:55], v7 offset:1536
    ds_read_b128 v[56:59], v7 offset:2048
    ds_read_b128 v[60:63], v7 offset:2560
    ds_read_b128 v[64:67], v7 offset:3072
    ds_read_b128 v[68:71], v7 offset:3584
    s_cmp_lt_u32 s13, 4
    s_cbranch_scc1 L_prod
    s_lshl_b32 s41, s49, 14
    s_add_u32 s92, s49, 2
    s_mov_b32 s55, 2
    s_mov_b32 s54, 2
    s_cmp_eq_u32 s49, 0
    s_waitcnt lgkmcnt(0)
    s_cbranch_scc1 L_hq
    s_add_u32 m0, s53, 4096
    s_add_u32 s42, s42, s98
    buffer_load_dwordx4 v9, s[16:19], s42 offen offset:2048 lds
    s_add_u32 s42, s42, s98
    buffer_load_dwordx4 v10, s[16:19], s42 offen offset:3072 lds
    s_lshl_b32 s50, s49, 2
    s_lshr_b64 s[50:51], s[82:83], s50
    s_and_b32 s50, s50, 15
    s_mul_i32 s43, s50, 917504
    tbuffer_load_format_d16_xyzw v[72:73], v8, s[20:23], s43 format:[BUF_DATA_FORMAT_32_32_32_32,BUF_NUM_FORMAT_UINT] offen
    s_add_u32 s43, s43, s97
    tbuffer_load_format_d16_xyzw v[74:75], v8, s[20:23], s43 format:[BUF_DATA_FORMAT_32_32_32_32,BUF_NUM_FORMAT_UINT] offen
    s_add_u32 s43, s43, s97
    tbuffer_load_format_d16_xyzw v[76:77], v8, s[20:23], s43 format:[BUF_DATA_FORMAT_32_32_32_32,BUF_NUM_FORMAT_UINT] offen
    s_add_u32 s43, s43, s97
    tbuffer_load_format_d16_xyzw v[78:79], v8, s[20:23], s43 format:[BUF_DATA_FORMAT_32_32_32_32,BUF_NUM_FORMAT_UINT] offen
    s_add_u32 s43, s43, s97
    tbuffer_load_format_d16_xyzw v[80:81], v8, s[20:23], s43 format:[BUF_DATA_FORMAT_32_32_32_32,BUF_NUM_FORMAT_UINT] offen
    s_add_u32 s43, s43, s97
    tbuffer_load_format_d16_xyzw v[82:83], v8, s[20:23], s43 format:[BUF_DATA_FORMAT_32_32_32_32,BUF_NUM_FORMAT_UINT] offen
    s_add_u32 s43, s43, s97
    tbuffer_load_format_d16_xyzw v[84:85], v8, s[20:23], s43 format:[BUF_DATA_FORMAT_32_32_32_32,BUF_NUM_FORMAT_UINT] offen
    s_add_u32 s43, s43, s97
    tbuffer_load_format_d16_xyzw v[86:87], v8, s[20:23], s43 format:[BUF_DATA_FORMAT_32_32_32_32,BUF_NUM_FORMAT_UINT] offen
    s_waitcnt vmcnt(8)
    s_barrier
    s_setprio 3
    s_add_u32 s53, s44, 32768
    s_mov_b32 m0, s53
    s_lshl_b32 s42, s50, 7
    buffer_load_dwordx4 v9, s[16:19], s42 offen offset:0 lds
    s_add_u32 s42, s42, s98
    buffer_load_dwordx4 v10, s[16:19], s42 offen offset:1024 lds
    s_add_u32 s42, s42, s98
    buffer_load_dwordx4 v9, s[16:19], s42 offen offset:2048 lds
    s_add_u32 s42, s42, s98
    buffer_load_dwordx4 v10, s[16:19], s42 offen offset:3072 lds
    s_add_u32 m0, s53, 4096
    s_add_u32 s42, s42, s99
    buffer_load_dwordx4 v9, s[16:19], s42 offen offset:0 lds
    s_add_u32 s42, s42, s98
    buffer_load_dwordx4 v10, s[16:19], s42 offen offset:1024 lds
    s_add_u32 s42, s42, s98
    buffer_load_dwordx4 v9, s[16:19], s42 offen offset:2048 lds
    s_add_u32 s42, s42, s98
    buffer_load_dwordx4 v10, s[16:19], s42 offen offset:3072 lds
    s_mov_b32 s55, 0
    s_mov_b32 s54, 8
    v_add_u32 v17, s41, v11
    s_waitcnt vmcnt(8)
    s_branch L_hq0
L_m2:
    s_mov_b64 s[28:29], s[10:11]
    s_mov_b32 s30, 14680064
    s_mov_b32 s31, 0x20000
    v_and_b32 v7, 15, v2
    v_lshrrev_b32 v6, 4, v2
    v_lshrrev_b32 v4, 1, v7
    v_xor_b32 v4, v4, v6
    v_lshlrev_b32 v4, 4, v4
    v_lshl_add_u32 v4, v7, 7, v4
    s_lshl_b32 s35, s32, 13
    s_add_u32 s35, s35, 65536
    v_add_u32 v1, s35, v4
    v_xor_b32 v3, 64, v1
    v_and_b32 v4, 1, v6
    v_lshl_add_u32 v4, v7, 1, v4
    v_lshlrev_b32 v4, 4, v4
    v_lshl_add_u32 v4, v6, 11, v4
    v_xor_b32 v5, 16, v4
    v_mul_u32_u24 v6, 28672, v6
    v_lshl_add_u32 v6, v7, 4, v6
    s_lshl_b32 s36, s14, 2
    s_add_u32 s36, s36, s32
    s_mul_i32 s36, s36, 458752
    s_lshl_b32 s37, s15, 8
    s_add_u32 s36, s36, s37
    s_mov_b32 s40, 0
    s_mov_b32 s41, 0
    s_mov_b32 s46, 32768
    s_mov_b32 s47, 16384
    s_mov_b64 exec, 0
    s_cmp_eq_u32 s32, 0
    s_cbranch_scc1 L_mh0
    s_cmp_eq_u32 s32, 1
    s_cbranch_scc1 L_mh6
    s_cmp_eq_u32 s32, 2
    s_cbranch_scc1 L_mh12
    s_cmp_eq_u32 s32, 3
    s_cbranch_scc1 L_mh18
L_mhret:
    s_mov_b64 exec, -1
    s_setprio 3
    s_barrier
    ds_read_b128 v[24:27], v4 offset:0
    ds_read_b128 v[28:31], v4 offset:512
    ds_read_b128 v[8:11], v1 offset:0
    ds_read_b128 v[12:15], v1 offset:2048
    ds_read_b128 v[16:19], v1 offset:4096
    ds_read_b128 v[32:35], v4 offset:1024
    ds_read_b128 v[20:23], v1 offset:6144
    ds_read_b128 v[36:39], v4 offset:1536
    s_waitcnt lgkmcnt(5)
    v_mfma_f32_16x16x32_bf16 v[40:43], v[8:11], v[24:27], 0
    v_mfma_f32_16x16x32_bf16 v[44:47], v[8:11], v[28:31], 0
    s_waitcnt lgkmcnt(4)
    v_mfma_f32_16x16x32_bf16 v[72:75], v[12:15], v[24:27], 0
    v_mfma_f32_16x16x32_bf16 v[76:79], v[12:15], v[28:31], 0
    s_waitcnt lgkmcnt(3)
    v_mfma_f32_16x16x32_bf16 v[104:107], v[16:19], v[24:27], 0
    v_mfma_f32_16x16x32_bf16 v[108:111], v[16:19], v[28:31], 0
    s_waitcnt lgkmcnt(1)
    v_mfma_f32_16x16x32_bf16 v[136:139], v[20:23], v[24:27], 0
    ds_read_b128 v[24:27], v5 offset:0
    v_mfma_f32_16x16x32_bf16 v[140:143], v[20:23], v[28:31], 0
    ds_read_b128 v[28:31], v5 offset:512
    v_mfma_f32_16x16x32_bf16 v[48:51], v[8:11], v[32:35], 0
    s_add_u32 s40, s40, 1
L_mh0:
    s_cbranch_execz L_mh1
    s_waitcnt lgkmcnt(2)
    v_mfma_f32_16x16x32_bf16 v[52:55], v[8:11], v[36:39], 0
    s_and_b32 s42, s40, 3
    v_mfma_f32_16x16x32_bf16 v[80:83], v[12:15], v[32:35], 0
    s_cselect_b32 s42, s47, 0xffff4000
    v_mfma_f32_16x16x32_bf16 v[84:87], v[12:15], v[36:39], 0
    s_add_u32 s41, s41, 1
    v_mfma_f32_16x16x32_bf16 v[112:115], v[16:19], v[32:35], 0
    s_cmp_eq_u32 s41, 3
    v_mfma_f32_16x16x32_bf16 v[116:119], v[16:19], v[36:39], 0
    s_cselect_b32 s43, 0xffff0000, s46
    v_mfma_f32_16x16x32_bf16 v[144:147], v[20:23], v[32:35], 0
    s_cselect_b32 s41, 0, s41
    ds_read_b128 v[32:35], v5 offset:1024
    v_mfma_f32_16x16x32_bf16 v[148:151], v[20:23], v[36:39], 0
    ds_read_b128 v[36:39], v5 offset:1536
    s_waitcnt lgkmcnt(3)
    v_mfma_f32_16x16x32_bf16 v[56:59], v[8:11], v[24:27], 0
    s_waitcnt lgkmcnt(2)
    v_mfma_f32_16x16x32_bf16 v[60:63], v[8:11], v[28:31], 0
    v_mfma_f32_16x16x32_bf16 v[88:91], v[12:15], v[24:27], 0
    v_mfma_f32_16x16x32_bf16 v[92:95], v[12:15], v[28:31], 0
    v_mfma_f32_16x16x32_bf16 v[120:123], v[16:19], v[24:27], 0
    v_mfma_f32_16x16x32_bf16 v[124:127], v[16:19], v[28:31], 0
    v_mfma_f32_16x16x32_bf16 v[152:155], v[20:23], v[24:27], 0
    ds_read_b128 v[24:27], v4 offset:8192
    v_mfma_f32_16x16x32_bf16 v[156:159], v[20:23], v[28:31], 0
    ds_read_b128 v[28:31], v4 offset:8704
    s_waitcnt lgkmcnt(3)
    v_mfma_f32_16x16x32_bf16 v[64:67], v[8:11], v[32:35], 0
    s_waitcnt lgkmcnt(2)
    v_mfma_f32_16x16x32_bf16 v[68:71], v[8:11], v[36:39], 0
    ds_read_b128 v[8:11], v3 offset:0
    v_mfma_f32_16x16x32_bf16 v[96:99], v[12:15], v[32:35], 0
    v_mfma_f32_16x16x32_bf16 v[100:103], v[12:15], v[36:39], 0
    ds_read_b128 v[12:15], v3 offset:2048
    v_mfma_f32_16x16x32_bf16 v[128:131], v[16:19], v[32:35], 0
    v_mfma_f32_16x16x32_bf16 v[132:135], v[16:19], v[36:39], 0
    ds_read_b128 v[16:19], v3 offset:4096
    v_mfma_f32_16x16x32_bf16 v[160:163], v[20:23], v[32:35], 0
    ds_read_b128 v[32:35], v4 offset:9216
    v_mfma_f32_16x16x32_bf16 v[164:167], v[20:23], v[36:39], 0
    ds_read_b128 v[20:23], v3 offset:6144
    ds_read_b128 v[36:39], v4 offset:9728
    s_waitcnt lgkmcnt(5)
    v_mfma_f32_16x16x32_bf16 v[40:43], v[8:11], v[24:27], v[40:43]
    v_mfma_f32_16x16x32_bf16 v[44:47], v[8:11], v[28:31], v[44:47]
    s_waitcnt lgkmcnt(4)
L_mh1:
    s_cbranch_execz L_mh2
    v_mfma_f32_16x16x32_bf16 v[72:75], v[12:15], v[24:27], v[72:75]
    v_mfma_f32_16x16x32_bf16 v[76:79], v[12:15], v[28:31], v[76:79]
    s_waitcnt lgkmcnt(3)
    v_mfma_f32_16x16x32_bf16 v[104:107], v[16:19], v[24:27], v[104:107]
    v_mfma_f32_16x16x32_bf16 v[108:111], v[16:19], v[28:31], v[108:111]
    s_waitcnt lgkmcnt(1)
    v_mfma_f32_16x16x32_bf16 v[136:139], v[20:23], v[24:27], v[136:139]
    ds_read_b128 v[24:27], v5 offset:8192
    v_mfma_f32_16x16x32_bf16 v[140:143], v[20:23], v[28:31], v[140:143]
    ds_read_b128 v[28:31], v5 offset:8704
    v_mfma_f32_16x16x32_bf16 v[48:51], v[8:11], v[32:35], v[48:51]
    s_waitcnt lgkmcnt(2)
    v_mfma_f32_16x16x32_bf16 v[52:55], v[8:11], v[36:39], v[52:55]
    v_mfma_f32_16x16x32_bf16 v[80:83], v[12:15], v[32:35], v[80:83]
    v_mfma_f32_16x16x32_bf16 v[84:87], v[12:15], v[36:39], v[84:87]
    v_mfma_f32_16x16x32_bf16 v[112:115], v[16:19], v[32:35], v[112:115]
    v_mfma_f32_16x16x32_bf16 v[116:119], v[16:19], v[36:39], v[116:119]
    v_mfma_f32_16x16x32_bf16 v[144:147], v[20:23], v[32:35], v[144:147]
    ds_read_b128 v[32:35], v5 offset:9216
    v_mfma_f32_16x16x32_bf16 v[148:151], v[20:23], v[36:39], v[148:151]
    ds_read_b128 v[36:39], v5 offset:9728
    s_waitcnt lgkmcnt(3)
    v_mfma_f32_16x16x32_bf16 v[56:59], v[8:11], v[24:27], v[56:59]
    s_waitcnt lgkmcnt(2)
    v_mfma_f32_16x16x32_bf16 v[60:63], v[8:11], v[28:31], v[60:63]
    v_mfma_f32_16x16x32_bf16 v[88:91], v[12:15], v[24:27], v[88:91]
    v_mfma_f32_16x16x32_bf16 v[92:95], v[12:15], v[28:31], v[92:95]
    s_waitcnt lgkmcnt(0)
    s_barrier
    v_add_u32 v4, s42, v4
    v_mfma_f32_16x16x32_bf16 v[120:123], v[16:19], v[24:27], v[120:123]
    v_add_u32 v1, s43, v1
    v_mfma_f32_16x16x32_bf16 v[124:127], v[16:19], v[28:31], v[124:127]
    v_add_u32 v5, s42, v5
    v_mfma_f32_16x16x32_bf16 v[152:155], v[20:23], v[24:27], v[152:155]
    v_add_u32 v3, s43, v3
    ds_read_b128 v[24:27], v4 offset:0
    v_mfma_f32_16x16x32_bf16 v[156:159], v[20:23], v[28:31], v[156:159]
    ds_read_b128 v[28:31], v4 offset:512
    v_mfma_f32_16x16x32_bf16 v[64:67], v[8:11], v[32:35], v[64:67]
    v_mfma_f32_16x16x32_bf16 v[68:71], v[8:11], v[36:39], v[68:71]
    ds_read_b128 v[8:11], v1 offset:0
    v_mfma_f32_16x16x32_bf16 v[96:99], v[12:15], v[32:35], v[96:99]
    v_mfma_f32_16x16x32_bf16 v[100:103], v[12:15], v[36:39], v[100:103]
    ds_read_b128 v[12:15], v1 offset:2048
    v_mfma_f32_16x16x32_bf16 v[128:131], v[16:19], v[32:35], v[128:131]
    v_mfma_f32_16x16x32_bf16 v[132:135], v[16:19], v[36:39], v[132:135]
    ds_read_b128 v[16:19], v1 offset:4096
L_mh2:
    s_cbranch_execz L_mh3
    v_mfma_f32_16x16x32_bf16 v[160:163], v[20:23], v[32:35], v[160:163]
    ds_read_b128 v[32:35], v4 offset:1024
    v_mfma_f32_16x16x32_bf16 v[164:167], v[20:23], v[36:39], v[164:167]
    ds_read_b128 v[20:23], v1 offset:6144
    ds_read_b128 v[36:39], v4 offset:1536
    .p2align 6
L_mloop:
    s_waitcnt lgkmcnt(5)
    v_mfma_f32_16x16x32_bf16 v[40:43], v[8:11], v[24:27], v[40:43]
    v_mfma_f32_16x16x32_bf16 v[44:47], v[8:11], v[28:31], v[44:47]
    s_waitcnt lgkmcnt(4)
    v_mfma_f32_16x16x32_bf16 v[72:75], v[12:15], v[24:27], v[72:75]
    v_mfma_f32_16x16x32_bf16 v[76:79], v[12:15], v[28:31], v[76:79]
    s_waitcnt lgkmcnt(3)
    v_mfma_f32_16x16x32_bf16 v[104:107], v[16:19], v[24:27], v[104:107]
    v_mfma_f32_16x16x32_bf16 v[108:111], v[16:19], v[28:31], v[108:111]
    s_waitcnt lgkmcnt(1)
    v_mfma_f32_16x16x32_bf16 v[136:139], v[20:23], v[24:27], v[136:139]
    ds_read_b128 v[24:27], v5 offset:0
    v_mfma_f32_16x16x32_bf16 v[140:143], v[20:23], v[28:31], v[140:143]
    ds_read_b128 v[28:31], v5 offset:512
    v_mfma_f32_16x16x32_bf16 v[48:51], v[8:11], v[32:35], v[48:51]
    s_add_u32 s40, s40, 1
    s_waitcnt lgkmcnt(2)
    v_mfma_f32_16x16x32_bf16 v[52:55], v[8:11], v[36:39], v[52:55]
    s_and_b32 s42, s40, 3
    v_mfma_f32_16x16x32_bf16 v[80:83], v[12:15], v[32:35], v[80:83]
    s_cselect_b32 s42, s47, 0xffff4000
    v_mfma_f32_16x16x32_bf16 v[84:87], v[12:15], v[36:39], v[84:87]
    s_add_u32 s41, s41, 1
    v_mfma_f32_16x16x32_bf16 v[112:115], v[16:19], v[32:35], v[112:115]
    s_cmp_eq_u32 s41, 3
    v_mfma_f32_16x16x32_bf16 v[116:119], v[16:19], v[36:39], v[116:119]
    s_cselect_b32 s43, 0xffff0000, s46
    v_mfma_f32_16x16x32_bf16 v[144:147], v[20:23], v[32:35], v[144:147]
    s_cselect_b32 s41, 0, s41
    ds_read_b128 v[32:35], v5 offset:1024
    v_mfma_f32_16x16x32_bf16 v[148:151], v[20:23], v[36:39], v[148:151]
    ds_read_b128 v[36:39], v5 offset:1536
    s_waitcnt lgkmcnt(3)
    v_mfma_f32_16x16x32_bf16 v[56:59], v[8:11], v[24:27], v[56:59]
    s_waitcnt lgkmcnt(2)
    v_mfma_f32_16x16x32_bf16 v[60:63], v[8:11], v[28:31], v[60:63]
    v_mfma_f32_16x16x32_bf16 v[88:91], v[12:15], v[24:27], v[88:91]
    v_mfma_f32_16x16x32_bf16 v[92:95], v[12:15], v[28:31], v[92:95]
    v_mfma_f32_16x16x32_bf16 v[120:123], v[16:19], v[24:27], v[120:123]
    v_mfma_f32_16x16x32_bf16 v[124:127], v[16:19], v[28:31], v[124:127]
    v_mfma_f32_16x16x32_bf16 v[152:155], v[20:23], v[24:27], v[152:155]
L_mh3:
    s_cbranch_execz L_mh4
    ds_read_b128 v[24:27], v4 offset:8192
    v_mfma_f32_16x16x32_bf16 v[156:159], v[20:23], v[28:31], v[156:159]
    ds_read_b128 v[28:31], v4 offset:8704
    s_waitcnt lgkmcnt(3)
    v_mfma_f32_16x16x32_bf16 v[64:67], v[8:11], v[32:35], v[64:67]
    s_waitcnt lgkmcnt(2)
    v_mfma_f32_16x16x32_bf16 v[68:71], v[8:11], v[36:39], v[68:71]
    ds_read_b128 v[8:11], v3 offset:0
    v_mfma_f32_16x16x32_bf16 v[96:99], v[12:15], v[32:35], v[96:99]
    v_mfma_f32_16x16x32_bf16 v[100:103], v[12:15], v[36:39], v[100:103]
    ds_read_b128 v[12:15], v3 offset:2048
    v_mfma_f32_16x16x32_bf16 v[128:131], v[16:19], v[32:35], v[128:131]
    v_mfma_f32_16x16x32_bf16 v[132:135], v[16:19], v[36:39], v[132:135]
    ds_read_b128 v[16:19], v3 offset:4096
    v_mfma_f32_16x16x32_bf16 v[160:163], v[20:23], v[32:35], v[160:163]
    ds_read_b128 v[32:35], v4 offset:9216
    v_mfma_f32_16x16x32_bf16 v[164:167], v[20:23], v[36:39], v[164:167]
    ds_read_b128 v[20:23], v3 offset:6144
    ds_read_b128 v[36:39], v4 offset:9728
    s_waitcnt lgkmcnt(5)
    v_mfma_f32_16x16x32_bf16 v[40:43], v[8:11], v[24:27], v[40:43]
    v_mfma_f32_16x16x32_bf16 v[44:47], v[8:11], v[28:31], v[44:47]
    s_waitcnt lgkmcnt(4)
    v_mfma_f32_16x16x32_bf16 v[72:75], v[12:15], v[24:27], v[72:75]
    v_mfma_f32_16x16x32_bf16 v[76:79], v[12:15], v[28:31], v[76:79]
    s_waitcnt lgkmcnt(3)
    v_mfma_f32_16x16x32_bf16 v[104:107], v[16:19], v[24:27], v[104:107]
    v_mfma_f32_16x16x32_bf16 v[108:111], v[16:19], v[28:31], v[108:111]
    s_waitcnt lgkmcnt(1)
    v_mfma_f32_16x16x32_bf16 v[136:139], v[20:23], v[24:27], v[136:139]
    ds_read_b128 v[24:27], v5 offset:8192
    v_mfma_f32_16x16x32_bf16 v[140:143], v[20:23], v[28:31], v[140:143]
    ds_read_b128 v[28:31], v5 offset:8704
    v_mfma_f32_16x16x32_bf16 v[48:51], v[8:11], v[32:35], v[48:51]
    s_waitcnt lgkmcnt(2)
    v_mfma_f32_16x16x32_bf16 v[52:55], v[8:11], v[36:39], v[52:55]
    v_mfma_f32_16x16x32_bf16 v[80:83], v[12:15], v[32:35], v[80:83]
    v_mfma_f32_16x16x32_bf16 v[84:87], v[12:15], v[36:39], v[84:87]
    v_mfma_f32_16x16x32_bf16 v[112:115], v[16:19], v[32:35], v[112:115]
    v_mfma_f32_16x16x32_bf16 v[116:119], v[16:19], v[36:39], v[116:119]
    v_mfma_f32_16x16x32_bf16 v[144:147], v[20:23], v[32:35], v[144:147]
    ds_read_b128 v[32:35], v5 offset:9216
    v_mfma_f32_16x16x32_bf16 v[148:151], v[20:23], v[36:39], v[148:151]
    ds_read_b128 v[36:39], v5 offset:9728
    s_waitcnt lgkmcnt(3)
    v_mfma_f32_16x16x32_bf16 v[56:59], v[8:11], v[24:27], v[56:59]
    s_waitcnt lgkmcnt(2)
    v_mfma_f32_16x16x32_bf16 v[60:63], v[8:11], v[28:31], v[60:63]
L_mh4:
    s_cbranch_execz L_mh5
    v_mfma_f32_16x16x32_bf16 v[88:91], v[12:15], v[24:27], v[88:91]
    v_mfma_f32_16x16x32_bf16 v[92:95], v[12:15], v[28:31], v[92:95]
    s_waitcnt lgkmcnt(0)
    s_barrier
    v_add_u32 v4, s42, v4
    v_mfma_f32_16x16x32_bf16 v[120:123], v[16:19], v[24:27], v[120:123]
    v_add_u32 v1, s43, v1
    v_mfma_f32_16x16x32_bf16 v[124:127], v[16:19], v[28:31], v[124:127]
    v_add_u32 v5, s42, v5
    v_mfma_f32_16x16x32_bf16 v[152:155], v[20:23], v[24:27], v[152:155]
    v_add_u32 v3, s43, v3
    ds_read_b128 v[24:27], v4 offset:0
    v_mfma_f32_16x16x32_bf16 v[156:159], v[20:23], v[28:31], v[156:159]
    ds_read_b128 v[28:31], v4 offset:512
    v_mfma_f32_16x16x32_bf16 v[64:67], v[8:11], v[32:35], v[64:67]
    v_mfma_f32_16x16x32_bf16 v[68:71], v[8:11], v[36:39], v[68:71]
    ds_read_b128 v[8:11], v1 offset:0
    v_mfma_f32_16x16x32_bf16 v[96:99], v[12:15], v[32:35], v[96:99]
    v_mfma_f32_16x16x32_bf16 v[100:103], v[12:15], v[36:39], v[100:103]
    ds_read_b128 v[12:15], v1 offset:2048
    v_mfma_f32_16x16x32_bf16 v[128:131], v[16:19], v[32:35], v[128:131]
    v_mfma_f32_16x16x32_bf16 v[132:135], v[16:19], v[36:39], v[132:135]
    ds_read_b128 v[16:19], v1 offset:4096
    v_mfma_f32_16x16x32_bf16 v[160:163], v[20:23], v[32:35], v[160:163]
    ds_read_b128 v[32:35], v4 offset:1024
    v_mfma_f32_16x16x32_bf16 v[164:167], v[20:23], v[36:39], v[164:167]
    ds_read_b128 v[20:23], v1 offset:6144
    ds_read_b128 v[36:39], v4 offset:1536
    s_cmp_lt_u32 s40, 11
    s_cbranch_scc1 L_mloop
    s_waitcnt lgkmcnt(5)
    v_mfma_f32_16x16x32_bf16 v[40:43], v[8:11], v[24:27], v[40:43]
    v_mfma_f32_16x16x32_bf16 v[44:47], v[8:11], v[28:31], v[44:47]
    s_waitcnt lgkmcnt(4)
    v_mfma_f32_16x16x32_bf16 v[72:75], v[12:15], v[24:27], v[72:75]
    v_mfma_f32_16x16x32_bf16 v[76:79], v[12:15], v[28:31], v[76:79]
    s_waitcnt lgkmcnt(3)
    v_mfma_f32_16x16x32_bf16 v[104:107], v[16:19], v[24:27], v[104:107]
    v_mfma_f32_16x16x32_bf16 v[108:111], v[16:19], v[28:31], v[108:111]
    s_waitcnt lgkmcnt(1)
    v_mfma_f32_16x16x32_bf16 v[136:139], v[20:23], v[24:27], v[136:139]
    ds_read_b128 v[24:27], v5 offset:0
    v_mfma_f32_16x16x32_bf16 v[140:143], v[20:23], v[28:31], v[140:143]
    ds_read_b128 v[28:31], v5 offset:512
    v_mfma_f32_16x16x32_bf16 v[48:51], v[8:11], v[32:35], v[48:51]
    s_waitcnt lgkmcnt(2)
    v_mfma_f32_16x16x32_bf16 v[52:55], v[8:11], v[36:39], v[52:55]
    v_mfma_f32_16x16x32_bf16 v[80:83], v[12:15], v[32:35], v[80:83]
L_mh5:
    s_cbranch_execz L_mhret
    v_mfma_f32_16x16x32_bf16 v[84:87], v[12:15], v[36:39], v[84:87]
    v_mfma_f32_16x16x32_bf16 v[112:115], v[16:19], v[32:35], v[112:115]
    v_mfma_f32_16x16x32_bf16 v[116:119], v[16:19], v[36:39], v[116:119]
    v_mfma_f32_16x16x32_bf16 v[144:147], v[20:23], v[32:35], v[144:147]
    ds_read_b128 v[32:35], v5 offset:1024
    v_mfma_f32_16x16x32_bf16 v[148:151], v[20:23], v[36:39], v[148:151]
    ds_read_b128 v[36:39], v5 offset:1536
    s_waitcnt lgkmcnt(3)
    v_mfma_f32_16x16x32_bf16 v[56:59], v[8:11], v[24:27], v[56:59]
    s_waitcnt lgkmcnt(2)
    v_mfma_f32_16x16x32_bf16 v[60:63], v[8:11], v[28:31], v[60:63]
    v_mfma_f32_16x16x32_bf16 v[88:91], v[12:15], v[24:27], v[88:91]
    v_mfma_f32_16x16x32_bf16 v[92:95], v[12:15], v[28:31], v[92:95]
    v_mfma_f32_16x16x32_bf16 v[120:123], v[16:19], v[24:27], v[120:123]
    v_mfma_f32_16x16x32_bf16 v[124:127], v[16:19], v[28:31], v[124:127]
    v_mfma_f32_16x16x32_bf16 v[152:155], v[20:23], v[24:27], v[152:155]
    ds_read_b128 v[24:27], v4 offset:8192
    v_mfma_f32_16x16x32_bf16 v[156:159], v[20:23], v[28:31], v[156:159]
    ds_read_b128 v[28:31], v4 offset:8704
    s_waitcnt lgkmcnt(3)
    v_mfma_f32_16x16x32_bf16 v[64:67], v[8:11], v[32:35], v[64:67]
    s_waitcnt lgkmcnt(2)
    v_mfma_f32_16x16x32_bf16 v[68:71], v[8:11], v[36:39], v[68:71]
    ds_read_b128 v[8:11], v3 offset:0
    v_mfma_f32_16x16x32_bf16 v[96:99], v[12:15], v[32:35], v[96:99]
    v_mfma_f32_16x16x32_bf16 v[100:103], v[12:15], v[36:39], v[100:103]
    ds_read_b128 v[12:15], v3 offset:2048
    v_mfma_f32_16x16x32_bf16 v[128:131], v[16:19], v[32:35], v[128:131]
    v_mfma_f32_16x16x32_bf16 v[132:135], v[16:19], v[36:39], v[132:135]
    ds_read_b128 v[16:19], v3 offset:4096
    v_mfma_f32_16x16x32_bf16 v[160:163], v[20:23], v[32:35], v[160:163]
    ds_read_b128 v[32:35], v4 offset:9216
    v_mfma_f32_16x16x32_bf16 v[164:167], v[20:23], v[36:39], v[164:167]
    ds_read_b128 v[20:23], v3 offset:6144
    ds_read_b128 v[36:39], v4 offset:9728
    s_waitcnt lgkmcnt(5)
    v_mfma_f32_16x16x32_bf16 v[40:43], v[8:11], v[24:27], v[40:43]
    v_mfma_f32_16x16x32_bf16 v[44:47], v[8:11], v[28:31], v[44:47]
    s_waitcnt lgkmcnt(4)
    v_mfma_f32_16x16x32_bf16 v[72:75], v[12:15], v[24:27], v[72:75]
    v_mfma_f32_16x16x32_bf16 v[76:79], v[12:15], v[28:31], v[76:79]
    s_waitcnt lgkmcnt(3)
    v_mfma_f32_16x16x32_bf16 v[104:107], v[16:19], v[24:27], v[104:107]
    v_mfma_f32_16x16x32_bf16 v[108:111], v[16:19], v[28:31], v[108:111]
    s_waitcnt lgkmcnt(1)
    v_mfma_f32_16x16x32_bf16 v[136:139], v[20:23], v[24:27], v[136:139]
    ds_read_b128 v[24:27], v5 offset:8192
    v_mfma_f32_16x16x32_bf16 v[140:143], v[20:23], v[28:31], v[140:143]
L_mh6:
    s_cbranch_execz L_mh7
    ds_read_b128 v[28:31], v5 offset:8704
    v_mfma_f32_16x16x32_bf16 v[48:51], v[8:11], v[32:35], v[48:51]
    s_waitcnt lgkmcnt(2)
    v_mfma_f32_16x16x32_bf16 v[52:55], v[8:11], v[36:39], v[52:55]
    v_mfma_f32_16x16x32_bf16 v[80:83], v[12:15], v[32:35], v[80:83]
    v_mfma_f32_16x16x32_bf16 v[84:87], v[12:15], v[36:39], v[84:87]
    v_mfma_f32_16x16x32_bf16 v[112:115], v[16:19], v[32:35], v[112:115]
    v_mfma_f32_16x16x32_bf16 v[116:119], v[16:19], v[36:39], v[116:119]
    v_mfma_f32_16x16x32_bf16 v[144:147], v[20:23], v[32:35], v[144:147]
    ds_read_b128 v[32:35], v5 offset:9216
    v_mfma_f32_16x16x32_bf16 v[148:151], v[20:23], v[36:39], v[148:151]
    ds_read_b128 v[36:39], v5 offset:9728
    s_waitcnt lgkmcnt(3)
    v_mfma_f32_16x16x32_bf16 v[56:59], v[8:11], v[24:27], v[56:59]
    s_waitcnt lgkmcnt(2)
    v_mfma_f32_16x16x32_bf16 v[60:63], v[8:11], v[28:31], v[60:63]
    v_mfma_f32_16x16x32_bf16 v[88:91], v[12:15], v[24:27], v[88:91]
    v_mfma_f32_16x16x32_bf16 v[92:95], v[12:15], v[28:31], v[92:95]
    s_waitcnt lgkmcnt(0)
    s_barrier
    v_add_u32 v4, 0xffff4000, v4
    v_mfma_f32_16x16x32_bf16 v[120:123], v[16:19], v[24:27], v[120:123]
    v_add_u32 v7, 0x0, v1
    v_mfma_f32_16x16x32_bf16 v[124:127], v[16:19], v[28:31], v[124:127]
    v_add_u32 v1, 0xffff0000, v1
    v_mfma_f32_16x16x32_bf16 v[152:155], v[20:23], v[24:27], v[152:155]
    v_add_u32 v5, 0xffff4000, v5
    ds_read_b128 v[24:27], v1 offset:0
    v_mfma_f32_16x16x32_bf16 v[156:159], v[20:23], v[28:31], v[156:159]
    v_add_u32 v0, 0x0, v3
    v_mfma_f32_16x16x32_bf16 v[64:67], v[8:11], v[32:35], v[64:67]
    v_add_u32 v3, 0xffff0000, v3
    ds_read_b128 v[28:31], v4 offset:0
    v_mfma_f32_16x16x32_bf16 v[68:71], v[8:11], v[36:39], v[68:71]
    ds_read_b128 v[8:11], v1 offset:2048
    v_mfma_f32_16x16x32_bf16 v[96:99], v[12:15], v[32:35], v[96:99]
    v_mfma_f32_16x16x32_bf16 v[100:103], v[12:15], v[36:39], v[100:103]
    ds_read_b128 v[12:15], v4 offset:512
    v_mfma_f32_16x16x32_bf16 v[128:131], v[16:19], v[32:35], v[128:131]
    v_mfma_f32_16x16x32_bf16 v[132:135], v[16:19], v[36:39], v[132:135]
    ds_read_b128 v[16:19], v4 offset:1024
    v_mfma_f32_16x16x32_bf16 v[160:163], v[20:23], v[32:35], v[160:163]
    ds_read_b128 v[32:35], v4 offset:1536
    v_mfma_f32_16x16x32_bf16 v[164:167], v[20:23], v[36:39], v[164:167]
    s_waitcnt lgkmcnt(4)
    v_mfma_f32_16x16x32_bf16 v[40:43], v[24:27], v[28:31], v[40:43]
    ds_read_b128 v[20:23], v5 offset:0
    s_waitcnt lgkmcnt(4)
L_mh7:
    s_cbranch_execz L_mh8
    v_mfma_f32_16x16x32_bf16 v[72:75], v[8:11], v[28:31], v[72:75]
    s_waitcnt lgkmcnt(3)
    v_mfma_f32_16x16x32_bf16 v[44:47], v[24:27], v[12:15], v[44:47]
    ds_read_b128 v[28:31], v5 offset:512
    v_mfma_f32_16x16x32_bf16 v[76:79], v[8:11], v[12:15], v[76:79]
    s_waitcnt lgkmcnt(3)
    v_mfma_f32_16x16x32_bf16 v[48:51], v[24:27], v[16:19], v[48:51]
    ds_read_b128 v[12:15], v5 offset:1024
    v_mfma_f32_16x16x32_bf16 v[80:83], v[8:11], v[16:19], v[80:83]
    ds_read_b128 v[36:39], v3 offset:0
    s_waitcnt lgkmcnt(4)
    v_mfma_f32_16x16x32_bf16 v[52:55], v[24:27], v[32:35], v[52:55]
    ds_read_b128 v[16:19], v5 offset:1536
    v_mfma_f32_16x16x32_bf16 v[84:87], v[8:11], v[32:35], v[84:87]
    s_waitcnt lgkmcnt(4)
    v_mfma_f32_16x16x32_bf16 v[56:59], v[24:27], v[20:23], v[56:59]
    ds_read_b128 v[32:35], v4 offset:8192
    v_mfma_f32_16x16x32_bf16 v[88:91], v[8:11], v[20:23], v[88:91]
    ds_read_b128 v[20:23], v3 offset:2048
    s_waitcnt lgkmcnt(5)
    v_mfma_f32_16x16x32_bf16 v[60:63], v[24:27], v[28:31], v[60:63]
    v_mfma_f32_16x16x32_bf16 v[92:95], v[8:11], v[28:31], v[92:95]
    ds_read_b128 v[28:31], v4 offset:8704
    s_waitcnt lgkmcnt(5)
    v_mfma_f32_16x16x32_bf16 v[64:67], v[24:27], v[12:15], v[64:67]
    v_mfma_f32_16x16x32_bf16 v[96:99], v[8:11], v[12:15], v[96:99]
    ds_read_b128 v[12:15], v4 offset:9216
    s_waitcnt lgkmcnt(4)
    v_mfma_f32_16x16x32_bf16 v[68:71], v[24:27], v[16:19], v[68:71]
    ds_read_b128 v[24:27], v4 offset:9728
    v_mfma_f32_16x16x32_bf16 v[100:103], v[8:11], v[16:19], v[100:103]
    s_waitcnt lgkmcnt(4)
    v_mfma_f32_16x16x32_bf16 v[40:43], v[36:39], v[32:35], v[40:43]
    ds_read_b128 v[8:11], v5 offset:8192
    s_waitcnt lgkmcnt(4)
    v_mfma_f32_16x16x32_bf16 v[72:75], v[20:23], v[32:35], v[72:75]
    s_waitcnt lgkmcnt(3)
    v_mfma_f32_16x16x32_bf16 v[44:47], v[36:39], v[28:31], v[44:47]
    ds_read_b128 v[32:35], v5 offset:8704
    v_mfma_f32_16x16x32_bf16 v[76:79], v[20:23], v[28:31], v[76:79]
    s_waitcnt lgkmcnt(3)
    v_mfma_f32_16x16x32_bf16 v[48:51], v[36:39], v[12:15], v[48:51]
    ds_read_b128 v[28:31], v5 offset:9216
    v_mfma_f32_16x16x32_bf16 v[80:83], v[20:23], v[12:15], v[80:83]
    s_barrier
    ds_read_b128 v[16:19], v1 offset:32768
    s_waitcnt lgkmcnt(4)
    v_mfma_f32_16x16x32_bf16 v[52:55], v[36:39], v[24:27], v[52:55]
L_mh8:
    s_cbranch_execz L_mh9
    ds_read_b128 v[12:15], v5 offset:9728
    v_mfma_f32_16x16x32_bf16 v[84:87], v[20:23], v[24:27], v[84:87]
    s_waitcnt lgkmcnt(4)
    v_mfma_f32_16x16x32_bf16 v[56:59], v[36:39], v[8:11], v[56:59]
    ds_read_b128 v[24:27], v4 offset:16384
    v_mfma_f32_16x16x32_bf16 v[88:91], v[20:23], v[8:11], v[88:91]
    ds_read_b128 v[8:11], v1 offset:34816
    s_waitcnt lgkmcnt(5)
    v_mfma_f32_16x16x32_bf16 v[60:63], v[36:39], v[32:35], v[60:63]
    v_mfma_f32_16x16x32_bf16 v[92:95], v[20:23], v[32:35], v[92:95]
    ds_read_b128 v[32:35], v4 offset:16896
    s_waitcnt lgkmcnt(5)
    v_mfma_f32_16x16x32_bf16 v[64:67], v[36:39], v[28:31], v[64:67]
    v_mfma_f32_16x16x32_bf16 v[96:99], v[20:23], v[28:31], v[96:99]
    ds_read_b128 v[28:31], v4 offset:17408
    s_waitcnt lgkmcnt(4)
    v_mfma_f32_16x16x32_bf16 v[68:71], v[36:39], v[12:15], v[68:71]
    ds_read_b128 v[36:39], v4 offset:17920
    v_mfma_f32_16x16x32_bf16 v[100:103], v[20:23], v[12:15], v[100:103]
    s_waitcnt lgkmcnt(4)
    v_mfma_f32_16x16x32_bf16 v[40:43], v[16:19], v[24:27], v[40:43]
    ds_read_b128 v[12:15], v5 offset:16384
    s_waitcnt lgkmcnt(4)
    v_mfma_f32_16x16x32_bf16 v[72:75], v[8:11], v[24:27], v[72:75]
    s_waitcnt lgkmcnt(3)
    v_mfma_f32_16x16x32_bf16 v[44:47], v[16:19], v[32:35], v[44:47]
    ds_read_b128 v[24:27], v5 offset:16896
    v_mfma_f32_16x16x32_bf16 v[76:79], v[8:11], v[32:35], v[76:79]
    s_waitcnt lgkmcnt(3)
    v_mfma_f32_16x16x32_bf16 v[48:51], v[16:19], v[28:31], v[48:51]
    ds_read_b128 v[32:35], v5 offset:17408
    v_mfma_f32_16x16x32_bf16 v[80:83], v[8:11], v[28:31], v[80:83]
    ds_read_b128 v[20:23], v3 offset:32768
    s_waitcnt lgkmcnt(4)
    v_mfma_f32_16x16x32_bf16 v[52:55], v[16:19], v[36:39], v[52:55]
    ds_read_b128 v[28:31], v5 offset:17920
    v_mfma_f32_16x16x32_bf16 v[84:87], v[8:11], v[36:39], v[84:87]
    s_waitcnt lgkmcnt(4)
    v_mfma_f32_16x16x32_bf16 v[56:59], v[16:19], v[12:15], v[56:59]
    ds_read_b128 v[36:39], v4 offset:24576
    v_mfma_f32_16x16x32_bf16 v[88:91], v[8:11], v[12:15], v[88:91]
    ds_read_b128 v[12:15], v3 offset:34816
    s_waitcnt lgkmcnt(5)
    v_mfma_f32_16x16x32_bf16 v[60:63], v[16:19], v[24:27], v[60:63]
    v_mfma_f32_16x16x32_bf16 v[92:95], v[8:11], v[24:27], v[92:95]
    ds_read_b128 v[24:27], v4 offset:25088
    s_waitcnt lgkmcnt(5)
    v_mfma_f32_16x16x32_bf16 v[64:67], v[16:19], v[32:35], v[64:67]
L_mh9:
    s_cbranch_execz L_mh10
    v_mfma_f32_16x16x32_bf16 v[96:99], v[8:11], v[32:35], v[96:99]
    ds_read_b128 v[32:35], v4 offset:25600
    s_waitcnt lgkmcnt(4)
    v_mfma_f32_16x16x32_bf16 v[68:71], v[16:19], v[28:31], v[68:71]
    ds_read_b128 v[16:19], v4 offset:26112
    v_mfma_f32_16x16x32_bf16 v[100:103], v[8:11], v[28:31], v[100:103]
    s_waitcnt lgkmcnt(4)
    v_mfma_f32_16x16x32_bf16 v[40:43], v[20:23], v[36:39], v[40:43]
    ds_read_b128 v[8:11], v5 offset:24576
    s_waitcnt lgkmcnt(4)
    v_mfma_f32_16x16x32_bf16 v[72:75], v[12:15], v[36:39], v[72:75]
    s_waitcnt lgkmcnt(3)
    v_mfma_f32_16x16x32_bf16 v[44:47], v[20:23], v[24:27], v[44:47]
    ds_read_b128 v[36:39], v5 offset:25088
    v_mfma_f32_16x16x32_bf16 v[76:79], v[12:15], v[24:27], v[76:79]
    s_waitcnt lgkmcnt(3)
    v_mfma_f32_16x16x32_bf16 v[48:51], v[20:23], v[32:35], v[48:51]
    ds_read_b128 v[24:27], v5 offset:25600
    v_mfma_f32_16x16x32_bf16 v[80:83], v[12:15], v[32:35], v[80:83]
    s_barrier
    ds_read_b128 v[28:31], v7 offset:0
    s_waitcnt lgkmcnt(4)
    v_mfma_f32_16x16x32_bf16 v[52:55], v[20:23], v[16:19], v[52:55]
    ds_read_b128 v[32:35], v5 offset:26112
    v_mfma_f32_16x16x32_bf16 v[84:87], v[12:15], v[16:19], v[84:87]
    s_waitcnt lgkmcnt(4)
    v_mfma_f32_16x16x32_bf16 v[56:59], v[20:23], v[8:11], v[56:59]
    ds_read_b128 v[16:19], v4 offset:32768
    v_mfma_f32_16x16x32_bf16 v[88:91], v[12:15], v[8:11], v[88:91]
    ds_read_b128 v[8:11], v7 offset:2048
    s_waitcnt lgkmcnt(5)
    v_mfma_f32_16x16x32_bf16 v[60:63], v[20:23], v[36:39], v[60:63]
    v_mfma_f32_16x16x32_bf16 v[92:95], v[12:15], v[36:39], v[92:95]
    ds_read_b128 v[36:39], v4 offset:33280
    s_waitcnt lgkmcnt(5)
    v_mfma_f32_16x16x32_bf16 v[64:67], v[20:23], v[24:27], v[64:67]
    v_mfma_f32_16x16x32_bf16 v[96:99], v[12:15], v[24:27], v[96:99]
    ds_read_b128 v[24:27], v4 offset:33792
    s_waitcnt lgkmcnt(4)
    v_mfma_f32_16x16x32_bf16 v[68:71], v[20:23], v[32:35], v[68:71]
    ds_read_b128 v[20:23], v4 offset:34304
    v_mfma_f32_16x16x32_bf16 v[100:103], v[12:15], v[32:35], v[100:103]
    s_waitcnt lgkmcnt(4)
    v_mfma_f32_16x16x32_bf16 v[40:43], v[28:31], v[16:19], v[40:43]
    ds_read_b128 v[12:15], v5 offset:32768
    s_waitcnt lgkmcnt(4)
    v_mfma_f32_16x16x32_bf16 v[72:75], v[8:11], v[16:19], v[72:75]
    s_waitcnt lgkmcnt(3)
L_mh10:
    s_cbranch_execz L_mh11
    v_mfma_f32_16x16x32_bf16 v[44:47], v[28:31], v[36:39], v[44:47]
    ds_read_b128 v[16:19], v5 offset:33280
    v_mfma_f32_16x16x32_bf16 v[76:79], v[8:11], v[36:39], v[76:79]
    s_waitcnt lgkmcnt(3)
    v_mfma_f32_16x16x32_bf16 v[48:51], v[28:31], v[24:27], v[48:51]
    ds_read_b128 v[36:39], v5 offset:33792
    v_mfma_f32_16x16x32_bf16 v[80:83], v[8:11], v[24:27], v[80:83]
    ds_read_b128 v[32:35], v0 offset:0
    s_waitcnt lgkmcnt(4)
    v_mfma_f32_16x16x32_bf16 v[52:55], v[28:31], v[20:23], v[52:55]
    ds_read_b128 v[24:27], v5 offset:34304
    v_mfma_f32_16x16x32_bf16 v[84:87], v[8:11], v[20:23], v[84:87]
    s_waitcnt lgkmcnt(4)
    v_mfma_f32_16x16x32_bf16 v[56:59], v[28:31], v[12:15], v[56:59]
    ds_read_b128 v[20:23], v4 offset:40960
    v_mfma_f32_16x16x32_bf16 v[88:91], v[8:11], v[12:15], v[88:91]
    ds_read_b128 v[12:15], v0 offset:2048
    s_waitcnt lgkmcnt(5)
    v_mfma_f32_16x16x32_bf16 v[60:63], v[28:31], v[16:19], v[60:63]
    v_mfma_f32_16x16x32_bf16 v[92:95], v[8:11], v[16:19], v[92:95]
    ds_read_b128 v[16:19], v4 offset:41472
    s_waitcnt lgkmcnt(5)
    v_mfma_f32_16x16x32_bf16 v[64:67], v[28:31], v[36:39], v[64:67]
    v_mfma_f32_16x16x32_bf16 v[96:99], v[8:11], v[36:39], v[96:99]
    ds_read_b128 v[36:39], v4 offset:41984
    s_waitcnt lgkmcnt(4)
    v_mfma_f32_16x16x32_bf16 v[68:71], v[28:31], v[24:27], v[68:71]
    ds_read_b128 v[28:31], v4 offset:42496
    v_mfma_f32_16x16x32_bf16 v[100:103], v[8:11], v[24:27], v[100:103]
    s_waitcnt lgkmcnt(4)
    v_mfma_f32_16x16x32_bf16 v[40:43], v[32:35], v[20:23], v[40:43]
    ds_read_b128 v[8:11], v5 offset:40960
    s_waitcnt lgkmcnt(4)
    v_mfma_f32_16x16x32_bf16 v[72:75], v[12:15], v[20:23], v[72:75]
    s_waitcnt lgkmcnt(3)
    v_mfma_f32_16x16x32_bf16 v[44:47], v[32:35], v[16:19], v[44:47]
    ds_read_b128 v[20:23], v5 offset:41472
    v_mfma_f32_16x16x32_bf16 v[76:79], v[12:15], v[16:19], v[76:79]
    s_waitcnt lgkmcnt(3)
    v_mfma_f32_16x16x32_bf16 v[48:51], v[32:35], v[36:39], v[48:51]
    ds_read_b128 v[16:19], v5 offset:41984
    v_mfma_f32_16x16x32_bf16 v[80:83], v[12:15], v[36:39], v[80:83]
    s_barrier
    ds_read_b128 v[24:27], v1 offset:0
    s_waitcnt lgkmcnt(4)
    v_mfma_f32_16x16x32_bf16 v[52:55], v[32:35], v[28:31], v[52:55]
    ds_read_b128 v[36:39], v5 offset:42496
    v_mfma_f32_16x16x32_bf16 v[84:87], v[12:15], v[28:31], v[84:87]
L_mh11:
    s_cbranch_execz L_mhret
    s_waitcnt lgkmcnt(4)
    v_mfma_f32_16x16x32_bf16 v[56:59], v[32:35], v[8:11], v[56:59]
    ds_read_b128 v[28:31], v4 offset:49152
    v_mfma_f32_16x16x32_bf16 v[88:91], v[12:15], v[8:11], v[88:91]
    ds_read_b128 v[8:11], v1 offset:2048
    s_waitcnt lgkmcnt(5)
    v_mfma_f32_16x16x32_bf16 v[60:63], v[32:35], v[20:23], v[60:63]
    v_mfma_f32_16x16x32_bf16 v[92:95], v[12:15], v[20:23], v[92:95]
    ds_read_b128 v[20:23], v4 offset:49664
    s_waitcnt lgkmcnt(5)
    v_mfma_f32_16x16x32_bf16 v[64:67], v[32:35], v[16:19], v[64:67]
    v_mfma_f32_16x16x32_bf16 v[96:99], v[12:15], v[16:19], v[96:99]
    ds_read_b128 v[16:19], v4 offset:50176
    s_waitcnt lgkmcnt(4)
    v_mfma_f32_16x16x32_bf16 v[68:71], v[32:35], v[36:39], v[68:71]
    ds_read_b128 v[32:35], v4 offset:50688
    v_mfma_f32_16x16x32_bf16 v[100:103], v[12:15], v[36:39], v[100:103]
    s_waitcnt lgkmcnt(4)
    v_mfma_f32_16x16x32_bf16 v[40:43], v[24:27], v[28:31], v[40:43]
    ds_read_b128 v[12:15], v5 offset:49152
    s_waitcnt lgkmcnt(4)
    v_mfma_f32_16x16x32_bf16 v[72:75], v[8:11], v[28:31], v[72:75]
    s_waitcnt lgkmcnt(3)
    v_mfma_f32_16x16x32_bf16 v[44:47], v[24:27], v[20:23], v[44:47]
    ds_read_b128 v[28:31], v5 offset:49664
    v_mfma_f32_16x16x32_bf16 v[76:79], v[8:11], v[20:23], v[76:79]
    s_waitcnt lgkmcnt(3)
    v_mfma_f32_16x16x32_bf16 v[48:51], v[24:27], v[16:19], v[48:51]
    ds_read_b128 v[20:23], v5 offset:50176
    v_mfma_f32_16x16x32_bf16 v[80:83], v[8:11], v[16:19], v[80:83]
    ds_read_b128 v[36:39], v3 offset:0
    s_waitcnt lgkmcnt(4)
    v_mfma_f32_16x16x32_bf16 v[52:55], v[24:27], v[32:35], v[52:55]
    ds_read_b128 v[16:19], v5 offset:50688
    v_mfma_f32_16x16x32_bf16 v[84:87], v[8:11], v[32:35], v[84:87]
    s_waitcnt lgkmcnt(4)
    v_mfma_f32_16x16x32_bf16 v[56:59], v[24:27], v[12:15], v[56:59]
    ds_read_b128 v[32:35], v4 offset:57344
    v_mfma_f32_16x16x32_bf16 v[88:91], v[8:11], v[12:15], v[88:91]
    ds_read_b128 v[12:15], v3 offset:2048
    s_waitcnt lgkmcnt(5)
    v_mfma_f32_16x16x32_bf16 v[60:63], v[24:27], v[28:31], v[60:63]
    v_mfma_f32_16x16x32_bf16 v[92:95], v[8:11], v[28:31], v[92:95]
    ds_read_b128 v[28:31], v4 offset:57856
    s_waitcnt lgkmcnt(5)
    v_mfma_f32_16x16x32_bf16 v[64:67], v[24:27], v[20:23], v[64:67]
    v_mfma_f32_16x16x32_bf16 v[96:99], v[8:11], v[20:23], v[96:99]
    ds_read_b128 v[20:23], v4 offset:58368
L_mh12:
    s_cbranch_execz L_mh13
    s_waitcnt lgkmcnt(4)
    v_mfma_f32_16x16x32_bf16 v[68:71], v[24:27], v[16:19], v[68:71]
    ds_read_b128 v[24:27], v4 offset:58880
    v_mfma_f32_16x16x32_bf16 v[100:103], v[8:11], v[16:19], v[100:103]
    s_waitcnt lgkmcnt(4)
    v_mfma_f32_16x16x32_bf16 v[40:43], v[36:39], v[32:35], v[40:43]
    ds_read_b128 v[8:11], v5 offset:57344
    s_waitcnt lgkmcnt(4)
    v_mfma_f32_16x16x32_bf16 v[72:75], v[12:15], v[32:35], v[72:75]
    s_waitcnt lgkmcnt(3)
    v_mfma_f32_16x16x32_bf16 v[44:47], v[36:39], v[28:31], v[44:47]
    ds_read_b128 v[32:35], v5 offset:57856
    v_mfma_f32_16x16x32_bf16 v[76:79], v[12:15], v[28:31], v[76:79]
    s_waitcnt lgkmcnt(3)
    v_mfma_f32_16x16x32_bf16 v[48:51], v[36:39], v[20:23], v[48:51]
    ds_read_b128 v[28:31], v5 offset:58368
    v_mfma_f32_16x16x32_bf16 v[80:83], v[12:15], v[20:23], v[80:83]
    ds_read_b128 v[16:19], v1 offset:4096
    s_waitcnt lgkmcnt(4)
    v_mfma_f32_16x16x32_bf16 v[52:55], v[36:39], v[24:27], v[52:55]
    ds_read_b128 v[20:23], v5 offset:58880
    v_mfma_f32_16x16x32_bf16 v[84:87], v[12:15], v[24:27], v[84:87]
    s_waitcnt lgkmcnt(4)
    v_mfma_f32_16x16x32_bf16 v[56:59], v[36:39], v[8:11], v[56:59]
    ds_read_b128 v[24:27], v4 offset:0
    v_mfma_f32_16x16x32_bf16 v[88:91], v[12:15], v[8:11], v[88:91]
    ds_read_b128 v[8:11], v1 offset:6144
    s_waitcnt lgkmcnt(5)
    v_mfma_f32_16x16x32_bf16 v[60:63], v[36:39], v[32:35], v[60:63]
    v_mfma_f32_16x16x32_bf16 v[92:95], v[12:15], v[32:35], v[92:95]
    ds_read_b128 v[32:35], v4 offset:512
    s_waitcnt lgkmcnt(5)
    v_mfma_f32_16x16x32_bf16 v[64:67], v[36:39], v[28:31], v[64:67]
    v_mfma_f32_16x16x32_bf16 v[96:99], v[12:15], v[28:31], v[96:99]
    ds_read_b128 v[28:31], v4 offset:1024
    s_waitcnt lgkmcnt(4)
    v_mfma_f32_16x16x32_bf16 v[68:71], v[36:39], v[20:23], v[68:71]
    ds_read_b128 v[36:39], v4 offset:1536
    v_mfma_f32_16x16x32_bf16 v[100:103], v[12:15], v[20:23], v[100:103]
    s_waitcnt lgkmcnt(4)
    v_mfma_f32_16x16x32_bf16 v[104:107], v[16:19], v[24:27], v[104:107]
    ds_read_b128 v[12:15], v5 offset:0
    s_waitcnt lgkmcnt(4)
    v_mfma_f32_16x16x32_bf16 v[136:139], v[8:11], v[24:27], v[136:139]
    s_waitcnt lgkmcnt(3)
    v_mfma_f32_16x16x32_bf16 v[108:111], v[16:19], v[32:35], v[108:111]
    ds_read_b128 v[24:27], v5 offset:512
    v_mfma_f32_16x16x32_bf16 v[140:143], v[8:11], v[32:35], v[140:143]
L_mh13:
    s_cbranch_execz L_mh14
    s_waitcnt lgkmcnt(3)
    v_mfma_f32_16x16x32_bf16 v[112:115], v[16:19], v[28:31], v[112:115]
    ds_read_b128 v[20:23], v5 offset:1024
    v_cvt_pk_bf16_f32 v32, v40, v44
    v_mfma_f32_16x16x32_bf16 v[144:147], v[8:11], v[28:31], v[144:147]
    v_cvt_pk_bf16_f32 v33, v48, v52
    s_waitcnt lgkmcnt(3)
    v_mfma_f32_16x16x32_bf16 v[116:119], v[16:19], v[36:39], v[116:119]
    ds_read_b128 v[28:31], v5 offset:1536
    v_cvt_pk_bf16_f32 v34, v56, v60
    v_mfma_f32_16x16x32_bf16 v[148:151], v[8:11], v[36:39], v[148:151]
    ds_read_b128 v[36:39], v3 offset:4096
    v_cvt_pk_bf16_f32 v35, v64, v68
    s_waitcnt lgkmcnt(4)
    v_mfma_f32_16x16x32_bf16 v[120:123], v[16:19], v[12:15], v[120:123]
    buffer_store_dwordx4 v[32:35], v6, s[28:31], s36 offen sc1 nt
    v_mfma_f32_16x16x32_bf16 v[152:155], v[8:11], v[12:15], v[152:155]
    ds_read_b128 v[12:15], v4 offset:8192
    s_add_u32 s36, s36, 7168
    s_waitcnt lgkmcnt(4)
    v_mfma_f32_16x16x32_bf16 v[124:127], v[16:19], v[24:27], v[124:127]
    v_cvt_pk_bf16_f32 v32, v41, v45
    v_mfma_f32_16x16x32_bf16 v[156:159], v[8:11], v[24:27], v[156:159]
    ds_read_b128 v[24:27], v3 offset:6144
    v_cvt_pk_bf16_f32 v33, v49, v53
    s_waitcnt lgkmcnt(4)
    v_mfma_f32_16x16x32_bf16 v[128:131], v[16:19], v[20:23], v[128:131]
    v_cvt_pk_bf16_f32 v34, v57, v61
    v_mfma_f32_16x16x32_bf16 v[160:163], v[8:11], v[20:23], v[160:163]
    ds_read_b128 v[20:23], v4 offset:8704
    v_cvt_pk_bf16_f32 v35, v65, v69
    s_waitcnt lgkmcnt(4)
    v_mfma_f32_16x16x32_bf16 v[132:135], v[16:19], v[28:31], v[132:135]
    ds_read_b128 v[16:19], v4 offset:9216
    buffer_store_dwordx4 v[32:35], v6, s[28:31], s36 offen sc1 nt
    v_mfma_f32_16x16x32_bf16 v[164:167], v[8:11], v[28:31], v[164:167]
    ds_read_b128 v[8:11], v4 offset:9728
    s_add_u32 s36, s36, 7168
    s_waitcnt lgkmcnt(4)
    v_mfma_f32_16x16x32_bf16 v[104:107], v[36:39], v[12:15], v[104:107]
    ds_read_b128 v[28:31], v5 offset:8192
    v_cvt_pk_bf16_f32 v32, v42, v46
    s_waitcnt lgkmcnt(4)
    v_mfma_f32_16x16x32_bf16 v[136:139], v[24:27], v[12:15], v[136:139]
    v_cvt_pk_bf16_f32 v33, v50, v54
    s_waitcnt lgkmcnt(3)
    v_mfma_f32_16x16x32_bf16 v[108:111], v[36:39], v[20:23], v[108:111]
    ds_read_b128 v[12:15], v5 offset:8704
L_mh14:
    s_cbranch_execz L_mh15
    v_cvt_pk_bf16_f32 v34, v58, v62
    v_mfma_f32_16x16x32_bf16 v[140:143], v[24:27], v[20:23], v[140:143]
    v_cvt_pk_bf16_f32 v35, v66, v70
    s_waitcnt lgkmcnt(3)
    v_mfma_f32_16x16x32_bf16 v[112:115], v[36:39], v[16:19], v[112:115]
    ds_read_b128 v[20:23], v5 offset:9216
    buffer_store_dwordx4 v[32:35], v6, s[28:31], s36 offen sc1 nt
    v_mfma_f32_16x16x32_bf16 v[144:147], v[24:27], v[16:19], v[144:147]
    s_add_u32 s36, s36, 7168
    s_waitcnt lgkmcnt(3)
    v_mfma_f32_16x16x32_bf16 v[116:119], v[36:39], v[8:11], v[116:119]
    ds_read_b128 v[16:19], v5 offset:9728
    v_cvt_pk_bf16_f32 v32, v43, v47
    v_mfma_f32_16x16x32_bf16 v[148:151], v[24:27], v[8:11], v[148:151]
    ds_read_b128 v[8:11], v1 offset:36864
    v_cvt_pk_bf16_f32 v33, v51, v55
    s_waitcnt lgkmcnt(4)
    v_mfma_f32_16x16x32_bf16 v[120:123], v[36:39], v[28:31], v[120:123]
    v_cvt_pk_bf16_f32 v34, v59, v63
    v_mfma_f32_16x16x32_bf16 v[152:155], v[24:27], v[28:31], v[152:155]
    ds_read_b128 v[28:31], v4 offset:16384
    v_cvt_pk_bf16_f32 v35, v67, v71
    s_waitcnt lgkmcnt(4)
    v_mfma_f32_16x16x32_bf16 v[124:127], v[36:39], v[12:15], v[124:127]
    buffer_store_dwordx4 v[32:35], v6, s[28:31], s36 offen sc1 nt
    v_mfma_f32_16x16x32_bf16 v[156:159], v[24:27], v[12:15], v[156:159]
    ds_read_b128 v[12:15], v1 offset:38912
    s_add_u32 s36, s36, 93184
    s_waitcnt lgkmcnt(4)
    v_mfma_f32_16x16x32_bf16 v[128:131], v[36:39], v[20:23], v[128:131]
    ds_read_b128 v[32:35], v4 offset:16896
    v_cvt_pk_bf16_f32 v40, v72, v76
    v_mfma_f32_16x16x32_bf16 v[160:163], v[24:27], v[20:23], v[160:163]
    ds_read_b128 v[48:51], v4 offset:17408
    v_cvt_pk_bf16_f32 v41, v80, v84
    s_waitcnt lgkmcnt(5)
    v_mfma_f32_16x16x32_bf16 v[132:135], v[36:39], v[16:19], v[132:135]
    ds_read_b128 v[36:39], v4 offset:17920
    v_cvt_pk_bf16_f32 v42, v88, v92
    v_mfma_f32_16x16x32_bf16 v[164:167], v[24:27], v[16:19], v[164:167]
    v_cvt_pk_bf16_f32 v43, v96, v100
    s_waitcnt lgkmcnt(4)
    v_mfma_f32_16x16x32_bf16 v[104:107], v[8:11], v[28:31], v[104:107]
    ds_read_b128 v[24:27], v5 offset:16384
    buffer_store_dwordx4 v[40:43], v6, s[28:31], s36 offen sc1 nt
    s_waitcnt lgkmcnt(4)
    v_mfma_f32_16x16x32_bf16 v[136:139], v[12:15], v[28:31], v[136:139]
    s_add_u32 s36, s36, 7168
L_mh15:
    s_cbranch_execz L_mh16
    s_waitcnt lgkmcnt(3)
    v_mfma_f32_16x16x32_bf16 v[108:111], v[8:11], v[32:35], v[108:111]
    ds_read_b128 v[28:31], v5 offset:16896
    v_cvt_pk_bf16_f32 v44, v73, v77
    v_mfma_f32_16x16x32_bf16 v[140:143], v[12:15], v[32:35], v[140:143]
    v_cvt_pk_bf16_f32 v45, v81, v85
    s_waitcnt lgkmcnt(3)
    v_mfma_f32_16x16x32_bf16 v[112:115], v[8:11], v[48:51], v[112:115]
    ds_read_b128 v[32:35], v5 offset:17408
    v_cvt_pk_bf16_f32 v46, v89, v93
    v_mfma_f32_16x16x32_bf16 v[144:147], v[12:15], v[48:51], v[144:147]
    ds_read_b128 v[16:19], v3 offset:36864
    v_cvt_pk_bf16_f32 v47, v97, v101
    s_waitcnt lgkmcnt(4)
    v_mfma_f32_16x16x32_bf16 v[116:119], v[8:11], v[36:39], v[116:119]
    ds_read_b128 v[48:51], v5 offset:17920
    buffer_store_dwordx4 v[44:47], v6, s[28:31], s36 offen sc1 nt
    v_mfma_f32_16x16x32_bf16 v[148:151], v[12:15], v[36:39], v[148:151]
    ds_read_b128 v[20:23], v3 offset:38912
    s_add_u32 s36, s36, 7168
    s_waitcnt lgkmcnt(5)
    v_mfma_f32_16x16x32_bf16 v[120:123], v[8:11], v[24:27], v[120:123]
    ds_read_b128 v[36:39], v4 offset:24576
    v_cvt_pk_bf16_f32 v40, v74, v78
    v_mfma_f32_16x16x32_bf16 v[152:155], v[12:15], v[24:27], v[152:155]
    v_cvt_pk_bf16_f32 v41, v82, v86
    s_waitcnt lgkmcnt(5)
    v_mfma_f32_16x16x32_bf16 v[124:127], v[8:11], v[28:31], v[124:127]
    ds_read_b128 v[24:27], v4 offset:25088
    v_cvt_pk_bf16_f32 v42, v90, v94
    v_mfma_f32_16x16x32_bf16 v[156:159], v[12:15], v[28:31], v[156:159]
    v_cvt_pk_bf16_f32 v43, v98, v102
    s_waitcnt lgkmcnt(5)
    v_mfma_f32_16x16x32_bf16 v[128:131], v[8:11], v[32:35], v[128:131]
    ds_read_b128 v[28:31], v4 offset:25600
    buffer_store_dwordx4 v[40:43], v6, s[28:31], s36 offen sc1 nt
    v_mfma_f32_16x16x32_bf16 v[160:163], v[12:15], v[32:35], v[160:163]
    s_add_u32 s36, s36, 7168
    s_waitcnt lgkmcnt(4)
    v_mfma_f32_16x16x32_bf16 v[132:135], v[8:11], v[48:51], v[132:135]
    ds_read_b128 v[8:11], v4 offset:26112
    v_cvt_pk_bf16_f32 v44, v75, v79
    v_mfma_f32_16x16x32_bf16 v[164:167], v[12:15], v[48:51], v[164:167]
    v_cvt_pk_bf16_f32 v45, v83, v87
    s_waitcnt lgkmcnt(3)
    v_mfma_f32_16x16x32_bf16 v[104:107], v[16:19], v[36:39], v[104:107]
    ds_read_b128 v[12:15], v5 offset:24576
    v_cvt_pk_bf16_f32 v46, v91, v95
L_mh16:
    s_cbranch_execz L_mh17
    v_mfma_f32_16x16x32_bf16 v[136:139], v[20:23], v[36:39], v[136:139]
    v_cvt_pk_bf16_f32 v47, v99, v103
    s_waitcnt lgkmcnt(3)
    v_mfma_f32_16x16x32_bf16 v[108:111], v[16:19], v[24:27], v[108:111]
    ds_read_b128 v[36:39], v5 offset:25088
    buffer_store_dwordx4 v[44:47], v6, s[28:31], s36 offen sc1 nt
    v_mfma_f32_16x16x32_bf16 v[140:143], v[20:23], v[24:27], v[140:143]
    ds_read_b128 v[48:51], v4 offset:49152
    s_add_u32 s36, s36, 93184
    s_waitcnt lgkmcnt(4)
    v_mfma_f32_16x16x32_bf16 v[112:115], v[16:19], v[28:31], v[112:115]
    ds_read_b128 v[80:83], v5 offset:25600
    v_mfma_f32_16x16x32_bf16 v[144:147], v[20:23], v[28:31], v[144:147]
    s_barrier
    ds_read_b128 v[24:27], v7 offset:4096
    s_waitcnt lgkmcnt(5)
    v_mfma_f32_16x16x32_bf16 v[116:119], v[16:19], v[8:11], v[116:119]
    ds_read_b128 v[28:31], v5 offset:26112
    v_mfma_f32_16x16x32_bf16 v[148:151], v[20:23], v[8:11], v[148:151]
    ds_read_b128 v[32:35], v0 offset:4096
    s_waitcnt lgkmcnt(6)
    v_mfma_f32_16x16x32_bf16 v[120:123], v[16:19], v[12:15], v[120:123]
    ds_read_b128 v[8:11], v4 offset:32768
    v_mfma_f32_16x16x32_bf16 v[152:155], v[20:23], v[12:15], v[152:155]
    ds_read_b128 v[12:15], v4 offset:33280
    s_waitcnt lgkmcnt(7)
    v_mfma_f32_16x16x32_bf16 v[124:127], v[16:19], v[36:39], v[124:127]
    ds_read_b128 v[84:87], v4 offset:33792
    v_mfma_f32_16x16x32_bf16 v[156:159], v[20:23], v[36:39], v[156:159]
    ds_read_b128 v[36:39], v4 offset:34304
    s_waitcnt lgkmcnt(7)
    v_mfma_f32_16x16x32_bf16 v[128:131], v[16:19], v[80:83], v[128:131]
    ds_read_b128 v[88:91], v5 offset:32768
    v_mfma_f32_16x16x32_bf16 v[160:163], v[20:23], v[80:83], v[160:163]
    ds_read_b128 v[80:83], v5 offset:33280
    s_waitcnt lgkmcnt(7)
    v_mfma_f32_16x16x32_bf16 v[132:135], v[16:19], v[28:31], v[132:135]
    ds_read_b128 v[16:19], v5 offset:33792
    v_mfma_f32_16x16x32_bf16 v[164:167], v[20:23], v[28:31], v[164:167]
    ds_read_b128 v[28:31], v5 offset:34304
    s_waitcnt lgkmcnt(7)
    v_mfma_f32_16x16x32_bf16 v[104:107], v[24:27], v[8:11], v[104:107]
    ds_read_b128 v[8:11], v4 offset:40960
    s_waitcnt lgkmcnt(7)
    v_mfma_f32_16x16x32_bf16 v[108:111], v[24:27], v[12:15], v[108:111]
    ds_read_b128 v[12:15], v4 offset:41472
    s_waitcnt lgkmcnt(7)
    v_mfma_f32_16x16x32_bf16 v[112:115], v[24:27], v[84:87], v[112:115]
L_mh17:
    s_cbranch_execz L_mhret
    ds_read_b128 v[84:87], v4 offset:41984
    s_waitcnt lgkmcnt(7)
    v_mfma_f32_16x16x32_bf16 v[116:119], v[24:27], v[36:39], v[116:119]
    ds_read_b128 v[36:39], v4 offset:42496
    s_waitcnt lgkmcnt(7)
    v_mfma_f32_16x16x32_bf16 v[120:123], v[24:27], v[88:91], v[120:123]
    ds_read_b128 v[88:91], v5 offset:40960
    s_waitcnt lgkmcnt(7)
    v_mfma_f32_16x16x32_bf16 v[124:127], v[24:27], v[80:83], v[124:127]
    ds_read_b128 v[80:83], v5 offset:41472
    s_waitcnt lgkmcnt(7)
    v_mfma_f32_16x16x32_bf16 v[128:131], v[24:27], v[16:19], v[128:131]
    ds_read_b128 v[16:19], v5 offset:41984
    s_waitcnt lgkmcnt(7)
    v_mfma_f32_16x16x32_bf16 v[132:135], v[24:27], v[28:31], v[132:135]
    ds_read_b128 v[24:27], v5 offset:42496
    s_waitcnt lgkmcnt(7)
    v_mfma_f32_16x16x32_bf16 v[104:107], v[32:35], v[8:11], v[104:107]
    ds_read_b128 v[20:23], v1 offset:32768
    s_waitcnt lgkmcnt(7)
    v_mfma_f32_16x16x32_bf16 v[108:111], v[32:35], v[12:15], v[108:111]
    ds_read_b128 v[12:15], v4 offset:49664
    s_waitcnt lgkmcnt(7)
    v_mfma_f32_16x16x32_bf16 v[112:115], v[32:35], v[84:87], v[112:115]
    ds_read_b128 v[84:87], v4 offset:50176
    s_waitcnt lgkmcnt(7)
    v_mfma_f32_16x16x32_bf16 v[116:119], v[32:35], v[36:39], v[116:119]
    ds_read_b128 v[36:39], v4 offset:50688
    s_waitcnt lgkmcnt(7)
    v_mfma_f32_16x16x32_bf16 v[120:123], v[32:35], v[88:91], v[120:123]
    ds_read_b128 v[88:91], v5 offset:49152
    s_waitcnt lgkmcnt(7)
    v_mfma_f32_16x16x32_bf16 v[124:127], v[32:35], v[80:83], v[124:127]
    ds_read_b128 v[80:83], v5 offset:49664
    s_waitcnt lgkmcnt(7)
    v_mfma_f32_16x16x32_bf16 v[128:131], v[32:35], v[16:19], v[128:131]
    ds_read_b128 v[16:19], v5 offset:50176
    s_waitcnt lgkmcnt(7)
    v_mfma_f32_16x16x32_bf16 v[132:135], v[32:35], v[24:27], v[132:135]
    ds_read_b128 v[24:27], v5 offset:50688
    s_waitcnt lgkmcnt(7)
    v_mfma_f32_16x16x32_bf16 v[104:107], v[20:23], v[48:51], v[104:107]
    ds_read_b128 v[8:11], v3 offset:32768
    s_waitcnt lgkmcnt(7)
    v_mfma_f32_16x16x32_bf16 v[108:111], v[20:23], v[12:15], v[108:111]
    ds_read_b128 v[32:35], v4 offset:57344
    s_waitcnt lgkmcnt(7)
    v_mfma_f32_16x16x32_bf16 v[112:115], v[20:23], v[84:87], v[112:115]
L_mh18:
    s_cbranch_execz L_mh19
    ds_read_b128 v[28:31], v4 offset:57856
    s_waitcnt lgkmcnt(7)
    v_mfma_f32_16x16x32_bf16 v[116:119], v[20:23], v[36:39], v[116:119]
    ds_read_b128 v[92:95], v4 offset:58368
    s_waitcnt lgkmcnt(7)
    v_mfma_f32_16x16x32_bf16 v[120:123], v[20:23], v[88:91], v[120:123]
    ds_read_b128 v[96:99], v4 offset:58880
    s_waitcnt lgkmcnt(7)
    v_mfma_f32_16x16x32_bf16 v[124:127], v[20:23], v[80:83], v[124:127]
    ds_read_b128 v[100:103], v5 offset:57344
    s_waitcnt lgkmcnt(7)
    v_mfma_f32_16x16x32_bf16 v[128:131], v[20:23], v[16:19], v[128:131]
    ds_read_b128 v[52:55], v5 offset:57856
    s_waitcnt lgkmcnt(7)
    v_mfma_f32_16x16x32_bf16 v[132:135], v[20:23], v[24:27], v[132:135]
    ds_read_b128 v[56:59], v5 offset:58368
    s_waitcnt lgkmcnt(6)
    v_mfma_f32_16x16x32_bf16 v[104:107], v[8:11], v[32:35], v[104:107]
    ds_read_b128 v[20:23], v5 offset:58880
    s_waitcnt lgkmcnt(6)
    v_mfma_f32_16x16x32_bf16 v[108:111], v[8:11], v[28:31], v[108:111]
    ds_read_b128 v[60:63], v1 offset:34816
    s_waitcnt lgkmcnt(6)
    v_mfma_f32_16x16x32_bf16 v[112:115], v[8:11], v[92:95], v[112:115]
    s_waitcnt lgkmcnt(5)
    v_mfma_f32_16x16x32_bf16 v[116:119], v[8:11], v[96:99], v[116:119]
    s_waitcnt lgkmcnt(4)
    v_mfma_f32_16x16x32_bf16 v[120:123], v[8:11], v[100:103], v[120:123]
    s_waitcnt lgkmcnt(3)
    v_mfma_f32_16x16x32_bf16 v[124:127], v[8:11], v[52:55], v[124:127]
    s_waitcnt lgkmcnt(2)
    v_mfma_f32_16x16x32_bf16 v[128:131], v[8:11], v[56:59], v[128:131]
    ds_read_b128 v[64:67], v3 offset:34816
    s_waitcnt lgkmcnt(2)
    v_mfma_f32_16x16x32_bf16 v[132:135], v[8:11], v[20:23], v[132:135]
    s_waitcnt lgkmcnt(1)
    v_mfma_f32_16x16x32_bf16 v[136:139], v[60:63], v[48:51], v[136:139]
    v_mfma_f32_16x16x32_bf16 v[140:143], v[60:63], v[12:15], v[140:143]
    v_mfma_f32_16x16x32_bf16 v[144:147], v[60:63], v[84:87], v[144:147]
    v_mfma_f32_16x16x32_bf16 v[148:151], v[60:63], v[36:39], v[148:151]
    v_mfma_f32_16x16x32_bf16 v[152:155], v[60:63], v[88:91], v[152:155]
    v_mfma_f32_16x16x32_bf16 v[156:159], v[60:63], v[80:83], v[156:159]
    v_cvt_pk_bf16_f32 v72, v104, v108
    v_mfma_f32_16x16x32_bf16 v[160:163], v[60:63], v[16:19], v[160:163]
    ds_read_b128 v[16:19], v7 offset:6144
    v_cvt_pk_bf16_f32 v73, v112, v116
    v_mfma_f32_16x16x32_bf16 v[164:167], v[60:63], v[24:27], v[164:167]
    ds_read_b128 v[8:11], v0 offset:6144
L_mh19:
    s_cbranch_execz L_mh20
    v_cvt_pk_bf16_f32 v74, v120, v124
    s_waitcnt lgkmcnt(2)
    v_mfma_f32_16x16x32_bf16 v[136:139], v[64:67], v[32:35], v[136:139]
    ds_read_b128 v[32:35], v4 offset:32768
    v_cvt_pk_bf16_f32 v75, v128, v132
    v_mfma_f32_16x16x32_bf16 v[140:143], v[64:67], v[28:31], v[140:143]
    ds_read_b128 v[28:31], v4 offset:33280
    buffer_store_dwordx4 v[72:75], v6, s[28:31], s36 offen sc1 nt
    v_mfma_f32_16x16x32_bf16 v[144:147], v[64:67], v[92:95], v[144:147]
    ds_read_b128 v[92:95], v4 offset:33792
    s_add_u32 s36, s36, 7168
    v_mfma_f32_16x16x32_bf16 v[148:151], v[64:67], v[96:99], v[148:151]
    ds_read_b128 v[96:99], v4 offset:34304
    v_cvt_pk_bf16_f32 v76, v105, v109
    v_mfma_f32_16x16x32_bf16 v[152:155], v[64:67], v[100:103], v[152:155]
    ds_read_b128 v[100:103], v5 offset:32768
    v_cvt_pk_bf16_f32 v77, v113, v117
    v_mfma_f32_16x16x32_bf16 v[156:159], v[64:67], v[52:55], v[156:159]
    ds_read_b128 v[52:55], v5 offset:33280
    v_cvt_pk_bf16_f32 v78, v121, v125
    v_mfma_f32_16x16x32_bf16 v[160:163], v[64:67], v[56:59], v[160:163]
    ds_read_b128 v[56:59], v5 offset:33792
    v_cvt_pk_bf16_f32 v79, v129, v133
    v_mfma_f32_16x16x32_bf16 v[164:167], v[64:67], v[20:23], v[164:167]
    ds_read_b128 v[20:23], v5 offset:34304
    buffer_store_dwordx4 v[76:79], v6, s[28:31], s36 offen sc1 nt
    s_waitcnt lgkmcnt(7)
    v_mfma_f32_16x16x32_bf16 v[136:139], v[16:19], v[32:35], v[136:139]
    ds_read_b128 v[32:35], v4 offset:40960
    s_add_u32 s36, s36, 7168
    s_waitcnt lgkmcnt(7)
    v_mfma_f32_16x16x32_bf16 v[140:143], v[16:19], v[28:31], v[140:143]
    ds_read_b128 v[28:31], v4 offset:41472
    v_cvt_pk_bf16_f32 v72, v106, v110
    s_waitcnt lgkmcnt(7)
    v_mfma_f32_16x16x32_bf16 v[144:147], v[16:19], v[92:95], v[144:147]
    ds_read_b128 v[92:95], v4 offset:41984
    v_cvt_pk_bf16_f32 v73, v114, v118
    s_waitcnt lgkmcnt(7)
    v_mfma_f32_16x16x32_bf16 v[148:151], v[16:19], v[96:99], v[148:151]
    ds_read_b128 v[96:99], v4 offset:42496
    v_cvt_pk_bf16_f32 v74, v122, v126
    s_waitcnt lgkmcnt(7)
    v_mfma_f32_16x16x32_bf16 v[152:155], v[16:19], v[100:103], v[152:155]
    ds_read_b128 v[100:103], v5 offset:40960
    v_cvt_pk_bf16_f32 v75, v130, v134
    s_waitcnt lgkmcnt(7)
    v_mfma_f32_16x16x32_bf16 v[156:159], v[16:19], v[52:55], v[156:159]
L_mh20:
    s_cbranch_execz L_mh21
    ds_read_b128 v[52:55], v5 offset:41472
    buffer_store_dwordx4 v[72:75], v6, s[28:31], s36 offen sc1 nt
    s_waitcnt lgkmcnt(7)
    v_mfma_f32_16x16x32_bf16 v[160:163], v[16:19], v[56:59], v[160:163]
    ds_read_b128 v[56:59], v5 offset:41984
    s_add_u32 s36, s36, 7168
    s_waitcnt lgkmcnt(7)
    v_mfma_f32_16x16x32_bf16 v[164:167], v[16:19], v[20:23], v[164:167]
    ds_read_b128 v[16:19], v5 offset:42496
    v_cvt_pk_bf16_f32 v76, v107, v111
    s_waitcnt lgkmcnt(7)
    v_mfma_f32_16x16x32_bf16 v[136:139], v[8:11], v[32:35], v[136:139]
    v_cvt_pk_bf16_f32 v77, v115, v119
    s_waitcnt lgkmcnt(6)
    v_mfma_f32_16x16x32_bf16 v[140:143], v[8:11], v[28:31], v[140:143]
    v_cvt_pk_bf16_f32 v78, v123, v127
    s_waitcnt lgkmcnt(5)
    v_mfma_f32_16x16x32_bf16 v[144:147], v[8:11], v[92:95], v[144:147]
    v_cvt_pk_bf16_f32 v79, v131, v135
    s_waitcnt lgkmcnt(4)
    v_mfma_f32_16x16x32_bf16 v[148:151], v[8:11], v[96:99], v[148:151]
    buffer_store_dwordx4 v[76:79], v6, s[28:31], s36 offen sc1 nt
    s_waitcnt lgkmcnt(3)
    v_mfma_f32_16x16x32_bf16 v[152:155], v[8:11], v[100:103], v[152:155]
    s_add_u32 s36, s36, 93184
    s_waitcnt lgkmcnt(2)
    v_mfma_f32_16x16x32_bf16 v[156:159], v[8:11], v[52:55], v[156:159]
    s_waitcnt lgkmcnt(1)
    v_mfma_f32_16x16x32_bf16 v[160:163], v[8:11], v[56:59], v[160:163]
    s_waitcnt lgkmcnt(0)
    v_mfma_f32_16x16x32_bf16 v[164:167], v[8:11], v[16:19], v[164:167]
    s_nop 7
    v_cvt_pk_bf16_f32 v32, v136, v140
    v_cvt_pk_bf16_f32 v33, v144, v148
    v_cvt_pk_bf16_f32 v34, v152, v156
    v_cvt_pk_bf16_f32 v35, v160, v164
    buffer_store_dwordx4 v[32:35], v6, s[28:31], s36 offen sc1 nt
    s_add_u32 s36, s36, 7168
    v_cvt_pk_bf16_f32 v36, v137, v141
    v_cvt_pk_bf16_f32 v37, v145, v149
    v_cvt_pk_bf16_f32 v38, v153, v157
    v_cvt_pk_bf16_f32 v39, v161, v165
    buffer_store_dwordx4 v[36:39], v6, s[28:31], s36 offen sc1 nt
    s_add_u32 s36, s36, 7168
    v_cvt_pk_bf16_f32 v32, v138, v142
    v_cvt_pk_bf16_f32 v33, v146, v150
    v_cvt_pk_bf16_f32 v34, v154, v158
    v_cvt_pk_bf16_f32 v35, v162, v166
L_mh21:
    s_cbranch_execz L_mhret
    buffer_store_dwordx4 v[32:35], v6, s[28:31], s36 offen sc1 nt
    s_add_u32 s36, s36, 7168
    v_cvt_pk_bf16_f32 v36, v139, v143
    v_cvt_pk_bf16_f32 v37, v147, v151
    v_cvt_pk_bf16_f32 v38, v155, v159
    v_cvt_pk_bf16_f32 v39, v163, v167
    buffer_store_dwordx4 v[36:39], v6, s[28:31], s36 offen sc1 nt
    s_add_u32 s36, s36, 93184
L_done:
    s_endpgm
    .p2align 6
L_hloop:
    s_cbranch_execz L_hopret
    s_setprio 1
    s_lshl_b32 s50, s49, 2
    s_lshr_b64 s[50:51], s[82:83], s50
    s_and_b32 s50, s50, 15
    s_lshl_b32 s53, s55, 15
    s_add_u32 s53, s53, s44
    s_and_b32 s41, s49, 3
    s_lshl_b32 s41, s41, 14
    s_sub_u32 s35, s55, 1
    s_cselect_b32 s55, 2, s35
    s_add_u32 s92, s49, 2
    s_lshl_b32 s86, s92, 2
    s_lshr_b64 s[86:87], s[82:83], s86
    s_and_b32 s86, s86, 15
    s_xor_b32 s88, s41, 32768
    s_cmp_eq_u32 s91, 1
    s_cbranch_scc1 L_hx1
    s_bitcmp1_b32 s38, s50
    s_cbranch_scc1 L_hx
    s_cmp_lt_u32 s49, s93
    s_cbranch_scc1 L_hn
    buffer_load_dword v14, v12, s[68:71], 0 offen sc0 sc1
    s_mov_b32 m0, s53
    s_lshl_b32 s42, s50, 7
    buffer_load_dwordx4 v9, s[16:19], s42 offen offset:0 lds
    s_add_u32 s42, s42, s98
    buffer_load_dwordx4 v10, s[16:19], s42 offen offset:1024 lds
    s_add_u32 s42, s42, s98
    buffer_load_dwordx4 v9, s[16:19], s42 offen offset:2048 lds
    s_add_u32 s42, s42, s98
    buffer_load_dwordx4 v10, s[16:19], s42 offen offset:3072 lds
    s_waitcnt vmcnt(4)
    v_cmp_ne_u32 vcc, v14, v13
    s_nop 4
    s_and_b32 s35, vcc_lo, 0xffff
    s_or_b32 s38, s38, s35
    s_bitcmp1_b32 s38, s50
    s_cbranch_scc1 L_hw
    s_branch L_hn1
L_hn:
    s_mov_b32 m0, s53
    s_lshl_b32 s42, s50, 7
    buffer_load_dwordx4 v9, s[16:19], s42 offen offset:0 lds
    s_add_u32 s42, s42, s98
    buffer_load_dwordx4 v10, s[16:19], s42 offen offset:1024 lds
    s_add_u32 s42, s42, s98
    buffer_load_dwordx4 v9, s[16:19], s42 offen offset:2048 lds
    s_add_u32 s42, s42, s98
    buffer_load_dwordx4 v10, s[16:19], s42 offen offset:3072 lds
L_hn1:
    s_cmp_ge_u32 s49, 14
    s_cbranch_scc1 L_hn2
    s_add_u32 m0, s53, 4096
    s_add_u32 s42, s42, s99
    buffer_load_dwordx4 v9, s[16:19], s42 offen offset:0 lds
    s_add_u32 s42, s42, s98
    buffer_load_dwordx4 v10, s[16:19], s42 offen offset:1024 lds
    s_add_u32 s42, s42, s98
    buffer_load_dwordx4 v9, s[16:19], s42 offen offset:2048 lds
    s_add_u32 s42, s42, s98
    buffer_load_dwordx4 v10, s[16:19], s42 offen offset:3072 lds
L_hn2:
    s_mov_b32 s54, 2
    s_mul_i32 s43, s50, 917504
    tbuffer_load_format_d16_xyzw v[72:73], v8, s[20:23], s43 format:[BUF_DATA_FORMAT_32_32_32_32,BUF_NUM_FORMAT_UINT] offen
    s_add_u32 s43, s43, s97
    tbuffer_load_format_d16_xyzw v[74:75], v8, s[20:23], s43 format:[BUF_DATA_FORMAT_32_32_32_32,BUF_NUM_FORMAT_UINT] offen
    s_add_u32 s43, s43, s97
    tbuffer_load_format_d16_xyzw v[76:77], v8, s[20:23], s43 format:[BUF_DATA_FORMAT_32_32_32_32,BUF_NUM_FORMAT_UINT] offen
    s_add_u32 s43, s43, s97
    tbuffer_load_format_d16_xyzw v[78:79], v8, s[20:23], s43 format:[BUF_DATA_FORMAT_32_32_32_32,BUF_NUM_FORMAT_UINT] offen
    s_add_u32 s43, s43, s97
    tbuffer_load_format_d16_xyzw v[80:81], v8, s[20:23], s43 format:[BUF_DATA_FORMAT_32_32_32_32,BUF_NUM_FORMAT_UINT] offen
    s_add_u32 s43, s43, s97
    tbuffer_load_format_d16_xyzw v[82:83], v8, s[20:23], s43 format:[BUF_DATA_FORMAT_32_32_32_32,BUF_NUM_FORMAT_UINT] offen
    s_add_u32 s43, s43, s97
    tbuffer_load_format_d16_xyzw v[84:85], v8, s[20:23], s43 format:[BUF_DATA_FORMAT_32_32_32_32,BUF_NUM_FORMAT_UINT] offen
    s_add_u32 s43, s43, s97
    tbuffer_load_format_d16_xyzw v[86:87], v8, s[20:23], s43 format:[BUF_DATA_FORMAT_32_32_32_32,BUF_NUM_FORMAT_UINT] offen
    s_branch L_hp
L_hx:
    s_cbranch_execz L_hopret
    s_lshl_b32 s43, s50, 14
    s_add_u32 m0, s45, s41
    s_nop 0
    buffer_load_dwordx4 v15, s[68:71], s43 offen offset:0 sc1 lds
    buffer_load_dwordx4 v15, s[68:71], s43 offen offset:1024 sc1 lds
    buffer_load_dwordx4 v15, s[68:71], s43 offen offset:2048 sc1 lds
    buffer_load_dwordx4 v15, s[68:71], s43 offen offset:3072 sc1 lds
L_hx1:
    s_mov_b32 m0, s53
    s_lshl_b32 s42, s50, 7
    buffer_load_dwordx4 v9, s[16:19], s42 offen offset:0 lds
    s_add_u32 s42, s42, s98
    buffer_load_dwordx4 v10, s[16:19], s42 offen offset:1024 lds
    s_add_u32 s42, s42, s98
    buffer_load_dwordx4 v9, s[16:19], s42 offen offset:2048 lds
    s_add_u32 s42, s42, s98
    buffer_load_dwordx4 v10, s[16:19], s42 offen offset:3072 lds
    s_branch L_hw1
L_hw:
    s_lshl_b32 s43, s50, 14
    s_add_u32 m0, s45, s41
    s_nop 0
    buffer_load_dwordx4 v15, s[68:71], s43 offen offset:0 sc1 lds
    buffer_load_dwordx4 v15, s[68:71], s43 offen offset:1024 sc1 lds
    buffer_load_dwordx4 v15, s[68:71], s43 offen offset:2048 sc1 lds
    buffer_load_dwordx4 v15, s[68:71], s43 offen offset:3072 sc1 lds
L_hw1:
    s_mov_b32 s54, 0
L_hy:
    s_cmp_ge_u32 s49, 14
    s_cbranch_scc1 L_hb
    s_add_u32 m0, s53, 4096
    s_add_u32 s42, s42, s99
    buffer_load_dwordx4 v9, s[16:19], s42 offen offset:0 lds
    s_add_u32 s42, s42, s98
    buffer_load_dwordx4 v10, s[16:19], s42 offen offset:1024 lds
    s_add_u32 s42, s42, s98
    buffer_load_dwordx4 v9, s[16:19], s42 offen offset:2048 lds
    s_add_u32 s42, s42, s98
    buffer_load_dwordx4 v10, s[16:19], s42 offen offset:3072 lds
L_hp:
    s_cmp_lt_u32 s92, s93
    s_cbranch_scc1 L_hb
    s_cmp_ge_u32 s92, 16
    s_cbranch_scc1 L_hb
    s_bitcmp1_b32 s38, s86
    s_cbranch_scc1 L_hb
    buffer_load_dword v14, v12, s[68:71], 0 offen sc0 sc1
    s_or_b32 s54, s54, 4
L_hb:
    s_barrier
    s_mov_b32 s91, 0
    s_cmp_lt_u32 s49, 14
    s_cbranch_scc1 L_hb2
    s_cmp_lg_u32 s54, 0
    s_cbranch_scc1 L_hb2
    s_cmp_eq_u32 s49, 15
    s_cselect_b32 s35, 28672, 0
    s_add_u32 s53, s53, s35
    s_add_u32 m0, s53, 4096
    s_add_u32 s42, s42, s99
    buffer_load_dwordx4 v9, s[16:19], s42 offen offset:0 lds
    s_add_u32 s42, s42, s98
    buffer_load_dwordx4 v10, s[16:19], s42 offen offset:1024 lds
    s_add_u32 s42, s42, s98
    buffer_load_dwordx4 v9, s[16:19], s42 offen offset:2048 lds
    s_add_u32 s42, s42, s98
    buffer_load_dwordx4 v10, s[16:19], s42 offen offset:3072 lds
    s_waitcnt vmcnt(4)
    s_barrier
    s_cmp_eq_u32 s49, 15
    s_cbranch_scc1 L_hb3
    s_barrier
L_hb3:
    s_waitcnt vmcnt(0)
    s_barrier
    s_branch L_hend
L_hb2:
    s_and_b32 s35, s54, 3
    s_cbranch_scc0 L_hf
L_hq:
    v_add_u32 v17, s41, v11
    s_setprio 2
    s_waitcnt vmcnt(4)
L_hq0:
    s_cbranch_execz L_hopret
    v_lshl_or_b32 v88, v74, 8, v72
    v_lshl_or_b32 v89, v78, 8, v76
    v_perm_b32 v96, v89, v88, s84
    v_perm_b32 v102, v89, v88, s85
    v_xor_b32 v97, s58, v96
    v_xor_b32 v103, s58, v102
    v_perm_b32 v98, v41, v40, v96
    v_perm_b32 v104, v49, v48, v102
    v_perm_b32 v100, v45, v44, v96
    v_perm_b32 v106, v53, v52, v102
    v_perm_b32 v99, v43, v42, v97
    v_perm_b32 v105, v51, v50, v103
    v_perm_b32 v101, v47, v46, v97
    v_perm_b32 v107, v55, v54, v103
    v_xor_b32 v98, v98, v99
    v_xor_b32 v104, v104, v105
    v_xor_b32 v100, v100, v101
    v_xor_b32 v106, v106, v107
    v_perm_b32 v24, v100, v98, s46
    v_perm_b32 v28, v106, v104, s46
    v_perm_b32 v25, v100, v98, s47
    v_perm_b32 v29, v106, v104, s47
    v_lshl_or_b32 v88, v75, 8, v73
    v_lshl_or_b32 v89, v79, 8, v77
    v_perm_b32 v96, v89, v88, s84
    v_perm_b32 v102, v89, v88, s85
    v_xor_b32 v97, s58, v96
    v_xor_b32 v103, s58, v102
    v_perm_b32 v98, v57, v56, v96
    v_perm_b32 v104, v65, v64, v102
    v_perm_b32 v100, v61, v60, v96
    v_perm_b32 v106, v69, v68, v102
    v_perm_b32 v99, v59, v58, v97
    v_perm_b32 v105, v67, v66, v103
    v_perm_b32 v101, v63, v62, v97
    v_perm_b32 v107, v71, v70, v103
    v_xor_b32 v98, v98, v99
    v_xor_b32 v104, v104, v105
    v_xor_b32 v100, v100, v101
    v_xor_b32 v106, v106, v107
    v_perm_b32 v32, v100, v98, s46
    v_perm_b32 v36, v106, v104, s46
    v_perm_b32 v33, v100, v98, s47
    v_perm_b32 v37, v106, v104, s47
    s_bitcmp1_b32 s54, 3
    s_cbranch_scc1 L_hq2
    s_bitcmp1_b32 s54, 2
    s_cbranch_scc1 L_hq1
    s_waitcnt vmcnt(0)
L_hq1:
    s_waitcnt vmcnt(1)
L_hq2:
    s_cbranch_execz L_hopret
    v_lshl_or_b32 v90, v82, 8, v80
    v_lshl_or_b32 v91, v86, 8, v84
    v_perm_b32 v96, v91, v90, s84
    v_perm_b32 v102, v91, v90, s85
    v_xor_b32 v97, s58, v96
    v_xor_b32 v103, s58, v102
    v_perm_b32 v98, v41, v40, v96
    v_perm_b32 v104, v49, v48, v102
    v_perm_b32 v100, v45, v44, v96
    v_perm_b32 v106, v53, v52, v102
    v_perm_b32 v99, v43, v42, v97
    v_perm_b32 v105, v51, v50, v103
    v_perm_b32 v101, v47, v46, v97
    v_perm_b32 v107, v55, v54, v103
    v_xor_b32 v98, v98, v99
    v_xor_b32 v104, v104, v105
    v_xor_b32 v100, v100, v101
    v_xor_b32 v106, v106, v107
    v_perm_b32 v26, v100, v98, s46
    v_perm_b32 v30, v106, v104, s46
    v_perm_b32 v27, v100, v98, s47
    v_perm_b32 v31, v106, v104, s47
    v_lshl_or_b32 v90, v83, 8, v81
    v_lshl_or_b32 v91, v87, 8, v85
    v_perm_b32 v96, v91, v90, s84
    v_perm_b32 v102, v91, v90, s85
    v_xor_b32 v97, s58, v96
    v_xor_b32 v103, s58, v102
    v_perm_b32 v98, v57, v56, v96
    v_perm_b32 v104, v65, v64, v102
    v_perm_b32 v100, v61, v60, v96
    v_perm_b32 v106, v69, v68, v102
    v_perm_b32 v99, v59, v58, v97
    v_perm_b32 v105, v67, v66, v103
    v_perm_b32 v101, v63, v62, v97
    v_perm_b32 v107, v71, v70, v103
    v_xor_b32 v98, v98, v99
    v_xor_b32 v104, v104, v105
    v_xor_b32 v100, v100, v101
    v_xor_b32 v106, v106, v107
    v_perm_b32 v34, v100, v98, s46
    v_perm_b32 v38, v106, v104, s46
    v_perm_b32 v35, v100, v98, s47
    v_perm_b32 v39, v106, v104, s47
    ds_write_b128 v17, v[24:27] offset:0
    ds_write_b128 v17, v[28:31] offset:512
    ds_write_b128 v17, v[32:35] offset:1024
    ds_write_b128 v17, v[36:39] offset:1536
L_hg:
    s_cbranch_execz L_hopret
    s_bitcmp1_b32 s54, 2
    s_cbranch_scc0 L_hf0
    s_waitcnt vmcnt(0)
    v_cmp_ne_u32 vcc, v14, v13
    s_nop 4
    s_and_b32 s35, vcc_lo, 0xffff
    s_or_b32 s38, s38, s35
    s_branch L_hf0
L_hf:
    s_bitcmp1_b32 s54, 2
    s_cbranch_scc0 L_hf1
    s_waitcnt vmcnt(0)
    v_cmp_ne_u32 vcc, v14, v13
    s_nop 4
    s_and_b32 s35, vcc_lo, 0xffff
    s_or_b32 s38, s38, s35
L_hf1:
    s_sub_u32 s35, s92, 0
    s_cmp_ge_u32 s35, 16
    s_cbranch_scc1 L_hf0
    s_bitcmp1_b32 s38, s86
    s_cbranch_scc0 L_hf0
    s_lshl_b32 s43, s86, 14
    s_add_u32 m0, s45, s88
    s_nop 0
    buffer_load_dwordx4 v15, s[68:71], s43 offen offset:0 sc1 lds
    buffer_load_dwordx4 v15, s[68:71], s43 offen offset:1024 sc1 lds
    buffer_load_dwordx4 v15, s[68:71], s43 offen offset:2048 sc1 lds
    buffer_load_dwordx4 v15, s[68:71], s43 offen offset:3072 sc1 lds
    s_mov_b32 s91, 1
    s_waitcnt vmcnt(4) lgkmcnt(0)
    s_branch L_hz
L_hf0:
    s_waitcnt vmcnt(0) lgkmcnt(0)
L_hz:
    s_barrier
    s_mov_b32 s49, s92
    s_cmp_lt_u32 s49, 16
    s_cbranch_scc1 L_hloop
    s_cmp_eq_u32 s49, 17
    s_cselect_b32 s35, 28672, 0
    s_add_u32 s53, s53, s35
    s_add_u32 m0, s53, 4096
    s_add_u32 s42, s42, s99
    buffer_load_dwordx4 v9, s[16:19], s42 offen offset:0 lds
    s_add_u32 s42, s42, s98
    buffer_load_dwordx4 v10, s[16:19], s42 offen offset:1024 lds
    s_add_u32 s42, s42, s98
    buffer_load_dwordx4 v9, s[16:19], s42 offen offset:2048 lds
    s_add_u32 s42, s42, s98
    buffer_load_dwordx4 v10, s[16:19], s42 offen offset:3072 lds
    s_cmp_eq_u32 s49, 17
    s_cbranch_scc1 L_hb4
    s_barrier
L_hb4:
    s_waitcnt vmcnt(0)
    s_barrier
L_hend:
    s_endpgm
L_prod:
    s_cbranch_execz L_hopret
    s_cmp_lt_u32 s32, 8
    s_cbranch_scc1 L_prod1
    s_lshl_b32 s50, s49, 2
    s_lshr_b64 s[50:51], s[82:83], s50
    s_and_b32 s50, s50, 15
    s_mul_i32 s43, s50, 917504
    tbuffer_load_format_d16_xyzw v[72:73], v8, s[20:23], s43 format:[BUF_DATA_FORMAT_32_32_32_32,BUF_NUM_FORMAT_UINT] offen
    s_add_u32 s43, s43, s97
    tbuffer_load_format_d16_xyzw v[74:75], v8, s[20:23], s43 format:[BUF_DATA_FORMAT_32_32_32_32,BUF_NUM_FORMAT_UINT] offen
    s_add_u32 s43, s43, s97
    tbuffer_load_format_d16_xyzw v[76:77], v8, s[20:23], s43 format:[BUF_DATA_FORMAT_32_32_32_32,BUF_NUM_FORMAT_UINT] offen
    s_add_u32 s43, s43, s97
    tbuffer_load_format_d16_xyzw v[78:79], v8, s[20:23], s43 format:[BUF_DATA_FORMAT_32_32_32_32,BUF_NUM_FORMAT_UINT] offen
    s_add_u32 s43, s43, s97
    tbuffer_load_format_d16_xyzw v[80:81], v8, s[20:23], s43 format:[BUF_DATA_FORMAT_32_32_32_32,BUF_NUM_FORMAT_UINT] offen
    s_add_u32 s43, s43, s97
    tbuffer_load_format_d16_xyzw v[82:83], v8, s[20:23], s43 format:[BUF_DATA_FORMAT_32_32_32_32,BUF_NUM_FORMAT_UINT] offen
    s_add_u32 s43, s43, s97
    tbuffer_load_format_d16_xyzw v[84:85], v8, s[20:23], s43 format:[BUF_DATA_FORMAT_32_32_32_32,BUF_NUM_FORMAT_UINT] offen
    s_add_u32 s43, s43, s97
    tbuffer_load_format_d16_xyzw v[86:87], v8, s[20:23], s43 format:[BUF_DATA_FORMAT_32_32_32_32,BUF_NUM_FORMAT_UINT] offen
L_prod1:
    s_waitcnt vmcnt(4) lgkmcnt(0)
L_ploop:
    s_cbranch_execz L_hopret
    v_lshl_or_b32 v88, v74, 8, v72
    v_lshl_or_b32 v89, v78, 8, v76
    v_perm_b32 v96, v89, v88, s84
    v_perm_b32 v102, v89, v88, s85
    v_xor_b32 v97, s58, v96
    v_xor_b32 v103, s58, v102
    v_perm_b32 v98, v41, v40, v96
    v_perm_b32 v104, v49, v48, v102
    v_perm_b32 v100, v45, v44, v96
    v_perm_b32 v106, v53, v52, v102
    v_perm_b32 v99, v43, v42, v97
    v_perm_b32 v105, v51, v50, v103
    v_perm_b32 v101, v47, v46, v97
    v_perm_b32 v107, v55, v54, v103
    v_xor_b32 v98, v98, v99
    v_xor_b32 v104, v104, v105
    v_xor_b32 v100, v100, v101
    v_xor_b32 v106, v106, v107
    v_perm_b32 v24, v100, v98, s46
    v_perm_b32 v28, v106, v104, s46
    v_perm_b32 v25, v100, v98, s47
    v_perm_b32 v29, v106, v104, s47
    v_lshl_or_b32 v88, v75, 8, v73
    v_lshl_or_b32 v89, v79, 8, v77
    v_perm_b32 v96, v89, v88, s84
    v_perm_b32 v102, v89, v88, s85
    v_xor_b32 v97, s58, v96
    v_xor_b32 v103, s58, v102
    v_perm_b32 v98, v57, v56, v96
    v_perm_b32 v104, v65, v64, v102
    v_perm_b32 v100, v61, v60, v96
    v_perm_b32 v106, v69, v68, v102
    v_perm_b32 v99, v59, v58, v97
    v_perm_b32 v105, v67, v66, v103
    v_perm_b32 v101, v63, v62, v97
    v_perm_b32 v107, v71, v70, v103
    v_xor_b32 v98, v98, v99
    v_xor_b32 v104, v104, v105
    v_xor_b32 v100, v100, v101
    v_xor_b32 v106, v106, v107
    v_perm_b32 v32, v100, v98, s46
    v_perm_b32 v36, v106, v104, s46
    v_perm_b32 v33, v100, v98, s47
    v_perm_b32 v37, v106, v104, s47
    s_waitcnt vmcnt(0)
L_pmid:
    s_cbranch_execz L_hopret
    v_lshl_or_b32 v90, v82, 8, v80
    v_lshl_or_b32 v91, v86, 8, v84
    v_perm_b32 v96, v91, v90, s84
    v_perm_b32 v102, v91, v90, s85
    v_xor_b32 v97, s58, v96
    v_xor_b32 v103, s58, v102
    v_perm_b32 v98, v41, v40, v96
    v_perm_b32 v104, v49, v48, v102
    v_perm_b32 v100, v45, v44, v96
    v_perm_b32 v106, v53, v52, v102
    v_perm_b32 v99, v43, v42, v97
    v_perm_b32 v105, v51, v50, v103
    v_perm_b32 v101, v47, v46, v97
    v_perm_b32 v107, v55, v54, v103
    v_xor_b32 v98, v98, v99
    v_xor_b32 v104, v104, v105
    v_xor_b32 v100, v100, v101
    v_xor_b32 v106, v106, v107
    v_perm_b32 v26, v100, v98, s46
    v_perm_b32 v30, v106, v104, s46
    v_perm_b32 v27, v100, v98, s47
    v_perm_b32 v31, v106, v104, s47
    v_lshl_or_b32 v90, v83, 8, v81
    v_lshl_or_b32 v91, v87, 8, v85
    v_perm_b32 v96, v91, v90, s84
    v_perm_b32 v102, v91, v90, s85
    v_xor_b32 v97, s58, v96
    v_xor_b32 v103, s58, v102
    v_perm_b32 v98, v57, v56, v96
    v_perm_b32 v104, v65, v64, v102
    v_perm_b32 v100, v61, v60, v96
    v_perm_b32 v106, v69, v68, v102
    v_perm_b32 v99, v59, v58, v97
    v_perm_b32 v105, v67, v66, v103
    v_perm_b32 v101, v63, v62, v97
    v_perm_b32 v107, v71, v70, v103
    v_xor_b32 v98, v98, v99
    v_xor_b32 v104, v104, v105
    v_xor_b32 v100, v100, v101
    v_xor_b32 v106, v106, v107
    v_perm_b32 v34, v100, v98, s46
    v_perm_b32 v38, v106, v104, s46
    v_perm_b32 v35, v100, v98, s47
    v_perm_b32 v39, v106, v104, s47
L_ppub:
    s_cbranch_execz L_hopret
    s_lshl_b32 s52, s50, 14
    s_lshl_b64 s[36:37], 1, s50
    buffer_store_dwordx4 v[24:27], v20, s[68:71], s52 offen offset:0 sc1
    buffer_store_dwordx4 v[28:31], v20, s[68:71], s52 offen offset:512 sc1
    buffer_store_dwordx4 v[32:35], v20, s[68:71], s52 offen offset:1024 sc1
    buffer_store_dwordx4 v[36:39], v20, s[68:71], s52 offen offset:1536 sc1
    v_not_b32 v16, v13
    s_add_u32 s49, s49, 2
    s_cmp_ge_u32 s49, 16
    s_cbranch_scc1 L_plast
    s_lshl_b32 s50, s49, 2
    s_lshr_b64 s[50:51], s[82:83], s50
    s_and_b32 s50, s50, 15
    s_mul_i32 s43, s50, 917504
    tbuffer_load_format_d16_xyzw v[72:73], v8, s[20:23], s43 format:[BUF_DATA_FORMAT_32_32_32_32,BUF_NUM_FORMAT_UINT] offen
    s_add_u32 s43, s43, s97
    tbuffer_load_format_d16_xyzw v[74:75], v8, s[20:23], s43 format:[BUF_DATA_FORMAT_32_32_32_32,BUF_NUM_FORMAT_UINT] offen
    s_add_u32 s43, s43, s97
    tbuffer_load_format_d16_xyzw v[76:77], v8, s[20:23], s43 format:[BUF_DATA_FORMAT_32_32_32_32,BUF_NUM_FORMAT_UINT] offen
    s_add_u32 s43, s43, s97
    tbuffer_load_format_d16_xyzw v[78:79], v8, s[20:23], s43 format:[BUF_DATA_FORMAT_32_32_32_32,BUF_NUM_FORMAT_UINT] offen
    s_add_u32 s43, s43, s97
    tbuffer_load_format_d16_xyzw v[80:81], v8, s[20:23], s43 format:[BUF_DATA_FORMAT_32_32_32_32,BUF_NUM_FORMAT_UINT] offen
    s_add_u32 s43, s43, s97
    tbuffer_load_format_d16_xyzw v[82:83], v8, s[20:23], s43 format:[BUF_DATA_FORMAT_32_32_32_32,BUF_NUM_FORMAT_UINT] offen
    s_add_u32 s43, s43, s97
    tbuffer_load_format_d16_xyzw v[84:85], v8, s[20:23], s43 format:[BUF_DATA_FORMAT_32_32_32_32,BUF_NUM_FORMAT_UINT] offen
    s_add_u32 s43, s43, s97
    tbuffer_load_format_d16_xyzw v[86:87], v8, s[20:23], s43 format:[BUF_DATA_FORMAT_32_32_32_32,BUF_NUM_FORMAT_UINT] offen
    s_waitcnt vmcnt(8)
    s_mov_b64 exec, s[36:37]
    buffer_store_dword v16, v12, s[68:71], 0 offen  sc0 sc1
    s_mov_b64 exec, -1
    s_waitcnt vmcnt(5)
    s_branch L_ploop
L_plast:
    s_waitcnt vmcnt(0)
    s_mov_b64 exec, s[36:37]
    buffer_store_dword v16, v12, s[68:71], 0 offen  sc0 sc1
    s_mov_b64 exec, -1
    s_endpgm
    .p2align 7
    .type L_sched,@object
L_sched:
    .size L_sched, 256
    .long 0x76543210, 0xfedcba98
    .long 0x47650321, 0xfedcba98
    .long 0x54761032, 0xfedcba98
    .long 0x65472103, 0xfedcba98
    .long 0x76543210, 0xcfed8ba9
    .long 0x73654021, 0xcfed8ba9
    .long 0x74365102, 0xcfed8ba9
    .long 0x75436210, 0xcfed8ba9
    .long 0x76543210, 0xdcfe98ba
    .long 0x67254301, 0xdcfe98ba
    .long 0x76325410, 0xdcfe98ba
    .long 0x67432501, 0xdcfe98ba
    .long 0x76543210, 0xedcfa98b
    .long 0x57614320, 0xedcfa98b
    .long 0x65721430, 0xedcfa98b
    .long 0x76532140, 0xedcfa98b
    .long 0x76543210, 0xfedcba98
    .long 0x47650321, 0xfedcba98
    .long 0x54761032, 0xfedcba98
    .long 0x65472103, 0xfedcba98
    .long 0x76543210, 0xcfed8ba9
    .long 0x73654021, 0xcfed8ba9
    .long 0x74365102, 0xcfed8ba9
    .long 0x75436210, 0xcfed8ba9
    .long 0x76543210, 0xdcfe98ba
    .long 0x67254301, 0xdcfe98ba
    .long 0x76325410, 0xdcfe98ba
    .long 0x67432501, 0xdcfe98ba
    .long 0x76543210, 0xedcfa98b
    .long 0x57614320, 0xedcfa98b
    .long 0x65721430, 0xedcfa98b
    .long 0x76532140, 0xedcfa98b
    .fill 64, 4, 0xbf800000
.section .rodata,"a"
.p2align 6
.amdhsa_kernel standalone__weight_only_int_squeezellm__prompt_kernel
  .amdhsa_next_free_vgpr 168
  .amdhsa_next_free_sgpr 102
  .amdhsa_accum_offset 168
  .amdhsa_group_segment_fixed_size 0
  .amdhsa_kernarg_size 48
  .amdhsa_user_sgpr_count 2
  .amdhsa_user_sgpr_kernarg_segment_ptr 1
  .amdhsa_system_sgpr_workgroup_id_x 1
.end_amdhsa_kernel
```

```asm
; @launch grid=(256,1,1) block=(768,1,1) lds=163840
.amdgcn_target "amdgcn-amd-amdhsa--gfx950"
.text
.p2align 9
.fill 64, 4, 0xbf800000
.globl standalone__weight_only_int_squeezellm__prompt_kernel
.p2align 8
.type standalone__weight_only_int_squeezellm__prompt_kernel,@function
standalone__weight_only_int_squeezellm__prompt_kernel:
    v_lshrrev_b32 v1, 6, v0
    s_load_dwordx8 s[4:11], s[0:1], 0
    v_readfirstlane_b32 s32, v1
    s_lshr_b32 s13, s2, 3
    s_cmp_ge_u32 s13, 32
    s_cbranch_scc1 L_done
    s_load_dwordx2 s[56:57], s[0:1], 40
    v_and_b32 v2, 63, v0
    s_cmp_ge_u32 s32, 8
    s_cbranch_scc1 L_h1
    s_sub_u32 s14, s13, 4
    s_lshr_b32 s15, s14, 2
    s_and_b32 s14, s14, 3
    s_and_b32 s16, s2, 1
    s_lshl2_add_u32 s14, s16, s14
    s_cmp_lt_u32 s13, 4
    s_cselect_b32 s15, s14, s15
    s_cmp_eq_u32 s15, 7
    s_cbranch_scc1 L_done
    s_bfe_u32 s16, s2, 0x20001
    s_mul_i32 s16, s16, 7
    s_add_u32 s15, s15, s16
    s_and_b32 s33, s32, 3
    s_cmp_ge_u32 s32, 4
    s_cbranch_scc1 L_h0
    s_getpc_b64 s[50:51]
    s_and_b32 s12, s13, 7
    s_mul_i32 s12, s12, 13
    v_add_lshl_u32 v1, v0, s12, 7
    v_cmp_gt_u32 vcc, 13, v0
    s_and_saveexec_b64 s[54:55], vcc
    s_cbranch_execz L_cw
    global_load_dword v39, v1, s[50:51] offset:512
L_cw:
    s_mov_b64 exec, s[54:55]
    v_lshrrev_b32 v5, 3, v2
    v_and_b32 v7, 7, v2
    v_mul_u32_u24 v5, 7168, v5
    v_lshl_add_u32 v5, v7, 4, v5
    s_and_b32 s36, s32, 1
    s_lshl1_add_u32 s35, s15, s36
    s_lshl_b32 s35, s35, 7
    s_add_u32 s36, s35, 56320
    s_lshl_b32 s37, s32, 11
    s_add_u32 m0, s37, 135168
    s_mov_b32 s26, 114688
    s_mov_b32 s27, 0x20000
    s_setprio 3
    s_waitcnt lgkmcnt(0)
    s_mov_b64 s[24:25], s[8:9]
    buffer_load_dwordx4 v5, s[24:27], s35 offen lds
    buffer_load_dwordx4 v5, s[24:27], s36 offen offset:1024 lds
    s_branch L_mfma
L_h0:
    s_and_b32 s48, s15, 3
    s_lshr_b32 s59, s15, 2
    s_add_u32 s59, s59, s14
    s_and_b32 s59, s59, 3
    s_lshl2_add_u32 s48, s48, s59
    s_mov_b32 s50, 0x64440010
    s_mov_b32 s51, 0x50004243
    s_lshl_b32 s59, s48, 2
    s_lshr_b64 s[50:51], s[50:51], s59
    s_and_b32 s50, s50, 15
    v_lshrrev_b32 v3, 5, v2
    s_lshl_b32 s35, s33, 1
    v_add_u32 v4, s35, v3
    v_and_b32 v6, 31, v2
    v_mul_u32_u24 v8, 114688, v4
    v_lshl_add_u32 v8, v6, 4, v8
    s_lshl_b32 s35, s15, 9
    v_add_u32 v8, s35, v8
    s_mov_b32 s22, 14680064
    s_mov_b32 s23, 0x20000
    s_movk_i32 s97, 14336
    s_and_b32 s16, s48, 12
    s_lshr_b32 s16, 0xba98, s16
    s_and_b32 s16, s16, 15
    s_cmp_lt_u32 s13, 4
    s_cselect_b32 s50, s16, s50
    s_mul_i32 s43, s50, 917504
    s_setprio 2
    s_waitcnt lgkmcnt(0)
    s_mov_b64 s[20:21], s[6:7]
    tbuffer_load_format_d16_xyzw v[72:73], v8, s[20:23], s43 format:[BUF_DATA_FORMAT_32_32_32_32,BUF_NUM_FORMAT_UINT] offen
    s_add_u32 s43, s43, s97
    tbuffer_load_format_d16_xyzw v[74:75], v8, s[20:23], s43 format:[BUF_DATA_FORMAT_32_32_32_32,BUF_NUM_FORMAT_UINT] offen
    s_add_u32 s43, s43, s97
    tbuffer_load_format_d16_xyzw v[76:77], v8, s[20:23], s43 format:[BUF_DATA_FORMAT_32_32_32_32,BUF_NUM_FORMAT_UINT] offen
    s_add_u32 s43, s43, s97
    tbuffer_load_format_d16_xyzw v[78:79], v8, s[20:23], s43 format:[BUF_DATA_FORMAT_32_32_32_32,BUF_NUM_FORMAT_UINT] offen
    s_add_u32 s43, s43, s97
    tbuffer_load_format_d16_xyzw v[80:81], v8, s[20:23], s43 format:[BUF_DATA_FORMAT_32_32_32_32,BUF_NUM_FORMAT_UINT] offen
    s_add_u32 s43, s43, s97
    tbuffer_load_format_d16_xyzw v[82:83], v8, s[20:23], s43 format:[BUF_DATA_FORMAT_32_32_32_32,BUF_NUM_FORMAT_UINT] offen
    s_add_u32 s43, s43, s97
    tbuffer_load_format_d16_xyzw v[84:85], v8, s[20:23], s43 format:[BUF_DATA_FORMAT_32_32_32_32,BUF_NUM_FORMAT_UINT] offen
    s_add_u32 s43, s43, s97
    tbuffer_load_format_d16_xyzw v[86:87], v8, s[20:23], s43 format:[BUF_DATA_FORMAT_32_32_32_32,BUF_NUM_FORMAT_UINT] offen
    s_branch L_e2
    .p2align 9
L_h1:
    s_sub_u32 s14, s13, 4
    s_lshr_b32 s15, s14, 2
    s_and_b32 s14, s14, 3
    s_and_b32 s16, s2, 1
    s_lshl2_add_u32 s14, s16, s14
    s_cmp_lt_u32 s13, 4
    s_cselect_b32 s15, s14, s15
    s_cmp_eq_u32 s15, 7
    s_cbranch_scc1 L_done
    s_bfe_u32 s16, s2, 0x20001
    s_mul_i32 s16, s16, 7
    s_add_u32 s15, s15, s16
    s_and_b32 s33, s32, 3
    s_and_b32 s48, s15, 3
    s_lshr_b32 s59, s15, 2
    s_add_u32 s59, s59, s14
    s_and_b32 s59, s59, 3
    s_lshl2_add_u32 s48, s48, s59
    s_mov_b32 s50, 0x64440010
    s_mov_b32 s51, 0x50004243
    s_lshl_b32 s59, s48, 2
    s_lshr_b64 s[50:51], s[50:51], s59
    s_and_b32 s50, s50, 15
    v_lshrrev_b32 v5, 3, v2
    v_lshrrev_b32 v7, 4, v2
    v_and_b32 v10, 7, v2
    v_xor_b32 v7, v7, v10
    v_lshlrev_b32 v7, 4, v7
    s_lshl_b32 s35, s14, 19
    s_lshl_b32 s36, s33, 17
    s_add_u32 s35, s35, s36
    v_lshl_add_u32 v7, v5, 11, v7
    v_add_u32 v9, s35, v7
    v_xor_b32 v10, 64, v9
    s_lshl_b32 s44, s33, 13
    s_add_u32 s44, s44, 65536
    s_mov_b32 s18, 4194304
    s_mov_b32 s19, 0x20000
    s_movk_i32 s98, 15360
    s_movk_i32 s99, 19456
    s_mov_b32 s53, s44
    s_mov_b32 m0, s53
    s_lshl_b32 s42, s50, 7
    s_setprio 1
    s_waitcnt lgkmcnt(0)
    s_mov_b64 s[16:17], s[4:5]
    s_cmp_lt_u32 s13, 4
    s_cbranch_scc1 L_e2
    buffer_load_dwordx4 v9, s[16:19], s42 offen offset:0 lds
    s_add_u32 s42, s42, s98
    buffer_load_dwordx4 v10, s[16:19], s42 offen offset:1024 lds
    s_add_u32 s42, s42, s98
    buffer_load_dwordx4 v9, s[16:19], s42 offen offset:2048 lds
    s_add_u32 s42, s42, s98
    buffer_load_dwordx4 v10, s[16:19], s42 offen offset:3072 lds
    s_add_u32 m0, s53, 4096
    s_add_u32 s42, s42, s99
    buffer_load_dwordx4 v9, s[16:19], s42 offen offset:0 lds
    s_add_u32 s42, s42, s98
    buffer_load_dwordx4 v10, s[16:19], s42 offen offset:1024 lds
    s_branch L_e2
L_mfma:
    s_mov_b32 s36, m0
    s_lshr_b32 s37, s32, 1
    s_add_u32 s36, s36, s37
    v_lshlrev_b32 v7, 1, v2
    v_add_u32 v7, s36, v7
    v_and_b32 v3, 127, v0
    v_and_b32 v6, 3, v3
    v_lshlrev_b32 v6, 1, v6
    v_add_u32 v6, s37, v6
    v_lshrrev_b32 v3, 2, v3
    v_lshl_add_u32 v6, v6, 5, v3
    v_lshlrev_b32 v6, 4, v6
    v_add_u32 v6, 131072, v6
    s_mov_b32 s45, 0x0b0a0908
    s_mov_b32 s54, 0xffffff00
    s_waitcnt vmcnt(0)
    ds_read_u8 v40, v7 offset:0
    ds_read_u8 v41, v7 offset:128
    ds_read_u8 v42, v7 offset:256
    ds_read_u8 v43, v7 offset:384
    ds_read_u8 v44, v7 offset:512
    ds_read_u8 v45, v7 offset:640
    ds_read_u8 v46, v7 offset:768
    ds_read_u8 v47, v7 offset:896
    ds_read_u8 v48, v7 offset:1024
    ds_read_u8 v49, v7 offset:1152
    ds_read_u8 v50, v7 offset:1280
    ds_read_u8 v51, v7 offset:1408
    ds_read_u8 v52, v7 offset:1536
    ds_read_u8 v53, v7 offset:1664
    ds_read_u8 v54, v7 offset:1792
    ds_read_u8 v55, v7 offset:1920
    s_waitcnt lgkmcnt(0)
    v_lshl_or_b32 v24, v41, 8, v40
    v_lshl_or_b32 v56, v43, 8, v42
    v_lshl_or_b32 v25, v45, 8, v44
    v_lshl_or_b32 v57, v47, 8, v46
    v_lshl_or_b32 v26, v49, 8, v48
    v_lshl_or_b32 v58, v51, 8, v50
    v_lshl_or_b32 v27, v53, 8, v52
    v_lshl_or_b32 v59, v55, 8, v54
    v_lshl_or_b32 v24, v56, 16, v24
    v_lshl_or_b32 v25, v57, 16, v25
    v_lshl_or_b32 v26, v58, 16, v26
    v_lshl_or_b32 v27, v59, 16, v27
    v_xor_b32 v25, s54, v25
    v_xor_b32 v27, s54, v27
    v_mov_b32 v28, v24
    v_mov_b32 v29, v26
    v_perm_b32 v30, v27, v26, s45
    v_perm_b32 v31, v25, v24, s45
    v_xor_b32 v24, v28, v30
    v_xor_b32 v26, v29, v31
    v_perm_b32 v30, v27, v26, s45
    v_perm_b32 v31, v25, v24, s45
    v_xor_b32 v24, v28, v30
    v_xor_b32 v26, v29, v31
    v_perm_b32 v30, v27, v26, s45
    v_perm_b32 v31, v25, v24, s45
    v_xor_b32 v24, v28, v30
    v_xor_b32 v26, v29, v31
    ds_write_b128 v6, v[24:27]
    s_waitcnt lgkmcnt(0)
    s_barrier
    s_cmp_lt_u32 s13, 4
    s_cbranch_scc1 L_done
    s_branch L_m2
L_e2:
    s_getpc_b64 s[86:87]
L_pcX:
    s_cmp_lt_u32 s13, 4
    s_cselect_b32 s35, 16, 0
    s_cselect_b32 s49, 8, 0
    s_add_u32 s35, s35, s48
    s_lshl_b32 s35, s35, 3
    s_add_u32 s35, s35, L_sched-L_pcX
    s_add_u32 s86, s86, s35
    s_addc_u32 s87, s87, 0
    s_load_dwordx2 s[82:83], s[86:87], 0
    s_lshr_b32 s35, s32, 3
    s_add_u32 s49, s49, s35
    s_lshl_b32 s35, s15, 2
    s_add_u32 s35, s35, s33
    s_lshl_b32 s35, s35, 7
    s_add_u32 s35, s35, 524288
    v_and_b32 v12, 15, v2
    v_lshlrev_b32 v12, 2, v12
    v_add_u32 v12, s35, v12
    s_mov_b64 s[68:69], s[56:57]
    s_mov_b32 s70, 268435456
    s_mov_b32 s71, 0x20000
    buffer_load_dword v13, v12, s[68:71], 0 offen sc0 sc1
    s_mov_b64 s[16:17], s[4:5]
    s_mov_b64 s[20:21], s[6:7]
    s_mov_b32 s22, 14680064
    s_mov_b32 s23, 0x20000
    s_mov_b32 s18, 4194304
    s_mov_b32 s19, 0x20000
    s_movk_i32 s97, 14336
    s_movk_i32 s98, 15360
    s_movk_i32 s99, 19456
    v_lshrrev_b32 v3, 5, v2
    s_lshl_b32 s35, s33, 1
    v_add_u32 v4, s35, v3
    v_and_b32 v6, 31, v2
    v_mul_u32_u24 v8, 114688, v4
    v_lshl_add_u32 v8, v6, 4, v8
    s_lshl_b32 s35, s15, 9
    v_add_u32 v8, s35, v8
    v_lshrrev_b32 v5, 3, v2
    v_lshrrev_b32 v7, 4, v2
    v_and_b32 v10, 7, v2
    v_xor_b32 v7, v7, v10
    v_lshlrev_b32 v7, 4, v7
    s_lshl_b32 s35, s14, 19
    s_lshl_b32 s36, s33, 17
    s_add_u32 s35, s35, s36
    v_lshl_add_u32 v7, v5, 11, v7
    v_add_u32 v9, s35, v7
    v_xor_b32 v10, 64, v9
    s_lshl_b32 s44, s33, 13
    s_add_u32 s44, s44, 65536
    s_lshl_b32 s36, s15, 18
    s_add_u32 s96, s36, 1048576
    v_xor_b32 v5, v6, v3
    v_lshlrev_b32 v5, 4, v5
    v_lshl_add_u32 v11, v4, 11, v5
    v_lshlrev_b32 v7, 4, v6
    v_add_u32 v7, 131072, v7
    s_lshl_b32 s45, s33, 12
    s_add_u32 s36, s96, s45
    v_lshlrev_b32 v15, 4, v2
    v_add_u32 v15, s36, v15
    v_add_u32 v20, s96, v11
    s_mov_b32 s46, 0x05010400
    s_mov_b32 s47, 0x07030602
    s_mov_b32 s58, 0x08080808
    s_mov_b32 s84, 0x05040100
    s_mov_b32 s85, 0x07060302
    s_mov_b32 s38, 0
    s_mov_b32 s39, 0
    s_mov_b32 s91, 0
    s_cmp_lt_u32 s32, 8
    s_cselect_b32 s93, 8, 9
    s_mov_b32 s90, 40
    s_mov_b64 exec, 0
    s_cmp_lt_u32 s13, 4
    s_cbranch_scc1 L_hopq
    s_cmp_eq_u32 s32, 4
    s_cbranch_scc1 L_hq0
    s_cmp_eq_u32 s32, 5
    s_cbranch_scc1 L_hq2
    s_cmp_eq_u32 s32, 6
    s_cbranch_scc1 L_hg
    s_cmp_eq_u32 s32, 7
    s_cbranch_scc1 L_hloop
    s_cmp_eq_u32 s32, 8
    s_cbranch_scc1 L_hx
    s_branch L_hopret
L_hopq:
    s_cmp_eq_u32 s32, 4
    s_cbranch_scc1 L_prod
    s_cmp_eq_u32 s32, 5
    s_cbranch_scc1 L_ploop
    s_cmp_eq_u32 s32, 6
    s_cbranch_scc1 L_pmid
    s_cmp_eq_u32 s32, 7
    s_cbranch_scc1 L_ppub
L_hopret:
    s_mov_b64 exec, -1
    s_waitcnt lgkmcnt(0)
    s_barrier
    ds_read_b128 v[40:43], v7 offset:0
    ds_read_b128 v[44:47], v7 offset:512
    ds_read_b128 v[48:51], v7 offset:1024
    ds_read_b128 v[52:55], v7 offset:1536
    ds_read_b128 v[56:59], v7 offset:2048
    ds_read_b128 v[60:63], v7 offset:2560
    ds_read_b128 v[64:67], v7 offset:3072
    ds_read_b128 v[68:71], v7 offset:3584
    s_cmp_lt_u32 s13, 4
    s_cbranch_scc1 L_prod
    s_lshl_b32 s41, s49, 14
    s_add_u32 s92, s49, 2
    s_mov_b32 s55, 2
    s_mov_b32 s54, 2
    s_cmp_eq_u32 s49, 0
    s_waitcnt lgkmcnt(0)
    s_cbranch_scc1 L_hq
    s_add_u32 m0, s53, 4096
    s_add_u32 s42, s42, s98
    buffer_load_dwordx4 v9, s[16:19], s42 offen offset:2048 lds
    s_add_u32 s42, s42, s98
    buffer_load_dwordx4 v10, s[16:19], s42 offen offset:3072 lds
    s_lshl_b32 s50, s49, 2
    s_lshr_b64 s[50:51], s[82:83], s50
    s_and_b32 s50, s50, 15
    s_mul_i32 s43, s50, 917504
    tbuffer_load_format_d16_xyzw v[72:73], v8, s[20:23], s43 format:[BUF_DATA_FORMAT_32_32_32_32,BUF_NUM_FORMAT_UINT] offen
    s_add_u32 s43, s43, s97
    tbuffer_load_format_d16_xyzw v[74:75], v8, s[20:23], s43 format:[BUF_DATA_FORMAT_32_32_32_32,BUF_NUM_FORMAT_UINT] offen
    s_add_u32 s43, s43, s97
    tbuffer_load_format_d16_xyzw v[76:77], v8, s[20:23], s43 format:[BUF_DATA_FORMAT_32_32_32_32,BUF_NUM_FORMAT_UINT] offen
    s_add_u32 s43, s43, s97
    tbuffer_load_format_d16_xyzw v[78:79], v8, s[20:23], s43 format:[BUF_DATA_FORMAT_32_32_32_32,BUF_NUM_FORMAT_UINT] offen
    s_add_u32 s43, s43, s97
    tbuffer_load_format_d16_xyzw v[80:81], v8, s[20:23], s43 format:[BUF_DATA_FORMAT_32_32_32_32,BUF_NUM_FORMAT_UINT] offen
    s_add_u32 s43, s43, s97
    tbuffer_load_format_d16_xyzw v[82:83], v8, s[20:23], s43 format:[BUF_DATA_FORMAT_32_32_32_32,BUF_NUM_FORMAT_UINT] offen
    s_add_u32 s43, s43, s97
    tbuffer_load_format_d16_xyzw v[84:85], v8, s[20:23], s43 format:[BUF_DATA_FORMAT_32_32_32_32,BUF_NUM_FORMAT_UINT] offen
    s_add_u32 s43, s43, s97
    tbuffer_load_format_d16_xyzw v[86:87], v8, s[20:23], s43 format:[BUF_DATA_FORMAT_32_32_32_32,BUF_NUM_FORMAT_UINT] offen
    s_waitcnt vmcnt(8)
    s_barrier
    s_setprio 3
    s_add_u32 s53, s44, 32768
    s_mov_b32 m0, s53
    s_lshl_b32 s42, s50, 7
    buffer_load_dwordx4 v9, s[16:19], s42 offen offset:0 lds
    s_add_u32 s42, s42, s98
    buffer_load_dwordx4 v10, s[16:19], s42 offen offset:1024 lds
    s_add_u32 s42, s42, s98
    buffer_load_dwordx4 v9, s[16:19], s42 offen offset:2048 lds
    s_add_u32 s42, s42, s98
    buffer_load_dwordx4 v10, s[16:19], s42 offen offset:3072 lds
    s_add_u32 m0, s53, 4096
    s_add_u32 s42, s42, s99
    buffer_load_dwordx4 v9, s[16:19], s42 offen offset:0 lds
    s_add_u32 s42, s42, s98
    buffer_load_dwordx4 v10, s[16:19], s42 offen offset:1024 lds
    s_add_u32 s42, s42, s98
    buffer_load_dwordx4 v9, s[16:19], s42 offen offset:2048 lds
    s_add_u32 s42, s42, s98
    buffer_load_dwordx4 v10, s[16:19], s42 offen offset:3072 lds
    s_mov_b32 s55, 0
    s_mov_b32 s54, 8
    v_add_u32 v17, s41, v11
    s_waitcnt vmcnt(8)
    s_branch L_hq0
L_m2:
    s_mov_b64 s[28:29], s[10:11]
    s_mov_b32 s30, 14680064
    s_mov_b32 s31, 0x20000
    v_and_b32 v7, 15, v2
    v_lshrrev_b32 v6, 4, v2
    v_lshrrev_b32 v4, 1, v7
    v_xor_b32 v4, v4, v6
    v_lshlrev_b32 v4, 4, v4
    v_lshl_add_u32 v4, v7, 7, v4
    s_lshl_b32 s35, s32, 13
    s_add_u32 s35, s35, 65536
    v_add_u32 v1, s35, v4
    v_xor_b32 v3, 64, v1
    v_and_b32 v4, 1, v6
    v_lshl_add_u32 v4, v7, 1, v4
    v_lshlrev_b32 v4, 4, v4
    v_lshl_add_u32 v4, v6, 11, v4
    v_xor_b32 v5, 16, v4
    v_mul_u32_u24 v6, 28672, v6
    v_lshl_add_u32 v6, v7, 4, v6
    s_lshl_b32 s36, s14, 2
    s_add_u32 s36, s36, s32
    s_mul_i32 s36, s36, 458752
    s_lshl_b32 s37, s15, 8
    s_add_u32 s36, s36, s37
    s_mov_b32 s40, 0
    s_mov_b32 s41, 0
    s_mov_b32 s46, 32768
    s_mov_b32 s47, 16384
    s_mov_b64 exec, 0
    s_cmp_eq_u32 s32, 0
    s_cbranch_scc1 L_mh0
    s_cmp_eq_u32 s32, 1
    s_cbranch_scc1 L_mh6
    s_cmp_eq_u32 s32, 2
    s_cbranch_scc1 L_mh12
    s_cmp_eq_u32 s32, 3
    s_cbranch_scc1 L_mh18
L_mhret:
    s_mov_b64 exec, -1
    s_setprio 3
    s_barrier
    ds_read_b128 v[24:27], v4 offset:0
    ds_read_b128 v[28:31], v4 offset:512
    ds_read_b128 v[8:11], v1 offset:0
    ds_read_b128 v[12:15], v1 offset:2048
    ds_read_b128 v[16:19], v1 offset:4096
    ds_read_b128 v[32:35], v4 offset:1024
    ds_read_b128 v[20:23], v1 offset:6144
    ds_read_b128 v[36:39], v4 offset:1536
    s_waitcnt lgkmcnt(5)
    v_mfma_f32_16x16x32_bf16 v[40:43], v[8:11], v[24:27], 0
    v_mfma_f32_16x16x32_bf16 v[44:47], v[8:11], v[28:31], 0
    s_waitcnt lgkmcnt(4)
    v_mfma_f32_16x16x32_bf16 v[72:75], v[12:15], v[24:27], 0
    v_mfma_f32_16x16x32_bf16 v[76:79], v[12:15], v[28:31], 0
    s_waitcnt lgkmcnt(3)
    v_mfma_f32_16x16x32_bf16 v[104:107], v[16:19], v[24:27], 0
    v_mfma_f32_16x16x32_bf16 v[108:111], v[16:19], v[28:31], 0
    s_waitcnt lgkmcnt(1)
    v_mfma_f32_16x16x32_bf16 v[136:139], v[20:23], v[24:27], 0
    ds_read_b128 v[24:27], v5 offset:0
    v_mfma_f32_16x16x32_bf16 v[140:143], v[20:23], v[28:31], 0
    ds_read_b128 v[28:31], v5 offset:512
    v_mfma_f32_16x16x32_bf16 v[48:51], v[8:11], v[32:35], 0
    s_add_u32 s40, s40, 1
L_mh0:
    s_cbranch_execz L_mh1
    s_waitcnt lgkmcnt(2)
    v_mfma_f32_16x16x32_bf16 v[52:55], v[8:11], v[36:39], 0
    s_and_b32 s42, s40, 3
    v_mfma_f32_16x16x32_bf16 v[80:83], v[12:15], v[32:35], 0
    s_cselect_b32 s42, s47, 0xffff4000
    v_mfma_f32_16x16x32_bf16 v[84:87], v[12:15], v[36:39], 0
    s_add_u32 s41, s41, 1
    v_mfma_f32_16x16x32_bf16 v[112:115], v[16:19], v[32:35], 0
    s_cmp_eq_u32 s41, 3
    v_mfma_f32_16x16x32_bf16 v[116:119], v[16:19], v[36:39], 0
    s_cselect_b32 s43, 0xffff0000, s46
    v_mfma_f32_16x16x32_bf16 v[144:147], v[20:23], v[32:35], 0
    s_cselect_b32 s41, 0, s41
    ds_read_b128 v[32:35], v5 offset:1024
    v_mfma_f32_16x16x32_bf16 v[148:151], v[20:23], v[36:39], 0
    ds_read_b128 v[36:39], v5 offset:1536
    s_waitcnt lgkmcnt(3)
    v_mfma_f32_16x16x32_bf16 v[56:59], v[8:11], v[24:27], 0
    s_waitcnt lgkmcnt(2)
    v_mfma_f32_16x16x32_bf16 v[60:63], v[8:11], v[28:31], 0
    v_mfma_f32_16x16x32_bf16 v[88:91], v[12:15], v[24:27], 0
    v_mfma_f32_16x16x32_bf16 v[92:95], v[12:15], v[28:31], 0
    v_mfma_f32_16x16x32_bf16 v[120:123], v[16:19], v[24:27], 0
    v_mfma_f32_16x16x32_bf16 v[124:127], v[16:19], v[28:31], 0
    v_mfma_f32_16x16x32_bf16 v[152:155], v[20:23], v[24:27], 0
    ds_read_b128 v[24:27], v4 offset:8192
    v_mfma_f32_16x16x32_bf16 v[156:159], v[20:23], v[28:31], 0
    ds_read_b128 v[28:31], v4 offset:8704
    s_waitcnt lgkmcnt(3)
    v_mfma_f32_16x16x32_bf16 v[64:67], v[8:11], v[32:35], 0
    s_waitcnt lgkmcnt(2)
    v_mfma_f32_16x16x32_bf16 v[68:71], v[8:11], v[36:39], 0
    ds_read_b128 v[8:11], v3 offset:0
    v_mfma_f32_16x16x32_bf16 v[96:99], v[12:15], v[32:35], 0
    v_mfma_f32_16x16x32_bf16 v[100:103], v[12:15], v[36:39], 0
    ds_read_b128 v[12:15], v3 offset:2048
    v_mfma_f32_16x16x32_bf16 v[128:131], v[16:19], v[32:35], 0
    v_mfma_f32_16x16x32_bf16 v[132:135], v[16:19], v[36:39], 0
    ds_read_b128 v[16:19], v3 offset:4096
    v_mfma_f32_16x16x32_bf16 v[160:163], v[20:23], v[32:35], 0
    ds_read_b128 v[32:35], v4 offset:9216
    v_mfma_f32_16x16x32_bf16 v[164:167], v[20:23], v[36:39], 0
    ds_read_b128 v[20:23], v3 offset:6144
    ds_read_b128 v[36:39], v4 offset:9728
    s_waitcnt lgkmcnt(5)
    v_mfma_f32_16x16x32_bf16 v[40:43], v[8:11], v[24:27], v[40:43]
    v_mfma_f32_16x16x32_bf16 v[44:47], v[8:11], v[28:31], v[44:47]
    s_waitcnt lgkmcnt(4)
L_mh1:
    s_cbranch_execz L_mh2
    v_mfma_f32_16x16x32_bf16 v[72:75], v[12:15], v[24:27], v[72:75]
    v_mfma_f32_16x16x32_bf16 v[76:79], v[12:15], v[28:31], v[76:79]
    s_waitcnt lgkmcnt(3)
    v_mfma_f32_16x16x32_bf16 v[104:107], v[16:19], v[24:27], v[104:107]
    v_mfma_f32_16x16x32_bf16 v[108:111], v[16:19], v[28:31], v[108:111]
    s_waitcnt lgkmcnt(1)
    v_mfma_f32_16x16x32_bf16 v[136:139], v[20:23], v[24:27], v[136:139]
    ds_read_b128 v[24:27], v5 offset:8192
    v_mfma_f32_16x16x32_bf16 v[140:143], v[20:23], v[28:31], v[140:143]
    ds_read_b128 v[28:31], v5 offset:8704
    v_mfma_f32_16x16x32_bf16 v[48:51], v[8:11], v[32:35], v[48:51]
    s_waitcnt lgkmcnt(2)
    v_mfma_f32_16x16x32_bf16 v[52:55], v[8:11], v[36:39], v[52:55]
    v_mfma_f32_16x16x32_bf16 v[80:83], v[12:15], v[32:35], v[80:83]
    v_mfma_f32_16x16x32_bf16 v[84:87], v[12:15], v[36:39], v[84:87]
    v_mfma_f32_16x16x32_bf16 v[112:115], v[16:19], v[32:35], v[112:115]
    v_mfma_f32_16x16x32_bf16 v[116:119], v[16:19], v[36:39], v[116:119]
    v_mfma_f32_16x16x32_bf16 v[144:147], v[20:23], v[32:35], v[144:147]
    ds_read_b128 v[32:35], v5 offset:9216
    v_mfma_f32_16x16x32_bf16 v[148:151], v[20:23], v[36:39], v[148:151]
    ds_read_b128 v[36:39], v5 offset:9728
    s_waitcnt lgkmcnt(3)
    v_mfma_f32_16x16x32_bf16 v[56:59], v[8:11], v[24:27], v[56:59]
    s_waitcnt lgkmcnt(2)
    v_mfma_f32_16x16x32_bf16 v[60:63], v[8:11], v[28:31], v[60:63]
    v_mfma_f32_16x16x32_bf16 v[88:91], v[12:15], v[24:27], v[88:91]
    v_mfma_f32_16x16x32_bf16 v[92:95], v[12:15], v[28:31], v[92:95]
    s_waitcnt lgkmcnt(0)
    s_barrier
    v_add_u32 v4, s42, v4
    v_mfma_f32_16x16x32_bf16 v[120:123], v[16:19], v[24:27], v[120:123]
    v_add_u32 v1, s43, v1
    v_mfma_f32_16x16x32_bf16 v[124:127], v[16:19], v[28:31], v[124:127]
    v_add_u32 v5, s42, v5
    v_mfma_f32_16x16x32_bf16 v[152:155], v[20:23], v[24:27], v[152:155]
    v_add_u32 v3, s43, v3
    ds_read_b128 v[24:27], v4 offset:0
    v_mfma_f32_16x16x32_bf16 v[156:159], v[20:23], v[28:31], v[156:159]
    ds_read_b128 v[28:31], v4 offset:512
    v_mfma_f32_16x16x32_bf16 v[64:67], v[8:11], v[32:35], v[64:67]
    v_mfma_f32_16x16x32_bf16 v[68:71], v[8:11], v[36:39], v[68:71]
    ds_read_b128 v[8:11], v1 offset:0
    v_mfma_f32_16x16x32_bf16 v[96:99], v[12:15], v[32:35], v[96:99]
    v_mfma_f32_16x16x32_bf16 v[100:103], v[12:15], v[36:39], v[100:103]
    ds_read_b128 v[12:15], v1 offset:2048
    v_mfma_f32_16x16x32_bf16 v[128:131], v[16:19], v[32:35], v[128:131]
    v_mfma_f32_16x16x32_bf16 v[132:135], v[16:19], v[36:39], v[132:135]
    ds_read_b128 v[16:19], v1 offset:4096
L_mh2:
    s_cbranch_execz L_mh3
    v_mfma_f32_16x16x32_bf16 v[160:163], v[20:23], v[32:35], v[160:163]
    ds_read_b128 v[32:35], v4 offset:1024
    v_mfma_f32_16x16x32_bf16 v[164:167], v[20:23], v[36:39], v[164:167]
    ds_read_b128 v[20:23], v1 offset:6144
    ds_read_b128 v[36:39], v4 offset:1536
    .p2align 6
L_mloop:
    s_waitcnt lgkmcnt(5)
    v_mfma_f32_16x16x32_bf16 v[40:43], v[8:11], v[24:27], v[40:43]
    v_mfma_f32_16x16x32_bf16 v[44:47], v[8:11], v[28:31], v[44:47]
    s_waitcnt lgkmcnt(4)
    v_mfma_f32_16x16x32_bf16 v[72:75], v[12:15], v[24:27], v[72:75]
    v_mfma_f32_16x16x32_bf16 v[76:79], v[12:15], v[28:31], v[76:79]
    s_waitcnt lgkmcnt(3)
    v_mfma_f32_16x16x32_bf16 v[104:107], v[16:19], v[24:27], v[104:107]
    v_mfma_f32_16x16x32_bf16 v[108:111], v[16:19], v[28:31], v[108:111]
    s_waitcnt lgkmcnt(1)
    v_mfma_f32_16x16x32_bf16 v[136:139], v[20:23], v[24:27], v[136:139]
    ds_read_b128 v[24:27], v5 offset:0
    v_mfma_f32_16x16x32_bf16 v[140:143], v[20:23], v[28:31], v[140:143]
    ds_read_b128 v[28:31], v5 offset:512
    v_mfma_f32_16x16x32_bf16 v[48:51], v[8:11], v[32:35], v[48:51]
    s_add_u32 s40, s40, 1
    s_waitcnt lgkmcnt(2)
    v_mfma_f32_16x16x32_bf16 v[52:55], v[8:11], v[36:39], v[52:55]
    s_and_b32 s42, s40, 3
    v_mfma_f32_16x16x32_bf16 v[80:83], v[12:15], v[32:35], v[80:83]
    s_cselect_b32 s42, s47, 0xffff4000
    v_mfma_f32_16x16x32_bf16 v[84:87], v[12:15], v[36:39], v[84:87]
    s_add_u32 s41, s41, 1
    v_mfma_f32_16x16x32_bf16 v[112:115], v[16:19], v[32:35], v[112:115]
    s_cmp_eq_u32 s41, 3
    v_mfma_f32_16x16x32_bf16 v[116:119], v[16:19], v[36:39], v[116:119]
    s_cselect_b32 s43, 0xffff0000, s46
    v_mfma_f32_16x16x32_bf16 v[144:147], v[20:23], v[32:35], v[144:147]
    s_cselect_b32 s41, 0, s41
    ds_read_b128 v[32:35], v5 offset:1024
    v_mfma_f32_16x16x32_bf16 v[148:151], v[20:23], v[36:39], v[148:151]
    ds_read_b128 v[36:39], v5 offset:1536
    s_waitcnt lgkmcnt(3)
    v_mfma_f32_16x16x32_bf16 v[56:59], v[8:11], v[24:27], v[56:59]
    s_waitcnt lgkmcnt(2)
    v_mfma_f32_16x16x32_bf16 v[60:63], v[8:11], v[28:31], v[60:63]
    v_mfma_f32_16x16x32_bf16 v[88:91], v[12:15], v[24:27], v[88:91]
    v_mfma_f32_16x16x32_bf16 v[92:95], v[12:15], v[28:31], v[92:95]
    v_mfma_f32_16x16x32_bf16 v[120:123], v[16:19], v[24:27], v[120:123]
    v_mfma_f32_16x16x32_bf16 v[124:127], v[16:19], v[28:31], v[124:127]
    v_mfma_f32_16x16x32_bf16 v[152:155], v[20:23], v[24:27], v[152:155]
L_mh3:
    s_cbranch_execz L_mh4
    ds_read_b128 v[24:27], v4 offset:8192
    v_mfma_f32_16x16x32_bf16 v[156:159], v[20:23], v[28:31], v[156:159]
    ds_read_b128 v[28:31], v4 offset:8704
    s_waitcnt lgkmcnt(3)
    v_mfma_f32_16x16x32_bf16 v[64:67], v[8:11], v[32:35], v[64:67]
    s_waitcnt lgkmcnt(2)
    v_mfma_f32_16x16x32_bf16 v[68:71], v[8:11], v[36:39], v[68:71]
    ds_read_b128 v[8:11], v3 offset:0
    v_mfma_f32_16x16x32_bf16 v[96:99], v[12:15], v[32:35], v[96:99]
    v_mfma_f32_16x16x32_bf16 v[100:103], v[12:15], v[36:39], v[100:103]
    ds_read_b128 v[12:15], v3 offset:2048
    v_mfma_f32_16x16x32_bf16 v[128:131], v[16:19], v[32:35], v[128:131]
    v_mfma_f32_16x16x32_bf16 v[132:135], v[16:19], v[36:39], v[132:135]
    ds_read_b128 v[16:19], v3 offset:4096
    v_mfma_f32_16x16x32_bf16 v[160:163], v[20:23], v[32:35], v[160:163]
    ds_read_b128 v[32:35], v4 offset:9216
    v_mfma_f32_16x16x32_bf16 v[164:167], v[20:23], v[36:39], v[164:167]
    ds_read_b128 v[20:23], v3 offset:6144
    ds_read_b128 v[36:39], v4 offset:9728
    s_waitcnt lgkmcnt(5)
    v_mfma_f32_16x16x32_bf16 v[40:43], v[8:11], v[24:27], v[40:43]
    v_mfma_f32_16x16x32_bf16 v[44:47], v[8:11], v[28:31], v[44:47]
    s_waitcnt lgkmcnt(4)
    v_mfma_f32_16x16x32_bf16 v[72:75], v[12:15], v[24:27], v[72:75]
    v_mfma_f32_16x16x32_bf16 v[76:79], v[12:15], v[28:31], v[76:79]
    s_waitcnt lgkmcnt(3)
    v_mfma_f32_16x16x32_bf16 v[104:107], v[16:19], v[24:27], v[104:107]
    v_mfma_f32_16x16x32_bf16 v[108:111], v[16:19], v[28:31], v[108:111]
    s_waitcnt lgkmcnt(1)
    v_mfma_f32_16x16x32_bf16 v[136:139], v[20:23], v[24:27], v[136:139]
    ds_read_b128 v[24:27], v5 offset:8192
    v_mfma_f32_16x16x32_bf16 v[140:143], v[20:23], v[28:31], v[140:143]
    ds_read_b128 v[28:31], v5 offset:8704
    v_mfma_f32_16x16x32_bf16 v[48:51], v[8:11], v[32:35], v[48:51]
    s_waitcnt lgkmcnt(2)
    v_mfma_f32_16x16x32_bf16 v[52:55], v[8:11], v[36:39], v[52:55]
    v_mfma_f32_16x16x32_bf16 v[80:83], v[12:15], v[32:35], v[80:83]
    v_mfma_f32_16x16x32_bf16 v[84:87], v[12:15], v[36:39], v[84:87]
    v_mfma_f32_16x16x32_bf16 v[112:115], v[16:19], v[32:35], v[112:115]
    v_mfma_f32_16x16x32_bf16 v[116:119], v[16:19], v[36:39], v[116:119]
    v_mfma_f32_16x16x32_bf16 v[144:147], v[20:23], v[32:35], v[144:147]
    ds_read_b128 v[32:35], v5 offset:9216
    v_mfma_f32_16x16x32_bf16 v[148:151], v[20:23], v[36:39], v[148:151]
    ds_read_b128 v[36:39], v5 offset:9728
    s_waitcnt lgkmcnt(3)
    v_mfma_f32_16x16x32_bf16 v[56:59], v[8:11], v[24:27], v[56:59]
    s_waitcnt lgkmcnt(2)
    v_mfma_f32_16x16x32_bf16 v[60:63], v[8:11], v[28:31], v[60:63]
L_mh4:
    s_cbranch_execz L_mh5
    v_mfma_f32_16x16x32_bf16 v[88:91], v[12:15], v[24:27], v[88:91]
    v_mfma_f32_16x16x32_bf16 v[92:95], v[12:15], v[28:31], v[92:95]
    s_waitcnt lgkmcnt(0)
    s_barrier
    v_add_u32 v4, s42, v4
    v_mfma_f32_16x16x32_bf16 v[120:123], v[16:19], v[24:27], v[120:123]
    v_add_u32 v1, s43, v1
    v_mfma_f32_16x16x32_bf16 v[124:127], v[16:19], v[28:31], v[124:127]
    v_add_u32 v5, s42, v5
    v_mfma_f32_16x16x32_bf16 v[152:155], v[20:23], v[24:27], v[152:155]
    v_add_u32 v3, s43, v3
    ds_read_b128 v[24:27], v4 offset:0
    v_mfma_f32_16x16x32_bf16 v[156:159], v[20:23], v[28:31], v[156:159]
    ds_read_b128 v[28:31], v4 offset:512
    v_mfma_f32_16x16x32_bf16 v[64:67], v[8:11], v[32:35], v[64:67]
    v_mfma_f32_16x16x32_bf16 v[68:71], v[8:11], v[36:39], v[68:71]
    ds_read_b128 v[8:11], v1 offset:0
    v_mfma_f32_16x16x32_bf16 v[96:99], v[12:15], v[32:35], v[96:99]
    v_mfma_f32_16x16x32_bf16 v[100:103], v[12:15], v[36:39], v[100:103]
    ds_read_b128 v[12:15], v1 offset:2048
    v_mfma_f32_16x16x32_bf16 v[128:131], v[16:19], v[32:35], v[128:131]
    v_mfma_f32_16x16x32_bf16 v[132:135], v[16:19], v[36:39], v[132:135]
    ds_read_b128 v[16:19], v1 offset:4096
    v_mfma_f32_16x16x32_bf16 v[160:163], v[20:23], v[32:35], v[160:163]
    ds_read_b128 v[32:35], v4 offset:1024
    v_mfma_f32_16x16x32_bf16 v[164:167], v[20:23], v[36:39], v[164:167]
    ds_read_b128 v[20:23], v1 offset:6144
    ds_read_b128 v[36:39], v4 offset:1536
    s_cmp_lt_u32 s40, 11
    s_cbranch_scc1 L_mloop
    s_waitcnt lgkmcnt(5)
    v_mfma_f32_16x16x32_bf16 v[40:43], v[8:11], v[24:27], v[40:43]
    v_mfma_f32_16x16x32_bf16 v[44:47], v[8:11], v[28:31], v[44:47]
    s_waitcnt lgkmcnt(4)
    v_mfma_f32_16x16x32_bf16 v[72:75], v[12:15], v[24:27], v[72:75]
    v_mfma_f32_16x16x32_bf16 v[76:79], v[12:15], v[28:31], v[76:79]
    s_waitcnt lgkmcnt(3)
    v_mfma_f32_16x16x32_bf16 v[104:107], v[16:19], v[24:27], v[104:107]
    v_mfma_f32_16x16x32_bf16 v[108:111], v[16:19], v[28:31], v[108:111]
    s_waitcnt lgkmcnt(1)
    v_mfma_f32_16x16x32_bf16 v[136:139], v[20:23], v[24:27], v[136:139]
    ds_read_b128 v[24:27], v5 offset:0
    v_mfma_f32_16x16x32_bf16 v[140:143], v[20:23], v[28:31], v[140:143]
    ds_read_b128 v[28:31], v5 offset:512
    v_mfma_f32_16x16x32_bf16 v[48:51], v[8:11], v[32:35], v[48:51]
    s_waitcnt lgkmcnt(2)
    v_mfma_f32_16x16x32_bf16 v[52:55], v[8:11], v[36:39], v[52:55]
    v_mfma_f32_16x16x32_bf16 v[80:83], v[12:15], v[32:35], v[80:83]
L_mh5:
    s_cbranch_execz L_mhret
    v_mfma_f32_16x16x32_bf16 v[84:87], v[12:15], v[36:39], v[84:87]
    v_mfma_f32_16x16x32_bf16 v[112:115], v[16:19], v[32:35], v[112:115]
    v_mfma_f32_16x16x32_bf16 v[116:119], v[16:19], v[36:39], v[116:119]
    v_mfma_f32_16x16x32_bf16 v[144:147], v[20:23], v[32:35], v[144:147]
    ds_read_b128 v[32:35], v5 offset:1024
    v_mfma_f32_16x16x32_bf16 v[148:151], v[20:23], v[36:39], v[148:151]
    ds_read_b128 v[36:39], v5 offset:1536
    s_waitcnt lgkmcnt(3)
    v_mfma_f32_16x16x32_bf16 v[56:59], v[8:11], v[24:27], v[56:59]
    s_waitcnt lgkmcnt(2)
    v_mfma_f32_16x16x32_bf16 v[60:63], v[8:11], v[28:31], v[60:63]
    v_mfma_f32_16x16x32_bf16 v[88:91], v[12:15], v[24:27], v[88:91]
    v_mfma_f32_16x16x32_bf16 v[92:95], v[12:15], v[28:31], v[92:95]
    v_mfma_f32_16x16x32_bf16 v[120:123], v[16:19], v[24:27], v[120:123]
    v_mfma_f32_16x16x32_bf16 v[124:127], v[16:19], v[28:31], v[124:127]
    v_mfma_f32_16x16x32_bf16 v[152:155], v[20:23], v[24:27], v[152:155]
    ds_read_b128 v[24:27], v4 offset:8192
    v_mfma_f32_16x16x32_bf16 v[156:159], v[20:23], v[28:31], v[156:159]
    ds_read_b128 v[28:31], v4 offset:8704
    s_waitcnt lgkmcnt(3)
    v_mfma_f32_16x16x32_bf16 v[64:67], v[8:11], v[32:35], v[64:67]
    s_waitcnt lgkmcnt(2)
    v_mfma_f32_16x16x32_bf16 v[68:71], v[8:11], v[36:39], v[68:71]
    ds_read_b128 v[8:11], v3 offset:0
    v_mfma_f32_16x16x32_bf16 v[96:99], v[12:15], v[32:35], v[96:99]
    v_mfma_f32_16x16x32_bf16 v[100:103], v[12:15], v[36:39], v[100:103]
    ds_read_b128 v[12:15], v3 offset:2048
    v_mfma_f32_16x16x32_bf16 v[128:131], v[16:19], v[32:35], v[128:131]
    v_mfma_f32_16x16x32_bf16 v[132:135], v[16:19], v[36:39], v[132:135]
    ds_read_b128 v[16:19], v3 offset:4096
    v_mfma_f32_16x16x32_bf16 v[160:163], v[20:23], v[32:35], v[160:163]
    ds_read_b128 v[32:35], v4 offset:9216
    v_mfma_f32_16x16x32_bf16 v[164:167], v[20:23], v[36:39], v[164:167]
    ds_read_b128 v[20:23], v3 offset:6144
    ds_read_b128 v[36:39], v4 offset:9728
    s_waitcnt lgkmcnt(5)
    v_mfma_f32_16x16x32_bf16 v[40:43], v[8:11], v[24:27], v[40:43]
    v_mfma_f32_16x16x32_bf16 v[44:47], v[8:11], v[28:31], v[44:47]
    s_waitcnt lgkmcnt(4)
    v_mfma_f32_16x16x32_bf16 v[72:75], v[12:15], v[24:27], v[72:75]
    v_mfma_f32_16x16x32_bf16 v[76:79], v[12:15], v[28:31], v[76:79]
    s_waitcnt lgkmcnt(3)
    v_mfma_f32_16x16x32_bf16 v[104:107], v[16:19], v[24:27], v[104:107]
    v_mfma_f32_16x16x32_bf16 v[108:111], v[16:19], v[28:31], v[108:111]
    s_waitcnt lgkmcnt(1)
    v_mfma_f32_16x16x32_bf16 v[136:139], v[20:23], v[24:27], v[136:139]
    ds_read_b128 v[24:27], v5 offset:8192
    v_mfma_f32_16x16x32_bf16 v[140:143], v[20:23], v[28:31], v[140:143]
L_mh6:
    s_cbranch_execz L_mh7
    ds_read_b128 v[28:31], v5 offset:8704
    v_mfma_f32_16x16x32_bf16 v[48:51], v[8:11], v[32:35], v[48:51]
    s_waitcnt lgkmcnt(2)
    v_mfma_f32_16x16x32_bf16 v[52:55], v[8:11], v[36:39], v[52:55]
    v_mfma_f32_16x16x32_bf16 v[80:83], v[12:15], v[32:35], v[80:83]
    v_mfma_f32_16x16x32_bf16 v[84:87], v[12:15], v[36:39], v[84:87]
    v_mfma_f32_16x16x32_bf16 v[112:115], v[16:19], v[32:35], v[112:115]
    v_mfma_f32_16x16x32_bf16 v[116:119], v[16:19], v[36:39], v[116:119]
    v_mfma_f32_16x16x32_bf16 v[144:147], v[20:23], v[32:35], v[144:147]
    ds_read_b128 v[32:35], v5 offset:9216
    v_mfma_f32_16x16x32_bf16 v[148:151], v[20:23], v[36:39], v[148:151]
    ds_read_b128 v[36:39], v5 offset:9728
    s_waitcnt lgkmcnt(3)
    v_mfma_f32_16x16x32_bf16 v[56:59], v[8:11], v[24:27], v[56:59]
    s_waitcnt lgkmcnt(2)
    v_mfma_f32_16x16x32_bf16 v[60:63], v[8:11], v[28:31], v[60:63]
    v_mfma_f32_16x16x32_bf16 v[88:91], v[12:15], v[24:27], v[88:91]
    v_mfma_f32_16x16x32_bf16 v[92:95], v[12:15], v[28:31], v[92:95]
    s_waitcnt lgkmcnt(0)
    s_barrier
    v_add_u32 v4, 0xffff4000, v4
    v_mfma_f32_16x16x32_bf16 v[120:123], v[16:19], v[24:27], v[120:123]
    v_add_u32 v7, 0x0, v1
    v_mfma_f32_16x16x32_bf16 v[124:127], v[16:19], v[28:31], v[124:127]
    v_add_u32 v1, 0xffff0000, v1
    v_mfma_f32_16x16x32_bf16 v[152:155], v[20:23], v[24:27], v[152:155]
    v_add_u32 v5, 0xffff4000, v5
    ds_read_b128 v[24:27], v1 offset:0
    v_mfma_f32_16x16x32_bf16 v[156:159], v[20:23], v[28:31], v[156:159]
    v_add_u32 v0, 0x0, v3
    v_mfma_f32_16x16x32_bf16 v[64:67], v[8:11], v[32:35], v[64:67]
    v_add_u32 v3, 0xffff0000, v3
    ds_read_b128 v[28:31], v4 offset:0
    v_mfma_f32_16x16x32_bf16 v[68:71], v[8:11], v[36:39], v[68:71]
    ds_read_b128 v[8:11], v1 offset:2048
    v_mfma_f32_16x16x32_bf16 v[96:99], v[12:15], v[32:35], v[96:99]
    v_mfma_f32_16x16x32_bf16 v[100:103], v[12:15], v[36:39], v[100:103]
    ds_read_b128 v[12:15], v4 offset:512
    v_mfma_f32_16x16x32_bf16 v[128:131], v[16:19], v[32:35], v[128:131]
    v_mfma_f32_16x16x32_bf16 v[132:135], v[16:19], v[36:39], v[132:135]
    ds_read_b128 v[16:19], v4 offset:1024
    v_mfma_f32_16x16x32_bf16 v[160:163], v[20:23], v[32:35], v[160:163]
    ds_read_b128 v[32:35], v4 offset:1536
    v_mfma_f32_16x16x32_bf16 v[164:167], v[20:23], v[36:39], v[164:167]
    s_waitcnt lgkmcnt(4)
    v_mfma_f32_16x16x32_bf16 v[40:43], v[24:27], v[28:31], v[40:43]
    ds_read_b128 v[20:23], v5 offset:0
    s_waitcnt lgkmcnt(4)
L_mh7:
    s_cbranch_execz L_mh8
    v_mfma_f32_16x16x32_bf16 v[72:75], v[8:11], v[28:31], v[72:75]
    s_waitcnt lgkmcnt(3)
    v_mfma_f32_16x16x32_bf16 v[44:47], v[24:27], v[12:15], v[44:47]
    ds_read_b128 v[28:31], v5 offset:512
    v_mfma_f32_16x16x32_bf16 v[76:79], v[8:11], v[12:15], v[76:79]
    s_waitcnt lgkmcnt(3)
    v_mfma_f32_16x16x32_bf16 v[48:51], v[24:27], v[16:19], v[48:51]
    ds_read_b128 v[12:15], v5 offset:1024
    v_mfma_f32_16x16x32_bf16 v[80:83], v[8:11], v[16:19], v[80:83]
    ds_read_b128 v[36:39], v3 offset:0
    s_waitcnt lgkmcnt(4)
    v_mfma_f32_16x16x32_bf16 v[52:55], v[24:27], v[32:35], v[52:55]
    ds_read_b128 v[16:19], v5 offset:1536
    v_mfma_f32_16x16x32_bf16 v[84:87], v[8:11], v[32:35], v[84:87]
    s_waitcnt lgkmcnt(4)
    v_mfma_f32_16x16x32_bf16 v[56:59], v[24:27], v[20:23], v[56:59]
    ds_read_b128 v[32:35], v4 offset:8192
    v_mfma_f32_16x16x32_bf16 v[88:91], v[8:11], v[20:23], v[88:91]
    ds_read_b128 v[20:23], v3 offset:2048
    s_waitcnt lgkmcnt(5)
    v_mfma_f32_16x16x32_bf16 v[60:63], v[24:27], v[28:31], v[60:63]
    v_mfma_f32_16x16x32_bf16 v[92:95], v[8:11], v[28:31], v[92:95]
    ds_read_b128 v[28:31], v4 offset:8704
    s_waitcnt lgkmcnt(5)
    v_mfma_f32_16x16x32_bf16 v[64:67], v[24:27], v[12:15], v[64:67]
    v_mfma_f32_16x16x32_bf16 v[96:99], v[8:11], v[12:15], v[96:99]
    ds_read_b128 v[12:15], v4 offset:9216
    s_waitcnt lgkmcnt(4)
    v_mfma_f32_16x16x32_bf16 v[68:71], v[24:27], v[16:19], v[68:71]
    ds_read_b128 v[24:27], v4 offset:9728
    v_mfma_f32_16x16x32_bf16 v[100:103], v[8:11], v[16:19], v[100:103]
    s_waitcnt lgkmcnt(4)
    v_mfma_f32_16x16x32_bf16 v[40:43], v[36:39], v[32:35], v[40:43]
    ds_read_b128 v[8:11], v5 offset:8192
    s_waitcnt lgkmcnt(4)
    v_mfma_f32_16x16x32_bf16 v[72:75], v[20:23], v[32:35], v[72:75]
    s_waitcnt lgkmcnt(3)
    v_mfma_f32_16x16x32_bf16 v[44:47], v[36:39], v[28:31], v[44:47]
    ds_read_b128 v[32:35], v5 offset:8704
    v_mfma_f32_16x16x32_bf16 v[76:79], v[20:23], v[28:31], v[76:79]
    s_waitcnt lgkmcnt(3)
    v_mfma_f32_16x16x32_bf16 v[48:51], v[36:39], v[12:15], v[48:51]
    ds_read_b128 v[28:31], v5 offset:9216
    v_mfma_f32_16x16x32_bf16 v[80:83], v[20:23], v[12:15], v[80:83]
    s_barrier
    ds_read_b128 v[16:19], v1 offset:32768
    s_waitcnt lgkmcnt(4)
    v_mfma_f32_16x16x32_bf16 v[52:55], v[36:39], v[24:27], v[52:55]
L_mh8:
    s_cbranch_execz L_mh9
    ds_read_b128 v[12:15], v5 offset:9728
    v_mfma_f32_16x16x32_bf16 v[84:87], v[20:23], v[24:27], v[84:87]
    s_waitcnt lgkmcnt(4)
    v_mfma_f32_16x16x32_bf16 v[56:59], v[36:39], v[8:11], v[56:59]
    ds_read_b128 v[24:27], v4 offset:16384
    v_mfma_f32_16x16x32_bf16 v[88:91], v[20:23], v[8:11], v[88:91]
    ds_read_b128 v[8:11], v1 offset:34816
    s_waitcnt lgkmcnt(5)
    v_mfma_f32_16x16x32_bf16 v[60:63], v[36:39], v[32:35], v[60:63]
    v_mfma_f32_16x16x32_bf16 v[92:95], v[20:23], v[32:35], v[92:95]
    ds_read_b128 v[32:35], v4 offset:16896
    s_waitcnt lgkmcnt(5)
    v_mfma_f32_16x16x32_bf16 v[64:67], v[36:39], v[28:31], v[64:67]
    v_mfma_f32_16x16x32_bf16 v[96:99], v[20:23], v[28:31], v[96:99]
    ds_read_b128 v[28:31], v4 offset:17408
    s_waitcnt lgkmcnt(4)
    v_mfma_f32_16x16x32_bf16 v[68:71], v[36:39], v[12:15], v[68:71]
    ds_read_b128 v[36:39], v4 offset:17920
    v_mfma_f32_16x16x32_bf16 v[100:103], v[20:23], v[12:15], v[100:103]
    s_waitcnt lgkmcnt(4)
    v_mfma_f32_16x16x32_bf16 v[40:43], v[16:19], v[24:27], v[40:43]
    ds_read_b128 v[12:15], v5 offset:16384
    s_waitcnt lgkmcnt(4)
    v_mfma_f32_16x16x32_bf16 v[72:75], v[8:11], v[24:27], v[72:75]
    s_waitcnt lgkmcnt(3)
    v_mfma_f32_16x16x32_bf16 v[44:47], v[16:19], v[32:35], v[44:47]
    ds_read_b128 v[24:27], v5 offset:16896
    v_mfma_f32_16x16x32_bf16 v[76:79], v[8:11], v[32:35], v[76:79]
    s_waitcnt lgkmcnt(3)
    v_mfma_f32_16x16x32_bf16 v[48:51], v[16:19], v[28:31], v[48:51]
    ds_read_b128 v[32:35], v5 offset:17408
    v_mfma_f32_16x16x32_bf16 v[80:83], v[8:11], v[28:31], v[80:83]
    ds_read_b128 v[20:23], v3 offset:32768
    s_waitcnt lgkmcnt(4)
    v_mfma_f32_16x16x32_bf16 v[52:55], v[16:19], v[36:39], v[52:55]
    ds_read_b128 v[28:31], v5 offset:17920
    v_mfma_f32_16x16x32_bf16 v[84:87], v[8:11], v[36:39], v[84:87]
    s_waitcnt lgkmcnt(4)
    v_mfma_f32_16x16x32_bf16 v[56:59], v[16:19], v[12:15], v[56:59]
    ds_read_b128 v[36:39], v4 offset:24576
    v_mfma_f32_16x16x32_bf16 v[88:91], v[8:11], v[12:15], v[88:91]
    ds_read_b128 v[12:15], v3 offset:34816
    s_waitcnt lgkmcnt(5)
    v_mfma_f32_16x16x32_bf16 v[60:63], v[16:19], v[24:27], v[60:63]
    v_mfma_f32_16x16x32_bf16 v[92:95], v[8:11], v[24:27], v[92:95]
    ds_read_b128 v[24:27], v4 offset:25088
    s_waitcnt lgkmcnt(5)
    v_mfma_f32_16x16x32_bf16 v[64:67], v[16:19], v[32:35], v[64:67]
L_mh9:
    s_cbranch_execz L_mh10
    v_mfma_f32_16x16x32_bf16 v[96:99], v[8:11], v[32:35], v[96:99]
    ds_read_b128 v[32:35], v4 offset:25600
    s_waitcnt lgkmcnt(4)
    v_mfma_f32_16x16x32_bf16 v[68:71], v[16:19], v[28:31], v[68:71]
    ds_read_b128 v[16:19], v4 offset:26112
    v_mfma_f32_16x16x32_bf16 v[100:103], v[8:11], v[28:31], v[100:103]
    s_waitcnt lgkmcnt(4)
    v_mfma_f32_16x16x32_bf16 v[40:43], v[20:23], v[36:39], v[40:43]
    ds_read_b128 v[8:11], v5 offset:24576
    s_waitcnt lgkmcnt(4)
    v_mfma_f32_16x16x32_bf16 v[72:75], v[12:15], v[36:39], v[72:75]
    s_waitcnt lgkmcnt(3)
    v_mfma_f32_16x16x32_bf16 v[44:47], v[20:23], v[24:27], v[44:47]
    ds_read_b128 v[36:39], v5 offset:25088
    v_mfma_f32_16x16x32_bf16 v[76:79], v[12:15], v[24:27], v[76:79]
    s_waitcnt lgkmcnt(3)
    v_mfma_f32_16x16x32_bf16 v[48:51], v[20:23], v[32:35], v[48:51]
    ds_read_b128 v[24:27], v5 offset:25600
    v_mfma_f32_16x16x32_bf16 v[80:83], v[12:15], v[32:35], v[80:83]
    s_barrier
    ds_read_b128 v[28:31], v7 offset:0
    s_waitcnt lgkmcnt(4)
    v_mfma_f32_16x16x32_bf16 v[52:55], v[20:23], v[16:19], v[52:55]
    ds_read_b128 v[32:35], v5 offset:26112
    v_mfma_f32_16x16x32_bf16 v[84:87], v[12:15], v[16:19], v[84:87]
    s_waitcnt lgkmcnt(4)
    v_mfma_f32_16x16x32_bf16 v[56:59], v[20:23], v[8:11], v[56:59]
    ds_read_b128 v[16:19], v4 offset:32768
    v_mfma_f32_16x16x32_bf16 v[88:91], v[12:15], v[8:11], v[88:91]
    ds_read_b128 v[8:11], v7 offset:2048
    s_waitcnt lgkmcnt(5)
    v_mfma_f32_16x16x32_bf16 v[60:63], v[20:23], v[36:39], v[60:63]
    v_mfma_f32_16x16x32_bf16 v[92:95], v[12:15], v[36:39], v[92:95]
    ds_read_b128 v[36:39], v4 offset:33280
    s_waitcnt lgkmcnt(5)
    v_mfma_f32_16x16x32_bf16 v[64:67], v[20:23], v[24:27], v[64:67]
    v_mfma_f32_16x16x32_bf16 v[96:99], v[12:15], v[24:27], v[96:99]
    ds_read_b128 v[24:27], v4 offset:33792
    s_waitcnt lgkmcnt(4)
    v_mfma_f32_16x16x32_bf16 v[68:71], v[20:23], v[32:35], v[68:71]
    ds_read_b128 v[20:23], v4 offset:34304
    v_mfma_f32_16x16x32_bf16 v[100:103], v[12:15], v[32:35], v[100:103]
    s_waitcnt lgkmcnt(4)
    v_mfma_f32_16x16x32_bf16 v[40:43], v[28:31], v[16:19], v[40:43]
    ds_read_b128 v[12:15], v5 offset:32768
    s_waitcnt lgkmcnt(4)
    v_mfma_f32_16x16x32_bf16 v[72:75], v[8:11], v[16:19], v[72:75]
    s_waitcnt lgkmcnt(3)
L_mh10:
    s_cbranch_execz L_mh11
    v_mfma_f32_16x16x32_bf16 v[44:47], v[28:31], v[36:39], v[44:47]
    ds_read_b128 v[16:19], v5 offset:33280
    v_mfma_f32_16x16x32_bf16 v[76:79], v[8:11], v[36:39], v[76:79]
    s_waitcnt lgkmcnt(3)
    v_mfma_f32_16x16x32_bf16 v[48:51], v[28:31], v[24:27], v[48:51]
    ds_read_b128 v[36:39], v5 offset:33792
    v_mfma_f32_16x16x32_bf16 v[80:83], v[8:11], v[24:27], v[80:83]
    ds_read_b128 v[32:35], v0 offset:0
    s_waitcnt lgkmcnt(4)
    v_mfma_f32_16x16x32_bf16 v[52:55], v[28:31], v[20:23], v[52:55]
    ds_read_b128 v[24:27], v5 offset:34304
    v_mfma_f32_16x16x32_bf16 v[84:87], v[8:11], v[20:23], v[84:87]
    s_waitcnt lgkmcnt(4)
    v_mfma_f32_16x16x32_bf16 v[56:59], v[28:31], v[12:15], v[56:59]
    ds_read_b128 v[20:23], v4 offset:40960
    v_mfma_f32_16x16x32_bf16 v[88:91], v[8:11], v[12:15], v[88:91]
    ds_read_b128 v[12:15], v0 offset:2048
    s_waitcnt lgkmcnt(5)
    v_mfma_f32_16x16x32_bf16 v[60:63], v[28:31], v[16:19], v[60:63]
    v_mfma_f32_16x16x32_bf16 v[92:95], v[8:11], v[16:19], v[92:95]
    ds_read_b128 v[16:19], v4 offset:41472
    s_waitcnt lgkmcnt(5)
    v_mfma_f32_16x16x32_bf16 v[64:67], v[28:31], v[36:39], v[64:67]
    v_mfma_f32_16x16x32_bf16 v[96:99], v[8:11], v[36:39], v[96:99]
    ds_read_b128 v[36:39], v4 offset:41984
    s_waitcnt lgkmcnt(4)
    v_mfma_f32_16x16x32_bf16 v[68:71], v[28:31], v[24:27], v[68:71]
    ds_read_b128 v[28:31], v4 offset:42496
    v_mfma_f32_16x16x32_bf16 v[100:103], v[8:11], v[24:27], v[100:103]
    s_waitcnt lgkmcnt(4)
    v_mfma_f32_16x16x32_bf16 v[40:43], v[32:35], v[20:23], v[40:43]
    ds_read_b128 v[8:11], v5 offset:40960
    s_waitcnt lgkmcnt(4)
    v_mfma_f32_16x16x32_bf16 v[72:75], v[12:15], v[20:23], v[72:75]
    s_waitcnt lgkmcnt(3)
    v_mfma_f32_16x16x32_bf16 v[44:47], v[32:35], v[16:19], v[44:47]
    ds_read_b128 v[20:23], v5 offset:41472
    v_mfma_f32_16x16x32_bf16 v[76:79], v[12:15], v[16:19], v[76:79]
    s_waitcnt lgkmcnt(3)
    v_mfma_f32_16x16x32_bf16 v[48:51], v[32:35], v[36:39], v[48:51]
    ds_read_b128 v[16:19], v5 offset:41984
    v_mfma_f32_16x16x32_bf16 v[80:83], v[12:15], v[36:39], v[80:83]
    s_barrier
    ds_read_b128 v[24:27], v1 offset:0
    s_waitcnt lgkmcnt(4)
    v_mfma_f32_16x16x32_bf16 v[52:55], v[32:35], v[28:31], v[52:55]
    ds_read_b128 v[36:39], v5 offset:42496
    v_mfma_f32_16x16x32_bf16 v[84:87], v[12:15], v[28:31], v[84:87]
L_mh11:
    s_cbranch_execz L_mhret
    s_waitcnt lgkmcnt(4)
    v_mfma_f32_16x16x32_bf16 v[56:59], v[32:35], v[8:11], v[56:59]
    ds_read_b128 v[28:31], v4 offset:49152
    v_mfma_f32_16x16x32_bf16 v[88:91], v[12:15], v[8:11], v[88:91]
    ds_read_b128 v[8:11], v1 offset:2048
    s_waitcnt lgkmcnt(5)
    v_mfma_f32_16x16x32_bf16 v[60:63], v[32:35], v[20:23], v[60:63]
    v_mfma_f32_16x16x32_bf16 v[92:95], v[12:15], v[20:23], v[92:95]
    ds_read_b128 v[20:23], v4 offset:49664
    s_waitcnt lgkmcnt(5)
    v_mfma_f32_16x16x32_bf16 v[64:67], v[32:35], v[16:19], v[64:67]
    v_mfma_f32_16x16x32_bf16 v[96:99], v[12:15], v[16:19], v[96:99]
    ds_read_b128 v[16:19], v4 offset:50176
    s_waitcnt lgkmcnt(4)
    v_mfma_f32_16x16x32_bf16 v[68:71], v[32:35], v[36:39], v[68:71]
    ds_read_b128 v[32:35], v4 offset:50688
    v_mfma_f32_16x16x32_bf16 v[100:103], v[12:15], v[36:39], v[100:103]
    s_waitcnt lgkmcnt(4)
    v_mfma_f32_16x16x32_bf16 v[40:43], v[24:27], v[28:31], v[40:43]
    ds_read_b128 v[12:15], v5 offset:49152
    s_waitcnt lgkmcnt(4)
    v_mfma_f32_16x16x32_bf16 v[72:75], v[8:11], v[28:31], v[72:75]
    s_waitcnt lgkmcnt(3)
    v_mfma_f32_16x16x32_bf16 v[44:47], v[24:27], v[20:23], v[44:47]
    ds_read_b128 v[28:31], v5 offset:49664
    v_mfma_f32_16x16x32_bf16 v[76:79], v[8:11], v[20:23], v[76:79]
    s_waitcnt lgkmcnt(3)
    v_mfma_f32_16x16x32_bf16 v[48:51], v[24:27], v[16:19], v[48:51]
    ds_read_b128 v[20:23], v5 offset:50176
    v_mfma_f32_16x16x32_bf16 v[80:83], v[8:11], v[16:19], v[80:83]
    ds_read_b128 v[36:39], v3 offset:0
    s_waitcnt lgkmcnt(4)
    v_mfma_f32_16x16x32_bf16 v[52:55], v[24:27], v[32:35], v[52:55]
    ds_read_b128 v[16:19], v5 offset:50688
    v_mfma_f32_16x16x32_bf16 v[84:87], v[8:11], v[32:35], v[84:87]
    s_waitcnt lgkmcnt(4)
    v_mfma_f32_16x16x32_bf16 v[56:59], v[24:27], v[12:15], v[56:59]
    ds_read_b128 v[32:35], v4 offset:57344
    v_mfma_f32_16x16x32_bf16 v[88:91], v[8:11], v[12:15], v[88:91]
    ds_read_b128 v[12:15], v3 offset:2048
    s_waitcnt lgkmcnt(5)
    v_mfma_f32_16x16x32_bf16 v[60:63], v[24:27], v[28:31], v[60:63]
    v_mfma_f32_16x16x32_bf16 v[92:95], v[8:11], v[28:31], v[92:95]
    ds_read_b128 v[28:31], v4 offset:57856
    s_waitcnt lgkmcnt(5)
    v_mfma_f32_16x16x32_bf16 v[64:67], v[24:27], v[20:23], v[64:67]
    v_mfma_f32_16x16x32_bf16 v[96:99], v[8:11], v[20:23], v[96:99]
    ds_read_b128 v[20:23], v4 offset:58368
L_mh12:
    s_cbranch_execz L_mh13
    s_waitcnt lgkmcnt(4)
    v_mfma_f32_16x16x32_bf16 v[68:71], v[24:27], v[16:19], v[68:71]
    ds_read_b128 v[24:27], v4 offset:58880
    v_mfma_f32_16x16x32_bf16 v[100:103], v[8:11], v[16:19], v[100:103]
    s_waitcnt lgkmcnt(4)
    v_mfma_f32_16x16x32_bf16 v[40:43], v[36:39], v[32:35], v[40:43]
    ds_read_b128 v[8:11], v5 offset:57344
    s_waitcnt lgkmcnt(4)
    v_mfma_f32_16x16x32_bf16 v[72:75], v[12:15], v[32:35], v[72:75]
    s_waitcnt lgkmcnt(3)
    v_mfma_f32_16x16x32_bf16 v[44:47], v[36:39], v[28:31], v[44:47]
    ds_read_b128 v[32:35], v5 offset:57856
    v_mfma_f32_16x16x32_bf16 v[76:79], v[12:15], v[28:31], v[76:79]
    s_waitcnt lgkmcnt(3)
    v_mfma_f32_16x16x32_bf16 v[48:51], v[36:39], v[20:23], v[48:51]
    ds_read_b128 v[28:31], v5 offset:58368
    v_mfma_f32_16x16x32_bf16 v[80:83], v[12:15], v[20:23], v[80:83]
    ds_read_b128 v[16:19], v1 offset:4096
    s_waitcnt lgkmcnt(4)
    v_mfma_f32_16x16x32_bf16 v[52:55], v[36:39], v[24:27], v[52:55]
    ds_read_b128 v[20:23], v5 offset:58880
    v_mfma_f32_16x16x32_bf16 v[84:87], v[12:15], v[24:27], v[84:87]
    s_waitcnt lgkmcnt(4)
    v_mfma_f32_16x16x32_bf16 v[56:59], v[36:39], v[8:11], v[56:59]
    ds_read_b128 v[24:27], v4 offset:0
    v_mfma_f32_16x16x32_bf16 v[88:91], v[12:15], v[8:11], v[88:91]
    ds_read_b128 v[8:11], v1 offset:6144
    s_waitcnt lgkmcnt(5)
    v_mfma_f32_16x16x32_bf16 v[60:63], v[36:39], v[32:35], v[60:63]
    v_mfma_f32_16x16x32_bf16 v[92:95], v[12:15], v[32:35], v[92:95]
    ds_read_b128 v[32:35], v4 offset:512
    s_waitcnt lgkmcnt(5)
    v_mfma_f32_16x16x32_bf16 v[64:67], v[36:39], v[28:31], v[64:67]
    v_mfma_f32_16x16x32_bf16 v[96:99], v[12:15], v[28:31], v[96:99]
    ds_read_b128 v[28:31], v4 offset:1024
    s_waitcnt lgkmcnt(4)
    v_mfma_f32_16x16x32_bf16 v[68:71], v[36:39], v[20:23], v[68:71]
    ds_read_b128 v[36:39], v4 offset:1536
    v_mfma_f32_16x16x32_bf16 v[100:103], v[12:15], v[20:23], v[100:103]
    s_waitcnt lgkmcnt(4)
    v_mfma_f32_16x16x32_bf16 v[104:107], v[16:19], v[24:27], v[104:107]
    ds_read_b128 v[12:15], v5 offset:0
    s_waitcnt lgkmcnt(4)
    v_mfma_f32_16x16x32_bf16 v[136:139], v[8:11], v[24:27], v[136:139]
    s_waitcnt lgkmcnt(3)
    v_mfma_f32_16x16x32_bf16 v[108:111], v[16:19], v[32:35], v[108:111]
    ds_read_b128 v[24:27], v5 offset:512
    v_mfma_f32_16x16x32_bf16 v[140:143], v[8:11], v[32:35], v[140:143]
L_mh13:
    s_cbranch_execz L_mh14
    s_waitcnt lgkmcnt(3)
    v_mfma_f32_16x16x32_bf16 v[112:115], v[16:19], v[28:31], v[112:115]
    ds_read_b128 v[20:23], v5 offset:1024
    v_cvt_pk_bf16_f32 v32, v40, v44
    v_mfma_f32_16x16x32_bf16 v[144:147], v[8:11], v[28:31], v[144:147]
    v_cvt_pk_bf16_f32 v33, v48, v52
    s_waitcnt lgkmcnt(3)
    v_mfma_f32_16x16x32_bf16 v[116:119], v[16:19], v[36:39], v[116:119]
    ds_read_b128 v[28:31], v5 offset:1536
    v_cvt_pk_bf16_f32 v34, v56, v60
    v_mfma_f32_16x16x32_bf16 v[148:151], v[8:11], v[36:39], v[148:151]
    ds_read_b128 v[36:39], v3 offset:4096
    v_cvt_pk_bf16_f32 v35, v64, v68
    s_waitcnt lgkmcnt(4)
    v_mfma_f32_16x16x32_bf16 v[120:123], v[16:19], v[12:15], v[120:123]
    buffer_store_dwordx4 v[32:35], v6, s[28:31], s36 offen sc1 nt
    v_mfma_f32_16x16x32_bf16 v[152:155], v[8:11], v[12:15], v[152:155]
    ds_read_b128 v[12:15], v4 offset:8192
    s_add_u32 s36, s36, 7168
    s_waitcnt lgkmcnt(4)
    v_mfma_f32_16x16x32_bf16 v[124:127], v[16:19], v[24:27], v[124:127]
    v_cvt_pk_bf16_f32 v32, v41, v45
    v_mfma_f32_16x16x32_bf16 v[156:159], v[8:11], v[24:27], v[156:159]
    ds_read_b128 v[24:27], v3 offset:6144
    v_cvt_pk_bf16_f32 v33, v49, v53
    s_waitcnt lgkmcnt(4)
    v_mfma_f32_16x16x32_bf16 v[128:131], v[16:19], v[20:23], v[128:131]
    v_cvt_pk_bf16_f32 v34, v57, v61
    v_mfma_f32_16x16x32_bf16 v[160:163], v[8:11], v[20:23], v[160:163]
    ds_read_b128 v[20:23], v4 offset:8704
    v_cvt_pk_bf16_f32 v35, v65, v69
    s_waitcnt lgkmcnt(4)
    v_mfma_f32_16x16x32_bf16 v[132:135], v[16:19], v[28:31], v[132:135]
    ds_read_b128 v[16:19], v4 offset:9216
    buffer_store_dwordx4 v[32:35], v6, s[28:31], s36 offen sc1 nt
    v_mfma_f32_16x16x32_bf16 v[164:167], v[8:11], v[28:31], v[164:167]
    ds_read_b128 v[8:11], v4 offset:9728
    s_add_u32 s36, s36, 7168
    s_waitcnt lgkmcnt(4)
    v_mfma_f32_16x16x32_bf16 v[104:107], v[36:39], v[12:15], v[104:107]
    ds_read_b128 v[28:31], v5 offset:8192
    v_cvt_pk_bf16_f32 v32, v42, v46
    s_waitcnt lgkmcnt(4)
    v_mfma_f32_16x16x32_bf16 v[136:139], v[24:27], v[12:15], v[136:139]
    v_cvt_pk_bf16_f32 v33, v50, v54
    s_waitcnt lgkmcnt(3)
    v_mfma_f32_16x16x32_bf16 v[108:111], v[36:39], v[20:23], v[108:111]
    ds_read_b128 v[12:15], v5 offset:8704
L_mh14:
    s_cbranch_execz L_mh15
    v_cvt_pk_bf16_f32 v34, v58, v62
    v_mfma_f32_16x16x32_bf16 v[140:143], v[24:27], v[20:23], v[140:143]
    v_cvt_pk_bf16_f32 v35, v66, v70
    s_waitcnt lgkmcnt(3)
    v_mfma_f32_16x16x32_bf16 v[112:115], v[36:39], v[16:19], v[112:115]
    ds_read_b128 v[20:23], v5 offset:9216
    buffer_store_dwordx4 v[32:35], v6, s[28:31], s36 offen sc1 nt
    v_mfma_f32_16x16x32_bf16 v[144:147], v[24:27], v[16:19], v[144:147]
    s_add_u32 s36, s36, 7168
    s_waitcnt lgkmcnt(3)
    v_mfma_f32_16x16x32_bf16 v[116:119], v[36:39], v[8:11], v[116:119]
    ds_read_b128 v[16:19], v5 offset:9728
    v_cvt_pk_bf16_f32 v32, v43, v47
    v_mfma_f32_16x16x32_bf16 v[148:151], v[24:27], v[8:11], v[148:151]
    ds_read_b128 v[8:11], v1 offset:36864
    v_cvt_pk_bf16_f32 v33, v51, v55
    s_waitcnt lgkmcnt(4)
    v_mfma_f32_16x16x32_bf16 v[120:123], v[36:39], v[28:31], v[120:123]
    v_cvt_pk_bf16_f32 v34, v59, v63
    v_mfma_f32_16x16x32_bf16 v[152:155], v[24:27], v[28:31], v[152:155]
    ds_read_b128 v[28:31], v4 offset:16384
    v_cvt_pk_bf16_f32 v35, v67, v71
    s_waitcnt lgkmcnt(4)
    v_mfma_f32_16x16x32_bf16 v[124:127], v[36:39], v[12:15], v[124:127]
    buffer_store_dwordx4 v[32:35], v6, s[28:31], s36 offen sc1 nt
    v_mfma_f32_16x16x32_bf16 v[156:159], v[24:27], v[12:15], v[156:159]
    ds_read_b128 v[12:15], v1 offset:38912
    s_add_u32 s36, s36, 93184
    s_waitcnt lgkmcnt(4)
    v_mfma_f32_16x16x32_bf16 v[128:131], v[36:39], v[20:23], v[128:131]
    ds_read_b128 v[32:35], v4 offset:16896
    v_cvt_pk_bf16_f32 v40, v72, v76
    v_mfma_f32_16x16x32_bf16 v[160:163], v[24:27], v[20:23], v[160:163]
    ds_read_b128 v[48:51], v4 offset:17408
    v_cvt_pk_bf16_f32 v41, v80, v84
    s_waitcnt lgkmcnt(5)
    v_mfma_f32_16x16x32_bf16 v[132:135], v[36:39], v[16:19], v[132:135]
    ds_read_b128 v[36:39], v4 offset:17920
    v_cvt_pk_bf16_f32 v42, v88, v92
    v_mfma_f32_16x16x32_bf16 v[164:167], v[24:27], v[16:19], v[164:167]
    v_cvt_pk_bf16_f32 v43, v96, v100
    s_waitcnt lgkmcnt(4)
    v_mfma_f32_16x16x32_bf16 v[104:107], v[8:11], v[28:31], v[104:107]
    ds_read_b128 v[24:27], v5 offset:16384
    buffer_store_dwordx4 v[40:43], v6, s[28:31], s36 offen sc1 nt
    s_waitcnt lgkmcnt(4)
    v_mfma_f32_16x16x32_bf16 v[136:139], v[12:15], v[28:31], v[136:139]
    s_add_u32 s36, s36, 7168
L_mh15:
    s_cbranch_execz L_mh16
    s_waitcnt lgkmcnt(3)
    v_mfma_f32_16x16x32_bf16 v[108:111], v[8:11], v[32:35], v[108:111]
    ds_read_b128 v[28:31], v5 offset:16896
    v_cvt_pk_bf16_f32 v44, v73, v77
    v_mfma_f32_16x16x32_bf16 v[140:143], v[12:15], v[32:35], v[140:143]
    v_cvt_pk_bf16_f32 v45, v81, v85
    s_waitcnt lgkmcnt(3)
    v_mfma_f32_16x16x32_bf16 v[112:115], v[8:11], v[48:51], v[112:115]
    ds_read_b128 v[32:35], v5 offset:17408
    v_cvt_pk_bf16_f32 v46, v89, v93
    v_mfma_f32_16x16x32_bf16 v[144:147], v[12:15], v[48:51], v[144:147]
    ds_read_b128 v[16:19], v3 offset:36864
    v_cvt_pk_bf16_f32 v47, v97, v101
    s_waitcnt lgkmcnt(4)
    v_mfma_f32_16x16x32_bf16 v[116:119], v[8:11], v[36:39], v[116:119]
    ds_read_b128 v[48:51], v5 offset:17920
    buffer_store_dwordx4 v[44:47], v6, s[28:31], s36 offen sc1 nt
    v_mfma_f32_16x16x32_bf16 v[148:151], v[12:15], v[36:39], v[148:151]
    ds_read_b128 v[20:23], v3 offset:38912
    s_add_u32 s36, s36, 7168
    s_waitcnt lgkmcnt(5)
    v_mfma_f32_16x16x32_bf16 v[120:123], v[8:11], v[24:27], v[120:123]
    ds_read_b128 v[36:39], v4 offset:24576
    v_cvt_pk_bf16_f32 v40, v74, v78
    v_mfma_f32_16x16x32_bf16 v[152:155], v[12:15], v[24:27], v[152:155]
    v_cvt_pk_bf16_f32 v41, v82, v86
    s_waitcnt lgkmcnt(5)
    v_mfma_f32_16x16x32_bf16 v[124:127], v[8:11], v[28:31], v[124:127]
    ds_read_b128 v[24:27], v4 offset:25088
    v_cvt_pk_bf16_f32 v42, v90, v94
    v_mfma_f32_16x16x32_bf16 v[156:159], v[12:15], v[28:31], v[156:159]
    v_cvt_pk_bf16_f32 v43, v98, v102
    s_waitcnt lgkmcnt(5)
    v_mfma_f32_16x16x32_bf16 v[128:131], v[8:11], v[32:35], v[128:131]
    ds_read_b128 v[28:31], v4 offset:25600
    buffer_store_dwordx4 v[40:43], v6, s[28:31], s36 offen sc1 nt
    v_mfma_f32_16x16x32_bf16 v[160:163], v[12:15], v[32:35], v[160:163]
    s_add_u32 s36, s36, 7168
    s_waitcnt lgkmcnt(4)
    v_mfma_f32_16x16x32_bf16 v[132:135], v[8:11], v[48:51], v[132:135]
    ds_read_b128 v[8:11], v4 offset:26112
    v_cvt_pk_bf16_f32 v44, v75, v79
    v_mfma_f32_16x16x32_bf16 v[164:167], v[12:15], v[48:51], v[164:167]
    v_cvt_pk_bf16_f32 v45, v83, v87
    s_waitcnt lgkmcnt(3)
    v_mfma_f32_16x16x32_bf16 v[104:107], v[16:19], v[36:39], v[104:107]
    ds_read_b128 v[12:15], v5 offset:24576
    v_cvt_pk_bf16_f32 v46, v91, v95
L_mh16:
    s_cbranch_execz L_mh17
    v_mfma_f32_16x16x32_bf16 v[136:139], v[20:23], v[36:39], v[136:139]
    v_cvt_pk_bf16_f32 v47, v99, v103
    s_waitcnt lgkmcnt(3)
    v_mfma_f32_16x16x32_bf16 v[108:111], v[16:19], v[24:27], v[108:111]
    ds_read_b128 v[36:39], v5 offset:25088
    buffer_store_dwordx4 v[44:47], v6, s[28:31], s36 offen sc1 nt
    v_mfma_f32_16x16x32_bf16 v[140:143], v[20:23], v[24:27], v[140:143]
    ds_read_b128 v[48:51], v4 offset:49152
    s_add_u32 s36, s36, 93184
    s_waitcnt lgkmcnt(4)
    v_mfma_f32_16x16x32_bf16 v[112:115], v[16:19], v[28:31], v[112:115]
    ds_read_b128 v[80:83], v5 offset:25600
    v_mfma_f32_16x16x32_bf16 v[144:147], v[20:23], v[28:31], v[144:147]
    s_barrier
    ds_read_b128 v[24:27], v7 offset:4096
    s_waitcnt lgkmcnt(5)
    v_mfma_f32_16x16x32_bf16 v[116:119], v[16:19], v[8:11], v[116:119]
    ds_read_b128 v[28:31], v5 offset:26112
    v_mfma_f32_16x16x32_bf16 v[148:151], v[20:23], v[8:11], v[148:151]
    ds_read_b128 v[32:35], v0 offset:4096
    s_waitcnt lgkmcnt(6)
    v_mfma_f32_16x16x32_bf16 v[120:123], v[16:19], v[12:15], v[120:123]
    ds_read_b128 v[8:11], v4 offset:32768
    v_mfma_f32_16x16x32_bf16 v[152:155], v[20:23], v[12:15], v[152:155]
    ds_read_b128 v[12:15], v4 offset:33280
    s_waitcnt lgkmcnt(7)
    v_mfma_f32_16x16x32_bf16 v[124:127], v[16:19], v[36:39], v[124:127]
    ds_read_b128 v[84:87], v4 offset:33792
    v_mfma_f32_16x16x32_bf16 v[156:159], v[20:23], v[36:39], v[156:159]
    ds_read_b128 v[36:39], v4 offset:34304
    s_waitcnt lgkmcnt(7)
    v_mfma_f32_16x16x32_bf16 v[128:131], v[16:19], v[80:83], v[128:131]
    ds_read_b128 v[88:91], v5 offset:32768
    v_mfma_f32_16x16x32_bf16 v[160:163], v[20:23], v[80:83], v[160:163]
    ds_read_b128 v[80:83], v5 offset:33280
    s_waitcnt lgkmcnt(7)
    v_mfma_f32_16x16x32_bf16 v[132:135], v[16:19], v[28:31], v[132:135]
    ds_read_b128 v[16:19], v5 offset:33792
    v_mfma_f32_16x16x32_bf16 v[164:167], v[20:23], v[28:31], v[164:167]
    ds_read_b128 v[28:31], v5 offset:34304
    s_waitcnt lgkmcnt(7)
    v_mfma_f32_16x16x32_bf16 v[104:107], v[24:27], v[8:11], v[104:107]
    ds_read_b128 v[8:11], v4 offset:40960
    s_waitcnt lgkmcnt(7)
    v_mfma_f32_16x16x32_bf16 v[108:111], v[24:27], v[12:15], v[108:111]
    ds_read_b128 v[12:15], v4 offset:41472
    s_waitcnt lgkmcnt(7)
    v_mfma_f32_16x16x32_bf16 v[112:115], v[24:27], v[84:87], v[112:115]
L_mh17:
    s_cbranch_execz L_mhret
    ds_read_b128 v[84:87], v4 offset:41984
    s_waitcnt lgkmcnt(7)
    v_mfma_f32_16x16x32_bf16 v[116:119], v[24:27], v[36:39], v[116:119]
    ds_read_b128 v[36:39], v4 offset:42496
    s_waitcnt lgkmcnt(7)
    v_mfma_f32_16x16x32_bf16 v[120:123], v[24:27], v[88:91], v[120:123]
    ds_read_b128 v[88:91], v5 offset:40960
    s_waitcnt lgkmcnt(7)
    v_mfma_f32_16x16x32_bf16 v[124:127], v[24:27], v[80:83], v[124:127]
    ds_read_b128 v[80:83], v5 offset:41472
    s_waitcnt lgkmcnt(7)
    v_mfma_f32_16x16x32_bf16 v[128:131], v[24:27], v[16:19], v[128:131]
    ds_read_b128 v[16:19], v5 offset:41984
    s_waitcnt lgkmcnt(7)
    v_mfma_f32_16x16x32_bf16 v[132:135], v[24:27], v[28:31], v[132:135]
    ds_read_b128 v[24:27], v5 offset:42496
    s_waitcnt lgkmcnt(7)
    v_mfma_f32_16x16x32_bf16 v[104:107], v[32:35], v[8:11], v[104:107]
    ds_read_b128 v[20:23], v1 offset:32768
    s_waitcnt lgkmcnt(7)
    v_mfma_f32_16x16x32_bf16 v[108:111], v[32:35], v[12:15], v[108:111]
    ds_read_b128 v[12:15], v4 offset:49664
    s_waitcnt lgkmcnt(7)
    v_mfma_f32_16x16x32_bf16 v[112:115], v[32:35], v[84:87], v[112:115]
    ds_read_b128 v[84:87], v4 offset:50176
    s_waitcnt lgkmcnt(7)
    v_mfma_f32_16x16x32_bf16 v[116:119], v[32:35], v[36:39], v[116:119]
    ds_read_b128 v[36:39], v4 offset:50688
    s_waitcnt lgkmcnt(7)
    v_mfma_f32_16x16x32_bf16 v[120:123], v[32:35], v[88:91], v[120:123]
    ds_read_b128 v[88:91], v5 offset:49152
    s_waitcnt lgkmcnt(7)
    v_mfma_f32_16x16x32_bf16 v[124:127], v[32:35], v[80:83], v[124:127]
    ds_read_b128 v[80:83], v5 offset:49664
    s_waitcnt lgkmcnt(7)
    v_mfma_f32_16x16x32_bf16 v[128:131], v[32:35], v[16:19], v[128:131]
    ds_read_b128 v[16:19], v5 offset:50176
    s_waitcnt lgkmcnt(7)
    v_mfma_f32_16x16x32_bf16 v[132:135], v[32:35], v[24:27], v[132:135]
    ds_read_b128 v[24:27], v5 offset:50688
    s_waitcnt lgkmcnt(7)
    v_mfma_f32_16x16x32_bf16 v[104:107], v[20:23], v[48:51], v[104:107]
    ds_read_b128 v[8:11], v3 offset:32768
    s_waitcnt lgkmcnt(7)
    v_mfma_f32_16x16x32_bf16 v[108:111], v[20:23], v[12:15], v[108:111]
    ds_read_b128 v[32:35], v4 offset:57344
    s_waitcnt lgkmcnt(7)
    v_mfma_f32_16x16x32_bf16 v[112:115], v[20:23], v[84:87], v[112:115]
L_mh18:
    s_cbranch_execz L_mh19
    ds_read_b128 v[28:31], v4 offset:57856
    s_waitcnt lgkmcnt(7)
    v_mfma_f32_16x16x32_bf16 v[116:119], v[20:23], v[36:39], v[116:119]
    ds_read_b128 v[92:95], v4 offset:58368
    s_waitcnt lgkmcnt(7)
    v_mfma_f32_16x16x32_bf16 v[120:123], v[20:23], v[88:91], v[120:123]
    ds_read_b128 v[96:99], v4 offset:58880
    s_waitcnt lgkmcnt(7)
    v_mfma_f32_16x16x32_bf16 v[124:127], v[20:23], v[80:83], v[124:127]
    ds_read_b128 v[100:103], v5 offset:57344
    s_waitcnt lgkmcnt(7)
    v_mfma_f32_16x16x32_bf16 v[128:131], v[20:23], v[16:19], v[128:131]
    ds_read_b128 v[52:55], v5 offset:57856
    s_waitcnt lgkmcnt(7)
    v_mfma_f32_16x16x32_bf16 v[132:135], v[20:23], v[24:27], v[132:135]
    ds_read_b128 v[56:59], v5 offset:58368
    s_waitcnt lgkmcnt(6)
    v_mfma_f32_16x16x32_bf16 v[104:107], v[8:11], v[32:35], v[104:107]
    ds_read_b128 v[20:23], v5 offset:58880
    s_waitcnt lgkmcnt(6)
    v_mfma_f32_16x16x32_bf16 v[108:111], v[8:11], v[28:31], v[108:111]
    ds_read_b128 v[60:63], v1 offset:34816
    s_waitcnt lgkmcnt(6)
    v_mfma_f32_16x16x32_bf16 v[112:115], v[8:11], v[92:95], v[112:115]
    s_waitcnt lgkmcnt(5)
    v_mfma_f32_16x16x32_bf16 v[116:119], v[8:11], v[96:99], v[116:119]
    s_waitcnt lgkmcnt(4)
    v_mfma_f32_16x16x32_bf16 v[120:123], v[8:11], v[100:103], v[120:123]
    s_waitcnt lgkmcnt(3)
    v_mfma_f32_16x16x32_bf16 v[124:127], v[8:11], v[52:55], v[124:127]
    s_waitcnt lgkmcnt(2)
    v_mfma_f32_16x16x32_bf16 v[128:131], v[8:11], v[56:59], v[128:131]
    ds_read_b128 v[64:67], v3 offset:34816
    s_waitcnt lgkmcnt(2)
    v_mfma_f32_16x16x32_bf16 v[132:135], v[8:11], v[20:23], v[132:135]
    s_waitcnt lgkmcnt(1)
    v_mfma_f32_16x16x32_bf16 v[136:139], v[60:63], v[48:51], v[136:139]
    v_mfma_f32_16x16x32_bf16 v[140:143], v[60:63], v[12:15], v[140:143]
    v_mfma_f32_16x16x32_bf16 v[144:147], v[60:63], v[84:87], v[144:147]
    v_mfma_f32_16x16x32_bf16 v[148:151], v[60:63], v[36:39], v[148:151]
    v_mfma_f32_16x16x32_bf16 v[152:155], v[60:63], v[88:91], v[152:155]
    v_mfma_f32_16x16x32_bf16 v[156:159], v[60:63], v[80:83], v[156:159]
    v_cvt_pk_bf16_f32 v72, v104, v108
    v_mfma_f32_16x16x32_bf16 v[160:163], v[60:63], v[16:19], v[160:163]
    ds_read_b128 v[16:19], v7 offset:6144
    v_cvt_pk_bf16_f32 v73, v112, v116
    v_mfma_f32_16x16x32_bf16 v[164:167], v[60:63], v[24:27], v[164:167]
    ds_read_b128 v[8:11], v0 offset:6144
L_mh19:
    s_cbranch_execz L_mh20
    v_cvt_pk_bf16_f32 v74, v120, v124
    s_waitcnt lgkmcnt(2)
    v_mfma_f32_16x16x32_bf16 v[136:139], v[64:67], v[32:35], v[136:139]
    ds_read_b128 v[32:35], v4 offset:32768
    v_cvt_pk_bf16_f32 v75, v128, v132
    v_mfma_f32_16x16x32_bf16 v[140:143], v[64:67], v[28:31], v[140:143]
    ds_read_b128 v[28:31], v4 offset:33280
    buffer_store_dwordx4 v[72:75], v6, s[28:31], s36 offen sc1 nt
    v_mfma_f32_16x16x32_bf16 v[144:147], v[64:67], v[92:95], v[144:147]
    ds_read_b128 v[92:95], v4 offset:33792
    s_add_u32 s36, s36, 7168
    v_mfma_f32_16x16x32_bf16 v[148:151], v[64:67], v[96:99], v[148:151]
    ds_read_b128 v[96:99], v4 offset:34304
    v_cvt_pk_bf16_f32 v76, v105, v109
    v_mfma_f32_16x16x32_bf16 v[152:155], v[64:67], v[100:103], v[152:155]
    ds_read_b128 v[100:103], v5 offset:32768
    v_cvt_pk_bf16_f32 v77, v113, v117
    v_mfma_f32_16x16x32_bf16 v[156:159], v[64:67], v[52:55], v[156:159]
    ds_read_b128 v[52:55], v5 offset:33280
    v_cvt_pk_bf16_f32 v78, v121, v125
    v_mfma_f32_16x16x32_bf16 v[160:163], v[64:67], v[56:59], v[160:163]
    ds_read_b128 v[56:59], v5 offset:33792
    v_cvt_pk_bf16_f32 v79, v129, v133
    v_mfma_f32_16x16x32_bf16 v[164:167], v[64:67], v[20:23], v[164:167]
    ds_read_b128 v[20:23], v5 offset:34304
    buffer_store_dwordx4 v[76:79], v6, s[28:31], s36 offen sc1 nt
    s_waitcnt lgkmcnt(7)
    v_mfma_f32_16x16x32_bf16 v[136:139], v[16:19], v[32:35], v[136:139]
    ds_read_b128 v[32:35], v4 offset:40960
    s_add_u32 s36, s36, 7168
    s_waitcnt lgkmcnt(7)
    v_mfma_f32_16x16x32_bf16 v[140:143], v[16:19], v[28:31], v[140:143]
    ds_read_b128 v[28:31], v4 offset:41472
    v_cvt_pk_bf16_f32 v72, v106, v110
    s_waitcnt lgkmcnt(7)
    v_mfma_f32_16x16x32_bf16 v[144:147], v[16:19], v[92:95], v[144:147]
    ds_read_b128 v[92:95], v4 offset:41984
    v_cvt_pk_bf16_f32 v73, v114, v118
    s_waitcnt lgkmcnt(7)
    v_mfma_f32_16x16x32_bf16 v[148:151], v[16:19], v[96:99], v[148:151]
    ds_read_b128 v[96:99], v4 offset:42496
    v_cvt_pk_bf16_f32 v74, v122, v126
    s_waitcnt lgkmcnt(7)
    v_mfma_f32_16x16x32_bf16 v[152:155], v[16:19], v[100:103], v[152:155]
    ds_read_b128 v[100:103], v5 offset:40960
    v_cvt_pk_bf16_f32 v75, v130, v134
    s_waitcnt lgkmcnt(7)
    v_mfma_f32_16x16x32_bf16 v[156:159], v[16:19], v[52:55], v[156:159]
L_mh20:
    s_cbranch_execz L_mh21
    ds_read_b128 v[52:55], v5 offset:41472
    buffer_store_dwordx4 v[72:75], v6, s[28:31], s36 offen sc1 nt
    s_waitcnt lgkmcnt(7)
    v_mfma_f32_16x16x32_bf16 v[160:163], v[16:19], v[56:59], v[160:163]
    ds_read_b128 v[56:59], v5 offset:41984
    s_add_u32 s36, s36, 7168
    s_waitcnt lgkmcnt(7)
    v_mfma_f32_16x16x32_bf16 v[164:167], v[16:19], v[20:23], v[164:167]
    ds_read_b128 v[16:19], v5 offset:42496
    v_cvt_pk_bf16_f32 v76, v107, v111
    s_waitcnt lgkmcnt(7)
    v_mfma_f32_16x16x32_bf16 v[136:139], v[8:11], v[32:35], v[136:139]
    v_cvt_pk_bf16_f32 v77, v115, v119
    s_waitcnt lgkmcnt(6)
    v_mfma_f32_16x16x32_bf16 v[140:143], v[8:11], v[28:31], v[140:143]
    v_cvt_pk_bf16_f32 v78, v123, v127
    s_waitcnt lgkmcnt(5)
    v_mfma_f32_16x16x32_bf16 v[144:147], v[8:11], v[92:95], v[144:147]
    v_cvt_pk_bf16_f32 v79, v131, v135
    s_waitcnt lgkmcnt(4)
    v_mfma_f32_16x16x32_bf16 v[148:151], v[8:11], v[96:99], v[148:151]
    buffer_store_dwordx4 v[76:79], v6, s[28:31], s36 offen sc1 nt
    s_waitcnt lgkmcnt(3)
    v_mfma_f32_16x16x32_bf16 v[152:155], v[8:11], v[100:103], v[152:155]
    s_add_u32 s36, s36, 93184
    s_waitcnt lgkmcnt(2)
    v_mfma_f32_16x16x32_bf16 v[156:159], v[8:11], v[52:55], v[156:159]
    s_waitcnt lgkmcnt(1)
    v_mfma_f32_16x16x32_bf16 v[160:163], v[8:11], v[56:59], v[160:163]
    s_waitcnt lgkmcnt(0)
    v_mfma_f32_16x16x32_bf16 v[164:167], v[8:11], v[16:19], v[164:167]
    s_nop 7
    v_cvt_pk_bf16_f32 v32, v136, v140
    v_cvt_pk_bf16_f32 v33, v144, v148
    v_cvt_pk_bf16_f32 v34, v152, v156
    v_cvt_pk_bf16_f32 v35, v160, v164
    buffer_store_dwordx4 v[32:35], v6, s[28:31], s36 offen sc1 nt
    s_add_u32 s36, s36, 7168
    v_cvt_pk_bf16_f32 v36, v137, v141
    v_cvt_pk_bf16_f32 v37, v145, v149
    v_cvt_pk_bf16_f32 v38, v153, v157
    v_cvt_pk_bf16_f32 v39, v161, v165
    buffer_store_dwordx4 v[36:39], v6, s[28:31], s36 offen sc1 nt
    s_add_u32 s36, s36, 7168
    v_cvt_pk_bf16_f32 v32, v138, v142
    v_cvt_pk_bf16_f32 v33, v146, v150
    v_cvt_pk_bf16_f32 v34, v154, v158
    v_cvt_pk_bf16_f32 v35, v162, v166
L_mh21:
    s_cbranch_execz L_mhret
    buffer_store_dwordx4 v[32:35], v6, s[28:31], s36 offen sc1 nt
    s_add_u32 s36, s36, 7168
    v_cvt_pk_bf16_f32 v36, v139, v143
    v_cvt_pk_bf16_f32 v37, v147, v151
    v_cvt_pk_bf16_f32 v38, v155, v159
    v_cvt_pk_bf16_f32 v39, v163, v167
    buffer_store_dwordx4 v[36:39], v6, s[28:31], s36 offen sc1 nt
    s_add_u32 s36, s36, 93184
L_done:
    s_endpgm
    .p2align 6
L_hloop:
    s_cbranch_execz L_hopret
    s_setprio 1
    s_lshl_b32 s50, s49, 2
    s_lshr_b64 s[50:51], s[82:83], s50
    s_and_b32 s50, s50, 15
    s_lshl_b32 s53, s55, 15
    s_add_u32 s53, s53, s44
    s_and_b32 s41, s49, 3
    s_lshl_b32 s41, s41, 14
    s_sub_u32 s35, s55, 1
    s_cselect_b32 s55, 2, s35
    s_add_u32 s92, s49, 2
    s_lshl_b32 s86, s92, 2
    s_lshr_b64 s[86:87], s[82:83], s86
    s_and_b32 s86, s86, 15
    s_xor_b32 s88, s41, 32768
    s_cmp_eq_u32 s91, 1
    s_cbranch_scc1 L_hx1
    s_bitcmp1_b32 s38, s50
    s_cbranch_scc1 L_hx
    s_cmp_lt_u32 s49, s93
    s_cbranch_scc1 L_hn
    buffer_load_dword v14, v12, s[68:71], 0 offen sc0 sc1
    s_mov_b32 m0, s53
    s_lshl_b32 s42, s50, 7
    buffer_load_dwordx4 v9, s[16:19], s42 offen offset:0 lds
    s_add_u32 s42, s42, s98
    buffer_load_dwordx4 v10, s[16:19], s42 offen offset:1024 lds
    s_add_u32 s42, s42, s98
    buffer_load_dwordx4 v9, s[16:19], s42 offen offset:2048 lds
    s_add_u32 s42, s42, s98
    buffer_load_dwordx4 v10, s[16:19], s42 offen offset:3072 lds
    s_waitcnt vmcnt(4)
    v_cmp_ne_u32 vcc, v14, v13
    s_nop 4
    s_and_b32 s35, vcc_lo, 0xffff
    s_or_b32 s38, s38, s35
    s_bitcmp1_b32 s38, s50
    s_cbranch_scc1 L_hw
    s_branch L_hn1
L_hn:
    s_mov_b32 m0, s53
    s_lshl_b32 s42, s50, 7
    buffer_load_dwordx4 v9, s[16:19], s42 offen offset:0 lds
    s_add_u32 s42, s42, s98
    buffer_load_dwordx4 v10, s[16:19], s42 offen offset:1024 lds
    s_add_u32 s42, s42, s98
    buffer_load_dwordx4 v9, s[16:19], s42 offen offset:2048 lds
    s_add_u32 s42, s42, s98
    buffer_load_dwordx4 v10, s[16:19], s42 offen offset:3072 lds
L_hn1:
    s_cmp_ge_u32 s49, 14
    s_cbranch_scc1 L_hn2
    s_add_u32 m0, s53, 4096
    s_add_u32 s42, s42, s99
    buffer_load_dwordx4 v9, s[16:19], s42 offen offset:0 lds
    s_add_u32 s42, s42, s98
    buffer_load_dwordx4 v10, s[16:19], s42 offen offset:1024 lds
    s_add_u32 s42, s42, s98
    buffer_load_dwordx4 v9, s[16:19], s42 offen offset:2048 lds
    s_add_u32 s42, s42, s98
    buffer_load_dwordx4 v10, s[16:19], s42 offen offset:3072 lds
L_hn2:
    s_mov_b32 s54, 2
    s_mul_i32 s43, s50, 917504
    tbuffer_load_format_d16_xyzw v[72:73], v8, s[20:23], s43 format:[BUF_DATA_FORMAT_32_32_32_32,BUF_NUM_FORMAT_UINT] offen
    s_add_u32 s43, s43, s97
    tbuffer_load_format_d16_xyzw v[74:75], v8, s[20:23], s43 format:[BUF_DATA_FORMAT_32_32_32_32,BUF_NUM_FORMAT_UINT] offen
    s_add_u32 s43, s43, s97
    tbuffer_load_format_d16_xyzw v[76:77], v8, s[20:23], s43 format:[BUF_DATA_FORMAT_32_32_32_32,BUF_NUM_FORMAT_UINT] offen
    s_add_u32 s43, s43, s97
    tbuffer_load_format_d16_xyzw v[78:79], v8, s[20:23], s43 format:[BUF_DATA_FORMAT_32_32_32_32,BUF_NUM_FORMAT_UINT] offen
    s_add_u32 s43, s43, s97
    tbuffer_load_format_d16_xyzw v[80:81], v8, s[20:23], s43 format:[BUF_DATA_FORMAT_32_32_32_32,BUF_NUM_FORMAT_UINT] offen
    s_add_u32 s43, s43, s97
    tbuffer_load_format_d16_xyzw v[82:83], v8, s[20:23], s43 format:[BUF_DATA_FORMAT_32_32_32_32,BUF_NUM_FORMAT_UINT] offen
    s_add_u32 s43, s43, s97
    tbuffer_load_format_d16_xyzw v[84:85], v8, s[20:23], s43 format:[BUF_DATA_FORMAT_32_32_32_32,BUF_NUM_FORMAT_UINT] offen
    s_add_u32 s43, s43, s97
    tbuffer_load_format_d16_xyzw v[86:87], v8, s[20:23], s43 format:[BUF_DATA_FORMAT_32_32_32_32,BUF_NUM_FORMAT_UINT] offen
    s_branch L_hp
L_hx:
    s_cbranch_execz L_hopret
    s_lshl_b32 s43, s50, 14
    s_add_u32 m0, s45, s41
    s_nop 0
    buffer_load_dwordx4 v15, s[68:71], s43 offen offset:0 sc1 lds
    buffer_load_dwordx4 v15, s[68:71], s43 offen offset:1024 sc1 lds
    buffer_load_dwordx4 v15, s[68:71], s43 offen offset:2048 sc1 lds
    buffer_load_dwordx4 v15, s[68:71], s43 offen offset:3072 sc1 lds
L_hx1:
    s_mov_b32 m0, s53
    s_lshl_b32 s42, s50, 7
    buffer_load_dwordx4 v9, s[16:19], s42 offen offset:0 lds
    s_add_u32 s42, s42, s98
    buffer_load_dwordx4 v10, s[16:19], s42 offen offset:1024 lds
    s_add_u32 s42, s42, s98
    buffer_load_dwordx4 v9, s[16:19], s42 offen offset:2048 lds
    s_add_u32 s42, s42, s98
    buffer_load_dwordx4 v10, s[16:19], s42 offen offset:3072 lds
    s_branch L_hw1
L_hw:
    s_lshl_b32 s43, s50, 14
    s_add_u32 m0, s45, s41
    s_nop 0
    buffer_load_dwordx4 v15, s[68:71], s43 offen offset:0 sc1 lds
    buffer_load_dwordx4 v15, s[68:71], s43 offen offset:1024 sc1 lds
    buffer_load_dwordx4 v15, s[68:71], s43 offen offset:2048 sc1 lds
    buffer_load_dwordx4 v15, s[68:71], s43 offen offset:3072 sc1 lds
L_hw1:
    s_mov_b32 s54, 0
L_hy:
    s_cmp_ge_u32 s49, 14
    s_cbranch_scc1 L_hb
    s_add_u32 m0, s53, 4096
    s_add_u32 s42, s42, s99
    buffer_load_dwordx4 v9, s[16:19], s42 offen offset:0 lds
    s_add_u32 s42, s42, s98
    buffer_load_dwordx4 v10, s[16:19], s42 offen offset:1024 lds
    s_add_u32 s42, s42, s98
    buffer_load_dwordx4 v9, s[16:19], s42 offen offset:2048 lds
    s_add_u32 s42, s42, s98
    buffer_load_dwordx4 v10, s[16:19], s42 offen offset:3072 lds
L_hp:
    s_cmp_lt_u32 s92, s93
    s_cbranch_scc1 L_hb
    s_cmp_ge_u32 s92, 16
    s_cbranch_scc1 L_hb
    s_bitcmp1_b32 s38, s86
    s_cbranch_scc1 L_hb
    buffer_load_dword v14, v12, s[68:71], 0 offen sc0 sc1
    s_or_b32 s54, s54, 4
L_hb:
    s_barrier
    s_mov_b32 s91, 0
    s_cmp_lt_u32 s49, 14
    s_cbranch_scc1 L_hb2
    s_cmp_lg_u32 s54, 0
    s_cbranch_scc1 L_hb2
    s_cmp_eq_u32 s49, 15
    s_cselect_b32 s35, 28672, 0
    s_add_u32 s53, s53, s35
    s_add_u32 m0, s53, 4096
    s_add_u32 s42, s42, s99
    buffer_load_dwordx4 v9, s[16:19], s42 offen offset:0 lds
    s_add_u32 s42, s42, s98
    buffer_load_dwordx4 v10, s[16:19], s42 offen offset:1024 lds
    s_add_u32 s42, s42, s98
    buffer_load_dwordx4 v9, s[16:19], s42 offen offset:2048 lds
    s_add_u32 s42, s42, s98
    buffer_load_dwordx4 v10, s[16:19], s42 offen offset:3072 lds
    s_waitcnt vmcnt(4)
    s_barrier
    s_cmp_eq_u32 s49, 15
    s_cbranch_scc1 L_hb3
    s_barrier
L_hb3:
    s_waitcnt vmcnt(0)
    s_barrier
    s_branch L_hend
L_hb2:
    s_and_b32 s35, s54, 3
    s_cbranch_scc0 L_hf
L_hq:
    v_add_u32 v17, s41, v11
    s_setprio 2
    s_waitcnt vmcnt(4)
L_hq0:
    s_cbranch_execz L_hopret
    v_lshl_or_b32 v88, v74, 8, v72
    v_lshl_or_b32 v89, v78, 8, v76
    v_perm_b32 v96, v89, v88, s84
    v_perm_b32 v102, v89, v88, s85
    v_xor_b32 v97, s58, v96
    v_xor_b32 v103, s58, v102
    v_perm_b32 v98, v41, v40, v96
    v_perm_b32 v104, v49, v48, v102
    v_perm_b32 v100, v45, v44, v96
    v_perm_b32 v106, v53, v52, v102
    v_perm_b32 v99, v43, v42, v97
    v_perm_b32 v105, v51, v50, v103
    v_perm_b32 v101, v47, v46, v97
    v_perm_b32 v107, v55, v54, v103
    v_xor_b32 v98, v98, v99
    v_xor_b32 v104, v104, v105
    v_xor_b32 v100, v100, v101
    v_xor_b32 v106, v106, v107
    v_perm_b32 v24, v100, v98, s46
    v_perm_b32 v28, v106, v104, s46
    v_perm_b32 v25, v100, v98, s47
    v_perm_b32 v29, v106, v104, s47
    v_lshl_or_b32 v88, v75, 8, v73
    v_lshl_or_b32 v89, v79, 8, v77
    v_perm_b32 v96, v89, v88, s84
    v_perm_b32 v102, v89, v88, s85
    v_xor_b32 v97, s58, v96
    v_xor_b32 v103, s58, v102
    v_perm_b32 v98, v57, v56, v96
    v_perm_b32 v104, v65, v64, v102
    v_perm_b32 v100, v61, v60, v96
    v_perm_b32 v106, v69, v68, v102
    v_perm_b32 v99, v59, v58, v97
    v_perm_b32 v105, v67, v66, v103
    v_perm_b32 v101, v63, v62, v97
    v_perm_b32 v107, v71, v70, v103
    v_xor_b32 v98, v98, v99
    v_xor_b32 v104, v104, v105
    v_xor_b32 v100, v100, v101
    v_xor_b32 v106, v106, v107
    v_perm_b32 v32, v100, v98, s46
    v_perm_b32 v36, v106, v104, s46
    v_perm_b32 v33, v100, v98, s47
    v_perm_b32 v37, v106, v104, s47
    s_bitcmp1_b32 s54, 3
    s_cbranch_scc1 L_hq2
    s_bitcmp1_b32 s54, 2
    s_cbranch_scc1 L_hq1
    s_waitcnt vmcnt(0)
L_hq1:
    s_waitcnt vmcnt(1)
L_hq2:
    s_cbranch_execz L_hopret
    v_lshl_or_b32 v90, v82, 8, v80
    v_lshl_or_b32 v91, v86, 8, v84
    v_perm_b32 v96, v91, v90, s84
    v_perm_b32 v102, v91, v90, s85
    v_xor_b32 v97, s58, v96
    v_xor_b32 v103, s58, v102
    v_perm_b32 v98, v41, v40, v96
    v_perm_b32 v104, v49, v48, v102
    v_perm_b32 v100, v45, v44, v96
    v_perm_b32 v106, v53, v52, v102
    v_perm_b32 v99, v43, v42, v97
    v_perm_b32 v105, v51, v50, v103
    v_perm_b32 v101, v47, v46, v97
    v_perm_b32 v107, v55, v54, v103
    v_xor_b32 v98, v98, v99
    v_xor_b32 v104, v104, v105
    v_xor_b32 v100, v100, v101
    v_xor_b32 v106, v106, v107
    v_perm_b32 v26, v100, v98, s46
    v_perm_b32 v30, v106, v104, s46
    v_perm_b32 v27, v100, v98, s47
    v_perm_b32 v31, v106, v104, s47
    v_lshl_or_b32 v90, v83, 8, v81
    v_lshl_or_b32 v91, v87, 8, v85
    v_perm_b32 v96, v91, v90, s84
    v_perm_b32 v102, v91, v90, s85
    v_xor_b32 v97, s58, v96
    v_xor_b32 v103, s58, v102
    v_perm_b32 v98, v57, v56, v96
    v_perm_b32 v104, v65, v64, v102
    v_perm_b32 v100, v61, v60, v96
    v_perm_b32 v106, v69, v68, v102
    v_perm_b32 v99, v59, v58, v97
    v_perm_b32 v105, v67, v66, v103
    v_perm_b32 v101, v63, v62, v97
    v_perm_b32 v107, v71, v70, v103
    v_xor_b32 v98, v98, v99
    v_xor_b32 v104, v104, v105
    v_xor_b32 v100, v100, v101
    v_xor_b32 v106, v106, v107
    v_perm_b32 v34, v100, v98, s46
    v_perm_b32 v38, v106, v104, s46
    v_perm_b32 v35, v100, v98, s47
    v_perm_b32 v39, v106, v104, s47
    ds_write_b128 v17, v[24:27] offset:0
    ds_write_b128 v17, v[28:31] offset:512
    ds_write_b128 v17, v[32:35] offset:1024
    ds_write_b128 v17, v[36:39] offset:1536
L_hg:
    s_cbranch_execz L_hopret
    s_bitcmp1_b32 s54, 2
    s_cbranch_scc0 L_hf0
    s_waitcnt vmcnt(0)
    v_cmp_ne_u32 vcc, v14, v13
    s_nop 4
    s_and_b32 s35, vcc_lo, 0xffff
    s_or_b32 s38, s38, s35
    s_branch L_hf0
L_hf:
    s_bitcmp1_b32 s54, 2
    s_cbranch_scc0 L_hf1
    s_waitcnt vmcnt(0)
    v_cmp_ne_u32 vcc, v14, v13
    s_nop 4
    s_and_b32 s35, vcc_lo, 0xffff
    s_or_b32 s38, s38, s35
L_hf1:
    s_sub_u32 s35, s92, 0
    s_cmp_ge_u32 s35, 16
    s_cbranch_scc1 L_hf0
    s_bitcmp1_b32 s38, s86
    s_cbranch_scc0 L_hf0
    s_lshl_b32 s43, s86, 14
    s_add_u32 m0, s45, s88
    s_nop 0
    buffer_load_dwordx4 v15, s[68:71], s43 offen offset:0 sc1 lds
    buffer_load_dwordx4 v15, s[68:71], s43 offen offset:1024 sc1 lds
    buffer_load_dwordx4 v15, s[68:71], s43 offen offset:2048 sc1 lds
    buffer_load_dwordx4 v15, s[68:71], s43 offen offset:3072 sc1 lds
    s_mov_b32 s91, 1
    s_waitcnt vmcnt(4) lgkmcnt(0)
    s_branch L_hz
L_hf0:
    s_waitcnt vmcnt(0) lgkmcnt(0)
L_hz:
    s_barrier
    s_mov_b32 s49, s92
    s_cmp_lt_u32 s49, 16
    s_cbranch_scc1 L_hloop
    s_cmp_eq_u32 s49, 17
    s_cselect_b32 s35, 28672, 0
    s_add_u32 s53, s53, s35
    s_add_u32 m0, s53, 4096
    s_add_u32 s42, s42, s99
    buffer_load_dwordx4 v9, s[16:19], s42 offen offset:0 lds
    s_add_u32 s42, s42, s98
    buffer_load_dwordx4 v10, s[16:19], s42 offen offset:1024 lds
    s_add_u32 s42, s42, s98
    buffer_load_dwordx4 v9, s[16:19], s42 offen offset:2048 lds
    s_add_u32 s42, s42, s98
    buffer_load_dwordx4 v10, s[16:19], s42 offen offset:3072 lds
    s_cmp_eq_u32 s49, 17
    s_cbranch_scc1 L_hb4
    s_barrier
L_hb4:
    s_waitcnt vmcnt(0)
    s_barrier
L_hend:
    s_endpgm
L_prod:
    s_cbranch_execz L_hopret
    s_cmp_lt_u32 s32, 8
    s_cbranch_scc1 L_prod1
    s_lshl_b32 s50, s49, 2
    s_lshr_b64 s[50:51], s[82:83], s50
    s_and_b32 s50, s50, 15
    s_mul_i32 s43, s50, 917504
    tbuffer_load_format_d16_xyzw v[72:73], v8, s[20:23], s43 format:[BUF_DATA_FORMAT_32_32_32_32,BUF_NUM_FORMAT_UINT] offen
    s_add_u32 s43, s43, s97
    tbuffer_load_format_d16_xyzw v[74:75], v8, s[20:23], s43 format:[BUF_DATA_FORMAT_32_32_32_32,BUF_NUM_FORMAT_UINT] offen
    s_add_u32 s43, s43, s97
    tbuffer_load_format_d16_xyzw v[76:77], v8, s[20:23], s43 format:[BUF_DATA_FORMAT_32_32_32_32,BUF_NUM_FORMAT_UINT] offen
    s_add_u32 s43, s43, s97
    tbuffer_load_format_d16_xyzw v[78:79], v8, s[20:23], s43 format:[BUF_DATA_FORMAT_32_32_32_32,BUF_NUM_FORMAT_UINT] offen
    s_add_u32 s43, s43, s97
    tbuffer_load_format_d16_xyzw v[80:81], v8, s[20:23], s43 format:[BUF_DATA_FORMAT_32_32_32_32,BUF_NUM_FORMAT_UINT] offen
    s_add_u32 s43, s43, s97
    tbuffer_load_format_d16_xyzw v[82:83], v8, s[20:23], s43 format:[BUF_DATA_FORMAT_32_32_32_32,BUF_NUM_FORMAT_UINT] offen
    s_add_u32 s43, s43, s97
    tbuffer_load_format_d16_xyzw v[84:85], v8, s[20:23], s43 format:[BUF_DATA_FORMAT_32_32_32_32,BUF_NUM_FORMAT_UINT] offen
    s_add_u32 s43, s43, s97
    tbuffer_load_format_d16_xyzw v[86:87], v8, s[20:23], s43 format:[BUF_DATA_FORMAT_32_32_32_32,BUF_NUM_FORMAT_UINT] offen
L_prod1:
    s_waitcnt vmcnt(4) lgkmcnt(0)
L_ploop:
    s_cbranch_execz L_hopret
    v_lshl_or_b32 v88, v74, 8, v72
    v_lshl_or_b32 v89, v78, 8, v76
    v_perm_b32 v96, v89, v88, s84
    v_perm_b32 v102, v89, v88, s85
    v_xor_b32 v97, s58, v96
    v_xor_b32 v103, s58, v102
    v_perm_b32 v98, v41, v40, v96
    v_perm_b32 v104, v49, v48, v102
    v_perm_b32 v100, v45, v44, v96
    v_perm_b32 v106, v53, v52, v102
    v_perm_b32 v99, v43, v42, v97
    v_perm_b32 v105, v51, v50, v103
    v_perm_b32 v101, v47, v46, v97
    v_perm_b32 v107, v55, v54, v103
    v_xor_b32 v98, v98, v99
    v_xor_b32 v104, v104, v105
    v_xor_b32 v100, v100, v101
    v_xor_b32 v106, v106, v107
    v_perm_b32 v24, v100, v98, s46
    v_perm_b32 v28, v106, v104, s46
    v_perm_b32 v25, v100, v98, s47
    v_perm_b32 v29, v106, v104, s47
    v_lshl_or_b32 v88, v75, 8, v73
    v_lshl_or_b32 v89, v79, 8, v77
    v_perm_b32 v96, v89, v88, s84
    v_perm_b32 v102, v89, v88, s85
    v_xor_b32 v97, s58, v96
    v_xor_b32 v103, s58, v102
    v_perm_b32 v98, v57, v56, v96
    v_perm_b32 v104, v65, v64, v102
    v_perm_b32 v100, v61, v60, v96
    v_perm_b32 v106, v69, v68, v102
    v_perm_b32 v99, v59, v58, v97
    v_perm_b32 v105, v67, v66, v103
    v_perm_b32 v101, v63, v62, v97
    v_perm_b32 v107, v71, v70, v103
    v_xor_b32 v98, v98, v99
    v_xor_b32 v104, v104, v105
    v_xor_b32 v100, v100, v101
    v_xor_b32 v106, v106, v107
    v_perm_b32 v32, v100, v98, s46
    v_perm_b32 v36, v106, v104, s46
    v_perm_b32 v33, v100, v98, s47
    v_perm_b32 v37, v106, v104, s47
    s_waitcnt vmcnt(0)
L_pmid:
    s_cbranch_execz L_hopret
    v_lshl_or_b32 v90, v82, 8, v80
    v_lshl_or_b32 v91, v86, 8, v84
    v_perm_b32 v96, v91, v90, s84
    v_perm_b32 v102, v91, v90, s85
    v_xor_b32 v97, s58, v96
    v_xor_b32 v103, s58, v102
    v_perm_b32 v98, v41, v40, v96
    v_perm_b32 v104, v49, v48, v102
    v_perm_b32 v100, v45, v44, v96
    v_perm_b32 v106, v53, v52, v102
    v_perm_b32 v99, v43, v42, v97
    v_perm_b32 v105, v51, v50, v103
    v_perm_b32 v101, v47, v46, v97
    v_perm_b32 v107, v55, v54, v103
    v_xor_b32 v98, v98, v99
    v_xor_b32 v104, v104, v105
    v_xor_b32 v100, v100, v101
    v_xor_b32 v106, v106, v107
    v_perm_b32 v26, v100, v98, s46
    v_perm_b32 v30, v106, v104, s46
    v_perm_b32 v27, v100, v98, s47
    v_perm_b32 v31, v106, v104, s47
    v_lshl_or_b32 v90, v83, 8, v81
    v_lshl_or_b32 v91, v87, 8, v85
    v_perm_b32 v96, v91, v90, s84
    v_perm_b32 v102, v91, v90, s85
    v_xor_b32 v97, s58, v96
    v_xor_b32 v103, s58, v102
    v_perm_b32 v98, v57, v56, v96
    v_perm_b32 v104, v65, v64, v102
    v_perm_b32 v100, v61, v60, v96
    v_perm_b32 v106, v69, v68, v102
    v_perm_b32 v99, v59, v58, v97
    v_perm_b32 v105, v67, v66, v103
    v_perm_b32 v101, v63, v62, v97
    v_perm_b32 v107, v71, v70, v103
    v_xor_b32 v98, v98, v99
    v_xor_b32 v104, v104, v105
    v_xor_b32 v100, v100, v101
    v_xor_b32 v106, v106, v107
    v_perm_b32 v34, v100, v98, s46
    v_perm_b32 v38, v106, v104, s46
    v_perm_b32 v35, v100, v98, s47
    v_perm_b32 v39, v106, v104, s47
L_ppub:
    s_cbranch_execz L_hopret
    s_lshl_b32 s52, s50, 14
    s_lshl_b64 s[36:37], 1, s50
    buffer_store_dwordx4 v[24:27], v20, s[68:71], s52 offen offset:0 sc1
    buffer_store_dwordx4 v[28:31], v20, s[68:71], s52 offen offset:512 sc1
    buffer_store_dwordx4 v[32:35], v20, s[68:71], s52 offen offset:1024 sc1
    buffer_store_dwordx4 v[36:39], v20, s[68:71], s52 offen offset:1536 sc1
    v_not_b32 v16, v13
    s_add_u32 s49, s49, 2
    s_cmp_ge_u32 s49, 16
    s_cbranch_scc1 L_plast
    s_lshl_b32 s50, s49, 2
    s_lshr_b64 s[50:51], s[82:83], s50
    s_and_b32 s50, s50, 15
    s_mul_i32 s43, s50, 917504
    tbuffer_load_format_d16_xyzw v[72:73], v8, s[20:23], s43 format:[BUF_DATA_FORMAT_32_32_32_32,BUF_NUM_FORMAT_UINT] offen
    s_add_u32 s43, s43, s97
    tbuffer_load_format_d16_xyzw v[74:75], v8, s[20:23], s43 format:[BUF_DATA_FORMAT_32_32_32_32,BUF_NUM_FORMAT_UINT] offen
    s_add_u32 s43, s43, s97
    tbuffer_load_format_d16_xyzw v[76:77], v8, s[20:23], s43 format:[BUF_DATA_FORMAT_32_32_32_32,BUF_NUM_FORMAT_UINT] offen
    s_add_u32 s43, s43, s97
    tbuffer_load_format_d16_xyzw v[78:79], v8, s[20:23], s43 format:[BUF_DATA_FORMAT_32_32_32_32,BUF_NUM_FORMAT_UINT] offen
    s_add_u32 s43, s43, s97
    tbuffer_load_format_d16_xyzw v[80:81], v8, s[20:23], s43 format:[BUF_DATA_FORMAT_32_32_32_32,BUF_NUM_FORMAT_UINT] offen
    s_add_u32 s43, s43, s97
    tbuffer_load_format_d16_xyzw v[82:83], v8, s[20:23], s43 format:[BUF_DATA_FORMAT_32_32_32_32,BUF_NUM_FORMAT_UINT] offen
    s_add_u32 s43, s43, s97
    tbuffer_load_format_d16_xyzw v[84:85], v8, s[20:23], s43 format:[BUF_DATA_FORMAT_32_32_32_32,BUF_NUM_FORMAT_UINT] offen
    s_add_u32 s43, s43, s97
    tbuffer_load_format_d16_xyzw v[86:87], v8, s[20:23], s43 format:[BUF_DATA_FORMAT_32_32_32_32,BUF_NUM_FORMAT_UINT] offen
    s_waitcnt vmcnt(8)
    s_mov_b64 exec, s[36:37]
    buffer_store_dword v16, v12, s[68:71], 0 offen  sc0 sc1
    s_mov_b64 exec, -1
    s_waitcnt vmcnt(5)
    s_branch L_ploop
L_plast:
    s_waitcnt vmcnt(0)
    s_mov_b64 exec, s[36:37]
    buffer_store_dword v16, v12, s[68:71], 0 offen  sc0 sc1
    s_mov_b64 exec, -1
    s_endpgm
    .p2align 7
    .type L_sched,@object
L_sched:
    .size L_sched, 256
    .long 0x76243510, 0xfedcba98
    .long 0x65237401, 0xfedcba98
    .long 0x63725410, 0xfedcba98
    .long 0x37265140, 0xfedcba98
    .long 0x31570264, 0xcfed8ba9
    .long 0x70235164, 0xcfed8ba9
    .long 0x17523064, 0xcfed8ba9
    .long 0x35741026, 0xcfed8ba9
    .long 0x7561423, 0xdcfe98ba
    .long 0x76015324, 0xdcfe98ba
    .long 0x60541732, 0xdcfe98ba
    .long 0x70652314, 0xdcfe98ba
    .long 0x67412350, 0xedcfa98b
    .long 0x76421530, 0xedcfa98b
    .long 0x23671450, 0xedcfa98b
    .long 0x47236105, 0xedcfa98b
    .long 0x76243510, 0xfedcba98
    .long 0x65237401, 0xfedcba98
    .long 0x63725410, 0xfedcba98
    .long 0x37265140, 0xfedcba98
    .long 0x31570264, 0xcfed8ba9
    .long 0x70235164, 0xcfed8ba9
    .long 0x17523064, 0xcfed8ba9
    .long 0x35741026, 0xcfed8ba9
    .long 0x7561423, 0xdcfe98ba
    .long 0x76015324, 0xdcfe98ba
    .long 0x60541732, 0xdcfe98ba
    .long 0x70652314, 0xdcfe98ba
    .long 0x67412350, 0xedcfa98b
    .long 0x76421530, 0xedcfa98b
    .long 0x23671450, 0xedcfa98b
    .long 0x47236105, 0xedcfa98b
    .fill 64, 4, 0xbf800000
.section .rodata,"a"
.p2align 6
.amdhsa_kernel standalone__weight_only_int_squeezellm__prompt_kernel
  .amdhsa_next_free_vgpr 168
  .amdhsa_next_free_sgpr 102
  .amdhsa_accum_offset 168
  .amdhsa_group_segment_fixed_size 0
  .amdhsa_kernarg_size 48
  .amdhsa_user_sgpr_count 2
  .amdhsa_user_sgpr_kernarg_segment_ptr 1
  .amdhsa_system_sgpr_workgroup_id_x 1
.end_amdhsa_kernel
```

```asm
; @launch grid=(256,1,1) block=(768,1,1) lds=163840
.amdgcn_target "amdgcn-amd-amdhsa--gfx950"
.text
.p2align 9
.fill 64, 4, 0xbf800000
.globl standalone__weight_only_int_squeezellm__prompt_kernel
.p2align 8
.type standalone__weight_only_int_squeezellm__prompt_kernel,@function
standalone__weight_only_int_squeezellm__prompt_kernel:
    v_lshrrev_b32 v1, 6, v0
    s_load_dwordx8 s[4:11], s[0:1], 0
    v_readfirstlane_b32 s32, v1
    s_lshr_b32 s13, s2, 3
    s_cmp_ge_u32 s13, 32
    s_cbranch_scc1 L_done
    s_load_dwordx2 s[56:57], s[0:1], 40
    v_and_b32 v2, 63, v0
    s_cmp_ge_u32 s32, 8
    s_cbranch_scc1 L_h1
    s_sub_u32 s14, s13, 4
    s_lshr_b32 s15, s14, 2
    s_and_b32 s14, s14, 3
    s_and_b32 s16, s2, 1
    s_lshl2_add_u32 s14, s16, s14
    s_cmp_lt_u32 s13, 4
    s_cselect_b32 s15, s14, s15
    s_cmp_eq_u32 s15, 7
    s_cbranch_scc1 L_done
    s_bfe_u32 s16, s2, 0x20001
    s_mul_i32 s16, s16, 7
    s_add_u32 s15, s15, s16
    s_and_b32 s33, s32, 3
    s_cmp_ge_u32 s32, 4
    s_cbranch_scc1 L_h0
    s_getpc_b64 s[50:51]
    s_and_b32 s12, s13, 7
    s_mul_i32 s12, s12, 13
    v_add_lshl_u32 v1, v0, s12, 7
    v_cmp_gt_u32 vcc, 13, v0
    s_and_saveexec_b64 s[54:55], vcc
    s_cbranch_execz L_cw
    global_load_dword v39, v1, s[50:51] offset:512
L_cw:
    s_mov_b64 exec, s[54:55]
    v_lshrrev_b32 v5, 3, v2
    v_and_b32 v7, 7, v2
    v_mul_u32_u24 v5, 7168, v5
    v_lshl_add_u32 v5, v7, 4, v5
    s_and_b32 s36, s32, 1
    s_lshl1_add_u32 s35, s15, s36
    s_lshl_b32 s35, s35, 7
    s_add_u32 s36, s35, 56320
    s_lshl_b32 s37, s32, 11
    s_add_u32 m0, s37, 135168
    s_mov_b32 s26, 114688
    s_mov_b32 s27, 0x20000
    s_setprio 3
    s_waitcnt lgkmcnt(0)
    s_mov_b64 s[24:25], s[8:9]
    buffer_load_dwordx4 v5, s[24:27], s35 offen lds
    buffer_load_dwordx4 v5, s[24:27], s36 offen offset:1024 lds
    s_branch L_mfma
L_h0:
    s_and_b32 s48, s15, 3
    s_lshr_b32 s59, s15, 2
    s_add_u32 s59, s59, s14
    s_and_b32 s59, s59, 3
    s_lshl2_add_u32 s48, s48, s59
    s_mov_b32 s50, 0x64440010
    s_mov_b32 s51, 0x50004243
    s_lshl_b32 s59, s48, 2
    s_lshr_b64 s[50:51], s[50:51], s59
    s_and_b32 s50, s50, 15
    v_lshrrev_b32 v3, 5, v2
    s_lshl_b32 s35, s33, 1
    v_add_u32 v4, s35, v3
    v_and_b32 v6, 31, v2
    v_mul_u32_u24 v8, 114688, v4
    v_lshl_add_u32 v8, v6, 4, v8
    s_lshl_b32 s35, s15, 9
    v_add_u32 v8, s35, v8
    s_mov_b32 s22, 14680064
    s_mov_b32 s23, 0x20000
    s_movk_i32 s97, 14336
    s_and_b32 s16, s48, 12
    s_lshr_b32 s16, 0xba98, s16
    s_and_b32 s16, s16, 15
    s_cmp_lt_u32 s13, 4
    s_cselect_b32 s50, s16, s50
    s_mul_i32 s43, s50, 917504
    s_setprio 2
    s_waitcnt lgkmcnt(0)
    s_mov_b64 s[20:21], s[6:7]
    tbuffer_load_format_d16_xyzw v[72:73], v8, s[20:23], s43 format:[BUF_DATA_FORMAT_32_32_32_32,BUF_NUM_FORMAT_UINT] offen
    s_add_u32 s43, s43, s97
    tbuffer_load_format_d16_xyzw v[74:75], v8, s[20:23], s43 format:[BUF_DATA_FORMAT_32_32_32_32,BUF_NUM_FORMAT_UINT] offen
    s_add_u32 s43, s43, s97
    tbuffer_load_format_d16_xyzw v[76:77], v8, s[20:23], s43 format:[BUF_DATA_FORMAT_32_32_32_32,BUF_NUM_FORMAT_UINT] offen
    s_add_u32 s43, s43, s97
    tbuffer_load_format_d16_xyzw v[78:79], v8, s[20:23], s43 format:[BUF_DATA_FORMAT_32_32_32_32,BUF_NUM_FORMAT_UINT] offen
    s_add_u32 s43, s43, s97
    tbuffer_load_format_d16_xyzw v[80:81], v8, s[20:23], s43 format:[BUF_DATA_FORMAT_32_32_32_32,BUF_NUM_FORMAT_UINT] offen
    s_add_u32 s43, s43, s97
    tbuffer_load_format_d16_xyzw v[82:83], v8, s[20:23], s43 format:[BUF_DATA_FORMAT_32_32_32_32,BUF_NUM_FORMAT_UINT] offen
    s_add_u32 s43, s43, s97
    tbuffer_load_format_d16_xyzw v[84:85], v8, s[20:23], s43 format:[BUF_DATA_FORMAT_32_32_32_32,BUF_NUM_FORMAT_UINT] offen
    s_add_u32 s43, s43, s97
    tbuffer_load_format_d16_xyzw v[86:87], v8, s[20:23], s43 format:[BUF_DATA_FORMAT_32_32_32_32,BUF_NUM_FORMAT_UINT] offen
    s_branch L_e2
    .p2align 9
L_h1:
    s_sub_u32 s14, s13, 4
    s_lshr_b32 s15, s14, 2
    s_and_b32 s14, s14, 3
    s_and_b32 s16, s2, 1
    s_lshl2_add_u32 s14, s16, s14
    s_cmp_lt_u32 s13, 4
    s_cselect_b32 s15, s14, s15
    s_cmp_eq_u32 s15, 7
    s_cbranch_scc1 L_done
    s_bfe_u32 s16, s2, 0x20001
    s_mul_i32 s16, s16, 7
    s_add_u32 s15, s15, s16
    s_and_b32 s33, s32, 3
    s_and_b32 s48, s15, 3
    s_lshr_b32 s59, s15, 2
    s_add_u32 s59, s59, s14
    s_and_b32 s59, s59, 3
    s_lshl2_add_u32 s48, s48, s59
    s_mov_b32 s50, 0x64440010
    s_mov_b32 s51, 0x50004243
    s_lshl_b32 s59, s48, 2
    s_lshr_b64 s[50:51], s[50:51], s59
    s_and_b32 s50, s50, 15
    v_lshrrev_b32 v5, 3, v2
    v_lshrrev_b32 v7, 4, v2
    v_and_b32 v10, 7, v2
    v_xor_b32 v7, v7, v10
    v_lshlrev_b32 v7, 4, v7
    s_lshl_b32 s35, s14, 19
    s_lshl_b32 s36, s33, 17
    s_add_u32 s35, s35, s36
    v_lshl_add_u32 v7, v5, 11, v7
    v_add_u32 v9, s35, v7
    v_xor_b32 v10, 64, v9
    s_lshl_b32 s44, s33, 13
    s_add_u32 s44, s44, 65536
    s_mov_b32 s18, 4194304
    s_mov_b32 s19, 0x20000
    s_movk_i32 s98, 15360
    s_movk_i32 s99, 19456
    s_mov_b32 s53, s44
    s_mov_b32 m0, s53
    s_lshl_b32 s42, s50, 7
    s_setprio 1
    s_waitcnt lgkmcnt(0)
    s_mov_b64 s[16:17], s[4:5]
    s_cmp_lt_u32 s13, 4
    s_cbranch_scc1 L_e2
    buffer_load_dwordx4 v9, s[16:19], s42 offen offset:0  lds
    s_add_u32 s42, s42, s98
    buffer_load_dwordx4 v10, s[16:19], s42 offen offset:1024  lds
    s_add_u32 s42, s42, s98
    buffer_load_dwordx4 v9, s[16:19], s42 offen offset:2048  lds
    s_add_u32 s42, s42, s98
    buffer_load_dwordx4 v10, s[16:19], s42 offen offset:3072  lds
    s_add_u32 m0, s53, 4096
    s_add_u32 s42, s42, s99
    buffer_load_dwordx4 v9, s[16:19], s42 offen offset:0  lds
    s_add_u32 s42, s42, s98
    buffer_load_dwordx4 v10, s[16:19], s42 offen offset:1024  lds
    s_branch L_e2
L_mfma:
    s_mov_b32 s36, m0
    s_lshr_b32 s37, s32, 1
    s_add_u32 s36, s36, s37
    v_lshlrev_b32 v7, 1, v2
    v_add_u32 v7, s36, v7
    v_and_b32 v3, 127, v0
    v_and_b32 v6, 3, v3
    v_lshlrev_b32 v6, 1, v6
    v_add_u32 v6, s37, v6
    v_lshrrev_b32 v3, 2, v3
    v_lshl_add_u32 v6, v6, 5, v3
    v_lshlrev_b32 v6, 4, v6
    v_add_u32 v6, 131072, v6
    s_mov_b32 s45, 0x0b0a0908
    s_mov_b32 s54, 0xffffff00
    s_waitcnt vmcnt(0)
    ds_read_u8 v40, v7 offset:0
    ds_read_u8 v41, v7 offset:128
    ds_read_u8 v42, v7 offset:256
    ds_read_u8 v43, v7 offset:384
    ds_read_u8 v44, v7 offset:512
    ds_read_u8 v45, v7 offset:640
    ds_read_u8 v46, v7 offset:768
    ds_read_u8 v47, v7 offset:896
    ds_read_u8 v48, v7 offset:1024
    ds_read_u8 v49, v7 offset:1152
    ds_read_u8 v50, v7 offset:1280
    ds_read_u8 v51, v7 offset:1408
    ds_read_u8 v52, v7 offset:1536
    ds_read_u8 v53, v7 offset:1664
    ds_read_u8 v54, v7 offset:1792
    ds_read_u8 v55, v7 offset:1920
    s_waitcnt lgkmcnt(0)
    v_lshl_or_b32 v24, v41, 8, v40
    v_lshl_or_b32 v56, v43, 8, v42
    v_lshl_or_b32 v25, v45, 8, v44
    v_lshl_or_b32 v57, v47, 8, v46
    v_lshl_or_b32 v26, v49, 8, v48
    v_lshl_or_b32 v58, v51, 8, v50
    v_lshl_or_b32 v27, v53, 8, v52
    v_lshl_or_b32 v59, v55, 8, v54
    v_lshl_or_b32 v24, v56, 16, v24
    v_lshl_or_b32 v25, v57, 16, v25
    v_lshl_or_b32 v26, v58, 16, v26
    v_lshl_or_b32 v27, v59, 16, v27
    v_xor_b32 v25, s54, v25
    v_xor_b32 v27, s54, v27
    v_mov_b32 v28, v24
    v_mov_b32 v29, v26
    v_perm_b32 v30, v27, v26, s45
    v_perm_b32 v31, v25, v24, s45
    v_xor_b32 v24, v28, v30
    v_xor_b32 v26, v29, v31
    v_perm_b32 v30, v27, v26, s45
    v_perm_b32 v31, v25, v24, s45
    v_xor_b32 v24, v28, v30
    v_xor_b32 v26, v29, v31
    v_perm_b32 v30, v27, v26, s45
    v_perm_b32 v31, v25, v24, s45
    v_xor_b32 v24, v28, v30
    v_xor_b32 v26, v29, v31
    ds_write_b128 v6, v[24:27]
    s_waitcnt lgkmcnt(0)
    s_barrier
    s_cmp_lt_u32 s13, 4
    s_cbranch_scc1 L_done
    s_branch L_m2
L_e2:
    s_getpc_b64 s[86:87]
L_pcX:
    s_cmp_lt_u32 s13, 4
    s_cselect_b32 s35, 16, 0
    s_cselect_b32 s49, 8, 0
    s_add_u32 s35, s35, s48
    s_lshl_b32 s35, s35, 3
    s_add_u32 s35, s35, L_sched-L_pcX
    s_add_u32 s86, s86, s35
    s_addc_u32 s87, s87, 0
    s_load_dwordx2 s[82:83], s[86:87], 0
    s_lshr_b32 s35, s32, 3
    s_add_u32 s49, s49, s35
    s_lshl_b32 s35, s15, 2
    s_add_u32 s35, s35, s33
    s_lshl_b32 s35, s35, 7
    s_add_u32 s35, s35, 524288
    v_and_b32 v12, 15, v2
    v_lshlrev_b32 v12, 2, v12
    v_add_u32 v12, s35, v12
    s_mov_b64 s[68:69], s[56:57]
    s_mov_b32 s70, 268435456
    s_mov_b32 s71, 0x20000
    buffer_load_dword v13, v12, s[68:71], 0 offen sc0 sc1
    s_mov_b64 s[16:17], s[4:5]
    s_mov_b64 s[20:21], s[6:7]
    s_mov_b32 s22, 14680064
    s_mov_b32 s23, 0x20000
    s_mov_b32 s18, 4194304
    s_mov_b32 s19, 0x20000
    s_movk_i32 s97, 14336
    s_movk_i32 s98, 15360
    s_movk_i32 s99, 19456
    v_lshrrev_b32 v3, 5, v2
    s_lshl_b32 s35, s33, 1
    v_add_u32 v4, s35, v3
    v_and_b32 v6, 31, v2
    v_mul_u32_u24 v8, 114688, v4
    v_lshl_add_u32 v8, v6, 4, v8
    s_lshl_b32 s35, s15, 9
    v_add_u32 v8, s35, v8
    v_lshrrev_b32 v5, 3, v2
    v_lshrrev_b32 v7, 4, v2
    v_and_b32 v10, 7, v2
    v_xor_b32 v7, v7, v10
    v_lshlrev_b32 v7, 4, v7
    s_lshl_b32 s35, s14, 19
    s_lshl_b32 s36, s33, 17
    s_add_u32 s35, s35, s36
    v_lshl_add_u32 v7, v5, 11, v7
    v_add_u32 v9, s35, v7
    v_xor_b32 v10, 64, v9
    s_lshl_b32 s44, s33, 13
    s_add_u32 s44, s44, 65536
    s_lshl_b32 s36, s15, 18
    s_add_u32 s96, s36, 1048576
    v_xor_b32 v5, v6, v3
    v_lshlrev_b32 v5, 4, v5
    v_lshl_add_u32 v11, v4, 11, v5
    v_lshlrev_b32 v7, 4, v6
    v_add_u32 v7, 131072, v7
    s_lshl_b32 s45, s33, 12
    s_add_u32 s36, s96, s45
    v_lshlrev_b32 v15, 4, v2
    v_add_u32 v15, s36, v15
    v_add_u32 v20, s96, v11
    s_mov_b32 s46, 0x05010400
    s_mov_b32 s47, 0x07030602
    s_mov_b32 s58, 0x08080808
    s_mov_b32 s84, 0x05040100
    s_mov_b32 s85, 0x07060302
    s_mov_b32 s38, 0
    s_mov_b32 s39, 0
    s_mov_b32 s91, 0
    s_cmp_lt_u32 s32, 8
    s_cselect_b32 s93, 8, 9
    s_mov_b32 s90, 40
    s_mov_b64 exec, 0
    s_cmp_lt_u32 s13, 4
    s_cbranch_scc1 L_hopq
    s_cmp_eq_u32 s32, 4
    s_cbranch_scc1 L_hq0
    s_cmp_eq_u32 s32, 5
    s_cbranch_scc1 L_hq2
    s_cmp_eq_u32 s32, 6
    s_cbranch_scc1 L_hg
    s_cmp_eq_u32 s32, 7
    s_cbranch_scc1 L_hloop
    s_cmp_eq_u32 s32, 8
    s_cbranch_scc1 L_hx
    s_branch L_hopret
L_hopq:
    s_cmp_eq_u32 s32, 4
    s_cbranch_scc1 L_prod
    s_cmp_eq_u32 s32, 5
    s_cbranch_scc1 L_ploop
    s_cmp_eq_u32 s32, 6
    s_cbranch_scc1 L_pmid
    s_cmp_eq_u32 s32, 7
    s_cbranch_scc1 L_ppub
L_hopret:
    s_mov_b64 exec, -1
    s_waitcnt lgkmcnt(0)
    s_barrier
    ds_read_b128 v[40:43], v7 offset:0
    ds_read_b128 v[44:47], v7 offset:512
    ds_read_b128 v[48:51], v7 offset:1024
    ds_read_b128 v[52:55], v7 offset:1536
    ds_read_b128 v[56:59], v7 offset:2048
    ds_read_b128 v[60:63], v7 offset:2560
    ds_read_b128 v[64:67], v7 offset:3072
    ds_read_b128 v[68:71], v7 offset:3584
    s_cmp_lt_u32 s13, 4
    s_cbranch_scc1 L_prod
    s_lshl_b32 s41, s49, 14
    s_add_u32 s92, s49, 2
    s_mov_b32 s55, 2
    s_mov_b32 s54, 2
    s_cmp_eq_u32 s49, 0
    s_waitcnt lgkmcnt(0)
    s_cbranch_scc1 L_hq
    s_add_u32 m0, s53, 4096
    s_add_u32 s42, s42, s98
    buffer_load_dwordx4 v9, s[16:19], s42 offen offset:2048  lds
    s_add_u32 s42, s42, s98
    buffer_load_dwordx4 v10, s[16:19], s42 offen offset:3072  lds
    s_lshl_b32 s50, s49, 2
    s_lshr_b64 s[50:51], s[82:83], s50
    s_and_b32 s50, s50, 15
    s_mul_i32 s43, s50, 917504
    tbuffer_load_format_d16_xyzw v[72:73], v8, s[20:23], s43 format:[BUF_DATA_FORMAT_32_32_32_32,BUF_NUM_FORMAT_UINT] offen
    s_add_u32 s43, s43, s97
    tbuffer_load_format_d16_xyzw v[74:75], v8, s[20:23], s43 format:[BUF_DATA_FORMAT_32_32_32_32,BUF_NUM_FORMAT_UINT] offen
    s_add_u32 s43, s43, s97
    tbuffer_load_format_d16_xyzw v[76:77], v8, s[20:23], s43 format:[BUF_DATA_FORMAT_32_32_32_32,BUF_NUM_FORMAT_UINT] offen
    s_add_u32 s43, s43, s97
    tbuffer_load_format_d16_xyzw v[78:79], v8, s[20:23], s43 format:[BUF_DATA_FORMAT_32_32_32_32,BUF_NUM_FORMAT_UINT] offen
    s_add_u32 s43, s43, s97
    tbuffer_load_format_d16_xyzw v[80:81], v8, s[20:23], s43 format:[BUF_DATA_FORMAT_32_32_32_32,BUF_NUM_FORMAT_UINT] offen
    s_add_u32 s43, s43, s97
    tbuffer_load_format_d16_xyzw v[82:83], v8, s[20:23], s43 format:[BUF_DATA_FORMAT_32_32_32_32,BUF_NUM_FORMAT_UINT] offen
    s_add_u32 s43, s43, s97
    tbuffer_load_format_d16_xyzw v[84:85], v8, s[20:23], s43 format:[BUF_DATA_FORMAT_32_32_32_32,BUF_NUM_FORMAT_UINT] offen
    s_add_u32 s43, s43, s97
    tbuffer_load_format_d16_xyzw v[86:87], v8, s[20:23], s43 format:[BUF_DATA_FORMAT_32_32_32_32,BUF_NUM_FORMAT_UINT] offen
    s_waitcnt vmcnt(8)
    s_barrier
    s_setprio 3
    s_add_u32 s53, s44, 32768
    s_mov_b32 m0, s53
    s_lshl_b32 s42, s50, 7
    buffer_load_dwordx4 v9, s[16:19], s42 offen offset:0  lds
    s_add_u32 s42, s42, s98
    buffer_load_dwordx4 v10, s[16:19], s42 offen offset:1024  lds
    s_add_u32 s42, s42, s98
    buffer_load_dwordx4 v9, s[16:19], s42 offen offset:2048  lds
    s_add_u32 s42, s42, s98
    buffer_load_dwordx4 v10, s[16:19], s42 offen offset:3072  lds
    s_add_u32 m0, s53, 4096
    s_add_u32 s42, s42, s99
    buffer_load_dwordx4 v9, s[16:19], s42 offen offset:0  lds
    s_add_u32 s42, s42, s98
    buffer_load_dwordx4 v10, s[16:19], s42 offen offset:1024  lds
    s_add_u32 s42, s42, s98
    buffer_load_dwordx4 v9, s[16:19], s42 offen offset:2048  lds
    s_add_u32 s42, s42, s98
    buffer_load_dwordx4 v10, s[16:19], s42 offen offset:3072  lds
    s_mov_b32 s55, 0
    s_mov_b32 s54, 8
    v_add_u32 v17, s41, v11
    s_waitcnt vmcnt(8)
    s_branch L_hq0
L_m2:
    s_mov_b64 s[28:29], s[10:11]
    s_mov_b32 s30, 14680064
    s_mov_b32 s31, 0x20000
    v_and_b32 v7, 15, v2
    v_lshrrev_b32 v6, 4, v2
    v_lshrrev_b32 v4, 1, v7
    v_xor_b32 v4, v4, v6
    v_lshlrev_b32 v4, 4, v4
    v_lshl_add_u32 v4, v7, 7, v4
    s_lshl_b32 s35, s32, 13
    s_add_u32 s35, s35, 65536
    v_add_u32 v1, s35, v4
    v_xor_b32 v3, 64, v1
    v_and_b32 v4, 1, v6
    v_lshl_add_u32 v4, v7, 1, v4
    v_lshlrev_b32 v4, 4, v4
    v_lshl_add_u32 v4, v6, 11, v4
    v_xor_b32 v5, 16, v4
    v_mul_u32_u24 v6, 28672, v6
    v_lshl_add_u32 v6, v7, 4, v6
    s_lshl_b32 s36, s14, 2
    s_add_u32 s36, s36, s32
    s_mul_i32 s36, s36, 458752
    s_lshl_b32 s37, s15, 8
    s_add_u32 s36, s36, s37
    s_mov_b32 s40, 0
    s_mov_b32 s41, 0
    s_mov_b32 s46, 32768
    s_mov_b32 s47, 16384
    s_mov_b64 exec, 0
    s_cmp_eq_u32 s32, 0
    s_cbranch_scc1 L_mh0
    s_cmp_eq_u32 s32, 1
    s_cbranch_scc1 L_mh6
    s_cmp_eq_u32 s32, 2
    s_cbranch_scc1 L_mh12
    s_cmp_eq_u32 s32, 3
    s_cbranch_scc1 L_mh18
L_mhret:
    s_mov_b64 exec, -1
    s_setprio 3
    s_barrier
    ds_read_b128 v[24:27], v4 offset:0
    ds_read_b128 v[28:31], v4 offset:512
    ds_read_b128 v[8:11], v1 offset:0
    ds_read_b128 v[12:15], v1 offset:2048
    ds_read_b128 v[16:19], v1 offset:4096
    ds_read_b128 v[32:35], v4 offset:1024
    ds_read_b128 v[20:23], v1 offset:6144
    ds_read_b128 v[36:39], v4 offset:1536
    s_waitcnt lgkmcnt(5)
    v_mfma_f32_16x16x32_bf16 v[40:43], v[8:11], v[24:27], 0
    v_mfma_f32_16x16x32_bf16 v[44:47], v[8:11], v[28:31], 0
    s_waitcnt lgkmcnt(4)
    v_mfma_f32_16x16x32_bf16 v[72:75], v[12:15], v[24:27], 0
    v_mfma_f32_16x16x32_bf16 v[76:79], v[12:15], v[28:31], 0
    s_waitcnt lgkmcnt(3)
    v_mfma_f32_16x16x32_bf16 v[104:107], v[16:19], v[24:27], 0
    v_mfma_f32_16x16x32_bf16 v[108:111], v[16:19], v[28:31], 0
    s_waitcnt lgkmcnt(1)
    v_mfma_f32_16x16x32_bf16 v[136:139], v[20:23], v[24:27], 0
    ds_read_b128 v[24:27], v5 offset:0
    v_mfma_f32_16x16x32_bf16 v[140:143], v[20:23], v[28:31], 0
    ds_read_b128 v[28:31], v5 offset:512
    v_mfma_f32_16x16x32_bf16 v[48:51], v[8:11], v[32:35], 0
    s_add_u32 s40, s40, 1
L_mh0:
    s_cbranch_execz L_mh1
    s_waitcnt lgkmcnt(2)
    v_mfma_f32_16x16x32_bf16 v[52:55], v[8:11], v[36:39], 0
    s_and_b32 s42, s40, 3
    v_mfma_f32_16x16x32_bf16 v[80:83], v[12:15], v[32:35], 0
    s_cselect_b32 s42, s47, 0xffff4000
    v_mfma_f32_16x16x32_bf16 v[84:87], v[12:15], v[36:39], 0
    s_add_u32 s41, s41, 1
    v_mfma_f32_16x16x32_bf16 v[112:115], v[16:19], v[32:35], 0
    s_cmp_eq_u32 s41, 3
    v_mfma_f32_16x16x32_bf16 v[116:119], v[16:19], v[36:39], 0
    s_cselect_b32 s43, 0xffff0000, s46
    v_mfma_f32_16x16x32_bf16 v[144:147], v[20:23], v[32:35], 0
    s_cselect_b32 s41, 0, s41
    ds_read_b128 v[32:35], v5 offset:1024
    v_mfma_f32_16x16x32_bf16 v[148:151], v[20:23], v[36:39], 0
    ds_read_b128 v[36:39], v5 offset:1536
    s_waitcnt lgkmcnt(3)
    v_mfma_f32_16x16x32_bf16 v[56:59], v[8:11], v[24:27], 0
    s_waitcnt lgkmcnt(2)
    v_mfma_f32_16x16x32_bf16 v[60:63], v[8:11], v[28:31], 0
    v_mfma_f32_16x16x32_bf16 v[88:91], v[12:15], v[24:27], 0
    v_mfma_f32_16x16x32_bf16 v[92:95], v[12:15], v[28:31], 0
    v_mfma_f32_16x16x32_bf16 v[120:123], v[16:19], v[24:27], 0
    v_mfma_f32_16x16x32_bf16 v[124:127], v[16:19], v[28:31], 0
    v_mfma_f32_16x16x32_bf16 v[152:155], v[20:23], v[24:27], 0
    ds_read_b128 v[24:27], v4 offset:8192
    v_mfma_f32_16x16x32_bf16 v[156:159], v[20:23], v[28:31], 0
    ds_read_b128 v[28:31], v4 offset:8704
    s_waitcnt lgkmcnt(3)
    v_mfma_f32_16x16x32_bf16 v[64:67], v[8:11], v[32:35], 0
    s_waitcnt lgkmcnt(2)
    v_mfma_f32_16x16x32_bf16 v[68:71], v[8:11], v[36:39], 0
    ds_read_b128 v[8:11], v3 offset:0
    v_mfma_f32_16x16x32_bf16 v[96:99], v[12:15], v[32:35], 0
    v_mfma_f32_16x16x32_bf16 v[100:103], v[12:15], v[36:39], 0
    ds_read_b128 v[12:15], v3 offset:2048
    v_mfma_f32_16x16x32_bf16 v[128:131], v[16:19], v[32:35], 0
    v_mfma_f32_16x16x32_bf16 v[132:135], v[16:19], v[36:39], 0
    ds_read_b128 v[16:19], v3 offset:4096
    v_mfma_f32_16x16x32_bf16 v[160:163], v[20:23], v[32:35], 0
    ds_read_b128 v[32:35], v4 offset:9216
    v_mfma_f32_16x16x32_bf16 v[164:167], v[20:23], v[36:39], 0
    ds_read_b128 v[20:23], v3 offset:6144
    ds_read_b128 v[36:39], v4 offset:9728
    s_waitcnt lgkmcnt(5)
    v_mfma_f32_16x16x32_bf16 v[40:43], v[8:11], v[24:27], v[40:43]
    v_mfma_f32_16x16x32_bf16 v[44:47], v[8:11], v[28:31], v[44:47]
    s_waitcnt lgkmcnt(4)
L_mh1:
    s_cbranch_execz L_mh2
    v_mfma_f32_16x16x32_bf16 v[72:75], v[12:15], v[24:27], v[72:75]
    v_mfma_f32_16x16x32_bf16 v[76:79], v[12:15], v[28:31], v[76:79]
    s_waitcnt lgkmcnt(3)
    v_mfma_f32_16x16x32_bf16 v[104:107], v[16:19], v[24:27], v[104:107]
    v_mfma_f32_16x16x32_bf16 v[108:111], v[16:19], v[28:31], v[108:111]
    s_waitcnt lgkmcnt(1)
    v_mfma_f32_16x16x32_bf16 v[136:139], v[20:23], v[24:27], v[136:139]
    ds_read_b128 v[24:27], v5 offset:8192
    v_mfma_f32_16x16x32_bf16 v[140:143], v[20:23], v[28:31], v[140:143]
    ds_read_b128 v[28:31], v5 offset:8704
    v_mfma_f32_16x16x32_bf16 v[48:51], v[8:11], v[32:35], v[48:51]
    s_waitcnt lgkmcnt(2)
    v_mfma_f32_16x16x32_bf16 v[52:55], v[8:11], v[36:39], v[52:55]
    v_mfma_f32_16x16x32_bf16 v[80:83], v[12:15], v[32:35], v[80:83]
    v_mfma_f32_16x16x32_bf16 v[84:87], v[12:15], v[36:39], v[84:87]
    v_mfma_f32_16x16x32_bf16 v[112:115], v[16:19], v[32:35], v[112:115]
    v_mfma_f32_16x16x32_bf16 v[116:119], v[16:19], v[36:39], v[116:119]
    v_mfma_f32_16x16x32_bf16 v[144:147], v[20:23], v[32:35], v[144:147]
    ds_read_b128 v[32:35], v5 offset:9216
    v_mfma_f32_16x16x32_bf16 v[148:151], v[20:23], v[36:39], v[148:151]
    ds_read_b128 v[36:39], v5 offset:9728
    s_waitcnt lgkmcnt(3)
    v_mfma_f32_16x16x32_bf16 v[56:59], v[8:11], v[24:27], v[56:59]
    s_waitcnt lgkmcnt(2)
    v_mfma_f32_16x16x32_bf16 v[60:63], v[8:11], v[28:31], v[60:63]
    v_mfma_f32_16x16x32_bf16 v[88:91], v[12:15], v[24:27], v[88:91]
    v_mfma_f32_16x16x32_bf16 v[92:95], v[12:15], v[28:31], v[92:95]
    s_waitcnt lgkmcnt(0)
    s_barrier
    v_add_u32 v4, s42, v4
    v_mfma_f32_16x16x32_bf16 v[120:123], v[16:19], v[24:27], v[120:123]
    v_add_u32 v1, s43, v1
    v_mfma_f32_16x16x32_bf16 v[124:127], v[16:19], v[28:31], v[124:127]
    v_add_u32 v5, s42, v5
    v_mfma_f32_16x16x32_bf16 v[152:155], v[20:23], v[24:27], v[152:155]
    v_add_u32 v3, s43, v3
    ds_read_b128 v[24:27], v4 offset:0
    v_mfma_f32_16x16x32_bf16 v[156:159], v[20:23], v[28:31], v[156:159]
    ds_read_b128 v[28:31], v4 offset:512
    v_mfma_f32_16x16x32_bf16 v[64:67], v[8:11], v[32:35], v[64:67]
    v_mfma_f32_16x16x32_bf16 v[68:71], v[8:11], v[36:39], v[68:71]
    ds_read_b128 v[8:11], v1 offset:0
    v_mfma_f32_16x16x32_bf16 v[96:99], v[12:15], v[32:35], v[96:99]
    v_mfma_f32_16x16x32_bf16 v[100:103], v[12:15], v[36:39], v[100:103]
    ds_read_b128 v[12:15], v1 offset:2048
    v_mfma_f32_16x16x32_bf16 v[128:131], v[16:19], v[32:35], v[128:131]
    v_mfma_f32_16x16x32_bf16 v[132:135], v[16:19], v[36:39], v[132:135]
    ds_read_b128 v[16:19], v1 offset:4096
L_mh2:
    s_cbranch_execz L_mh3
    v_mfma_f32_16x16x32_bf16 v[160:163], v[20:23], v[32:35], v[160:163]
    ds_read_b128 v[32:35], v4 offset:1024
    v_mfma_f32_16x16x32_bf16 v[164:167], v[20:23], v[36:39], v[164:167]
    ds_read_b128 v[20:23], v1 offset:6144
    ds_read_b128 v[36:39], v4 offset:1536
    .p2align 6
L_mloop:
    s_waitcnt lgkmcnt(5)
    v_mfma_f32_16x16x32_bf16 v[40:43], v[8:11], v[24:27], v[40:43]
    v_mfma_f32_16x16x32_bf16 v[44:47], v[8:11], v[28:31], v[44:47]
    s_waitcnt lgkmcnt(4)
    v_mfma_f32_16x16x32_bf16 v[72:75], v[12:15], v[24:27], v[72:75]
    v_mfma_f32_16x16x32_bf16 v[76:79], v[12:15], v[28:31], v[76:79]
    s_waitcnt lgkmcnt(3)
    v_mfma_f32_16x16x32_bf16 v[104:107], v[16:19], v[24:27], v[104:107]
    v_mfma_f32_16x16x32_bf16 v[108:111], v[16:19], v[28:31], v[108:111]
    s_waitcnt lgkmcnt(1)
    v_mfma_f32_16x16x32_bf16 v[136:139], v[20:23], v[24:27], v[136:139]
    ds_read_b128 v[24:27], v5 offset:0
    v_mfma_f32_16x16x32_bf16 v[140:143], v[20:23], v[28:31], v[140:143]
    ds_read_b128 v[28:31], v5 offset:512
    v_mfma_f32_16x16x32_bf16 v[48:51], v[8:11], v[32:35], v[48:51]
    s_add_u32 s40, s40, 1
    s_waitcnt lgkmcnt(2)
    v_mfma_f32_16x16x32_bf16 v[52:55], v[8:11], v[36:39], v[52:55]
    s_and_b32 s42, s40, 3
    v_mfma_f32_16x16x32_bf16 v[80:83], v[12:15], v[32:35], v[80:83]
    s_cselect_b32 s42, s47, 0xffff4000
    v_mfma_f32_16x16x32_bf16 v[84:87], v[12:15], v[36:39], v[84:87]
    s_add_u32 s41, s41, 1
    v_mfma_f32_16x16x32_bf16 v[112:115], v[16:19], v[32:35], v[112:115]
    s_cmp_eq_u32 s41, 3
    v_mfma_f32_16x16x32_bf16 v[116:119], v[16:19], v[36:39], v[116:119]
    s_cselect_b32 s43, 0xffff0000, s46
    v_mfma_f32_16x16x32_bf16 v[144:147], v[20:23], v[32:35], v[144:147]
    s_cselect_b32 s41, 0, s41
    ds_read_b128 v[32:35], v5 offset:1024
    v_mfma_f32_16x16x32_bf16 v[148:151], v[20:23], v[36:39], v[148:151]
    ds_read_b128 v[36:39], v5 offset:1536
    s_waitcnt lgkmcnt(3)
    v_mfma_f32_16x16x32_bf16 v[56:59], v[8:11], v[24:27], v[56:59]
    s_waitcnt lgkmcnt(2)
    v_mfma_f32_16x16x32_bf16 v[60:63], v[8:11], v[28:31], v[60:63]
    v_mfma_f32_16x16x32_bf16 v[88:91], v[12:15], v[24:27], v[88:91]
    v_mfma_f32_16x16x32_bf16 v[92:95], v[12:15], v[28:31], v[92:95]
    v_mfma_f32_16x16x32_bf16 v[120:123], v[16:19], v[24:27], v[120:123]
    v_mfma_f32_16x16x32_bf16 v[124:127], v[16:19], v[28:31], v[124:127]
    v_mfma_f32_16x16x32_bf16 v[152:155], v[20:23], v[24:27], v[152:155]
L_mh3:
    s_cbranch_execz L_mh4
    ds_read_b128 v[24:27], v4 offset:8192
    v_mfma_f32_16x16x32_bf16 v[156:159], v[20:23], v[28:31], v[156:159]
    ds_read_b128 v[28:31], v4 offset:8704
    s_waitcnt lgkmcnt(3)
    v_mfma_f32_16x16x32_bf16 v[64:67], v[8:11], v[32:35], v[64:67]
    s_waitcnt lgkmcnt(2)
    v_mfma_f32_16x16x32_bf16 v[68:71], v[8:11], v[36:39], v[68:71]
    ds_read_b128 v[8:11], v3 offset:0
    v_mfma_f32_16x16x32_bf16 v[96:99], v[12:15], v[32:35], v[96:99]
    v_mfma_f32_16x16x32_bf16 v[100:103], v[12:15], v[36:39], v[100:103]
    ds_read_b128 v[12:15], v3 offset:2048
    v_mfma_f32_16x16x32_bf16 v[128:131], v[16:19], v[32:35], v[128:131]
    v_mfma_f32_16x16x32_bf16 v[132:135], v[16:19], v[36:39], v[132:135]
    ds_read_b128 v[16:19], v3 offset:4096
    v_mfma_f32_16x16x32_bf16 v[160:163], v[20:23], v[32:35], v[160:163]
    ds_read_b128 v[32:35], v4 offset:9216
    v_mfma_f32_16x16x32_bf16 v[164:167], v[20:23], v[36:39], v[164:167]
    ds_read_b128 v[20:23], v3 offset:6144
    ds_read_b128 v[36:39], v4 offset:9728
    s_waitcnt lgkmcnt(5)
    v_mfma_f32_16x16x32_bf16 v[40:43], v[8:11], v[24:27], v[40:43]
    v_mfma_f32_16x16x32_bf16 v[44:47], v[8:11], v[28:31], v[44:47]
    s_waitcnt lgkmcnt(4)
    v_mfma_f32_16x16x32_bf16 v[72:75], v[12:15], v[24:27], v[72:75]
    v_mfma_f32_16x16x32_bf16 v[76:79], v[12:15], v[28:31], v[76:79]
    s_waitcnt lgkmcnt(3)
    v_mfma_f32_16x16x32_bf16 v[104:107], v[16:19], v[24:27], v[104:107]
    v_mfma_f32_16x16x32_bf16 v[108:111], v[16:19], v[28:31], v[108:111]
    s_waitcnt lgkmcnt(1)
    v_mfma_f32_16x16x32_bf16 v[136:139], v[20:23], v[24:27], v[136:139]
    ds_read_b128 v[24:27], v5 offset:8192
    v_mfma_f32_16x16x32_bf16 v[140:143], v[20:23], v[28:31], v[140:143]
    ds_read_b128 v[28:31], v5 offset:8704
    v_mfma_f32_16x16x32_bf16 v[48:51], v[8:11], v[32:35], v[48:51]
    s_waitcnt lgkmcnt(2)
    v_mfma_f32_16x16x32_bf16 v[52:55], v[8:11], v[36:39], v[52:55]
    v_mfma_f32_16x16x32_bf16 v[80:83], v[12:15], v[32:35], v[80:83]
    v_mfma_f32_16x16x32_bf16 v[84:87], v[12:15], v[36:39], v[84:87]
    v_mfma_f32_16x16x32_bf16 v[112:115], v[16:19], v[32:35], v[112:115]
    v_mfma_f32_16x16x32_bf16 v[116:119], v[16:19], v[36:39], v[116:119]
    v_mfma_f32_16x16x32_bf16 v[144:147], v[20:23], v[32:35], v[144:147]
    ds_read_b128 v[32:35], v5 offset:9216
    v_mfma_f32_16x16x32_bf16 v[148:151], v[20:23], v[36:39], v[148:151]
    ds_read_b128 v[36:39], v5 offset:9728
    s_waitcnt lgkmcnt(3)
    v_mfma_f32_16x16x32_bf16 v[56:59], v[8:11], v[24:27], v[56:59]
    s_waitcnt lgkmcnt(2)
    v_mfma_f32_16x16x32_bf16 v[60:63], v[8:11], v[28:31], v[60:63]
L_mh4:
    s_cbranch_execz L_mh5
    v_mfma_f32_16x16x32_bf16 v[88:91], v[12:15], v[24:27], v[88:91]
    v_mfma_f32_16x16x32_bf16 v[92:95], v[12:15], v[28:31], v[92:95]
    s_waitcnt lgkmcnt(0)
    s_barrier
    v_add_u32 v4, s42, v4
    v_mfma_f32_16x16x32_bf16 v[120:123], v[16:19], v[24:27], v[120:123]
    v_add_u32 v1, s43, v1
    v_mfma_f32_16x16x32_bf16 v[124:127], v[16:19], v[28:31], v[124:127]
    v_add_u32 v5, s42, v5
    v_mfma_f32_16x16x32_bf16 v[152:155], v[20:23], v[24:27], v[152:155]
    v_add_u32 v3, s43, v3
    ds_read_b128 v[24:27], v4 offset:0
    v_mfma_f32_16x16x32_bf16 v[156:159], v[20:23], v[28:31], v[156:159]
    ds_read_b128 v[28:31], v4 offset:512
    v_mfma_f32_16x16x32_bf16 v[64:67], v[8:11], v[32:35], v[64:67]
    v_mfma_f32_16x16x32_bf16 v[68:71], v[8:11], v[36:39], v[68:71]
    ds_read_b128 v[8:11], v1 offset:0
    v_mfma_f32_16x16x32_bf16 v[96:99], v[12:15], v[32:35], v[96:99]
    v_mfma_f32_16x16x32_bf16 v[100:103], v[12:15], v[36:39], v[100:103]
    ds_read_b128 v[12:15], v1 offset:2048
    v_mfma_f32_16x16x32_bf16 v[128:131], v[16:19], v[32:35], v[128:131]
    v_mfma_f32_16x16x32_bf16 v[132:135], v[16:19], v[36:39], v[132:135]
    ds_read_b128 v[16:19], v1 offset:4096
    v_mfma_f32_16x16x32_bf16 v[160:163], v[20:23], v[32:35], v[160:163]
    ds_read_b128 v[32:35], v4 offset:1024
    v_mfma_f32_16x16x32_bf16 v[164:167], v[20:23], v[36:39], v[164:167]
    ds_read_b128 v[20:23], v1 offset:6144
    ds_read_b128 v[36:39], v4 offset:1536
    s_cmp_lt_u32 s40, 11
    s_cbranch_scc1 L_mloop
    s_waitcnt lgkmcnt(5)
    v_mfma_f32_16x16x32_bf16 v[40:43], v[8:11], v[24:27], v[40:43]
    v_mfma_f32_16x16x32_bf16 v[44:47], v[8:11], v[28:31], v[44:47]
    s_waitcnt lgkmcnt(4)
    v_mfma_f32_16x16x32_bf16 v[72:75], v[12:15], v[24:27], v[72:75]
    v_mfma_f32_16x16x32_bf16 v[76:79], v[12:15], v[28:31], v[76:79]
    s_waitcnt lgkmcnt(3)
    v_mfma_f32_16x16x32_bf16 v[104:107], v[16:19], v[24:27], v[104:107]
    v_mfma_f32_16x16x32_bf16 v[108:111], v[16:19], v[28:31], v[108:111]
    s_waitcnt lgkmcnt(1)
    v_mfma_f32_16x16x32_bf16 v[136:139], v[20:23], v[24:27], v[136:139]
    ds_read_b128 v[24:27], v5 offset:0
    v_mfma_f32_16x16x32_bf16 v[140:143], v[20:23], v[28:31], v[140:143]
    ds_read_b128 v[28:31], v5 offset:512
    v_mfma_f32_16x16x32_bf16 v[48:51], v[8:11], v[32:35], v[48:51]
    s_waitcnt lgkmcnt(2)
    v_mfma_f32_16x16x32_bf16 v[52:55], v[8:11], v[36:39], v[52:55]
    v_mfma_f32_16x16x32_bf16 v[80:83], v[12:15], v[32:35], v[80:83]
L_mh5:
    s_cbranch_execz L_mhret
    v_mfma_f32_16x16x32_bf16 v[84:87], v[12:15], v[36:39], v[84:87]
    v_mfma_f32_16x16x32_bf16 v[112:115], v[16:19], v[32:35], v[112:115]
    v_mfma_f32_16x16x32_bf16 v[116:119], v[16:19], v[36:39], v[116:119]
    v_mfma_f32_16x16x32_bf16 v[144:147], v[20:23], v[32:35], v[144:147]
    ds_read_b128 v[32:35], v5 offset:1024
    v_mfma_f32_16x16x32_bf16 v[148:151], v[20:23], v[36:39], v[148:151]
    ds_read_b128 v[36:39], v5 offset:1536
    s_waitcnt lgkmcnt(3)
    v_mfma_f32_16x16x32_bf16 v[56:59], v[8:11], v[24:27], v[56:59]
    s_waitcnt lgkmcnt(2)
    v_mfma_f32_16x16x32_bf16 v[60:63], v[8:11], v[28:31], v[60:63]
    v_mfma_f32_16x16x32_bf16 v[88:91], v[12:15], v[24:27], v[88:91]
    v_mfma_f32_16x16x32_bf16 v[92:95], v[12:15], v[28:31], v[92:95]
    v_mfma_f32_16x16x32_bf16 v[120:123], v[16:19], v[24:27], v[120:123]
    v_mfma_f32_16x16x32_bf16 v[124:127], v[16:19], v[28:31], v[124:127]
    v_mfma_f32_16x16x32_bf16 v[152:155], v[20:23], v[24:27], v[152:155]
    ds_read_b128 v[24:27], v4 offset:8192
    v_mfma_f32_16x16x32_bf16 v[156:159], v[20:23], v[28:31], v[156:159]
    ds_read_b128 v[28:31], v4 offset:8704
    s_waitcnt lgkmcnt(3)
    v_mfma_f32_16x16x32_bf16 v[64:67], v[8:11], v[32:35], v[64:67]
    s_waitcnt lgkmcnt(2)
    v_mfma_f32_16x16x32_bf16 v[68:71], v[8:11], v[36:39], v[68:71]
    ds_read_b128 v[8:11], v3 offset:0
    v_mfma_f32_16x16x32_bf16 v[96:99], v[12:15], v[32:35], v[96:99]
    v_mfma_f32_16x16x32_bf16 v[100:103], v[12:15], v[36:39], v[100:103]
    ds_read_b128 v[12:15], v3 offset:2048
    v_mfma_f32_16x16x32_bf16 v[128:131], v[16:19], v[32:35], v[128:131]
    v_mfma_f32_16x16x32_bf16 v[132:135], v[16:19], v[36:39], v[132:135]
    ds_read_b128 v[16:19], v3 offset:4096
    v_mfma_f32_16x16x32_bf16 v[160:163], v[20:23], v[32:35], v[160:163]
    ds_read_b128 v[32:35], v4 offset:9216
    v_mfma_f32_16x16x32_bf16 v[164:167], v[20:23], v[36:39], v[164:167]
    ds_read_b128 v[20:23], v3 offset:6144
    ds_read_b128 v[36:39], v4 offset:9728
    s_waitcnt lgkmcnt(5)
    v_mfma_f32_16x16x32_bf16 v[40:43], v[8:11], v[24:27], v[40:43]
    v_mfma_f32_16x16x32_bf16 v[44:47], v[8:11], v[28:31], v[44:47]
    s_waitcnt lgkmcnt(4)
    v_mfma_f32_16x16x32_bf16 v[72:75], v[12:15], v[24:27], v[72:75]
    v_mfma_f32_16x16x32_bf16 v[76:79], v[12:15], v[28:31], v[76:79]
    s_waitcnt lgkmcnt(3)
    v_mfma_f32_16x16x32_bf16 v[104:107], v[16:19], v[24:27], v[104:107]
    v_mfma_f32_16x16x32_bf16 v[108:111], v[16:19], v[28:31], v[108:111]
    s_waitcnt lgkmcnt(1)
    v_mfma_f32_16x16x32_bf16 v[136:139], v[20:23], v[24:27], v[136:139]
    ds_read_b128 v[24:27], v5 offset:8192
    v_mfma_f32_16x16x32_bf16 v[140:143], v[20:23], v[28:31], v[140:143]
L_mh6:
    s_cbranch_execz L_mh7
    ds_read_b128 v[28:31], v5 offset:8704
    v_mfma_f32_16x16x32_bf16 v[48:51], v[8:11], v[32:35], v[48:51]
    s_waitcnt lgkmcnt(2)
    v_mfma_f32_16x16x32_bf16 v[52:55], v[8:11], v[36:39], v[52:55]
    v_mfma_f32_16x16x32_bf16 v[80:83], v[12:15], v[32:35], v[80:83]
    v_mfma_f32_16x16x32_bf16 v[84:87], v[12:15], v[36:39], v[84:87]
    v_mfma_f32_16x16x32_bf16 v[112:115], v[16:19], v[32:35], v[112:115]
    v_mfma_f32_16x16x32_bf16 v[116:119], v[16:19], v[36:39], v[116:119]
    v_mfma_f32_16x16x32_bf16 v[144:147], v[20:23], v[32:35], v[144:147]
    ds_read_b128 v[32:35], v5 offset:9216
    v_mfma_f32_16x16x32_bf16 v[148:151], v[20:23], v[36:39], v[148:151]
    ds_read_b128 v[36:39], v5 offset:9728
    s_waitcnt lgkmcnt(3)
    v_mfma_f32_16x16x32_bf16 v[56:59], v[8:11], v[24:27], v[56:59]
    s_waitcnt lgkmcnt(2)
    v_mfma_f32_16x16x32_bf16 v[60:63], v[8:11], v[28:31], v[60:63]
    v_mfma_f32_16x16x32_bf16 v[88:91], v[12:15], v[24:27], v[88:91]
    v_mfma_f32_16x16x32_bf16 v[92:95], v[12:15], v[28:31], v[92:95]
    s_waitcnt lgkmcnt(0)
    s_barrier
    v_add_u32 v4, 0xffff4000, v4
    v_mfma_f32_16x16x32_bf16 v[120:123], v[16:19], v[24:27], v[120:123]
    v_add_u32 v7, 0x0, v1
    v_mfma_f32_16x16x32_bf16 v[124:127], v[16:19], v[28:31], v[124:127]
    v_add_u32 v1, 0xffff0000, v1
    v_mfma_f32_16x16x32_bf16 v[152:155], v[20:23], v[24:27], v[152:155]
    v_add_u32 v5, 0xffff4000, v5
    ds_read_b128 v[24:27], v1 offset:0
    v_mfma_f32_16x16x32_bf16 v[156:159], v[20:23], v[28:31], v[156:159]
    v_add_u32 v0, 0x0, v3
    v_mfma_f32_16x16x32_bf16 v[64:67], v[8:11], v[32:35], v[64:67]
    v_add_u32 v3, 0xffff0000, v3
    ds_read_b128 v[28:31], v4 offset:0
    v_mfma_f32_16x16x32_bf16 v[68:71], v[8:11], v[36:39], v[68:71]
    ds_read_b128 v[8:11], v1 offset:2048
    v_mfma_f32_16x16x32_bf16 v[96:99], v[12:15], v[32:35], v[96:99]
    v_mfma_f32_16x16x32_bf16 v[100:103], v[12:15], v[36:39], v[100:103]
    ds_read_b128 v[12:15], v4 offset:512
    v_mfma_f32_16x16x32_bf16 v[128:131], v[16:19], v[32:35], v[128:131]
    v_mfma_f32_16x16x32_bf16 v[132:135], v[16:19], v[36:39], v[132:135]
    ds_read_b128 v[16:19], v4 offset:1024
    v_mfma_f32_16x16x32_bf16 v[160:163], v[20:23], v[32:35], v[160:163]
    ds_read_b128 v[32:35], v4 offset:1536
    v_mfma_f32_16x16x32_bf16 v[164:167], v[20:23], v[36:39], v[164:167]
    s_waitcnt lgkmcnt(4)
    v_mfma_f32_16x16x32_bf16 v[40:43], v[24:27], v[28:31], v[40:43]
    ds_read_b128 v[20:23], v5 offset:0
    s_waitcnt lgkmcnt(4)
L_mh7:
    s_cbranch_execz L_mh8
    v_mfma_f32_16x16x32_bf16 v[72:75], v[8:11], v[28:31], v[72:75]
    s_waitcnt lgkmcnt(3)
    v_mfma_f32_16x16x32_bf16 v[44:47], v[24:27], v[12:15], v[44:47]
    ds_read_b128 v[28:31], v5 offset:512
    v_mfma_f32_16x16x32_bf16 v[76:79], v[8:11], v[12:15], v[76:79]
    s_waitcnt lgkmcnt(3)
    v_mfma_f32_16x16x32_bf16 v[48:51], v[24:27], v[16:19], v[48:51]
    ds_read_b128 v[12:15], v5 offset:1024
    v_mfma_f32_16x16x32_bf16 v[80:83], v[8:11], v[16:19], v[80:83]
    ds_read_b128 v[36:39], v3 offset:0
    s_waitcnt lgkmcnt(4)
    v_mfma_f32_16x16x32_bf16 v[52:55], v[24:27], v[32:35], v[52:55]
    ds_read_b128 v[16:19], v5 offset:1536
    v_mfma_f32_16x16x32_bf16 v[84:87], v[8:11], v[32:35], v[84:87]
    s_waitcnt lgkmcnt(4)
    v_mfma_f32_16x16x32_bf16 v[56:59], v[24:27], v[20:23], v[56:59]
    ds_read_b128 v[32:35], v4 offset:8192
    v_mfma_f32_16x16x32_bf16 v[88:91], v[8:11], v[20:23], v[88:91]
    ds_read_b128 v[20:23], v3 offset:2048
    s_waitcnt lgkmcnt(5)
    v_mfma_f32_16x16x32_bf16 v[60:63], v[24:27], v[28:31], v[60:63]
    v_mfma_f32_16x16x32_bf16 v[92:95], v[8:11], v[28:31], v[92:95]
    ds_read_b128 v[28:31], v4 offset:8704
    s_waitcnt lgkmcnt(5)
    v_mfma_f32_16x16x32_bf16 v[64:67], v[24:27], v[12:15], v[64:67]
    v_mfma_f32_16x16x32_bf16 v[96:99], v[8:11], v[12:15], v[96:99]
    ds_read_b128 v[12:15], v4 offset:9216
    s_waitcnt lgkmcnt(4)
    v_mfma_f32_16x16x32_bf16 v[68:71], v[24:27], v[16:19], v[68:71]
    ds_read_b128 v[24:27], v4 offset:9728
    v_mfma_f32_16x16x32_bf16 v[100:103], v[8:11], v[16:19], v[100:103]
    s_waitcnt lgkmcnt(4)
    v_mfma_f32_16x16x32_bf16 v[40:43], v[36:39], v[32:35], v[40:43]
    ds_read_b128 v[8:11], v5 offset:8192
    s_waitcnt lgkmcnt(4)
    v_mfma_f32_16x16x32_bf16 v[72:75], v[20:23], v[32:35], v[72:75]
    s_waitcnt lgkmcnt(3)
    v_mfma_f32_16x16x32_bf16 v[44:47], v[36:39], v[28:31], v[44:47]
    ds_read_b128 v[32:35], v5 offset:8704
    v_mfma_f32_16x16x32_bf16 v[76:79], v[20:23], v[28:31], v[76:79]
    s_waitcnt lgkmcnt(3)
    v_mfma_f32_16x16x32_bf16 v[48:51], v[36:39], v[12:15], v[48:51]
    ds_read_b128 v[28:31], v5 offset:9216
    v_mfma_f32_16x16x32_bf16 v[80:83], v[20:23], v[12:15], v[80:83]
    s_barrier
    ds_read_b128 v[16:19], v1 offset:32768
    s_waitcnt lgkmcnt(4)
    v_mfma_f32_16x16x32_bf16 v[52:55], v[36:39], v[24:27], v[52:55]
L_mh8:
    s_cbranch_execz L_mh9
    ds_read_b128 v[12:15], v5 offset:9728
    v_mfma_f32_16x16x32_bf16 v[84:87], v[20:23], v[24:27], v[84:87]
    s_waitcnt lgkmcnt(4)
    v_mfma_f32_16x16x32_bf16 v[56:59], v[36:39], v[8:11], v[56:59]
    ds_read_b128 v[24:27], v4 offset:16384
    v_mfma_f32_16x16x32_bf16 v[88:91], v[20:23], v[8:11], v[88:91]
    ds_read_b128 v[8:11], v1 offset:34816
    s_waitcnt lgkmcnt(5)
    v_mfma_f32_16x16x32_bf16 v[60:63], v[36:39], v[32:35], v[60:63]
    v_mfma_f32_16x16x32_bf16 v[92:95], v[20:23], v[32:35], v[92:95]
    ds_read_b128 v[32:35], v4 offset:16896
    s_waitcnt lgkmcnt(5)
    v_mfma_f32_16x16x32_bf16 v[64:67], v[36:39], v[28:31], v[64:67]
    v_mfma_f32_16x16x32_bf16 v[96:99], v[20:23], v[28:31], v[96:99]
    ds_read_b128 v[28:31], v4 offset:17408
    s_waitcnt lgkmcnt(4)
    v_mfma_f32_16x16x32_bf16 v[68:71], v[36:39], v[12:15], v[68:71]
    ds_read_b128 v[36:39], v4 offset:17920
    v_mfma_f32_16x16x32_bf16 v[100:103], v[20:23], v[12:15], v[100:103]
    s_waitcnt lgkmcnt(4)
    v_mfma_f32_16x16x32_bf16 v[40:43], v[16:19], v[24:27], v[40:43]
    ds_read_b128 v[12:15], v5 offset:16384
    s_waitcnt lgkmcnt(4)
    v_mfma_f32_16x16x32_bf16 v[72:75], v[8:11], v[24:27], v[72:75]
    s_waitcnt lgkmcnt(3)
    v_mfma_f32_16x16x32_bf16 v[44:47], v[16:19], v[32:35], v[44:47]
    ds_read_b128 v[24:27], v5 offset:16896
    v_mfma_f32_16x16x32_bf16 v[76:79], v[8:11], v[32:35], v[76:79]
    s_waitcnt lgkmcnt(3)
    v_mfma_f32_16x16x32_bf16 v[48:51], v[16:19], v[28:31], v[48:51]
    ds_read_b128 v[32:35], v5 offset:17408
    v_mfma_f32_16x16x32_bf16 v[80:83], v[8:11], v[28:31], v[80:83]
    ds_read_b128 v[20:23], v3 offset:32768
    s_waitcnt lgkmcnt(4)
    v_mfma_f32_16x16x32_bf16 v[52:55], v[16:19], v[36:39], v[52:55]
    ds_read_b128 v[28:31], v5 offset:17920
    v_mfma_f32_16x16x32_bf16 v[84:87], v[8:11], v[36:39], v[84:87]
    s_waitcnt lgkmcnt(4)
    v_mfma_f32_16x16x32_bf16 v[56:59], v[16:19], v[12:15], v[56:59]
    ds_read_b128 v[36:39], v4 offset:24576
    v_mfma_f32_16x16x32_bf16 v[88:91], v[8:11], v[12:15], v[88:91]
    ds_read_b128 v[12:15], v3 offset:34816
    s_waitcnt lgkmcnt(5)
    v_mfma_f32_16x16x32_bf16 v[60:63], v[16:19], v[24:27], v[60:63]
    v_mfma_f32_16x16x32_bf16 v[92:95], v[8:11], v[24:27], v[92:95]
    ds_read_b128 v[24:27], v4 offset:25088
    s_waitcnt lgkmcnt(5)
    v_mfma_f32_16x16x32_bf16 v[64:67], v[16:19], v[32:35], v[64:67]
L_mh9:
    s_cbranch_execz L_mh10
    v_mfma_f32_16x16x32_bf16 v[96:99], v[8:11], v[32:35], v[96:99]
    ds_read_b128 v[32:35], v4 offset:25600
    s_waitcnt lgkmcnt(4)
    v_mfma_f32_16x16x32_bf16 v[68:71], v[16:19], v[28:31], v[68:71]
    ds_read_b128 v[16:19], v4 offset:26112
    v_mfma_f32_16x16x32_bf16 v[100:103], v[8:11], v[28:31], v[100:103]
    s_waitcnt lgkmcnt(4)
    v_mfma_f32_16x16x32_bf16 v[40:43], v[20:23], v[36:39], v[40:43]
    ds_read_b128 v[8:11], v5 offset:24576
    s_waitcnt lgkmcnt(4)
    v_mfma_f32_16x16x32_bf16 v[72:75], v[12:15], v[36:39], v[72:75]
    s_waitcnt lgkmcnt(3)
    v_mfma_f32_16x16x32_bf16 v[44:47], v[20:23], v[24:27], v[44:47]
    ds_read_b128 v[36:39], v5 offset:25088
    v_mfma_f32_16x16x32_bf16 v[76:79], v[12:15], v[24:27], v[76:79]
    s_waitcnt lgkmcnt(3)
    v_mfma_f32_16x16x32_bf16 v[48:51], v[20:23], v[32:35], v[48:51]
    ds_read_b128 v[24:27], v5 offset:25600
    v_mfma_f32_16x16x32_bf16 v[80:83], v[12:15], v[32:35], v[80:83]
    s_barrier
    ds_read_b128 v[28:31], v7 offset:0
    s_waitcnt lgkmcnt(4)
    v_mfma_f32_16x16x32_bf16 v[52:55], v[20:23], v[16:19], v[52:55]
    ds_read_b128 v[32:35], v5 offset:26112
    v_mfma_f32_16x16x32_bf16 v[84:87], v[12:15], v[16:19], v[84:87]
    s_waitcnt lgkmcnt(4)
    v_mfma_f32_16x16x32_bf16 v[56:59], v[20:23], v[8:11], v[56:59]
    ds_read_b128 v[16:19], v4 offset:32768
    v_mfma_f32_16x16x32_bf16 v[88:91], v[12:15], v[8:11], v[88:91]
    ds_read_b128 v[8:11], v7 offset:2048
    s_waitcnt lgkmcnt(5)
    v_mfma_f32_16x16x32_bf16 v[60:63], v[20:23], v[36:39], v[60:63]
    v_mfma_f32_16x16x32_bf16 v[92:95], v[12:15], v[36:39], v[92:95]
    ds_read_b128 v[36:39], v4 offset:33280
    s_waitcnt lgkmcnt(5)
    v_mfma_f32_16x16x32_bf16 v[64:67], v[20:23], v[24:27], v[64:67]
    v_mfma_f32_16x16x32_bf16 v[96:99], v[12:15], v[24:27], v[96:99]
    ds_read_b128 v[24:27], v4 offset:33792
    s_waitcnt lgkmcnt(4)
    v_mfma_f32_16x16x32_bf16 v[68:71], v[20:23], v[32:35], v[68:71]
    ds_read_b128 v[20:23], v4 offset:34304
    v_mfma_f32_16x16x32_bf16 v[100:103], v[12:15], v[32:35], v[100:103]
    s_waitcnt lgkmcnt(4)
    v_mfma_f32_16x16x32_bf16 v[40:43], v[28:31], v[16:19], v[40:43]
    ds_read_b128 v[12:15], v5 offset:32768
    s_waitcnt lgkmcnt(4)
    v_mfma_f32_16x16x32_bf16 v[72:75], v[8:11], v[16:19], v[72:75]
    s_waitcnt lgkmcnt(3)
L_mh10:
    s_cbranch_execz L_mh11
    v_mfma_f32_16x16x32_bf16 v[44:47], v[28:31], v[36:39], v[44:47]
    ds_read_b128 v[16:19], v5 offset:33280
    v_mfma_f32_16x16x32_bf16 v[76:79], v[8:11], v[36:39], v[76:79]
    s_waitcnt lgkmcnt(3)
    v_mfma_f32_16x16x32_bf16 v[48:51], v[28:31], v[24:27], v[48:51]
    ds_read_b128 v[36:39], v5 offset:33792
    v_mfma_f32_16x16x32_bf16 v[80:83], v[8:11], v[24:27], v[80:83]
    ds_read_b128 v[32:35], v0 offset:0
    s_waitcnt lgkmcnt(4)
    v_mfma_f32_16x16x32_bf16 v[52:55], v[28:31], v[20:23], v[52:55]
    ds_read_b128 v[24:27], v5 offset:34304
    v_mfma_f32_16x16x32_bf16 v[84:87], v[8:11], v[20:23], v[84:87]
    s_waitcnt lgkmcnt(4)
    v_mfma_f32_16x16x32_bf16 v[56:59], v[28:31], v[12:15], v[56:59]
    ds_read_b128 v[20:23], v4 offset:40960
    v_mfma_f32_16x16x32_bf16 v[88:91], v[8:11], v[12:15], v[88:91]
    ds_read_b128 v[12:15], v0 offset:2048
    s_waitcnt lgkmcnt(5)
    v_mfma_f32_16x16x32_bf16 v[60:63], v[28:31], v[16:19], v[60:63]
    v_mfma_f32_16x16x32_bf16 v[92:95], v[8:11], v[16:19], v[92:95]
    ds_read_b128 v[16:19], v4 offset:41472
    s_waitcnt lgkmcnt(5)
    v_mfma_f32_16x16x32_bf16 v[64:67], v[28:31], v[36:39], v[64:67]
    v_mfma_f32_16x16x32_bf16 v[96:99], v[8:11], v[36:39], v[96:99]
    ds_read_b128 v[36:39], v4 offset:41984
    s_waitcnt lgkmcnt(4)
    v_mfma_f32_16x16x32_bf16 v[68:71], v[28:31], v[24:27], v[68:71]
    ds_read_b128 v[28:31], v4 offset:42496
    v_mfma_f32_16x16x32_bf16 v[100:103], v[8:11], v[24:27], v[100:103]
    s_waitcnt lgkmcnt(4)
    v_mfma_f32_16x16x32_bf16 v[40:43], v[32:35], v[20:23], v[40:43]
    ds_read_b128 v[8:11], v5 offset:40960
    s_waitcnt lgkmcnt(4)
    v_mfma_f32_16x16x32_bf16 v[72:75], v[12:15], v[20:23], v[72:75]
    s_waitcnt lgkmcnt(3)
    v_mfma_f32_16x16x32_bf16 v[44:47], v[32:35], v[16:19], v[44:47]
    ds_read_b128 v[20:23], v5 offset:41472
    v_mfma_f32_16x16x32_bf16 v[76:79], v[12:15], v[16:19], v[76:79]
    s_waitcnt lgkmcnt(3)
    v_mfma_f32_16x16x32_bf16 v[48:51], v[32:35], v[36:39], v[48:51]
    ds_read_b128 v[16:19], v5 offset:41984
    v_mfma_f32_16x16x32_bf16 v[80:83], v[12:15], v[36:39], v[80:83]
    s_barrier
    ds_read_b128 v[24:27], v1 offset:0
    s_waitcnt lgkmcnt(4)
    v_mfma_f32_16x16x32_bf16 v[52:55], v[32:35], v[28:31], v[52:55]
    ds_read_b128 v[36:39], v5 offset:42496
    v_mfma_f32_16x16x32_bf16 v[84:87], v[12:15], v[28:31], v[84:87]
L_mh11:
    s_cbranch_execz L_mhret
    s_waitcnt lgkmcnt(4)
    v_mfma_f32_16x16x32_bf16 v[56:59], v[32:35], v[8:11], v[56:59]
    ds_read_b128 v[28:31], v4 offset:49152
    v_mfma_f32_16x16x32_bf16 v[88:91], v[12:15], v[8:11], v[88:91]
    ds_read_b128 v[8:11], v1 offset:2048
    s_waitcnt lgkmcnt(5)
    v_mfma_f32_16x16x32_bf16 v[60:63], v[32:35], v[20:23], v[60:63]
    v_mfma_f32_16x16x32_bf16 v[92:95], v[12:15], v[20:23], v[92:95]
    ds_read_b128 v[20:23], v4 offset:49664
    s_waitcnt lgkmcnt(5)
    v_mfma_f32_16x16x32_bf16 v[64:67], v[32:35], v[16:19], v[64:67]
    v_mfma_f32_16x16x32_bf16 v[96:99], v[12:15], v[16:19], v[96:99]
    ds_read_b128 v[16:19], v4 offset:50176
    s_waitcnt lgkmcnt(4)
    v_mfma_f32_16x16x32_bf16 v[68:71], v[32:35], v[36:39], v[68:71]
    ds_read_b128 v[32:35], v4 offset:50688
    v_mfma_f32_16x16x32_bf16 v[100:103], v[12:15], v[36:39], v[100:103]
    s_waitcnt lgkmcnt(4)
    v_mfma_f32_16x16x32_bf16 v[40:43], v[24:27], v[28:31], v[40:43]
    ds_read_b128 v[12:15], v5 offset:49152
    s_waitcnt lgkmcnt(4)
    v_mfma_f32_16x16x32_bf16 v[72:75], v[8:11], v[28:31], v[72:75]
    s_waitcnt lgkmcnt(3)
    v_mfma_f32_16x16x32_bf16 v[44:47], v[24:27], v[20:23], v[44:47]
    ds_read_b128 v[28:31], v5 offset:49664
    v_mfma_f32_16x16x32_bf16 v[76:79], v[8:11], v[20:23], v[76:79]
    s_waitcnt lgkmcnt(3)
    v_mfma_f32_16x16x32_bf16 v[48:51], v[24:27], v[16:19], v[48:51]
    ds_read_b128 v[20:23], v5 offset:50176
    v_mfma_f32_16x16x32_bf16 v[80:83], v[8:11], v[16:19], v[80:83]
    ds_read_b128 v[36:39], v3 offset:0
    s_waitcnt lgkmcnt(4)
    v_mfma_f32_16x16x32_bf16 v[52:55], v[24:27], v[32:35], v[52:55]
    ds_read_b128 v[16:19], v5 offset:50688
    v_mfma_f32_16x16x32_bf16 v[84:87], v[8:11], v[32:35], v[84:87]
    s_waitcnt lgkmcnt(4)
    v_mfma_f32_16x16x32_bf16 v[56:59], v[24:27], v[12:15], v[56:59]
    ds_read_b128 v[32:35], v4 offset:57344
    v_mfma_f32_16x16x32_bf16 v[88:91], v[8:11], v[12:15], v[88:91]
    ds_read_b128 v[12:15], v3 offset:2048
    s_waitcnt lgkmcnt(5)
    v_mfma_f32_16x16x32_bf16 v[60:63], v[24:27], v[28:31], v[60:63]
    v_mfma_f32_16x16x32_bf16 v[92:95], v[8:11], v[28:31], v[92:95]
    ds_read_b128 v[28:31], v4 offset:57856
    s_waitcnt lgkmcnt(5)
    v_mfma_f32_16x16x32_bf16 v[64:67], v[24:27], v[20:23], v[64:67]
    v_mfma_f32_16x16x32_bf16 v[96:99], v[8:11], v[20:23], v[96:99]
    ds_read_b128 v[20:23], v4 offset:58368
L_mh12:
    s_cbranch_execz L_mh13
    s_waitcnt lgkmcnt(4)
    v_mfma_f32_16x16x32_bf16 v[68:71], v[24:27], v[16:19], v[68:71]
    ds_read_b128 v[24:27], v4 offset:58880
    v_mfma_f32_16x16x32_bf16 v[100:103], v[8:11], v[16:19], v[100:103]
    s_waitcnt lgkmcnt(4)
    v_mfma_f32_16x16x32_bf16 v[40:43], v[36:39], v[32:35], v[40:43]
    ds_read_b128 v[8:11], v5 offset:57344
    s_waitcnt lgkmcnt(4)
    v_mfma_f32_16x16x32_bf16 v[72:75], v[12:15], v[32:35], v[72:75]
    s_waitcnt lgkmcnt(3)
    v_mfma_f32_16x16x32_bf16 v[44:47], v[36:39], v[28:31], v[44:47]
    ds_read_b128 v[32:35], v5 offset:57856
    v_mfma_f32_16x16x32_bf16 v[76:79], v[12:15], v[28:31], v[76:79]
    s_waitcnt lgkmcnt(3)
    v_mfma_f32_16x16x32_bf16 v[48:51], v[36:39], v[20:23], v[48:51]
    ds_read_b128 v[28:31], v5 offset:58368
    v_mfma_f32_16x16x32_bf16 v[80:83], v[12:15], v[20:23], v[80:83]
    ds_read_b128 v[16:19], v1 offset:4096
    s_waitcnt lgkmcnt(4)
    v_mfma_f32_16x16x32_bf16 v[52:55], v[36:39], v[24:27], v[52:55]
    ds_read_b128 v[20:23], v5 offset:58880
    v_mfma_f32_16x16x32_bf16 v[84:87], v[12:15], v[24:27], v[84:87]
    s_waitcnt lgkmcnt(4)
    v_mfma_f32_16x16x32_bf16 v[56:59], v[36:39], v[8:11], v[56:59]
    ds_read_b128 v[24:27], v4 offset:0
    v_mfma_f32_16x16x32_bf16 v[88:91], v[12:15], v[8:11], v[88:91]
    ds_read_b128 v[8:11], v1 offset:6144
    s_waitcnt lgkmcnt(5)
    v_mfma_f32_16x16x32_bf16 v[60:63], v[36:39], v[32:35], v[60:63]
    v_mfma_f32_16x16x32_bf16 v[92:95], v[12:15], v[32:35], v[92:95]
    ds_read_b128 v[32:35], v4 offset:512
    s_waitcnt lgkmcnt(5)
    v_mfma_f32_16x16x32_bf16 v[64:67], v[36:39], v[28:31], v[64:67]
    v_mfma_f32_16x16x32_bf16 v[96:99], v[12:15], v[28:31], v[96:99]
    ds_read_b128 v[28:31], v4 offset:1024
    s_waitcnt lgkmcnt(4)
    v_mfma_f32_16x16x32_bf16 v[68:71], v[36:39], v[20:23], v[68:71]
    ds_read_b128 v[36:39], v4 offset:1536
    v_mfma_f32_16x16x32_bf16 v[100:103], v[12:15], v[20:23], v[100:103]
    s_waitcnt lgkmcnt(4)
    v_mfma_f32_16x16x32_bf16 v[104:107], v[16:19], v[24:27], v[104:107]
    ds_read_b128 v[12:15], v5 offset:0
    s_waitcnt lgkmcnt(4)
    v_mfma_f32_16x16x32_bf16 v[136:139], v[8:11], v[24:27], v[136:139]
    s_waitcnt lgkmcnt(3)
    v_mfma_f32_16x16x32_bf16 v[108:111], v[16:19], v[32:35], v[108:111]
    ds_read_b128 v[24:27], v5 offset:512
    v_mfma_f32_16x16x32_bf16 v[140:143], v[8:11], v[32:35], v[140:143]
L_mh13:
    s_cbranch_execz L_mh14
    s_waitcnt lgkmcnt(3)
    v_mfma_f32_16x16x32_bf16 v[112:115], v[16:19], v[28:31], v[112:115]
    ds_read_b128 v[20:23], v5 offset:1024
    v_cvt_pk_bf16_f32 v32, v40, v44
    v_mfma_f32_16x16x32_bf16 v[144:147], v[8:11], v[28:31], v[144:147]
    v_cvt_pk_bf16_f32 v33, v48, v52
    s_waitcnt lgkmcnt(3)
    v_mfma_f32_16x16x32_bf16 v[116:119], v[16:19], v[36:39], v[116:119]
    ds_read_b128 v[28:31], v5 offset:1536
    v_cvt_pk_bf16_f32 v34, v56, v60
    v_mfma_f32_16x16x32_bf16 v[148:151], v[8:11], v[36:39], v[148:151]
    ds_read_b128 v[36:39], v3 offset:4096
    v_cvt_pk_bf16_f32 v35, v64, v68
    s_waitcnt lgkmcnt(4)
    v_mfma_f32_16x16x32_bf16 v[120:123], v[16:19], v[12:15], v[120:123]
    buffer_store_dwordx4 v[32:35], v6, s[28:31], s36 offen sc1 nt
    v_mfma_f32_16x16x32_bf16 v[152:155], v[8:11], v[12:15], v[152:155]
    ds_read_b128 v[12:15], v4 offset:8192
    s_add_u32 s36, s36, 7168
    s_waitcnt lgkmcnt(4)
    v_mfma_f32_16x16x32_bf16 v[124:127], v[16:19], v[24:27], v[124:127]
    v_cvt_pk_bf16_f32 v32, v41, v45
    v_mfma_f32_16x16x32_bf16 v[156:159], v[8:11], v[24:27], v[156:159]
    ds_read_b128 v[24:27], v3 offset:6144
    v_cvt_pk_bf16_f32 v33, v49, v53
    s_waitcnt lgkmcnt(4)
    v_mfma_f32_16x16x32_bf16 v[128:131], v[16:19], v[20:23], v[128:131]
    v_cvt_pk_bf16_f32 v34, v57, v61
    v_mfma_f32_16x16x32_bf16 v[160:163], v[8:11], v[20:23], v[160:163]
    ds_read_b128 v[20:23], v4 offset:8704
    v_cvt_pk_bf16_f32 v35, v65, v69
    s_waitcnt lgkmcnt(4)
    v_mfma_f32_16x16x32_bf16 v[132:135], v[16:19], v[28:31], v[132:135]
    ds_read_b128 v[16:19], v4 offset:9216
    buffer_store_dwordx4 v[32:35], v6, s[28:31], s36 offen sc1 nt
    v_mfma_f32_16x16x32_bf16 v[164:167], v[8:11], v[28:31], v[164:167]
    ds_read_b128 v[8:11], v4 offset:9728
    s_add_u32 s36, s36, 7168
    s_waitcnt lgkmcnt(4)
    v_mfma_f32_16x16x32_bf16 v[104:107], v[36:39], v[12:15], v[104:107]
    ds_read_b128 v[28:31], v5 offset:8192
    v_cvt_pk_bf16_f32 v32, v42, v46
    s_waitcnt lgkmcnt(4)
    v_mfma_f32_16x16x32_bf16 v[136:139], v[24:27], v[12:15], v[136:139]
    v_cvt_pk_bf16_f32 v33, v50, v54
    s_waitcnt lgkmcnt(3)
    v_mfma_f32_16x16x32_bf16 v[108:111], v[36:39], v[20:23], v[108:111]
    ds_read_b128 v[12:15], v5 offset:8704
L_mh14:
    s_cbranch_execz L_mh15
    v_cvt_pk_bf16_f32 v34, v58, v62
    v_mfma_f32_16x16x32_bf16 v[140:143], v[24:27], v[20:23], v[140:143]
    v_cvt_pk_bf16_f32 v35, v66, v70
    s_waitcnt lgkmcnt(3)
    v_mfma_f32_16x16x32_bf16 v[112:115], v[36:39], v[16:19], v[112:115]
    ds_read_b128 v[20:23], v5 offset:9216
    buffer_store_dwordx4 v[32:35], v6, s[28:31], s36 offen sc1 nt
    v_mfma_f32_16x16x32_bf16 v[144:147], v[24:27], v[16:19], v[144:147]
    s_add_u32 s36, s36, 7168
    s_waitcnt lgkmcnt(3)
    v_mfma_f32_16x16x32_bf16 v[116:119], v[36:39], v[8:11], v[116:119]
    ds_read_b128 v[16:19], v5 offset:9728
    v_cvt_pk_bf16_f32 v32, v43, v47
    v_mfma_f32_16x16x32_bf16 v[148:151], v[24:27], v[8:11], v[148:151]
    ds_read_b128 v[8:11], v1 offset:36864
    v_cvt_pk_bf16_f32 v33, v51, v55
    s_waitcnt lgkmcnt(4)
    v_mfma_f32_16x16x32_bf16 v[120:123], v[36:39], v[28:31], v[120:123]
    v_cvt_pk_bf16_f32 v34, v59, v63
    v_mfma_f32_16x16x32_bf16 v[152:155], v[24:27], v[28:31], v[152:155]
    ds_read_b128 v[28:31], v4 offset:16384
    v_cvt_pk_bf16_f32 v35, v67, v71
    s_waitcnt lgkmcnt(4)
    v_mfma_f32_16x16x32_bf16 v[124:127], v[36:39], v[12:15], v[124:127]
    buffer_store_dwordx4 v[32:35], v6, s[28:31], s36 offen sc1 nt
    v_mfma_f32_16x16x32_bf16 v[156:159], v[24:27], v[12:15], v[156:159]
    ds_read_b128 v[12:15], v1 offset:38912
    s_add_u32 s36, s36, 93184
    s_waitcnt lgkmcnt(4)
    v_mfma_f32_16x16x32_bf16 v[128:131], v[36:39], v[20:23], v[128:131]
    ds_read_b128 v[32:35], v4 offset:16896
    v_cvt_pk_bf16_f32 v40, v72, v76
    v_mfma_f32_16x16x32_bf16 v[160:163], v[24:27], v[20:23], v[160:163]
    ds_read_b128 v[48:51], v4 offset:17408
    v_cvt_pk_bf16_f32 v41, v80, v84
    s_waitcnt lgkmcnt(5)
    v_mfma_f32_16x16x32_bf16 v[132:135], v[36:39], v[16:19], v[132:135]
    ds_read_b128 v[36:39], v4 offset:17920
    v_cvt_pk_bf16_f32 v42, v88, v92
    v_mfma_f32_16x16x32_bf16 v[164:167], v[24:27], v[16:19], v[164:167]
    v_cvt_pk_bf16_f32 v43, v96, v100
    s_waitcnt lgkmcnt(4)
    v_mfma_f32_16x16x32_bf16 v[104:107], v[8:11], v[28:31], v[104:107]
    ds_read_b128 v[24:27], v5 offset:16384
    buffer_store_dwordx4 v[40:43], v6, s[28:31], s36 offen sc1 nt
    s_waitcnt lgkmcnt(4)
    v_mfma_f32_16x16x32_bf16 v[136:139], v[12:15], v[28:31], v[136:139]
    s_add_u32 s36, s36, 7168
L_mh15:
    s_cbranch_execz L_mh16
    s_waitcnt lgkmcnt(3)
    v_mfma_f32_16x16x32_bf16 v[108:111], v[8:11], v[32:35], v[108:111]
    ds_read_b128 v[28:31], v5 offset:16896
    v_cvt_pk_bf16_f32 v44, v73, v77
    v_mfma_f32_16x16x32_bf16 v[140:143], v[12:15], v[32:35], v[140:143]
    v_cvt_pk_bf16_f32 v45, v81, v85
    s_waitcnt lgkmcnt(3)
    v_mfma_f32_16x16x32_bf16 v[112:115], v[8:11], v[48:51], v[112:115]
    ds_read_b128 v[32:35], v5 offset:17408
    v_cvt_pk_bf16_f32 v46, v89, v93
    v_mfma_f32_16x16x32_bf16 v[144:147], v[12:15], v[48:51], v[144:147]
    ds_read_b128 v[16:19], v3 offset:36864
    v_cvt_pk_bf16_f32 v47, v97, v101
    s_waitcnt lgkmcnt(4)
    v_mfma_f32_16x16x32_bf16 v[116:119], v[8:11], v[36:39], v[116:119]
    ds_read_b128 v[48:51], v5 offset:17920
    buffer_store_dwordx4 v[44:47], v6, s[28:31], s36 offen sc1 nt
    v_mfma_f32_16x16x32_bf16 v[148:151], v[12:15], v[36:39], v[148:151]
    ds_read_b128 v[20:23], v3 offset:38912
    s_add_u32 s36, s36, 7168
    s_waitcnt lgkmcnt(5)
    v_mfma_f32_16x16x32_bf16 v[120:123], v[8:11], v[24:27], v[120:123]
    ds_read_b128 v[36:39], v4 offset:24576
    v_cvt_pk_bf16_f32 v40, v74, v78
    v_mfma_f32_16x16x32_bf16 v[152:155], v[12:15], v[24:27], v[152:155]
    v_cvt_pk_bf16_f32 v41, v82, v86
    s_waitcnt lgkmcnt(5)
    v_mfma_f32_16x16x32_bf16 v[124:127], v[8:11], v[28:31], v[124:127]
    ds_read_b128 v[24:27], v4 offset:25088
    v_cvt_pk_bf16_f32 v42, v90, v94
    v_mfma_f32_16x16x32_bf16 v[156:159], v[12:15], v[28:31], v[156:159]
    v_cvt_pk_bf16_f32 v43, v98, v102
    s_waitcnt lgkmcnt(5)
    v_mfma_f32_16x16x32_bf16 v[128:131], v[8:11], v[32:35], v[128:131]
    ds_read_b128 v[28:31], v4 offset:25600
    buffer_store_dwordx4 v[40:43], v6, s[28:31], s36 offen sc1 nt
    v_mfma_f32_16x16x32_bf16 v[160:163], v[12:15], v[32:35], v[160:163]
    s_add_u32 s36, s36, 7168
    s_waitcnt lgkmcnt(4)
    v_mfma_f32_16x16x32_bf16 v[132:135], v[8:11], v[48:51], v[132:135]
    ds_read_b128 v[8:11], v4 offset:26112
    v_cvt_pk_bf16_f32 v44, v75, v79
    v_mfma_f32_16x16x32_bf16 v[164:167], v[12:15], v[48:51], v[164:167]
    v_cvt_pk_bf16_f32 v45, v83, v87
    s_waitcnt lgkmcnt(3)
    v_mfma_f32_16x16x32_bf16 v[104:107], v[16:19], v[36:39], v[104:107]
    ds_read_b128 v[12:15], v5 offset:24576
    v_cvt_pk_bf16_f32 v46, v91, v95
L_mh16:
    s_cbranch_execz L_mh17
    v_mfma_f32_16x16x32_bf16 v[136:139], v[20:23], v[36:39], v[136:139]
    v_cvt_pk_bf16_f32 v47, v99, v103
    s_waitcnt lgkmcnt(3)
    v_mfma_f32_16x16x32_bf16 v[108:111], v[16:19], v[24:27], v[108:111]
    ds_read_b128 v[36:39], v5 offset:25088
    buffer_store_dwordx4 v[44:47], v6, s[28:31], s36 offen sc1 nt
    v_mfma_f32_16x16x32_bf16 v[140:143], v[20:23], v[24:27], v[140:143]
    ds_read_b128 v[48:51], v4 offset:49152
    s_add_u32 s36, s36, 93184
    s_waitcnt lgkmcnt(4)
    v_mfma_f32_16x16x32_bf16 v[112:115], v[16:19], v[28:31], v[112:115]
    ds_read_b128 v[80:83], v5 offset:25600
    v_mfma_f32_16x16x32_bf16 v[144:147], v[20:23], v[28:31], v[144:147]
    s_barrier
    ds_read_b128 v[24:27], v7 offset:4096
    s_waitcnt lgkmcnt(5)
    v_mfma_f32_16x16x32_bf16 v[116:119], v[16:19], v[8:11], v[116:119]
    ds_read_b128 v[28:31], v5 offset:26112
    v_mfma_f32_16x16x32_bf16 v[148:151], v[20:23], v[8:11], v[148:151]
    ds_read_b128 v[32:35], v0 offset:4096
    s_waitcnt lgkmcnt(6)
    v_mfma_f32_16x16x32_bf16 v[120:123], v[16:19], v[12:15], v[120:123]
    ds_read_b128 v[8:11], v4 offset:32768
    v_mfma_f32_16x16x32_bf16 v[152:155], v[20:23], v[12:15], v[152:155]
    ds_read_b128 v[12:15], v4 offset:33280
    s_waitcnt lgkmcnt(7)
    v_mfma_f32_16x16x32_bf16 v[124:127], v[16:19], v[36:39], v[124:127]
    ds_read_b128 v[84:87], v4 offset:33792
    v_mfma_f32_16x16x32_bf16 v[156:159], v[20:23], v[36:39], v[156:159]
    ds_read_b128 v[36:39], v4 offset:34304
    s_waitcnt lgkmcnt(7)
    v_mfma_f32_16x16x32_bf16 v[128:131], v[16:19], v[80:83], v[128:131]
    ds_read_b128 v[88:91], v5 offset:32768
    v_mfma_f32_16x16x32_bf16 v[160:163], v[20:23], v[80:83], v[160:163]
    ds_read_b128 v[80:83], v5 offset:33280
    s_waitcnt lgkmcnt(7)
    v_mfma_f32_16x16x32_bf16 v[132:135], v[16:19], v[28:31], v[132:135]
    ds_read_b128 v[16:19], v5 offset:33792
    v_mfma_f32_16x16x32_bf16 v[164:167], v[20:23], v[28:31], v[164:167]
    ds_read_b128 v[28:31], v5 offset:34304
    s_waitcnt lgkmcnt(7)
    v_mfma_f32_16x16x32_bf16 v[104:107], v[24:27], v[8:11], v[104:107]
    ds_read_b128 v[8:11], v4 offset:40960
    s_waitcnt lgkmcnt(7)
    v_mfma_f32_16x16x32_bf16 v[108:111], v[24:27], v[12:15], v[108:111]
    ds_read_b128 v[12:15], v4 offset:41472
    s_waitcnt lgkmcnt(7)
    v_mfma_f32_16x16x32_bf16 v[112:115], v[24:27], v[84:87], v[112:115]
L_mh17:
    s_cbranch_execz L_mhret
    ds_read_b128 v[84:87], v4 offset:41984
    s_waitcnt lgkmcnt(7)
    v_mfma_f32_16x16x32_bf16 v[116:119], v[24:27], v[36:39], v[116:119]
    ds_read_b128 v[36:39], v4 offset:42496
    s_waitcnt lgkmcnt(7)
    v_mfma_f32_16x16x32_bf16 v[120:123], v[24:27], v[88:91], v[120:123]
    ds_read_b128 v[88:91], v5 offset:40960
    s_waitcnt lgkmcnt(7)
    v_mfma_f32_16x16x32_bf16 v[124:127], v[24:27], v[80:83], v[124:127]
    ds_read_b128 v[80:83], v5 offset:41472
    s_waitcnt lgkmcnt(7)
    v_mfma_f32_16x16x32_bf16 v[128:131], v[24:27], v[16:19], v[128:131]
    ds_read_b128 v[16:19], v5 offset:41984
    s_waitcnt lgkmcnt(7)
    v_mfma_f32_16x16x32_bf16 v[132:135], v[24:27], v[28:31], v[132:135]
    ds_read_b128 v[24:27], v5 offset:42496
    s_waitcnt lgkmcnt(7)
    v_mfma_f32_16x16x32_bf16 v[104:107], v[32:35], v[8:11], v[104:107]
    ds_read_b128 v[20:23], v1 offset:32768
    s_waitcnt lgkmcnt(7)
    v_mfma_f32_16x16x32_bf16 v[108:111], v[32:35], v[12:15], v[108:111]
    ds_read_b128 v[12:15], v4 offset:49664
    s_waitcnt lgkmcnt(7)
    v_mfma_f32_16x16x32_bf16 v[112:115], v[32:35], v[84:87], v[112:115]
    ds_read_b128 v[84:87], v4 offset:50176
    s_waitcnt lgkmcnt(7)
    v_mfma_f32_16x16x32_bf16 v[116:119], v[32:35], v[36:39], v[116:119]
    ds_read_b128 v[36:39], v4 offset:50688
    s_waitcnt lgkmcnt(7)
    v_mfma_f32_16x16x32_bf16 v[120:123], v[32:35], v[88:91], v[120:123]
    ds_read_b128 v[88:91], v5 offset:49152
    s_waitcnt lgkmcnt(7)
    v_mfma_f32_16x16x32_bf16 v[124:127], v[32:35], v[80:83], v[124:127]
    ds_read_b128 v[80:83], v5 offset:49664
    s_waitcnt lgkmcnt(7)
    v_mfma_f32_16x16x32_bf16 v[128:131], v[32:35], v[16:19], v[128:131]
    ds_read_b128 v[16:19], v5 offset:50176
    s_waitcnt lgkmcnt(7)
    v_mfma_f32_16x16x32_bf16 v[132:135], v[32:35], v[24:27], v[132:135]
    ds_read_b128 v[24:27], v5 offset:50688
    s_waitcnt lgkmcnt(7)
    v_mfma_f32_16x16x32_bf16 v[104:107], v[20:23], v[48:51], v[104:107]
    ds_read_b128 v[8:11], v3 offset:32768
    s_waitcnt lgkmcnt(7)
    v_mfma_f32_16x16x32_bf16 v[108:111], v[20:23], v[12:15], v[108:111]
    ds_read_b128 v[32:35], v4 offset:57344
    s_waitcnt lgkmcnt(7)
    v_mfma_f32_16x16x32_bf16 v[112:115], v[20:23], v[84:87], v[112:115]
L_mh18:
    s_cbranch_execz L_mh19
    ds_read_b128 v[28:31], v4 offset:57856
    s_waitcnt lgkmcnt(7)
    v_mfma_f32_16x16x32_bf16 v[116:119], v[20:23], v[36:39], v[116:119]
    ds_read_b128 v[92:95], v4 offset:58368
    s_waitcnt lgkmcnt(7)
    v_mfma_f32_16x16x32_bf16 v[120:123], v[20:23], v[88:91], v[120:123]
    ds_read_b128 v[96:99], v4 offset:58880
    s_waitcnt lgkmcnt(7)
    v_mfma_f32_16x16x32_bf16 v[124:127], v[20:23], v[80:83], v[124:127]
    ds_read_b128 v[100:103], v5 offset:57344
    s_waitcnt lgkmcnt(7)
    v_mfma_f32_16x16x32_bf16 v[128:131], v[20:23], v[16:19], v[128:131]
    ds_read_b128 v[52:55], v5 offset:57856
    s_waitcnt lgkmcnt(7)
    v_mfma_f32_16x16x32_bf16 v[132:135], v[20:23], v[24:27], v[132:135]
    ds_read_b128 v[56:59], v5 offset:58368
    s_waitcnt lgkmcnt(6)
    v_mfma_f32_16x16x32_bf16 v[104:107], v[8:11], v[32:35], v[104:107]
    ds_read_b128 v[20:23], v5 offset:58880
    s_waitcnt lgkmcnt(6)
    v_mfma_f32_16x16x32_bf16 v[108:111], v[8:11], v[28:31], v[108:111]
    ds_read_b128 v[60:63], v1 offset:34816
    s_waitcnt lgkmcnt(6)
    v_mfma_f32_16x16x32_bf16 v[112:115], v[8:11], v[92:95], v[112:115]
    s_waitcnt lgkmcnt(5)
    v_mfma_f32_16x16x32_bf16 v[116:119], v[8:11], v[96:99], v[116:119]
    s_waitcnt lgkmcnt(4)
    v_mfma_f32_16x16x32_bf16 v[120:123], v[8:11], v[100:103], v[120:123]
    s_waitcnt lgkmcnt(3)
    v_mfma_f32_16x16x32_bf16 v[124:127], v[8:11], v[52:55], v[124:127]
    s_waitcnt lgkmcnt(2)
    v_mfma_f32_16x16x32_bf16 v[128:131], v[8:11], v[56:59], v[128:131]
    ds_read_b128 v[64:67], v3 offset:34816
    s_waitcnt lgkmcnt(2)
    v_mfma_f32_16x16x32_bf16 v[132:135], v[8:11], v[20:23], v[132:135]
    s_waitcnt lgkmcnt(1)
    v_mfma_f32_16x16x32_bf16 v[136:139], v[60:63], v[48:51], v[136:139]
    v_mfma_f32_16x16x32_bf16 v[140:143], v[60:63], v[12:15], v[140:143]
    v_mfma_f32_16x16x32_bf16 v[144:147], v[60:63], v[84:87], v[144:147]
    v_mfma_f32_16x16x32_bf16 v[148:151], v[60:63], v[36:39], v[148:151]
    v_mfma_f32_16x16x32_bf16 v[152:155], v[60:63], v[88:91], v[152:155]
    v_mfma_f32_16x16x32_bf16 v[156:159], v[60:63], v[80:83], v[156:159]
    v_cvt_pk_bf16_f32 v72, v104, v108
    v_mfma_f32_16x16x32_bf16 v[160:163], v[60:63], v[16:19], v[160:163]
    ds_read_b128 v[16:19], v7 offset:6144
    v_cvt_pk_bf16_f32 v73, v112, v116
    v_mfma_f32_16x16x32_bf16 v[164:167], v[60:63], v[24:27], v[164:167]
    ds_read_b128 v[8:11], v0 offset:6144
L_mh19:
    s_cbranch_execz L_mh20
    v_cvt_pk_bf16_f32 v74, v120, v124
    s_waitcnt lgkmcnt(2)
    v_mfma_f32_16x16x32_bf16 v[136:139], v[64:67], v[32:35], v[136:139]
    ds_read_b128 v[32:35], v4 offset:32768
    v_cvt_pk_bf16_f32 v75, v128, v132
    v_mfma_f32_16x16x32_bf16 v[140:143], v[64:67], v[28:31], v[140:143]
    ds_read_b128 v[28:31], v4 offset:33280
    buffer_store_dwordx4 v[72:75], v6, s[28:31], s36 offen sc1 nt
    v_mfma_f32_16x16x32_bf16 v[144:147], v[64:67], v[92:95], v[144:147]
    ds_read_b128 v[92:95], v4 offset:33792
    s_add_u32 s36, s36, 7168
    v_mfma_f32_16x16x32_bf16 v[148:151], v[64:67], v[96:99], v[148:151]
    ds_read_b128 v[96:99], v4 offset:34304
    v_cvt_pk_bf16_f32 v76, v105, v109
    v_mfma_f32_16x16x32_bf16 v[152:155], v[64:67], v[100:103], v[152:155]
    ds_read_b128 v[100:103], v5 offset:32768
    v_cvt_pk_bf16_f32 v77, v113, v117
    v_mfma_f32_16x16x32_bf16 v[156:159], v[64:67], v[52:55], v[156:159]
    ds_read_b128 v[52:55], v5 offset:33280
    v_cvt_pk_bf16_f32 v78, v121, v125
    v_mfma_f32_16x16x32_bf16 v[160:163], v[64:67], v[56:59], v[160:163]
    ds_read_b128 v[56:59], v5 offset:33792
    v_cvt_pk_bf16_f32 v79, v129, v133
    v_mfma_f32_16x16x32_bf16 v[164:167], v[64:67], v[20:23], v[164:167]
    ds_read_b128 v[20:23], v5 offset:34304
    buffer_store_dwordx4 v[76:79], v6, s[28:31], s36 offen sc1 nt
    s_waitcnt lgkmcnt(7)
    v_mfma_f32_16x16x32_bf16 v[136:139], v[16:19], v[32:35], v[136:139]
    ds_read_b128 v[32:35], v4 offset:40960
    s_add_u32 s36, s36, 7168
    s_waitcnt lgkmcnt(7)
    v_mfma_f32_16x16x32_bf16 v[140:143], v[16:19], v[28:31], v[140:143]
    ds_read_b128 v[28:31], v4 offset:41472
    v_cvt_pk_bf16_f32 v72, v106, v110
    s_waitcnt lgkmcnt(7)
    v_mfma_f32_16x16x32_bf16 v[144:147], v[16:19], v[92:95], v[144:147]
    ds_read_b128 v[92:95], v4 offset:41984
    v_cvt_pk_bf16_f32 v73, v114, v118
    s_waitcnt lgkmcnt(7)
    v_mfma_f32_16x16x32_bf16 v[148:151], v[16:19], v[96:99], v[148:151]
    ds_read_b128 v[96:99], v4 offset:42496
    v_cvt_pk_bf16_f32 v74, v122, v126
    s_waitcnt lgkmcnt(7)
    v_mfma_f32_16x16x32_bf16 v[152:155], v[16:19], v[100:103], v[152:155]
    ds_read_b128 v[100:103], v5 offset:40960
    v_cvt_pk_bf16_f32 v75, v130, v134
    s_waitcnt lgkmcnt(7)
    v_mfma_f32_16x16x32_bf16 v[156:159], v[16:19], v[52:55], v[156:159]
L_mh20:
    s_cbranch_execz L_mh21
    ds_read_b128 v[52:55], v5 offset:41472
    buffer_store_dwordx4 v[72:75], v6, s[28:31], s36 offen sc1 nt
    s_waitcnt lgkmcnt(7)
    v_mfma_f32_16x16x32_bf16 v[160:163], v[16:19], v[56:59], v[160:163]
    ds_read_b128 v[56:59], v5 offset:41984
    s_add_u32 s36, s36, 7168
    s_waitcnt lgkmcnt(7)
    v_mfma_f32_16x16x32_bf16 v[164:167], v[16:19], v[20:23], v[164:167]
    ds_read_b128 v[16:19], v5 offset:42496
    v_cvt_pk_bf16_f32 v76, v107, v111
    s_waitcnt lgkmcnt(7)
    v_mfma_f32_16x16x32_bf16 v[136:139], v[8:11], v[32:35], v[136:139]
    v_cvt_pk_bf16_f32 v77, v115, v119
    s_waitcnt lgkmcnt(6)
    v_mfma_f32_16x16x32_bf16 v[140:143], v[8:11], v[28:31], v[140:143]
    v_cvt_pk_bf16_f32 v78, v123, v127
    s_waitcnt lgkmcnt(5)
    v_mfma_f32_16x16x32_bf16 v[144:147], v[8:11], v[92:95], v[144:147]
    v_cvt_pk_bf16_f32 v79, v131, v135
    s_waitcnt lgkmcnt(4)
    v_mfma_f32_16x16x32_bf16 v[148:151], v[8:11], v[96:99], v[148:151]
    buffer_store_dwordx4 v[76:79], v6, s[28:31], s36 offen sc1 nt
    s_waitcnt lgkmcnt(3)
    v_mfma_f32_16x16x32_bf16 v[152:155], v[8:11], v[100:103], v[152:155]
    s_add_u32 s36, s36, 93184
    s_waitcnt lgkmcnt(2)
    v_mfma_f32_16x16x32_bf16 v[156:159], v[8:11], v[52:55], v[156:159]
    s_waitcnt lgkmcnt(1)
    v_mfma_f32_16x16x32_bf16 v[160:163], v[8:11], v[56:59], v[160:163]
    s_waitcnt lgkmcnt(0)
    v_mfma_f32_16x16x32_bf16 v[164:167], v[8:11], v[16:19], v[164:167]
    s_nop 7
    v_cvt_pk_bf16_f32 v32, v136, v140
    v_cvt_pk_bf16_f32 v33, v144, v148
    v_cvt_pk_bf16_f32 v34, v152, v156
    v_cvt_pk_bf16_f32 v35, v160, v164
    buffer_store_dwordx4 v[32:35], v6, s[28:31], s36 offen sc1 nt
    s_add_u32 s36, s36, 7168
    v_cvt_pk_bf16_f32 v36, v137, v141
    v_cvt_pk_bf16_f32 v37, v145, v149
    v_cvt_pk_bf16_f32 v38, v153, v157
    v_cvt_pk_bf16_f32 v39, v161, v165
    buffer_store_dwordx4 v[36:39], v6, s[28:31], s36 offen sc1 nt
    s_add_u32 s36, s36, 7168
    v_cvt_pk_bf16_f32 v32, v138, v142
    v_cvt_pk_bf16_f32 v33, v146, v150
    v_cvt_pk_bf16_f32 v34, v154, v158
    v_cvt_pk_bf16_f32 v35, v162, v166
L_mh21:
    s_cbranch_execz L_mhret
    buffer_store_dwordx4 v[32:35], v6, s[28:31], s36 offen sc1 nt
    s_add_u32 s36, s36, 7168
    v_cvt_pk_bf16_f32 v36, v139, v143
    v_cvt_pk_bf16_f32 v37, v147, v151
    v_cvt_pk_bf16_f32 v38, v155, v159
    v_cvt_pk_bf16_f32 v39, v163, v167
    buffer_store_dwordx4 v[36:39], v6, s[28:31], s36 offen sc1 nt
    s_add_u32 s36, s36, 93184
L_done:
    s_endpgm
    .p2align 6
L_hloop:
    s_cbranch_execz L_hopret
    s_setprio 1
    s_lshl_b32 s50, s49, 2
    s_lshr_b64 s[50:51], s[82:83], s50
    s_and_b32 s50, s50, 15
    s_lshl_b32 s53, s55, 15
    s_add_u32 s53, s53, s44
    s_and_b32 s41, s49, 3
    s_lshl_b32 s41, s41, 14
    s_sub_u32 s35, s55, 1
    s_cselect_b32 s55, 2, s35
    s_add_u32 s92, s49, 2
    s_lshl_b32 s86, s92, 2
    s_lshr_b64 s[86:87], s[82:83], s86
    s_and_b32 s86, s86, 15
    s_xor_b32 s88, s41, 32768
    s_cmp_eq_u32 s91, 1
    s_cbranch_scc1 L_hx1
    s_bitcmp1_b32 s38, s50
    s_cbranch_scc1 L_hx
    s_cmp_lt_u32 s49, s93
    s_cbranch_scc1 L_hn
    buffer_load_dword v14, v12, s[68:71], 0 offen sc0 sc1
    s_mov_b32 m0, s53
    s_lshl_b32 s42, s50, 7
    buffer_load_dwordx4 v9, s[16:19], s42 offen offset:0  lds
    s_add_u32 s42, s42, s98
    buffer_load_dwordx4 v10, s[16:19], s42 offen offset:1024  lds
    s_add_u32 s42, s42, s98
    buffer_load_dwordx4 v9, s[16:19], s42 offen offset:2048  lds
    s_add_u32 s42, s42, s98
    buffer_load_dwordx4 v10, s[16:19], s42 offen offset:3072  lds
    s_waitcnt vmcnt(4)
    v_cmp_ne_u32 vcc, v14, v13
    s_nop 4
    s_and_b32 s35, vcc_lo, 0xffff
    s_or_b32 s38, s38, s35
    s_bitcmp1_b32 s38, s50
    s_cbranch_scc1 L_hw
    s_branch L_hn1
L_hn:
    s_mov_b32 m0, s53
    s_lshl_b32 s42, s50, 7
    buffer_load_dwordx4 v9, s[16:19], s42 offen offset:0  lds
    s_add_u32 s42, s42, s98
    buffer_load_dwordx4 v10, s[16:19], s42 offen offset:1024  lds
    s_add_u32 s42, s42, s98
    buffer_load_dwordx4 v9, s[16:19], s42 offen offset:2048  lds
    s_add_u32 s42, s42, s98
    buffer_load_dwordx4 v10, s[16:19], s42 offen offset:3072  lds
L_hn1:
    s_cmp_ge_u32 s49, 14
    s_cbranch_scc1 L_hn2
    s_add_u32 m0, s53, 4096
    s_add_u32 s42, s42, s99
    buffer_load_dwordx4 v9, s[16:19], s42 offen offset:0  lds
    s_add_u32 s42, s42, s98
    buffer_load_dwordx4 v10, s[16:19], s42 offen offset:1024  lds
    s_add_u32 s42, s42, s98
    buffer_load_dwordx4 v9, s[16:19], s42 offen offset:2048  lds
    s_add_u32 s42, s42, s98
    buffer_load_dwordx4 v10, s[16:19], s42 offen offset:3072  lds
L_hn2:
    s_mov_b32 s54, 2
    s_mul_i32 s43, s50, 917504
    tbuffer_load_format_d16_xyzw v[72:73], v8, s[20:23], s43 format:[BUF_DATA_FORMAT_32_32_32_32,BUF_NUM_FORMAT_UINT] offen
    s_add_u32 s43, s43, s97
    tbuffer_load_format_d16_xyzw v[74:75], v8, s[20:23], s43 format:[BUF_DATA_FORMAT_32_32_32_32,BUF_NUM_FORMAT_UINT] offen
    s_add_u32 s43, s43, s97
    tbuffer_load_format_d16_xyzw v[76:77], v8, s[20:23], s43 format:[BUF_DATA_FORMAT_32_32_32_32,BUF_NUM_FORMAT_UINT] offen
    s_add_u32 s43, s43, s97
    tbuffer_load_format_d16_xyzw v[78:79], v8, s[20:23], s43 format:[BUF_DATA_FORMAT_32_32_32_32,BUF_NUM_FORMAT_UINT] offen
    s_add_u32 s43, s43, s97
    tbuffer_load_format_d16_xyzw v[80:81], v8, s[20:23], s43 format:[BUF_DATA_FORMAT_32_32_32_32,BUF_NUM_FORMAT_UINT] offen
    s_add_u32 s43, s43, s97
    tbuffer_load_format_d16_xyzw v[82:83], v8, s[20:23], s43 format:[BUF_DATA_FORMAT_32_32_32_32,BUF_NUM_FORMAT_UINT] offen
    s_add_u32 s43, s43, s97
    tbuffer_load_format_d16_xyzw v[84:85], v8, s[20:23], s43 format:[BUF_DATA_FORMAT_32_32_32_32,BUF_NUM_FORMAT_UINT] offen
    s_add_u32 s43, s43, s97
    tbuffer_load_format_d16_xyzw v[86:87], v8, s[20:23], s43 format:[BUF_DATA_FORMAT_32_32_32_32,BUF_NUM_FORMAT_UINT] offen
    s_branch L_hp
L_hx:
    s_cbranch_execz L_hopret
    s_lshl_b32 s43, s50, 14
    s_add_u32 m0, s45, s41
    s_nop 0
    buffer_load_dwordx4 v15, s[68:71], s43 offen offset:0 sc1 lds
    buffer_load_dwordx4 v15, s[68:71], s43 offen offset:1024 sc1 lds
    buffer_load_dwordx4 v15, s[68:71], s43 offen offset:2048 sc1 lds
    buffer_load_dwordx4 v15, s[68:71], s43 offen offset:3072 sc1 lds
L_hx1:
    s_mov_b32 m0, s53
    s_lshl_b32 s42, s50, 7
    buffer_load_dwordx4 v9, s[16:19], s42 offen offset:0  lds
    s_add_u32 s42, s42, s98
    buffer_load_dwordx4 v10, s[16:19], s42 offen offset:1024  lds
    s_add_u32 s42, s42, s98
    buffer_load_dwordx4 v9, s[16:19], s42 offen offset:2048  lds
    s_add_u32 s42, s42, s98
    buffer_load_dwordx4 v10, s[16:19], s42 offen offset:3072  lds
    s_branch L_hw1
L_hw:
    s_lshl_b32 s43, s50, 14
    s_add_u32 m0, s45, s41
    s_nop 0
    buffer_load_dwordx4 v15, s[68:71], s43 offen offset:0 sc1 lds
    buffer_load_dwordx4 v15, s[68:71], s43 offen offset:1024 sc1 lds
    buffer_load_dwordx4 v15, s[68:71], s43 offen offset:2048 sc1 lds
    buffer_load_dwordx4 v15, s[68:71], s43 offen offset:3072 sc1 lds
L_hw1:
    s_mov_b32 s54, 0
L_hy:
    s_cmp_ge_u32 s49, 14
    s_cbranch_scc1 L_hb
    s_add_u32 m0, s53, 4096
    s_add_u32 s42, s42, s99
    buffer_load_dwordx4 v9, s[16:19], s42 offen offset:0  lds
    s_add_u32 s42, s42, s98
    buffer_load_dwordx4 v10, s[16:19], s42 offen offset:1024  lds
    s_add_u32 s42, s42, s98
    buffer_load_dwordx4 v9, s[16:19], s42 offen offset:2048  lds
    s_add_u32 s42, s42, s98
    buffer_load_dwordx4 v10, s[16:19], s42 offen offset:3072  lds
L_hp:
    s_cmp_lt_u32 s92, s93
    s_cbranch_scc1 L_hb
    s_cmp_ge_u32 s92, 16
    s_cbranch_scc1 L_hb
    s_bitcmp1_b32 s38, s86
    s_cbranch_scc1 L_hb
    buffer_load_dword v14, v12, s[68:71], 0 offen sc0 sc1
    s_or_b32 s54, s54, 4
L_hb:
    s_barrier
    s_mov_b32 s91, 0
    s_cmp_lt_u32 s49, 14
    s_cbranch_scc1 L_hb2
    s_cmp_lg_u32 s54, 0
    s_cbranch_scc1 L_hb2
    s_cmp_eq_u32 s49, 15
    s_cselect_b32 s35, 28672, 0
    s_add_u32 s53, s53, s35
    s_add_u32 m0, s53, 4096
    s_add_u32 s42, s42, s99
    buffer_load_dwordx4 v9, s[16:19], s42 offen offset:0  lds
    s_add_u32 s42, s42, s98
    buffer_load_dwordx4 v10, s[16:19], s42 offen offset:1024  lds
    s_add_u32 s42, s42, s98
    buffer_load_dwordx4 v9, s[16:19], s42 offen offset:2048  lds
    s_add_u32 s42, s42, s98
    buffer_load_dwordx4 v10, s[16:19], s42 offen offset:3072  lds
    s_waitcnt vmcnt(4)
    s_barrier
    s_cmp_eq_u32 s49, 15
    s_cbranch_scc1 L_hb3
    s_barrier
L_hb3:
    s_waitcnt vmcnt(0)
    s_barrier
    s_branch L_hend
L_hb2:
    s_and_b32 s35, s54, 3
    s_cbranch_scc0 L_hf
L_hq:
    v_add_u32 v17, s41, v11
    s_setprio 2
    s_waitcnt vmcnt(4)
L_hq0:
    s_cbranch_execz L_hopret
    v_lshl_or_b32 v88, v74, 8, v72
    v_lshl_or_b32 v89, v78, 8, v76
    v_perm_b32 v96, v89, v88, s84
    v_perm_b32 v102, v89, v88, s85
    v_xor_b32 v97, s58, v96
    v_xor_b32 v103, s58, v102
    v_perm_b32 v98, v41, v40, v96
    v_perm_b32 v104, v49, v48, v102
    v_perm_b32 v100, v45, v44, v96
    v_perm_b32 v106, v53, v52, v102
    v_perm_b32 v99, v43, v42, v97
    v_perm_b32 v105, v51, v50, v103
    v_perm_b32 v101, v47, v46, v97
    v_perm_b32 v107, v55, v54, v103
    v_xor_b32 v98, v98, v99
    v_xor_b32 v104, v104, v105
    v_xor_b32 v100, v100, v101
    v_xor_b32 v106, v106, v107
    v_perm_b32 v24, v100, v98, s46
    v_perm_b32 v28, v106, v104, s46
    v_perm_b32 v25, v100, v98, s47
    v_perm_b32 v29, v106, v104, s47
    v_lshl_or_b32 v88, v75, 8, v73
    v_lshl_or_b32 v89, v79, 8, v77
    v_perm_b32 v96, v89, v88, s84
    v_perm_b32 v102, v89, v88, s85
    v_xor_b32 v97, s58, v96
    v_xor_b32 v103, s58, v102
    v_perm_b32 v98, v57, v56, v96
    v_perm_b32 v104, v65, v64, v102
    v_perm_b32 v100, v61, v60, v96
    v_perm_b32 v106, v69, v68, v102
    v_perm_b32 v99, v59, v58, v97
    v_perm_b32 v105, v67, v66, v103
    v_perm_b32 v101, v63, v62, v97
    v_perm_b32 v107, v71, v70, v103
    v_xor_b32 v98, v98, v99
    v_xor_b32 v104, v104, v105
    v_xor_b32 v100, v100, v101
    v_xor_b32 v106, v106, v107
    v_perm_b32 v32, v100, v98, s46
    v_perm_b32 v36, v106, v104, s46
    v_perm_b32 v33, v100, v98, s47
    v_perm_b32 v37, v106, v104, s47
    s_bitcmp1_b32 s54, 3
    s_cbranch_scc1 L_hq2
    s_bitcmp1_b32 s54, 2
    s_cbranch_scc1 L_hq1
    s_waitcnt vmcnt(0)
L_hq1:
    s_waitcnt vmcnt(1)
L_hq2:
    s_cbranch_execz L_hopret
    v_lshl_or_b32 v90, v82, 8, v80
    v_lshl_or_b32 v91, v86, 8, v84
    v_perm_b32 v96, v91, v90, s84
    v_perm_b32 v102, v91, v90, s85
    v_xor_b32 v97, s58, v96
    v_xor_b32 v103, s58, v102
    v_perm_b32 v98, v41, v40, v96
    v_perm_b32 v104, v49, v48, v102
    v_perm_b32 v100, v45, v44, v96
    v_perm_b32 v106, v53, v52, v102
    v_perm_b32 v99, v43, v42, v97
    v_perm_b32 v105, v51, v50, v103
    v_perm_b32 v101, v47, v46, v97
    v_perm_b32 v107, v55, v54, v103
    v_xor_b32 v98, v98, v99
    v_xor_b32 v104, v104, v105
    v_xor_b32 v100, v100, v101
    v_xor_b32 v106, v106, v107
    v_perm_b32 v26, v100, v98, s46
    v_perm_b32 v30, v106, v104, s46
    v_perm_b32 v27, v100, v98, s47
    v_perm_b32 v31, v106, v104, s47
    v_lshl_or_b32 v90, v83, 8, v81
    v_lshl_or_b32 v91, v87, 8, v85
    v_perm_b32 v96, v91, v90, s84
    v_perm_b32 v102, v91, v90, s85
    v_xor_b32 v97, s58, v96
    v_xor_b32 v103, s58, v102
    v_perm_b32 v98, v57, v56, v96
    v_perm_b32 v104, v65, v64, v102
    v_perm_b32 v100, v61, v60, v96
    v_perm_b32 v106, v69, v68, v102
    v_perm_b32 v99, v59, v58, v97
    v_perm_b32 v105, v67, v66, v103
    v_perm_b32 v101, v63, v62, v97
    v_perm_b32 v107, v71, v70, v103
    v_xor_b32 v98, v98, v99
    v_xor_b32 v104, v104, v105
    v_xor_b32 v100, v100, v101
    v_xor_b32 v106, v106, v107
    v_perm_b32 v34, v100, v98, s46
    v_perm_b32 v38, v106, v104, s46
    v_perm_b32 v35, v100, v98, s47
    v_perm_b32 v39, v106, v104, s47
    ds_write_b128 v17, v[24:27] offset:0
    ds_write_b128 v17, v[28:31] offset:512
    ds_write_b128 v17, v[32:35] offset:1024
    ds_write_b128 v17, v[36:39] offset:1536
L_hg:
    s_cbranch_execz L_hopret
    s_bitcmp1_b32 s54, 2
    s_cbranch_scc0 L_hf0
    s_waitcnt vmcnt(0)
    v_cmp_ne_u32 vcc, v14, v13
    s_nop 4
    s_and_b32 s35, vcc_lo, 0xffff
    s_or_b32 s38, s38, s35
    s_branch L_hf0
L_hf:
    s_bitcmp1_b32 s54, 2
    s_cbranch_scc0 L_hf1
    s_waitcnt vmcnt(0)
    v_cmp_ne_u32 vcc, v14, v13
    s_nop 4
    s_and_b32 s35, vcc_lo, 0xffff
    s_or_b32 s38, s38, s35
L_hf1:
    s_sub_u32 s35, s92, 0
    s_cmp_ge_u32 s35, 16
    s_cbranch_scc1 L_hf0
    s_bitcmp1_b32 s38, s86
    s_cbranch_scc0 L_hf0
    s_lshl_b32 s43, s86, 14
    s_add_u32 m0, s45, s88
    s_nop 0
    buffer_load_dwordx4 v15, s[68:71], s43 offen offset:0 sc1 lds
    buffer_load_dwordx4 v15, s[68:71], s43 offen offset:1024 sc1 lds
    buffer_load_dwordx4 v15, s[68:71], s43 offen offset:2048 sc1 lds
    buffer_load_dwordx4 v15, s[68:71], s43 offen offset:3072 sc1 lds
    s_mov_b32 s91, 1
    s_waitcnt vmcnt(4) lgkmcnt(0)
    s_branch L_hz
L_hf0:
    s_waitcnt vmcnt(0) lgkmcnt(0)
L_hz:
    s_barrier
    s_mov_b32 s49, s92
    s_cmp_lt_u32 s49, 16
    s_cbranch_scc1 L_hloop
    s_cmp_eq_u32 s49, 17
    s_cselect_b32 s35, 28672, 0
    s_add_u32 s53, s53, s35
    s_add_u32 m0, s53, 4096
    s_add_u32 s42, s42, s99
    buffer_load_dwordx4 v9, s[16:19], s42 offen offset:0  lds
    s_add_u32 s42, s42, s98
    buffer_load_dwordx4 v10, s[16:19], s42 offen offset:1024  lds
    s_add_u32 s42, s42, s98
    buffer_load_dwordx4 v9, s[16:19], s42 offen offset:2048  lds
    s_add_u32 s42, s42, s98
    buffer_load_dwordx4 v10, s[16:19], s42 offen offset:3072  lds
    s_cmp_eq_u32 s49, 17
    s_cbranch_scc1 L_hb4
    s_barrier
L_hb4:
    s_waitcnt vmcnt(0)
    s_barrier
L_hend:
    s_endpgm
L_prod:
    s_cbranch_execz L_hopret
    s_cmp_lt_u32 s32, 8
    s_cbranch_scc1 L_prod1
    s_lshl_b32 s50, s49, 2
    s_lshr_b64 s[50:51], s[82:83], s50
    s_and_b32 s50, s50, 15
    s_mul_i32 s43, s50, 917504
    tbuffer_load_format_d16_xyzw v[72:73], v8, s[20:23], s43 format:[BUF_DATA_FORMAT_32_32_32_32,BUF_NUM_FORMAT_UINT] offen
    s_add_u32 s43, s43, s97
    tbuffer_load_format_d16_xyzw v[74:75], v8, s[20:23], s43 format:[BUF_DATA_FORMAT_32_32_32_32,BUF_NUM_FORMAT_UINT] offen
    s_add_u32 s43, s43, s97
    tbuffer_load_format_d16_xyzw v[76:77], v8, s[20:23], s43 format:[BUF_DATA_FORMAT_32_32_32_32,BUF_NUM_FORMAT_UINT] offen
    s_add_u32 s43, s43, s97
    tbuffer_load_format_d16_xyzw v[78:79], v8, s[20:23], s43 format:[BUF_DATA_FORMAT_32_32_32_32,BUF_NUM_FORMAT_UINT] offen
    s_add_u32 s43, s43, s97
    tbuffer_load_format_d16_xyzw v[80:81], v8, s[20:23], s43 format:[BUF_DATA_FORMAT_32_32_32_32,BUF_NUM_FORMAT_UINT] offen
    s_add_u32 s43, s43, s97
    tbuffer_load_format_d16_xyzw v[82:83], v8, s[20:23], s43 format:[BUF_DATA_FORMAT_32_32_32_32,BUF_NUM_FORMAT_UINT] offen
    s_add_u32 s43, s43, s97
    tbuffer_load_format_d16_xyzw v[84:85], v8, s[20:23], s43 format:[BUF_DATA_FORMAT_32_32_32_32,BUF_NUM_FORMAT_UINT] offen
    s_add_u32 s43, s43, s97
    tbuffer_load_format_d16_xyzw v[86:87], v8, s[20:23], s43 format:[BUF_DATA_FORMAT_32_32_32_32,BUF_NUM_FORMAT_UINT] offen
L_prod1:
    s_waitcnt vmcnt(4) lgkmcnt(0)
L_ploop:
    s_cbranch_execz L_hopret
    v_lshl_or_b32 v88, v74, 8, v72
    v_lshl_or_b32 v89, v78, 8, v76
    v_perm_b32 v96, v89, v88, s84
    v_perm_b32 v102, v89, v88, s85
    v_xor_b32 v97, s58, v96
    v_xor_b32 v103, s58, v102
    v_perm_b32 v98, v41, v40, v96
    v_perm_b32 v104, v49, v48, v102
    v_perm_b32 v100, v45, v44, v96
    v_perm_b32 v106, v53, v52, v102
    v_perm_b32 v99, v43, v42, v97
    v_perm_b32 v105, v51, v50, v103
    v_perm_b32 v101, v47, v46, v97
    v_perm_b32 v107, v55, v54, v103
    v_xor_b32 v98, v98, v99
    v_xor_b32 v104, v104, v105
    v_xor_b32 v100, v100, v101
    v_xor_b32 v106, v106, v107
    v_perm_b32 v24, v100, v98, s46
    v_perm_b32 v28, v106, v104, s46
    v_perm_b32 v25, v100, v98, s47
    v_perm_b32 v29, v106, v104, s47
    v_lshl_or_b32 v88, v75, 8, v73
    v_lshl_or_b32 v89, v79, 8, v77
    v_perm_b32 v96, v89, v88, s84
    v_perm_b32 v102, v89, v88, s85
    v_xor_b32 v97, s58, v96
    v_xor_b32 v103, s58, v102
    v_perm_b32 v98, v57, v56, v96
    v_perm_b32 v104, v65, v64, v102
    v_perm_b32 v100, v61, v60, v96
    v_perm_b32 v106, v69, v68, v102
    v_perm_b32 v99, v59, v58, v97
    v_perm_b32 v105, v67, v66, v103
    v_perm_b32 v101, v63, v62, v97
    v_perm_b32 v107, v71, v70, v103
    v_xor_b32 v98, v98, v99
    v_xor_b32 v104, v104, v105
    v_xor_b32 v100, v100, v101
    v_xor_b32 v106, v106, v107
    v_perm_b32 v32, v100, v98, s46
    v_perm_b32 v36, v106, v104, s46
    v_perm_b32 v33, v100, v98, s47
    v_perm_b32 v37, v106, v104, s47
    s_waitcnt vmcnt(0)
L_pmid:
    s_cbranch_execz L_hopret
    v_lshl_or_b32 v90, v82, 8, v80
    v_lshl_or_b32 v91, v86, 8, v84
    v_perm_b32 v96, v91, v90, s84
    v_perm_b32 v102, v91, v90, s85
    v_xor_b32 v97, s58, v96
    v_xor_b32 v103, s58, v102
    v_perm_b32 v98, v41, v40, v96
    v_perm_b32 v104, v49, v48, v102
    v_perm_b32 v100, v45, v44, v96
    v_perm_b32 v106, v53, v52, v102
    v_perm_b32 v99, v43, v42, v97
    v_perm_b32 v105, v51, v50, v103
    v_perm_b32 v101, v47, v46, v97
    v_perm_b32 v107, v55, v54, v103
    v_xor_b32 v98, v98, v99
    v_xor_b32 v104, v104, v105
    v_xor_b32 v100, v100, v101
    v_xor_b32 v106, v106, v107
    v_perm_b32 v26, v100, v98, s46
    v_perm_b32 v30, v106, v104, s46
    v_perm_b32 v27, v100, v98, s47
    v_perm_b32 v31, v106, v104, s47
    v_lshl_or_b32 v90, v83, 8, v81
    v_lshl_or_b32 v91, v87, 8, v85
    v_perm_b32 v96, v91, v90, s84
    v_perm_b32 v102, v91, v90, s85
    v_xor_b32 v97, s58, v96
    v_xor_b32 v103, s58, v102
    v_perm_b32 v98, v57, v56, v96
    v_perm_b32 v104, v65, v64, v102
    v_perm_b32 v100, v61, v60, v96
    v_perm_b32 v106, v69, v68, v102
    v_perm_b32 v99, v59, v58, v97
    v_perm_b32 v105, v67, v66, v103
    v_perm_b32 v101, v63, v62, v97
    v_perm_b32 v107, v71, v70, v103
    v_xor_b32 v98, v98, v99
    v_xor_b32 v104, v104, v105
    v_xor_b32 v100, v100, v101
    v_xor_b32 v106, v106, v107
    v_perm_b32 v34, v100, v98, s46
    v_perm_b32 v38, v106, v104, s46
    v_perm_b32 v35, v100, v98, s47
    v_perm_b32 v39, v106, v104, s47
L_ppub:
    s_cbranch_execz L_hopret
    s_lshl_b32 s52, s50, 14
    s_lshl_b64 s[36:37], 1, s50
    buffer_store_dwordx4 v[24:27], v20, s[68:71], s52 offen offset:0 sc1
    buffer_store_dwordx4 v[28:31], v20, s[68:71], s52 offen offset:512 sc1
    buffer_store_dwordx4 v[32:35], v20, s[68:71], s52 offen offset:1024 sc1
    buffer_store_dwordx4 v[36:39], v20, s[68:71], s52 offen offset:1536 sc1
    v_not_b32 v16, v13
    s_add_u32 s49, s49, 2
    s_cmp_ge_u32 s49, 16
    s_cbranch_scc1 L_plast
    s_lshl_b32 s50, s49, 2
    s_lshr_b64 s[50:51], s[82:83], s50
    s_and_b32 s50, s50, 15
    s_mul_i32 s43, s50, 917504
    tbuffer_load_format_d16_xyzw v[72:73], v8, s[20:23], s43 format:[BUF_DATA_FORMAT_32_32_32_32,BUF_NUM_FORMAT_UINT] offen
    s_add_u32 s43, s43, s97
    tbuffer_load_format_d16_xyzw v[74:75], v8, s[20:23], s43 format:[BUF_DATA_FORMAT_32_32_32_32,BUF_NUM_FORMAT_UINT] offen
    s_add_u32 s43, s43, s97
    tbuffer_load_format_d16_xyzw v[76:77], v8, s[20:23], s43 format:[BUF_DATA_FORMAT_32_32_32_32,BUF_NUM_FORMAT_UINT] offen
    s_add_u32 s43, s43, s97
    tbuffer_load_format_d16_xyzw v[78:79], v8, s[20:23], s43 format:[BUF_DATA_FORMAT_32_32_32_32,BUF_NUM_FORMAT_UINT] offen
    s_add_u32 s43, s43, s97
    tbuffer_load_format_d16_xyzw v[80:81], v8, s[20:23], s43 format:[BUF_DATA_FORMAT_32_32_32_32,BUF_NUM_FORMAT_UINT] offen
    s_add_u32 s43, s43, s97
    tbuffer_load_format_d16_xyzw v[82:83], v8, s[20:23], s43 format:[BUF_DATA_FORMAT_32_32_32_32,BUF_NUM_FORMAT_UINT] offen
    s_add_u32 s43, s43, s97
    tbuffer_load_format_d16_xyzw v[84:85], v8, s[20:23], s43 format:[BUF_DATA_FORMAT_32_32_32_32,BUF_NUM_FORMAT_UINT] offen
    s_add_u32 s43, s43, s97
    tbuffer_load_format_d16_xyzw v[86:87], v8, s[20:23], s43 format:[BUF_DATA_FORMAT_32_32_32_32,BUF_NUM_FORMAT_UINT] offen
    s_waitcnt vmcnt(8)
    s_mov_b64 exec, s[36:37]
    buffer_store_dword v16, v12, s[68:71], 0 offen  sc0 sc1
    s_mov_b64 exec, -1
    s_waitcnt vmcnt(5)
    s_branch L_ploop
L_plast:
    s_waitcnt vmcnt(0)
    s_mov_b64 exec, s[36:37]
    buffer_store_dword v16, v12, s[68:71], 0 offen  sc0 sc1
    s_mov_b64 exec, -1
    s_endpgm
    .p2align 7
    .type L_sched,@object
L_sched:
    .size L_sched, 256
    .long 0x76243510, 0xfedcba98
    .long 0x65237401, 0xfedcba98
    .long 0x63725410, 0xfedcba98
    .long 0x37265140, 0xfedcba98
    .long 0x31570264, 0xcfed8ba9
    .long 0x70235164, 0xcfed8ba9
    .long 0x17523064, 0xcfed8ba9
    .long 0x35741026, 0xcfed8ba9
    .long 0x7561423, 0xdcfe98ba
    .long 0x76015324, 0xdcfe98ba
    .long 0x60541732, 0xdcfe98ba
    .long 0x70652314, 0xdcfe98ba
    .long 0x67412350, 0xedcfa98b
    .long 0x76421530, 0xedcfa98b
    .long 0x23671450, 0xedcfa98b
    .long 0x47236105, 0xedcfa98b
    .long 0x76243510, 0xfedcba98
    .long 0x65237401, 0xfedcba98
    .long 0x63725410, 0xfedcba98
    .long 0x37265140, 0xfedcba98
    .long 0x31570264, 0xcfed8ba9
    .long 0x70235164, 0xcfed8ba9
    .long 0x17523064, 0xcfed8ba9
    .long 0x35741026, 0xcfed8ba9
    .long 0x7561423, 0xdcfe98ba
    .long 0x76015324, 0xdcfe98ba
    .long 0x60541732, 0xdcfe98ba
    .long 0x70652314, 0xdcfe98ba
    .long 0x67412350, 0xedcfa98b
    .long 0x76421530, 0xedcfa98b
    .long 0x23671450, 0xedcfa98b
    .long 0x47236105, 0xedcfa98b
    .fill 64, 4, 0xbf800000
.section .rodata,"a"
.p2align 6
.amdhsa_kernel standalone__weight_only_int_squeezellm__prompt_kernel
  .amdhsa_next_free_vgpr 168
  .amdhsa_next_free_sgpr 102
  .amdhsa_accum_offset 168
  .amdhsa_group_segment_fixed_size 0
  .amdhsa_kernarg_size 48
  .amdhsa_user_sgpr_count 2
  .amdhsa_user_sgpr_kernarg_segment_ptr 1
  .amdhsa_system_sgpr_workgroup_id_x 1
.end_amdhsa_kernel
```
